```python
import torch

def _softmax(x, axis=-1):
    return torch.softmax(x, dim=axis)

def _gelu(x):
    return torch.nn.functional.gelu(x, approximate='tanh')

def _silu(x):
    return torch.nn.functional.silu(x)

def _sigmoid(x):
    return torch.sigmoid(x)

def _layernorm(x, axis=-1, eps=1e-05):
    m = x.mean(dim=axis, keepdim=True)
    v = x.var(dim=axis, keepdim=True, unbiased=False)
    return (x - m) / torch.sqrt(v + eps)

def _scatter_add(tgt, idx, src, axis=0):
    return tgt.clone().index_add_(axis, idx, src)

def _segment_sum(src, seg, n):
    out = torch.zeros((n,) + src.shape[1:], dtype=src.dtype)
    return out.index_add_(0, seg, src)

def _pad(x, pw):
    flat = tuple((v for pair in reversed(pw) for v in pair))
    return torch.nn.functional.pad(x, flat)
kernel_name = 'sequential_preLN__memory_aug_recurrent_mem_tr__glu_gated_reglu__prompt'

def setup_inputs():

    _w = lambda a: (lambda t: t.to(torch.bfloat16) if t.is_floating_point() else t)(torch.as_tensor(a))

    def _A_setup():
        B, S, Dm = (1, 2048, 576)
        H, Dh = (32, 128)
        M, seg = (8, 32)
        seg = min(seg, S)
        S = S // seg * seg
        return {'x': _w((lambda *s: torch.randn(*s, dtype=torch.bfloat16) * 0.05)(B, S, Dm)), 'mem0': _w((lambda *s: torch.randn(*s, dtype=torch.bfloat16) * 0.2)(B, M, Dm)), 'Wq': _w((lambda *s: torch.randn(*s, dtype=torch.bfloat16) * 1.6)(Dm, H, Dh) * Dm ** (-0.5)), 'Wk': _w((lambda *s: torch.randn(*s, dtype=torch.bfloat16) * 1.6)(Dm, H, Dh) * Dm ** (-0.5)), 'Wv': _w((lambda *s: torch.randn(*s, dtype=torch.bfloat16) * 0.2)(Dm, H, Dh) * Dm ** (-0.5)), 'Wo': _w((lambda *s: torch.randn(*s, dtype=torch.bfloat16) * 0.2)(H, Dh, Dm) * (H * Dh) ** (-0.5)), 'seg_len': seg}
    _A_in = _A_setup()

    def _B_setup():
        B, S, D, F = (1, 2048, 576, 4608)
        return {'x': _w((lambda *s: torch.randn(*s, dtype=torch.bfloat16) * 0.05)(B, S, D)), 'W_gate': _w((lambda *s: torch.randn(*s, dtype=torch.bfloat16) * 0.2)(D, F) * (2.0 / D) ** 0.5), 'W_up': _w((lambda *s: torch.randn(*s, dtype=torch.bfloat16) * 0.2)(D, F) * (2.0 / D) ** 0.5), 'W_down': _w((lambda *s: torch.randn(*s, dtype=torch.bfloat16) * 0.2)(F, D) * (1.0 / F) ** 0.5)}
    _B_in = _B_setup()
    return {'A_x': _A_in['x'], 'A_mem0': _A_in['mem0'], 'A_Wq': _A_in['Wq'], 'A_Wk': _A_in['Wk'], 'A_Wv': _A_in['Wv'], 'A_Wo': _A_in['Wo'], 'A_seg_len': _A_in['seg_len'], 'B_x': _B_in['x'], 'B_W_gate': _B_in['W_gate'], 'B_W_up': _B_in['W_up'], 'B_W_down': _B_in['W_down']}

def reference(A_x, A_mem0, A_Wq, A_Wk, A_Wv, A_Wo, A_seg_len, B_x, B_W_gate, B_W_up, B_W_down):

    def _A_ref(x, mem0, Wq, Wk, Wv, Wo, seg_len):
        B, S, Dm = x.shape
        H, Dh = (Wq.shape[1], Wq.shape[2])
        M = mem0.shape[1]
        scale = Dh ** (-0.5)
        n_seg = S // seg_len
        L = M + seg_len
        idx = torch.arange(L)
        mask = (idx[:, None] < M) | (idx[:, None] >= idx[None, :])
        mem = mem0
        outs = []
        for s in range(n_seg):
            xs = x[:, s * seg_len:(s + 1) * seg_len, :].clone()
            h = torch.concatenate([mem, xs], axis=1)
            q = torch.einsum('btd,dhe->bhte', h, Wq)
            k = torch.einsum('btd,dhe->bhte', h, Wk)
            v = torch.einsum('btd,dhe->bhte', h, Wv)
            scores = torch.einsum('bhqe,bhke->bhqk', q, k) * scale
            scores = torch.where(mask[None, None], scores, -1000000000.0)
            p = _softmax(scores, axis=-1)
            o = torch.einsum('bhqk,bhke->bhqe', p, v)
            o = torch.einsum('bhte,hed->btd', o, Wo)
            mem = o[:, :M, :].clone()
            outs.append(o[:, M:, :])
        return torch.concatenate(outs, axis=1)

    def _B_ref(x, W_gate, W_up, W_down):
        gate = torch.einsum('bsd,df->bsf', x, W_gate)
        up = torch.einsum('bsd,df->bsf', x, W_up)
        gate = gate * (lambda x, dt: x.to(dt))(gate > 0, gate.dtype)
        h = gate * up
        return torch.einsum('bsf,fd->bsd', h, W_down)
    x = A_x
    h = x + _A_ref(_layernorm(x, axis=-1), A_mem0, A_Wq, A_Wk, A_Wv, A_Wo, A_seg_len)
    h2 = h + _B_ref(_layernorm(h, axis=-1), B_W_gate, B_W_up, B_W_down)
    return h2
```

```asm
; @launch grid=(256,1,1) block=(256,1,1) lds=163840
.amdgcn_target "amdgcn-amd-amdhsa--gfx950"
.text
.globl sequential_preLN__memory_aug_recurrent_mem_tr__glu_gated_reglu__prompt_kernel
.p2align 8
.type sequential_preLN__memory_aug_recurrent_mem_tr__glu_gated_reglu__prompt_kernel,@function
sequential_preLN__memory_aug_recurrent_mem_tr__glu_gated_reglu__prompt_kernel:
  s_cmp_ge_u32 s2, 256
  s_cbranch_scc1 L_exit
  s_load_dwordx2 s[4:5], s[0:1], 104
  s_mov_b32 s6, 0x10000000
  s_mov_b32 s7, 0x20000
  s_load_dwordx2 s[20:21], s[0:1], 96
  s_mov_b32 s22, 0x100
  s_mov_b32 s23, 0x20000
  v_lshrrev_b32 v2, 6, v0
  s_nop 0
  v_readfirstlane_b32 s25, v2
  v_and_b32 v1, 63, v0
  v_lshlrev_b32 v0, 4, v1
  s_waitcnt lgkmcnt(0)
  s_getreg_b32 s26, hwreg(HW_REG_XCC_ID)
  s_and_b32 s26, s26, 7
  v_mov_b32 v2, 0
  v_mov_b32 v3, 1
  s_lshl_b32 s26, s26, 2
  s_lshr_b32 s27, 0x65430721, s26
  s_and_b32 s27, s27, 7
  s_lshl_b32 s28, s27, 4
  s_add_u32 s28, s28, 128
  s_cmp_eq_u32 s27, 0
  s_cselect_b32 s28, 0, s28
  s_cselect_b32 s26, 0x10001, 1
  s_cmp_eq_u32 s25, 0
  s_cbranch_scc0 L_reginit
  s_mov_b64 exec, 1
  buffer_atomic_add v3, v2, s[20:23], s28 offen sc0 sc1
  s_mov_b64 exec, -1
L_reginit:
  s_lshl_b32 s29, s2, 12
  s_lshl_b32 s30, s25, 10
  s_add_u32 s29, s29, s30
  s_add_u32 s30, s29, 0x100000
  v_mov_b32 v4, 0
  v_mov_b32 v8, -1
  v_mov_b32 v5, 0
  v_mov_b32 v9, -1
  v_mov_b32 v6, 0
  v_mov_b32 v10, -1
  v_mov_b32 v7, 0
  v_mov_b32 v11, -1
  buffer_store_dwordx4 v[4:7], v0, s[4:7], s29 offen sc1
  buffer_store_dwordx4 v[8:11], v0, s[4:7], s30 offen sc1
  s_add_u32 s30, s29, 0x5000000
  buffer_store_dwordx4 v[8:11], v0, s[4:7], s30 offen sc1
  s_add_u32 s30, s29, 0x5100000
  s_cmp_lt_u32 s29, 0xb0000
  s_cselect_b32 s30, s30, 0x40000000
  buffer_store_dwordx4 v[8:11], v0, s[4:7], s30 offen sc1
  s_add_u32 s30, s29, 0x9000000
  buffer_store_dwordx4 v[8:11], v0, s[4:7], s30 offen sc1
  s_add_u32 s30, s29, 0x9100000
  s_cmp_lt_u32 s29, 0x44000
  s_cselect_b32 s30, s30, 0x40000000
  buffer_store_dwordx4 v[8:11], v0, s[4:7], s30 offen sc1
  s_add_u32 s30, s29, 0x480000
  s_cmp_lt_u32 s29, 0x24000
  s_cselect_b32 s30, s30, 0x40000000
  buffer_store_dwordx4 v[8:11], v0, s[4:7], s30 offen sc1
  s_add_u32 s30, s29, 0x700000
  s_cmp_lt_u32 s29, 0x8000
  s_cselect_b32 s30, s30, 0x40000000
  buffer_store_dwordx4 v[8:11], v0, s[4:7], s30 offen sc1
  s_cmp_eq_u32 s25, 0
  s_cbranch_scc0 L_regwait
  s_mov_b64 exec, 1
  s_mov_b32 s30, 0
L_regtry:
  s_waitcnt vmcnt(0)
  v_readfirstlane_b32 s29, v3
  s_cmp_lt_u32 s29, 32
  s_cbranch_scc1 L_regdone
  s_add_u32 s30, s30, 1
  s_cmp_ge_u32 s30, 8
  s_cselect_b32 s27, 8, s27
  s_cbranch_scc1 L_regdone
  s_add_u32 s27, s27, 1
  s_and_b32 s27, s27, 7
  s_lshl_b32 s28, s27, 4
  s_add_u32 s28, s28, 128
  s_cmp_eq_u32 s27, 0
  s_cselect_b32 s28, 0, s28
  s_mov_b32 s26, 1
  v_mov_b32 v3, 1
  buffer_atomic_add v3, v2, s[20:23], s28 offen sc0 sc1
  s_branch L_regtry
L_regdone:
  s_lshl_b32 s30, s27, 5
  s_add_u32 s29, s29, s30
  v_mov_b32 v3, s29
  ds_write_b32 v2, v3
  v_mov_b32 v13, s26
  s_mov_b64 exec, -1
L_regwait:
  s_waitcnt vmcnt(0) lgkmcnt(0)
  s_barrier
  s_cmp_eq_u32 s25, 0
  s_cbranch_scc0 L_regread
  s_mov_b64 exec, 1
  buffer_atomic_add v13, v2, s[20:23], 0 offen offset:64 sc1
  s_mov_b64 exec, -1
L_regread:
  ds_read_b32 v4, v2
  s_waitcnt lgkmcnt(0)
  v_readfirstlane_b32 s36, v4
  s_barrier
  s_cmp_ge_u32 s36, 256
  s_cbranch_scc1 L_fail
  s_cmp_lt_u32 s36, 32
  s_cbranch_scc1 L_rec
  s_sub_u32 s24, s36, 32
  s_lshr_b32 s26, s24, 5
  s_and_b32 s27, s24, 31
  s_mul_i32 s69, s26, 24
  s_add_u32 s69, s69, s27
  s_sub_u32 s69, s69, 8
  s_mov_b32 s29, s24
  s_mul_i32 s28, s26, 8
  s_add_u32 s28, s28, s27
  s_add_u32 s28, s28, 0
  s_cmp_ge_u32 s27, 0
  s_cselect_b32 s29, s28, s29
  s_mul_i32 s28, s26, 12
  s_add_u32 s28, s28, s27
  s_add_u32 s28, s28, 40
  s_cmp_ge_u32 s27, 8
  s_cselect_b32 s29, s28, s29
  s_mul_i32 s28, s26, 6
  s_add_u32 s28, s28, s27
  s_add_u32 s28, s28, 100
  s_cmp_ge_u32 s27, 20
  s_cselect_b32 s29, s28, s29
  s_mul_i32 s28, s26, 3
  s_add_u32 s28, s28, s27
  s_add_u32 s28, s28, 130
  s_cmp_ge_u32 s27, 26
  s_cselect_b32 s29, s28, s29
  s_mul_i32 s28, s26, 3
  s_add_u32 s28, s28, s27
  s_add_u32 s28, s28, 145
  s_cmp_ge_u32 s27, 29
  s_cselect_b32 s29, s28, s29
  s_cmp_lt_u32 s24, 192
  s_cselect_b32 s24, s29, s24
  s_cmp_lt_u32 s24, 48
  s_cbranch_scc1 L_p2
  s_cmp_lt_u32 s24, 192
  s_cbranch_scc1 L_p1_qkv
  s_sub_u32 s24, s24, 192
  s_load_dwordx2 s[12:13], s[0:1], 0
  s_mov_b32 s14, 0x240000
  s_mov_b32 s15, 0x20000
  s_lshl_b32 s26, s24, 2
  s_add_u32 s26, s26, s25
  s_mul_i32 s27, s26, 18432
  v_and_b32 v2, 15, v1
  v_mul_u32_u24 v2, 1152, v2
  v_and_b32 v3, 48, v1
  v_add_u32 v2, v2, v3
  s_waitcnt lgkmcnt(0)
  buffer_load_dwordx4 v[16:19], v2, s[12:15], s27 offen offset:0
  buffer_load_dwordx4 v[20:23], v2, s[12:15], s27 offen offset:64
  buffer_load_dwordx4 v[24:27], v2, s[12:15], s27 offen offset:128
  buffer_load_dwordx4 v[28:31], v2, s[12:15], s27 offen offset:192
  buffer_load_dwordx4 v[32:35], v2, s[12:15], s27 offen offset:256
  buffer_load_dwordx4 v[36:39], v2, s[12:15], s27 offen offset:320
  buffer_load_dwordx4 v[40:43], v2, s[12:15], s27 offen offset:384
  buffer_load_dwordx4 v[44:47], v2, s[12:15], s27 offen offset:448
  buffer_load_dwordx4 v[48:51], v2, s[12:15], s27 offen offset:512
  buffer_load_dwordx4 v[52:55], v2, s[12:15], s27 offen offset:576
  buffer_load_dwordx4 v[56:59], v2, s[12:15], s27 offen offset:640
  buffer_load_dwordx4 v[60:63], v2, s[12:15], s27 offen offset:704
  buffer_load_dwordx4 v[64:67], v2, s[12:15], s27 offen offset:768
  buffer_load_dwordx4 v[68:71], v2, s[12:15], s27 offen offset:832
  buffer_load_dwordx4 v[72:75], v2, s[12:15], s27 offen offset:896
  buffer_load_dwordx4 v[76:79], v2, s[12:15], s27 offen offset:960
  buffer_load_dwordx4 v[80:83], v2, s[12:15], s27 offen offset:1024
  buffer_load_dwordx4 v[84:87], v2, s[12:15], s27 offen offset:1088
  v_mov_b32 v4, 0x3f803f80
  v_mov_b32 v5, 0x3f803f80
  v_mov_b32 v6, 0x3f803f80
  v_mov_b32 v7, 0x3f803f80
  s_waitcnt vmcnt(17)
  s_nop 0
  v_mfma_f32_16x16x32_bf16 v[8:11], v[4:7], v[16:19], 0
  s_waitcnt vmcnt(16)
  v_mfma_f32_16x16x32_bf16 v[8:11], v[4:7], v[20:23], v[8:11]
  s_waitcnt vmcnt(15)
  v_mfma_f32_16x16x32_bf16 v[8:11], v[4:7], v[24:27], v[8:11]
  s_waitcnt vmcnt(14)
  v_mfma_f32_16x16x32_bf16 v[8:11], v[4:7], v[28:31], v[8:11]
  s_waitcnt vmcnt(13)
  v_mfma_f32_16x16x32_bf16 v[8:11], v[4:7], v[32:35], v[8:11]
  s_waitcnt vmcnt(12)
  v_mfma_f32_16x16x32_bf16 v[8:11], v[4:7], v[36:39], v[8:11]
  s_waitcnt vmcnt(11)
  v_mfma_f32_16x16x32_bf16 v[8:11], v[4:7], v[40:43], v[8:11]
  s_waitcnt vmcnt(10)
  v_mfma_f32_16x16x32_bf16 v[8:11], v[4:7], v[44:47], v[8:11]
  s_waitcnt vmcnt(9)
  v_mfma_f32_16x16x32_bf16 v[8:11], v[4:7], v[48:51], v[8:11]
  s_waitcnt vmcnt(8)
  v_mfma_f32_16x16x32_bf16 v[8:11], v[4:7], v[52:55], v[8:11]
  s_waitcnt vmcnt(7)
  v_mfma_f32_16x16x32_bf16 v[8:11], v[4:7], v[56:59], v[8:11]
  s_waitcnt vmcnt(6)
  v_mfma_f32_16x16x32_bf16 v[8:11], v[4:7], v[60:63], v[8:11]
  s_waitcnt vmcnt(5)
  v_mfma_f32_16x16x32_bf16 v[8:11], v[4:7], v[64:67], v[8:11]
  s_waitcnt vmcnt(4)
  v_mfma_f32_16x16x32_bf16 v[8:11], v[4:7], v[68:71], v[8:11]
  s_waitcnt vmcnt(3)
  v_mfma_f32_16x16x32_bf16 v[8:11], v[4:7], v[72:75], v[8:11]
  s_waitcnt vmcnt(2)
  v_mfma_f32_16x16x32_bf16 v[8:11], v[4:7], v[76:79], v[8:11]
  s_waitcnt vmcnt(1)
  v_mfma_f32_16x16x32_bf16 v[8:11], v[4:7], v[80:83], v[8:11]
  s_waitcnt vmcnt(0)
  v_mfma_f32_16x16x32_bf16 v[8:11], v[4:7], v[84:87], v[8:11]
  s_nop 7
  v_mul_f32 v12, 0x3ae38e39, v8
  v_mov_b32 v13, v12
  v_cvt_pk_bf16_f32 v13, v13, v13
  v_and_b32 v13, 0xffff0000, v13
  v_mov_b32 v4, 0
  v_mov_b32 v5, 0
  v_mov_b32 v6, 0
  v_mov_b32 v7, 0
  v_lshlrev_b32 v96, 16, v16
  v_and_b32 v97, 0xffff0000, v16
  v_sub_f32 v2, v96, v12
  v_sub_f32 v3, v97, v12
  v_sub_f32 v96, v96, v13
  v_sub_f32 v97, v97, v13
  v_fmac_f32 v4, v2, v2
  v_fmac_f32 v5, v3, v3
  v_lshlrev_b32 v98, 16, v17
  v_and_b32 v99, 0xffff0000, v17
  v_sub_f32 v2, v98, v12
  v_sub_f32 v3, v99, v12
  v_sub_f32 v98, v98, v13
  v_sub_f32 v99, v99, v13
  v_fmac_f32 v6, v2, v2
  v_fmac_f32 v7, v3, v3
  v_lshlrev_b32 v100, 16, v18
  v_and_b32 v101, 0xffff0000, v18
  v_sub_f32 v2, v100, v12
  v_sub_f32 v3, v101, v12
  v_sub_f32 v100, v100, v13
  v_sub_f32 v101, v101, v13
  v_fmac_f32 v4, v2, v2
  v_fmac_f32 v5, v3, v3
  v_lshlrev_b32 v102, 16, v19
  v_and_b32 v103, 0xffff0000, v19
  v_sub_f32 v2, v102, v12
  v_sub_f32 v3, v103, v12
  v_sub_f32 v102, v102, v13
  v_sub_f32 v103, v103, v13
  v_fmac_f32 v6, v2, v2
  v_fmac_f32 v7, v3, v3
  v_lshlrev_b32 v104, 16, v20
  v_and_b32 v105, 0xffff0000, v20
  v_sub_f32 v2, v104, v12
  v_sub_f32 v3, v105, v12
  v_sub_f32 v104, v104, v13
  v_sub_f32 v105, v105, v13
  v_fmac_f32 v4, v2, v2
  v_fmac_f32 v5, v3, v3
  v_lshlrev_b32 v106, 16, v21
  v_and_b32 v107, 0xffff0000, v21
  v_sub_f32 v2, v106, v12
  v_sub_f32 v3, v107, v12
  v_sub_f32 v106, v106, v13
  v_sub_f32 v107, v107, v13
  v_fmac_f32 v6, v2, v2
  v_fmac_f32 v7, v3, v3
  v_lshlrev_b32 v108, 16, v22
  v_and_b32 v109, 0xffff0000, v22
  v_sub_f32 v2, v108, v12
  v_sub_f32 v3, v109, v12
  v_sub_f32 v108, v108, v13
  v_sub_f32 v109, v109, v13
  v_fmac_f32 v4, v2, v2
  v_fmac_f32 v5, v3, v3
  v_lshlrev_b32 v110, 16, v23
  v_and_b32 v111, 0xffff0000, v23
  v_sub_f32 v2, v110, v12
  v_sub_f32 v3, v111, v12
  v_sub_f32 v110, v110, v13
  v_sub_f32 v111, v111, v13
  v_fmac_f32 v6, v2, v2
  v_fmac_f32 v7, v3, v3
  v_lshlrev_b32 v112, 16, v24
  v_and_b32 v113, 0xffff0000, v24
  v_sub_f32 v2, v112, v12
  v_sub_f32 v3, v113, v12
  v_sub_f32 v112, v112, v13
  v_sub_f32 v113, v113, v13
  v_fmac_f32 v4, v2, v2
  v_fmac_f32 v5, v3, v3
  v_lshlrev_b32 v114, 16, v25
  v_and_b32 v115, 0xffff0000, v25
  v_sub_f32 v2, v114, v12
  v_sub_f32 v3, v115, v12
  v_sub_f32 v114, v114, v13
  v_sub_f32 v115, v115, v13
  v_fmac_f32 v6, v2, v2
  v_fmac_f32 v7, v3, v3
  v_lshlrev_b32 v116, 16, v26
  v_and_b32 v117, 0xffff0000, v26
  v_sub_f32 v2, v116, v12
  v_sub_f32 v3, v117, v12
  v_sub_f32 v116, v116, v13
  v_sub_f32 v117, v117, v13
  v_fmac_f32 v4, v2, v2
  v_fmac_f32 v5, v3, v3
  v_lshlrev_b32 v118, 16, v27
  v_and_b32 v119, 0xffff0000, v27
  v_sub_f32 v2, v118, v12
  v_sub_f32 v3, v119, v12
  v_sub_f32 v118, v118, v13
  v_sub_f32 v119, v119, v13
  v_fmac_f32 v6, v2, v2
  v_fmac_f32 v7, v3, v3
  v_lshlrev_b32 v120, 16, v28
  v_and_b32 v121, 0xffff0000, v28
  v_sub_f32 v2, v120, v12
  v_sub_f32 v3, v121, v12
  v_sub_f32 v120, v120, v13
  v_sub_f32 v121, v121, v13
  v_fmac_f32 v4, v2, v2
  v_fmac_f32 v5, v3, v3
  v_lshlrev_b32 v122, 16, v29
  v_and_b32 v123, 0xffff0000, v29
  v_sub_f32 v2, v122, v12
  v_sub_f32 v3, v123, v12
  v_sub_f32 v122, v122, v13
  v_sub_f32 v123, v123, v13
  v_fmac_f32 v6, v2, v2
  v_fmac_f32 v7, v3, v3
  v_lshlrev_b32 v124, 16, v30
  v_and_b32 v125, 0xffff0000, v30
  v_sub_f32 v2, v124, v12
  v_sub_f32 v3, v125, v12
  v_sub_f32 v124, v124, v13
  v_sub_f32 v125, v125, v13
  v_fmac_f32 v4, v2, v2
  v_fmac_f32 v5, v3, v3
  v_lshlrev_b32 v126, 16, v31
  v_and_b32 v127, 0xffff0000, v31
  v_sub_f32 v2, v126, v12
  v_sub_f32 v3, v127, v12
  v_sub_f32 v126, v126, v13
  v_sub_f32 v127, v127, v13
  v_fmac_f32 v6, v2, v2
  v_fmac_f32 v7, v3, v3
  v_lshlrev_b32 v128, 16, v32
  v_and_b32 v129, 0xffff0000, v32
  v_sub_f32 v2, v128, v12
  v_sub_f32 v3, v129, v12
  v_sub_f32 v128, v128, v13
  v_sub_f32 v129, v129, v13
  v_fmac_f32 v4, v2, v2
  v_fmac_f32 v5, v3, v3
  v_lshlrev_b32 v130, 16, v33
  v_and_b32 v131, 0xffff0000, v33
  v_sub_f32 v2, v130, v12
  v_sub_f32 v3, v131, v12
  v_sub_f32 v130, v130, v13
  v_sub_f32 v131, v131, v13
  v_fmac_f32 v6, v2, v2
  v_fmac_f32 v7, v3, v3
  v_lshlrev_b32 v132, 16, v34
  v_and_b32 v133, 0xffff0000, v34
  v_sub_f32 v2, v132, v12
  v_sub_f32 v3, v133, v12
  v_sub_f32 v132, v132, v13
  v_sub_f32 v133, v133, v13
  v_fmac_f32 v4, v2, v2
  v_fmac_f32 v5, v3, v3
  v_lshlrev_b32 v134, 16, v35
  v_and_b32 v135, 0xffff0000, v35
  v_sub_f32 v2, v134, v12
  v_sub_f32 v3, v135, v12
  v_sub_f32 v134, v134, v13
  v_sub_f32 v135, v135, v13
  v_fmac_f32 v6, v2, v2
  v_fmac_f32 v7, v3, v3
  v_lshlrev_b32 v136, 16, v36
  v_and_b32 v137, 0xffff0000, v36
  v_sub_f32 v2, v136, v12
  v_sub_f32 v3, v137, v12
  v_sub_f32 v136, v136, v13
  v_sub_f32 v137, v137, v13
  v_fmac_f32 v4, v2, v2
  v_fmac_f32 v5, v3, v3
  v_lshlrev_b32 v138, 16, v37
  v_and_b32 v139, 0xffff0000, v37
  v_sub_f32 v2, v138, v12
  v_sub_f32 v3, v139, v12
  v_sub_f32 v138, v138, v13
  v_sub_f32 v139, v139, v13
  v_fmac_f32 v6, v2, v2
  v_fmac_f32 v7, v3, v3
  v_lshlrev_b32 v140, 16, v38
  v_and_b32 v141, 0xffff0000, v38
  v_sub_f32 v2, v140, v12
  v_sub_f32 v3, v141, v12
  v_sub_f32 v140, v140, v13
  v_sub_f32 v141, v141, v13
  v_fmac_f32 v4, v2, v2
  v_fmac_f32 v5, v3, v3
  v_lshlrev_b32 v142, 16, v39
  v_and_b32 v143, 0xffff0000, v39
  v_sub_f32 v2, v142, v12
  v_sub_f32 v3, v143, v12
  v_sub_f32 v142, v142, v13
  v_sub_f32 v143, v143, v13
  v_fmac_f32 v6, v2, v2
  v_fmac_f32 v7, v3, v3
  v_lshlrev_b32 v144, 16, v40
  v_and_b32 v145, 0xffff0000, v40
  v_sub_f32 v2, v144, v12
  v_sub_f32 v3, v145, v12
  v_sub_f32 v144, v144, v13
  v_sub_f32 v145, v145, v13
  v_fmac_f32 v4, v2, v2
  v_fmac_f32 v5, v3, v3
  v_lshlrev_b32 v146, 16, v41
  v_and_b32 v147, 0xffff0000, v41
  v_sub_f32 v2, v146, v12
  v_sub_f32 v3, v147, v12
  v_sub_f32 v146, v146, v13
  v_sub_f32 v147, v147, v13
  v_fmac_f32 v6, v2, v2
  v_fmac_f32 v7, v3, v3
  v_lshlrev_b32 v148, 16, v42
  v_and_b32 v149, 0xffff0000, v42
  v_sub_f32 v2, v148, v12
  v_sub_f32 v3, v149, v12
  v_sub_f32 v148, v148, v13
  v_sub_f32 v149, v149, v13
  v_fmac_f32 v4, v2, v2
  v_fmac_f32 v5, v3, v3
  v_lshlrev_b32 v150, 16, v43
  v_and_b32 v151, 0xffff0000, v43
  v_sub_f32 v2, v150, v12
  v_sub_f32 v3, v151, v12
  v_sub_f32 v150, v150, v13
  v_sub_f32 v151, v151, v13
  v_fmac_f32 v6, v2, v2
  v_fmac_f32 v7, v3, v3
  v_lshlrev_b32 v152, 16, v44
  v_and_b32 v153, 0xffff0000, v44
  v_sub_f32 v2, v152, v12
  v_sub_f32 v3, v153, v12
  v_sub_f32 v152, v152, v13
  v_sub_f32 v153, v153, v13
  v_fmac_f32 v4, v2, v2
  v_fmac_f32 v5, v3, v3
  v_lshlrev_b32 v154, 16, v45
  v_and_b32 v155, 0xffff0000, v45
  v_sub_f32 v2, v154, v12
  v_sub_f32 v3, v155, v12
  v_sub_f32 v154, v154, v13
  v_sub_f32 v155, v155, v13
  v_fmac_f32 v6, v2, v2
  v_fmac_f32 v7, v3, v3
  v_lshlrev_b32 v156, 16, v46
  v_and_b32 v157, 0xffff0000, v46
  v_sub_f32 v2, v156, v12
  v_sub_f32 v3, v157, v12
  v_sub_f32 v156, v156, v13
  v_sub_f32 v157, v157, v13
  v_fmac_f32 v4, v2, v2
  v_fmac_f32 v5, v3, v3
  v_lshlrev_b32 v158, 16, v47
  v_and_b32 v159, 0xffff0000, v47
  v_sub_f32 v2, v158, v12
  v_sub_f32 v3, v159, v12
  v_sub_f32 v158, v158, v13
  v_sub_f32 v159, v159, v13
  v_fmac_f32 v6, v2, v2
  v_fmac_f32 v7, v3, v3
  v_lshlrev_b32 v160, 16, v48
  v_and_b32 v161, 0xffff0000, v48
  v_sub_f32 v2, v160, v12
  v_sub_f32 v3, v161, v12
  v_sub_f32 v160, v160, v13
  v_sub_f32 v161, v161, v13
  v_fmac_f32 v4, v2, v2
  v_fmac_f32 v5, v3, v3
  v_lshlrev_b32 v162, 16, v49
  v_and_b32 v163, 0xffff0000, v49
  v_sub_f32 v2, v162, v12
  v_sub_f32 v3, v163, v12
  v_sub_f32 v162, v162, v13
  v_sub_f32 v163, v163, v13
  v_fmac_f32 v6, v2, v2
  v_fmac_f32 v7, v3, v3
  v_lshlrev_b32 v164, 16, v50
  v_and_b32 v165, 0xffff0000, v50
  v_sub_f32 v2, v164, v12
  v_sub_f32 v3, v165, v12
  v_sub_f32 v164, v164, v13
  v_sub_f32 v165, v165, v13
  v_fmac_f32 v4, v2, v2
  v_fmac_f32 v5, v3, v3
  v_lshlrev_b32 v166, 16, v51
  v_and_b32 v167, 0xffff0000, v51
  v_sub_f32 v2, v166, v12
  v_sub_f32 v3, v167, v12
  v_sub_f32 v166, v166, v13
  v_sub_f32 v167, v167, v13
  v_fmac_f32 v6, v2, v2
  v_fmac_f32 v7, v3, v3
  v_lshlrev_b32 v168, 16, v52
  v_and_b32 v169, 0xffff0000, v52
  v_sub_f32 v2, v168, v12
  v_sub_f32 v3, v169, v12
  v_sub_f32 v168, v168, v13
  v_sub_f32 v169, v169, v13
  v_fmac_f32 v4, v2, v2
  v_fmac_f32 v5, v3, v3
  v_lshlrev_b32 v170, 16, v53
  v_and_b32 v171, 0xffff0000, v53
  v_sub_f32 v2, v170, v12
  v_sub_f32 v3, v171, v12
  v_sub_f32 v170, v170, v13
  v_sub_f32 v171, v171, v13
  v_fmac_f32 v6, v2, v2
  v_fmac_f32 v7, v3, v3
  v_lshlrev_b32 v172, 16, v54
  v_and_b32 v173, 0xffff0000, v54
  v_sub_f32 v2, v172, v12
  v_sub_f32 v3, v173, v12
  v_sub_f32 v172, v172, v13
  v_sub_f32 v173, v173, v13
  v_fmac_f32 v4, v2, v2
  v_fmac_f32 v5, v3, v3
  v_lshlrev_b32 v174, 16, v55
  v_and_b32 v175, 0xffff0000, v55
  v_sub_f32 v2, v174, v12
  v_sub_f32 v3, v175, v12
  v_sub_f32 v174, v174, v13
  v_sub_f32 v175, v175, v13
  v_fmac_f32 v6, v2, v2
  v_fmac_f32 v7, v3, v3
  v_lshlrev_b32 v176, 16, v56
  v_and_b32 v177, 0xffff0000, v56
  v_sub_f32 v2, v176, v12
  v_sub_f32 v3, v177, v12
  v_sub_f32 v176, v176, v13
  v_sub_f32 v177, v177, v13
  v_fmac_f32 v4, v2, v2
  v_fmac_f32 v5, v3, v3
  v_lshlrev_b32 v178, 16, v57
  v_and_b32 v179, 0xffff0000, v57
  v_sub_f32 v2, v178, v12
  v_sub_f32 v3, v179, v12
  v_sub_f32 v178, v178, v13
  v_sub_f32 v179, v179, v13
  v_fmac_f32 v6, v2, v2
  v_fmac_f32 v7, v3, v3
  v_lshlrev_b32 v180, 16, v58
  v_and_b32 v181, 0xffff0000, v58
  v_sub_f32 v2, v180, v12
  v_sub_f32 v3, v181, v12
  v_sub_f32 v180, v180, v13
  v_sub_f32 v181, v181, v13
  v_fmac_f32 v4, v2, v2
  v_fmac_f32 v5, v3, v3
  v_lshlrev_b32 v182, 16, v59
  v_and_b32 v183, 0xffff0000, v59
  v_sub_f32 v2, v182, v12
  v_sub_f32 v3, v183, v12
  v_sub_f32 v182, v182, v13
  v_sub_f32 v183, v183, v13
  v_fmac_f32 v6, v2, v2
  v_fmac_f32 v7, v3, v3
  v_lshlrev_b32 v184, 16, v60
  v_and_b32 v185, 0xffff0000, v60
  v_sub_f32 v2, v184, v12
  v_sub_f32 v3, v185, v12
  v_sub_f32 v184, v184, v13
  v_sub_f32 v185, v185, v13
  v_fmac_f32 v4, v2, v2
  v_fmac_f32 v5, v3, v3
  v_lshlrev_b32 v186, 16, v61
  v_and_b32 v187, 0xffff0000, v61
  v_sub_f32 v2, v186, v12
  v_sub_f32 v3, v187, v12
  v_sub_f32 v186, v186, v13
  v_sub_f32 v187, v187, v13
  v_fmac_f32 v6, v2, v2
  v_fmac_f32 v7, v3, v3
  v_lshlrev_b32 v188, 16, v62
  v_and_b32 v189, 0xffff0000, v62
  v_sub_f32 v2, v188, v12
  v_sub_f32 v3, v189, v12
  v_sub_f32 v188, v188, v13
  v_sub_f32 v189, v189, v13
  v_fmac_f32 v4, v2, v2
  v_fmac_f32 v5, v3, v3
  v_lshlrev_b32 v190, 16, v63
  v_and_b32 v191, 0xffff0000, v63
  v_sub_f32 v2, v190, v12
  v_sub_f32 v3, v191, v12
  v_sub_f32 v190, v190, v13
  v_sub_f32 v191, v191, v13
  v_fmac_f32 v6, v2, v2
  v_fmac_f32 v7, v3, v3
  v_lshlrev_b32 v192, 16, v64
  v_and_b32 v193, 0xffff0000, v64
  v_sub_f32 v2, v192, v12
  v_sub_f32 v3, v193, v12
  v_sub_f32 v192, v192, v13
  v_sub_f32 v193, v193, v13
  v_fmac_f32 v4, v2, v2
  v_fmac_f32 v5, v3, v3
  v_lshlrev_b32 v194, 16, v65
  v_and_b32 v195, 0xffff0000, v65
  v_sub_f32 v2, v194, v12
  v_sub_f32 v3, v195, v12
  v_sub_f32 v194, v194, v13
  v_sub_f32 v195, v195, v13
  v_fmac_f32 v6, v2, v2
  v_fmac_f32 v7, v3, v3
  v_lshlrev_b32 v196, 16, v66
  v_and_b32 v197, 0xffff0000, v66
  v_sub_f32 v2, v196, v12
  v_sub_f32 v3, v197, v12
  v_sub_f32 v196, v196, v13
  v_sub_f32 v197, v197, v13
  v_fmac_f32 v4, v2, v2
  v_fmac_f32 v5, v3, v3
  v_lshlrev_b32 v198, 16, v67
  v_and_b32 v199, 0xffff0000, v67
  v_sub_f32 v2, v198, v12
  v_sub_f32 v3, v199, v12
  v_sub_f32 v198, v198, v13
  v_sub_f32 v199, v199, v13
  v_fmac_f32 v6, v2, v2
  v_fmac_f32 v7, v3, v3
  v_lshlrev_b32 v200, 16, v68
  v_and_b32 v201, 0xffff0000, v68
  v_sub_f32 v2, v200, v12
  v_sub_f32 v3, v201, v12
  v_sub_f32 v200, v200, v13
  v_sub_f32 v201, v201, v13
  v_fmac_f32 v4, v2, v2
  v_fmac_f32 v5, v3, v3
  v_lshlrev_b32 v202, 16, v69
  v_and_b32 v203, 0xffff0000, v69
  v_sub_f32 v2, v202, v12
  v_sub_f32 v3, v203, v12
  v_sub_f32 v202, v202, v13
  v_sub_f32 v203, v203, v13
  v_fmac_f32 v6, v2, v2
  v_fmac_f32 v7, v3, v3
  v_lshlrev_b32 v204, 16, v70
  v_and_b32 v205, 0xffff0000, v70
  v_sub_f32 v2, v204, v12
  v_sub_f32 v3, v205, v12
  v_sub_f32 v204, v204, v13
  v_sub_f32 v205, v205, v13
  v_fmac_f32 v4, v2, v2
  v_fmac_f32 v5, v3, v3
  v_lshlrev_b32 v206, 16, v71
  v_and_b32 v207, 0xffff0000, v71
  v_sub_f32 v2, v206, v12
  v_sub_f32 v3, v207, v12
  v_sub_f32 v206, v206, v13
  v_sub_f32 v207, v207, v13
  v_fmac_f32 v6, v2, v2
  v_fmac_f32 v7, v3, v3
  v_lshlrev_b32 v208, 16, v72
  v_and_b32 v209, 0xffff0000, v72
  v_sub_f32 v2, v208, v12
  v_sub_f32 v3, v209, v12
  v_sub_f32 v208, v208, v13
  v_sub_f32 v209, v209, v13
  v_fmac_f32 v4, v2, v2
  v_fmac_f32 v5, v3, v3
  v_lshlrev_b32 v210, 16, v73
  v_and_b32 v211, 0xffff0000, v73
  v_sub_f32 v2, v210, v12
  v_sub_f32 v3, v211, v12
  v_sub_f32 v210, v210, v13
  v_sub_f32 v211, v211, v13
  v_fmac_f32 v6, v2, v2
  v_fmac_f32 v7, v3, v3
  v_lshlrev_b32 v212, 16, v74
  v_and_b32 v213, 0xffff0000, v74
  v_sub_f32 v2, v212, v12
  v_sub_f32 v3, v213, v12
  v_sub_f32 v212, v212, v13
  v_sub_f32 v213, v213, v13
  v_fmac_f32 v4, v2, v2
  v_fmac_f32 v5, v3, v3
  v_lshlrev_b32 v214, 16, v75
  v_and_b32 v215, 0xffff0000, v75
  v_sub_f32 v2, v214, v12
  v_sub_f32 v3, v215, v12
  v_sub_f32 v214, v214, v13
  v_sub_f32 v215, v215, v13
  v_fmac_f32 v6, v2, v2
  v_fmac_f32 v7, v3, v3
  v_lshlrev_b32 v216, 16, v76
  v_and_b32 v217, 0xffff0000, v76
  v_sub_f32 v2, v216, v12
  v_sub_f32 v3, v217, v12
  v_sub_f32 v216, v216, v13
  v_sub_f32 v217, v217, v13
  v_fmac_f32 v4, v2, v2
  v_fmac_f32 v5, v3, v3
  v_lshlrev_b32 v218, 16, v77
  v_and_b32 v219, 0xffff0000, v77
  v_sub_f32 v2, v218, v12
  v_sub_f32 v3, v219, v12
  v_sub_f32 v218, v218, v13
  v_sub_f32 v219, v219, v13
  v_fmac_f32 v6, v2, v2
  v_fmac_f32 v7, v3, v3
  v_lshlrev_b32 v220, 16, v78
  v_and_b32 v221, 0xffff0000, v78
  v_sub_f32 v2, v220, v12
  v_sub_f32 v3, v221, v12
  v_sub_f32 v220, v220, v13
  v_sub_f32 v221, v221, v13
  v_fmac_f32 v4, v2, v2
  v_fmac_f32 v5, v3, v3
  v_lshlrev_b32 v222, 16, v79
  v_and_b32 v223, 0xffff0000, v79
  v_sub_f32 v2, v222, v12
  v_sub_f32 v3, v223, v12
  v_sub_f32 v222, v222, v13
  v_sub_f32 v223, v223, v13
  v_fmac_f32 v6, v2, v2
  v_fmac_f32 v7, v3, v3
  v_lshlrev_b32 v224, 16, v80
  v_and_b32 v225, 0xffff0000, v80
  v_sub_f32 v2, v224, v12
  v_sub_f32 v3, v225, v12
  v_sub_f32 v224, v224, v13
  v_sub_f32 v225, v225, v13
  v_fmac_f32 v4, v2, v2
  v_fmac_f32 v5, v3, v3
  v_lshlrev_b32 v226, 16, v81
  v_and_b32 v227, 0xffff0000, v81
  v_sub_f32 v2, v226, v12
  v_sub_f32 v3, v227, v12
  v_sub_f32 v226, v226, v13
  v_sub_f32 v227, v227, v13
  v_fmac_f32 v6, v2, v2
  v_fmac_f32 v7, v3, v3
  v_lshlrev_b32 v228, 16, v82
  v_and_b32 v229, 0xffff0000, v82
  v_sub_f32 v2, v228, v12
  v_sub_f32 v3, v229, v12
  v_sub_f32 v228, v228, v13
  v_sub_f32 v229, v229, v13
  v_fmac_f32 v4, v2, v2
  v_fmac_f32 v5, v3, v3
  v_lshlrev_b32 v230, 16, v83
  v_and_b32 v231, 0xffff0000, v83
  v_sub_f32 v2, v230, v12
  v_sub_f32 v3, v231, v12
  v_sub_f32 v230, v230, v13
  v_sub_f32 v231, v231, v13
  v_fmac_f32 v6, v2, v2
  v_fmac_f32 v7, v3, v3
  v_lshlrev_b32 v232, 16, v84
  v_and_b32 v233, 0xffff0000, v84
  v_sub_f32 v2, v232, v12
  v_sub_f32 v3, v233, v12
  v_sub_f32 v232, v232, v13
  v_sub_f32 v233, v233, v13
  v_fmac_f32 v4, v2, v2
  v_fmac_f32 v5, v3, v3
  v_lshlrev_b32 v234, 16, v85
  v_and_b32 v235, 0xffff0000, v85
  v_sub_f32 v2, v234, v12
  v_sub_f32 v3, v235, v12
  v_sub_f32 v234, v234, v13
  v_sub_f32 v235, v235, v13
  v_fmac_f32 v6, v2, v2
  v_fmac_f32 v7, v3, v3
  v_lshlrev_b32 v236, 16, v86
  v_and_b32 v237, 0xffff0000, v86
  v_sub_f32 v2, v236, v12
  v_sub_f32 v3, v237, v12
  v_sub_f32 v236, v236, v13
  v_sub_f32 v237, v237, v13
  v_fmac_f32 v4, v2, v2
  v_fmac_f32 v5, v3, v3
  v_lshlrev_b32 v238, 16, v87
  v_and_b32 v239, 0xffff0000, v87
  v_sub_f32 v2, v238, v12
  v_sub_f32 v3, v239, v12
  v_sub_f32 v238, v238, v13
  v_sub_f32 v239, v239, v13
  v_fmac_f32 v6, v2, v2
  v_fmac_f32 v7, v3, v3
  v_add_f32 v4, v4, v5
  v_add_f32 v6, v6, v7
  v_add_f32 v4, v4, v6
  v_mov_b32 v2, v4
  s_nop 1
  v_permlane32_swap_b32 v4, v2
  v_add_f32 v4, v4, v2
  v_mov_b32 v2, v4
  s_nop 1
  v_permlane16_swap_b32 v4, v2
  v_add_f32 v4, v4, v2
  v_mul_f32 v4, 0x3ae38e39, v4
  v_cvt_pk_bf16_f32 v4, v4, v4
  v_and_b32 v4, 0xffff0000, v4
  v_add_f32 v4, 0x3727c5ac, v4
  v_cvt_pk_bf16_f32 v4, v4, v4
  v_and_b32 v4, 0xffff0000, v4
  v_sqrt_f32 v4, v4
  s_nop 0
  v_cvt_pk_bf16_f32 v4, v4, v4
  v_and_b32 v4, 0xffff0000, v4
  v_rcp_f32 v4, v4
  s_mul_i32 s27, s26, 18432
  s_add_u32 s27, s27, 0x200000
  v_cvt_pk_bf16_f32 v2, v96, v97
  v_lshlrev_b32 v96, 16, v2
  v_and_b32 v97, 0xffff0000, v2
  v_mul_f32 v96, v96, v4
  v_mul_f32 v97, v97, v4
  v_cvt_pk_bf16_f32 v16, v96, v97
  v_cvt_pk_bf16_f32 v2, v98, v99
  v_lshlrev_b32 v98, 16, v2
  v_and_b32 v99, 0xffff0000, v2
  v_mul_f32 v98, v98, v4
  v_mul_f32 v99, v99, v4
  v_cvt_pk_bf16_f32 v17, v98, v99
  v_cvt_pk_bf16_f32 v2, v100, v101
  v_lshlrev_b32 v100, 16, v2
  v_and_b32 v101, 0xffff0000, v2
  v_mul_f32 v100, v100, v4
  v_mul_f32 v101, v101, v4
  v_cvt_pk_bf16_f32 v18, v100, v101
  v_cvt_pk_bf16_f32 v2, v102, v103
  v_lshlrev_b32 v102, 16, v2
  v_and_b32 v103, 0xffff0000, v2
  v_mul_f32 v102, v102, v4
  v_mul_f32 v103, v103, v4
  v_cvt_pk_bf16_f32 v19, v102, v103
  buffer_store_dwordx4 v[16:19], v0, s[4:7], s27 offen offset:0 sc1
  v_cvt_pk_bf16_f32 v2, v104, v105
  v_lshlrev_b32 v104, 16, v2
  v_and_b32 v105, 0xffff0000, v2
  v_mul_f32 v104, v104, v4
  v_mul_f32 v105, v105, v4
  v_cvt_pk_bf16_f32 v20, v104, v105
  v_cvt_pk_bf16_f32 v2, v106, v107
  v_lshlrev_b32 v106, 16, v2
  v_and_b32 v107, 0xffff0000, v2
  v_mul_f32 v106, v106, v4
  v_mul_f32 v107, v107, v4
  v_cvt_pk_bf16_f32 v21, v106, v107
  v_cvt_pk_bf16_f32 v2, v108, v109
  v_lshlrev_b32 v108, 16, v2
  v_and_b32 v109, 0xffff0000, v2
  v_mul_f32 v108, v108, v4
  v_mul_f32 v109, v109, v4
  v_cvt_pk_bf16_f32 v22, v108, v109
  v_cvt_pk_bf16_f32 v2, v110, v111
  v_lshlrev_b32 v110, 16, v2
  v_and_b32 v111, 0xffff0000, v2
  v_mul_f32 v110, v110, v4
  v_mul_f32 v111, v111, v4
  v_cvt_pk_bf16_f32 v23, v110, v111
  buffer_store_dwordx4 v[20:23], v0, s[4:7], s27 offen offset:1024 sc1
  v_cvt_pk_bf16_f32 v2, v112, v113
  v_lshlrev_b32 v112, 16, v2
  v_and_b32 v113, 0xffff0000, v2
  v_mul_f32 v112, v112, v4
  v_mul_f32 v113, v113, v4
  v_cvt_pk_bf16_f32 v24, v112, v113
  v_cvt_pk_bf16_f32 v2, v114, v115
  v_lshlrev_b32 v114, 16, v2
  v_and_b32 v115, 0xffff0000, v2
  v_mul_f32 v114, v114, v4
  v_mul_f32 v115, v115, v4
  v_cvt_pk_bf16_f32 v25, v114, v115
  v_cvt_pk_bf16_f32 v2, v116, v117
  v_lshlrev_b32 v116, 16, v2
  v_and_b32 v117, 0xffff0000, v2
  v_mul_f32 v116, v116, v4
  v_mul_f32 v117, v117, v4
  v_cvt_pk_bf16_f32 v26, v116, v117
  v_cvt_pk_bf16_f32 v2, v118, v119
  v_lshlrev_b32 v118, 16, v2
  v_and_b32 v119, 0xffff0000, v2
  v_mul_f32 v118, v118, v4
  v_mul_f32 v119, v119, v4
  v_cvt_pk_bf16_f32 v27, v118, v119
  buffer_store_dwordx4 v[24:27], v0, s[4:7], s27 offen offset:2048 sc1
  v_cvt_pk_bf16_f32 v2, v120, v121
  v_lshlrev_b32 v120, 16, v2
  v_and_b32 v121, 0xffff0000, v2
  v_mul_f32 v120, v120, v4
  v_mul_f32 v121, v121, v4
  v_cvt_pk_bf16_f32 v28, v120, v121
  v_cvt_pk_bf16_f32 v2, v122, v123
  v_lshlrev_b32 v122, 16, v2
  v_and_b32 v123, 0xffff0000, v2
  v_mul_f32 v122, v122, v4
  v_mul_f32 v123, v123, v4
  v_cvt_pk_bf16_f32 v29, v122, v123
  v_cvt_pk_bf16_f32 v2, v124, v125
  v_lshlrev_b32 v124, 16, v2
  v_and_b32 v125, 0xffff0000, v2
  v_mul_f32 v124, v124, v4
  v_mul_f32 v125, v125, v4
  v_cvt_pk_bf16_f32 v30, v124, v125
  v_cvt_pk_bf16_f32 v2, v126, v127
  v_lshlrev_b32 v126, 16, v2
  v_and_b32 v127, 0xffff0000, v2
  v_mul_f32 v126, v126, v4
  v_mul_f32 v127, v127, v4
  v_cvt_pk_bf16_f32 v31, v126, v127
  buffer_store_dwordx4 v[28:31], v0, s[4:7], s27 offen offset:3072 sc1
  v_cvt_pk_bf16_f32 v2, v128, v129
  v_lshlrev_b32 v128, 16, v2
  v_and_b32 v129, 0xffff0000, v2
  v_mul_f32 v128, v128, v4
  v_mul_f32 v129, v129, v4
  v_cvt_pk_bf16_f32 v32, v128, v129
  v_cvt_pk_bf16_f32 v2, v130, v131
  v_lshlrev_b32 v130, 16, v2
  v_and_b32 v131, 0xffff0000, v2
  v_mul_f32 v130, v130, v4
  v_mul_f32 v131, v131, v4
  v_cvt_pk_bf16_f32 v33, v130, v131
  v_cvt_pk_bf16_f32 v2, v132, v133
  v_lshlrev_b32 v132, 16, v2
  v_and_b32 v133, 0xffff0000, v2
  v_mul_f32 v132, v132, v4
  v_mul_f32 v133, v133, v4
  v_cvt_pk_bf16_f32 v34, v132, v133
  v_cvt_pk_bf16_f32 v2, v134, v135
  v_lshlrev_b32 v134, 16, v2
  v_and_b32 v135, 0xffff0000, v2
  v_mul_f32 v134, v134, v4
  v_mul_f32 v135, v135, v4
  v_cvt_pk_bf16_f32 v35, v134, v135
  s_add_u32 s27, s27, 4096
  buffer_store_dwordx4 v[32:35], v0, s[4:7], s27 offen offset:0 sc1
  v_cvt_pk_bf16_f32 v2, v136, v137
  v_lshlrev_b32 v136, 16, v2
  v_and_b32 v137, 0xffff0000, v2
  v_mul_f32 v136, v136, v4
  v_mul_f32 v137, v137, v4
  v_cvt_pk_bf16_f32 v36, v136, v137
  v_cvt_pk_bf16_f32 v2, v138, v139
  v_lshlrev_b32 v138, 16, v2
  v_and_b32 v139, 0xffff0000, v2
  v_mul_f32 v138, v138, v4
  v_mul_f32 v139, v139, v4
  v_cvt_pk_bf16_f32 v37, v138, v139
  v_cvt_pk_bf16_f32 v2, v140, v141
  v_lshlrev_b32 v140, 16, v2
  v_and_b32 v141, 0xffff0000, v2
  v_mul_f32 v140, v140, v4
  v_mul_f32 v141, v141, v4
  v_cvt_pk_bf16_f32 v38, v140, v141
  v_cvt_pk_bf16_f32 v2, v142, v143
  v_lshlrev_b32 v142, 16, v2
  v_and_b32 v143, 0xffff0000, v2
  v_mul_f32 v142, v142, v4
  v_mul_f32 v143, v143, v4
  v_cvt_pk_bf16_f32 v39, v142, v143
  buffer_store_dwordx4 v[36:39], v0, s[4:7], s27 offen offset:1024 sc1
  v_cvt_pk_bf16_f32 v2, v144, v145
  v_lshlrev_b32 v144, 16, v2
  v_and_b32 v145, 0xffff0000, v2
  v_mul_f32 v144, v144, v4
  v_mul_f32 v145, v145, v4
  v_cvt_pk_bf16_f32 v40, v144, v145
  v_cvt_pk_bf16_f32 v2, v146, v147
  v_lshlrev_b32 v146, 16, v2
  v_and_b32 v147, 0xffff0000, v2
  v_mul_f32 v146, v146, v4
  v_mul_f32 v147, v147, v4
  v_cvt_pk_bf16_f32 v41, v146, v147
  v_cvt_pk_bf16_f32 v2, v148, v149
  v_lshlrev_b32 v148, 16, v2
  v_and_b32 v149, 0xffff0000, v2
  v_mul_f32 v148, v148, v4
  v_mul_f32 v149, v149, v4
  v_cvt_pk_bf16_f32 v42, v148, v149
  v_cvt_pk_bf16_f32 v2, v150, v151
  v_lshlrev_b32 v150, 16, v2
  v_and_b32 v151, 0xffff0000, v2
  v_mul_f32 v150, v150, v4
  v_mul_f32 v151, v151, v4
  v_cvt_pk_bf16_f32 v43, v150, v151
  buffer_store_dwordx4 v[40:43], v0, s[4:7], s27 offen offset:2048 sc1
  v_cvt_pk_bf16_f32 v2, v152, v153
  v_lshlrev_b32 v152, 16, v2
  v_and_b32 v153, 0xffff0000, v2
  v_mul_f32 v152, v152, v4
  v_mul_f32 v153, v153, v4
  v_cvt_pk_bf16_f32 v44, v152, v153
  v_cvt_pk_bf16_f32 v2, v154, v155
  v_lshlrev_b32 v154, 16, v2
  v_and_b32 v155, 0xffff0000, v2
  v_mul_f32 v154, v154, v4
  v_mul_f32 v155, v155, v4
  v_cvt_pk_bf16_f32 v45, v154, v155
  v_cvt_pk_bf16_f32 v2, v156, v157
  v_lshlrev_b32 v156, 16, v2
  v_and_b32 v157, 0xffff0000, v2
  v_mul_f32 v156, v156, v4
  v_mul_f32 v157, v157, v4
  v_cvt_pk_bf16_f32 v46, v156, v157
  v_cvt_pk_bf16_f32 v2, v158, v159
  v_lshlrev_b32 v158, 16, v2
  v_and_b32 v159, 0xffff0000, v2
  v_mul_f32 v158, v158, v4
  v_mul_f32 v159, v159, v4
  v_cvt_pk_bf16_f32 v47, v158, v159
  buffer_store_dwordx4 v[44:47], v0, s[4:7], s27 offen offset:3072 sc1
  v_cvt_pk_bf16_f32 v2, v160, v161
  v_lshlrev_b32 v160, 16, v2
  v_and_b32 v161, 0xffff0000, v2
  v_mul_f32 v160, v160, v4
  v_mul_f32 v161, v161, v4
  v_cvt_pk_bf16_f32 v48, v160, v161
  v_cvt_pk_bf16_f32 v2, v162, v163
  v_lshlrev_b32 v162, 16, v2
  v_and_b32 v163, 0xffff0000, v2
  v_mul_f32 v162, v162, v4
  v_mul_f32 v163, v163, v4
  v_cvt_pk_bf16_f32 v49, v162, v163
  v_cvt_pk_bf16_f32 v2, v164, v165
  v_lshlrev_b32 v164, 16, v2
  v_and_b32 v165, 0xffff0000, v2
  v_mul_f32 v164, v164, v4
  v_mul_f32 v165, v165, v4
  v_cvt_pk_bf16_f32 v50, v164, v165
  v_cvt_pk_bf16_f32 v2, v166, v167
  v_lshlrev_b32 v166, 16, v2
  v_and_b32 v167, 0xffff0000, v2
  v_mul_f32 v166, v166, v4
  v_mul_f32 v167, v167, v4
  v_cvt_pk_bf16_f32 v51, v166, v167
  s_add_u32 s27, s27, 4096
  buffer_store_dwordx4 v[48:51], v0, s[4:7], s27 offen offset:0 sc1
  v_cvt_pk_bf16_f32 v2, v168, v169
  v_lshlrev_b32 v168, 16, v2
  v_and_b32 v169, 0xffff0000, v2
  v_mul_f32 v168, v168, v4
  v_mul_f32 v169, v169, v4
  v_cvt_pk_bf16_f32 v52, v168, v169
  v_cvt_pk_bf16_f32 v2, v170, v171
  v_lshlrev_b32 v170, 16, v2
  v_and_b32 v171, 0xffff0000, v2
  v_mul_f32 v170, v170, v4
  v_mul_f32 v171, v171, v4
  v_cvt_pk_bf16_f32 v53, v170, v171
  v_cvt_pk_bf16_f32 v2, v172, v173
  v_lshlrev_b32 v172, 16, v2
  v_and_b32 v173, 0xffff0000, v2
  v_mul_f32 v172, v172, v4
  v_mul_f32 v173, v173, v4
  v_cvt_pk_bf16_f32 v54, v172, v173
  v_cvt_pk_bf16_f32 v2, v174, v175
  v_lshlrev_b32 v174, 16, v2
  v_and_b32 v175, 0xffff0000, v2
  v_mul_f32 v174, v174, v4
  v_mul_f32 v175, v175, v4
  v_cvt_pk_bf16_f32 v55, v174, v175
  buffer_store_dwordx4 v[52:55], v0, s[4:7], s27 offen offset:1024 sc1
  v_cvt_pk_bf16_f32 v2, v176, v177
  v_lshlrev_b32 v176, 16, v2
  v_and_b32 v177, 0xffff0000, v2
  v_mul_f32 v176, v176, v4
  v_mul_f32 v177, v177, v4
  v_cvt_pk_bf16_f32 v56, v176, v177
  v_cvt_pk_bf16_f32 v2, v178, v179
  v_lshlrev_b32 v178, 16, v2
  v_and_b32 v179, 0xffff0000, v2
  v_mul_f32 v178, v178, v4
  v_mul_f32 v179, v179, v4
  v_cvt_pk_bf16_f32 v57, v178, v179
  v_cvt_pk_bf16_f32 v2, v180, v181
  v_lshlrev_b32 v180, 16, v2
  v_and_b32 v181, 0xffff0000, v2
  v_mul_f32 v180, v180, v4
  v_mul_f32 v181, v181, v4
  v_cvt_pk_bf16_f32 v58, v180, v181
  v_cvt_pk_bf16_f32 v2, v182, v183
  v_lshlrev_b32 v182, 16, v2
  v_and_b32 v183, 0xffff0000, v2
  v_mul_f32 v182, v182, v4
  v_mul_f32 v183, v183, v4
  v_cvt_pk_bf16_f32 v59, v182, v183
  buffer_store_dwordx4 v[56:59], v0, s[4:7], s27 offen offset:2048 sc1
  v_cvt_pk_bf16_f32 v2, v184, v185
  v_lshlrev_b32 v184, 16, v2
  v_and_b32 v185, 0xffff0000, v2
  v_mul_f32 v184, v184, v4
  v_mul_f32 v185, v185, v4
  v_cvt_pk_bf16_f32 v60, v184, v185
  v_cvt_pk_bf16_f32 v2, v186, v187
  v_lshlrev_b32 v186, 16, v2
  v_and_b32 v187, 0xffff0000, v2
  v_mul_f32 v186, v186, v4
  v_mul_f32 v187, v187, v4
  v_cvt_pk_bf16_f32 v61, v186, v187
  v_cvt_pk_bf16_f32 v2, v188, v189
  v_lshlrev_b32 v188, 16, v2
  v_and_b32 v189, 0xffff0000, v2
  v_mul_f32 v188, v188, v4
  v_mul_f32 v189, v189, v4
  v_cvt_pk_bf16_f32 v62, v188, v189
  v_cvt_pk_bf16_f32 v2, v190, v191
  v_lshlrev_b32 v190, 16, v2
  v_and_b32 v191, 0xffff0000, v2
  v_mul_f32 v190, v190, v4
  v_mul_f32 v191, v191, v4
  v_cvt_pk_bf16_f32 v63, v190, v191
  buffer_store_dwordx4 v[60:63], v0, s[4:7], s27 offen offset:3072 sc1
  v_cvt_pk_bf16_f32 v2, v192, v193
  v_lshlrev_b32 v192, 16, v2
  v_and_b32 v193, 0xffff0000, v2
  v_mul_f32 v192, v192, v4
  v_mul_f32 v193, v193, v4
  v_cvt_pk_bf16_f32 v64, v192, v193
  v_cvt_pk_bf16_f32 v2, v194, v195
  v_lshlrev_b32 v194, 16, v2
  v_and_b32 v195, 0xffff0000, v2
  v_mul_f32 v194, v194, v4
  v_mul_f32 v195, v195, v4
  v_cvt_pk_bf16_f32 v65, v194, v195
  v_cvt_pk_bf16_f32 v2, v196, v197
  v_lshlrev_b32 v196, 16, v2
  v_and_b32 v197, 0xffff0000, v2
  v_mul_f32 v196, v196, v4
  v_mul_f32 v197, v197, v4
  v_cvt_pk_bf16_f32 v66, v196, v197
  v_cvt_pk_bf16_f32 v2, v198, v199
  v_lshlrev_b32 v198, 16, v2
  v_and_b32 v199, 0xffff0000, v2
  v_mul_f32 v198, v198, v4
  v_mul_f32 v199, v199, v4
  v_cvt_pk_bf16_f32 v67, v198, v199
  s_add_u32 s27, s27, 4096
  buffer_store_dwordx4 v[64:67], v0, s[4:7], s27 offen offset:0 sc1
  v_cvt_pk_bf16_f32 v2, v200, v201
  v_lshlrev_b32 v200, 16, v2
  v_and_b32 v201, 0xffff0000, v2
  v_mul_f32 v200, v200, v4
  v_mul_f32 v201, v201, v4
  v_cvt_pk_bf16_f32 v68, v200, v201
  v_cvt_pk_bf16_f32 v2, v202, v203
  v_lshlrev_b32 v202, 16, v2
  v_and_b32 v203, 0xffff0000, v2
  v_mul_f32 v202, v202, v4
  v_mul_f32 v203, v203, v4
  v_cvt_pk_bf16_f32 v69, v202, v203
  v_cvt_pk_bf16_f32 v2, v204, v205
  v_lshlrev_b32 v204, 16, v2
  v_and_b32 v205, 0xffff0000, v2
  v_mul_f32 v204, v204, v4
  v_mul_f32 v205, v205, v4
  v_cvt_pk_bf16_f32 v70, v204, v205
  v_cvt_pk_bf16_f32 v2, v206, v207
  v_lshlrev_b32 v206, 16, v2
  v_and_b32 v207, 0xffff0000, v2
  v_mul_f32 v206, v206, v4
  v_mul_f32 v207, v207, v4
  v_cvt_pk_bf16_f32 v71, v206, v207
  buffer_store_dwordx4 v[68:71], v0, s[4:7], s27 offen offset:1024 sc1
  v_cvt_pk_bf16_f32 v2, v208, v209
  v_lshlrev_b32 v208, 16, v2
  v_and_b32 v209, 0xffff0000, v2
  v_mul_f32 v208, v208, v4
  v_mul_f32 v209, v209, v4
  v_cvt_pk_bf16_f32 v72, v208, v209
  v_cvt_pk_bf16_f32 v2, v210, v211
  v_lshlrev_b32 v210, 16, v2
  v_and_b32 v211, 0xffff0000, v2
  v_mul_f32 v210, v210, v4
  v_mul_f32 v211, v211, v4
  v_cvt_pk_bf16_f32 v73, v210, v211
  v_cvt_pk_bf16_f32 v2, v212, v213
  v_lshlrev_b32 v212, 16, v2
  v_and_b32 v213, 0xffff0000, v2
  v_mul_f32 v212, v212, v4
  v_mul_f32 v213, v213, v4
  v_cvt_pk_bf16_f32 v74, v212, v213
  v_cvt_pk_bf16_f32 v2, v214, v215
  v_lshlrev_b32 v214, 16, v2
  v_and_b32 v215, 0xffff0000, v2
  v_mul_f32 v214, v214, v4
  v_mul_f32 v215, v215, v4
  v_cvt_pk_bf16_f32 v75, v214, v215
  buffer_store_dwordx4 v[72:75], v0, s[4:7], s27 offen offset:2048 sc1
  v_cvt_pk_bf16_f32 v2, v216, v217
  v_lshlrev_b32 v216, 16, v2
  v_and_b32 v217, 0xffff0000, v2
  v_mul_f32 v216, v216, v4
  v_mul_f32 v217, v217, v4
  v_cvt_pk_bf16_f32 v76, v216, v217
  v_cvt_pk_bf16_f32 v2, v218, v219
  v_lshlrev_b32 v218, 16, v2
  v_and_b32 v219, 0xffff0000, v2
  v_mul_f32 v218, v218, v4
  v_mul_f32 v219, v219, v4
  v_cvt_pk_bf16_f32 v77, v218, v219
  v_cvt_pk_bf16_f32 v2, v220, v221
  v_lshlrev_b32 v220, 16, v2
  v_and_b32 v221, 0xffff0000, v2
  v_mul_f32 v220, v220, v4
  v_mul_f32 v221, v221, v4
  v_cvt_pk_bf16_f32 v78, v220, v221
  v_cvt_pk_bf16_f32 v2, v222, v223
  v_lshlrev_b32 v222, 16, v2
  v_and_b32 v223, 0xffff0000, v2
  v_mul_f32 v222, v222, v4
  v_mul_f32 v223, v223, v4
  v_cvt_pk_bf16_f32 v79, v222, v223
  buffer_store_dwordx4 v[76:79], v0, s[4:7], s27 offen offset:3072 sc1
  v_cvt_pk_bf16_f32 v2, v224, v225
  v_lshlrev_b32 v224, 16, v2
  v_and_b32 v225, 0xffff0000, v2
  v_mul_f32 v224, v224, v4
  v_mul_f32 v225, v225, v4
  v_cvt_pk_bf16_f32 v80, v224, v225
  v_cvt_pk_bf16_f32 v2, v226, v227
  v_lshlrev_b32 v226, 16, v2
  v_and_b32 v227, 0xffff0000, v2
  v_mul_f32 v226, v226, v4
  v_mul_f32 v227, v227, v4
  v_cvt_pk_bf16_f32 v81, v226, v227
  v_cvt_pk_bf16_f32 v2, v228, v229
  v_lshlrev_b32 v228, 16, v2
  v_and_b32 v229, 0xffff0000, v2
  v_mul_f32 v228, v228, v4
  v_mul_f32 v229, v229, v4
  v_cvt_pk_bf16_f32 v82, v228, v229
  v_cvt_pk_bf16_f32 v2, v230, v231
  v_lshlrev_b32 v230, 16, v2
  v_and_b32 v231, 0xffff0000, v2
  v_mul_f32 v230, v230, v4
  v_mul_f32 v231, v231, v4
  v_cvt_pk_bf16_f32 v83, v230, v231
  s_add_u32 s27, s27, 4096
  buffer_store_dwordx4 v[80:83], v0, s[4:7], s27 offen offset:0 sc1
  v_cvt_pk_bf16_f32 v2, v232, v233
  v_lshlrev_b32 v232, 16, v2
  v_and_b32 v233, 0xffff0000, v2
  v_mul_f32 v232, v232, v4
  v_mul_f32 v233, v233, v4
  v_cvt_pk_bf16_f32 v84, v232, v233
  v_cvt_pk_bf16_f32 v2, v234, v235
  v_lshlrev_b32 v234, 16, v2
  v_and_b32 v235, 0xffff0000, v2
  v_mul_f32 v234, v234, v4
  v_mul_f32 v235, v235, v4
  v_cvt_pk_bf16_f32 v85, v234, v235
  v_cvt_pk_bf16_f32 v2, v236, v237
  v_lshlrev_b32 v236, 16, v2
  v_and_b32 v237, 0xffff0000, v2
  v_mul_f32 v236, v236, v4
  v_mul_f32 v237, v237, v4
  v_cvt_pk_bf16_f32 v86, v236, v237
  v_cvt_pk_bf16_f32 v2, v238, v239
  v_lshlrev_b32 v238, 16, v2
  v_and_b32 v239, 0xffff0000, v2
  v_mul_f32 v238, v238, v4
  v_mul_f32 v239, v239, v4
  v_cvt_pk_bf16_f32 v87, v238, v239
  buffer_store_dwordx4 v[84:87], v0, s[4:7], s27 offen offset:1024 sc1
  s_mov_b32 s28, 0
L_reg_1:
  v_mov_b32 v8, 0
  buffer_load_dword v9, v8, s[20:23], 0 offen offset:64 sc1
  s_add_u32 s28, s28, 1
  s_cmp_gt_u32 s28, 1048576
  s_cbranch_scc1 L_fail
  s_waitcnt vmcnt(0)
  v_readfirstlane_b32 s67, v9
L_regc_2:
  s_and_b32 s26, s67, 0xffff
  s_cmp_lt_u32 s26, 256
  s_cbranch_scc1 L_reg_1
  s_lshr_b32 s67, s67, 16
  s_lshl_b32 s26, s24, 2
  s_add_u32 s26, s26, s25
  v_mov_b32 v2, 0x40000000
  v_cmp_eq_u32 vcc, 0, v0
  s_nop 1
  v_cndmask_b32 v2, v2, 0, vcc
  v_mov_b32 v3, 1
  s_lshl_b32 s27, s26, 2
  s_add_u32 s27, s27, 0x0
  s_waitcnt vmcnt(0)
  buffer_store_dword v3, v2, s[4:7], s27 offen sc1
  s_add_u32 s24, s24, 192
  s_branch L_p2
L_p1_qkv:
  s_mov_b32 s26, s24
  s_mov_b32 s24, s69
  s_mov_b32 s69, s26
  s_mul_i32 s50, s24, 1366
  s_lshr_b32 s50, s50, 12
  s_mul_i32 s36, s50, 3
  s_sub_u32 s36, s24, s36
  s_and_b32 s51, s50, 15
  s_lshr_b32 s50, s50, 4
  s_cmp_eq_u32 s50, 2
  s_cbranch_scc1 L_qkv_v
  s_load_dwordx2 s[8:9], s[0:1], 16
  s_mov_b32 s10, 0x480000
  s_mov_b32 s11, 0x20000
  s_load_dwordx2 s[26:27], s[0:1], 24
  s_waitcnt lgkmcnt(0)
  s_cmp_eq_u32 s50, 1
  s_cselect_b32 s8, s26, s8
  s_cselect_b32 s9, s27, s9
  s_lshl_b32 s27, s51, 9
  s_lshl_b32 s28, s25, 7
  s_add_u32 s27, s27, s28
  v_lshrrev_b32 v10, 3, v1
  v_lshlrev_b32 v10, 13, v10
  v_and_b32 v11, 7, v1
  v_lshlrev_b32 v11, 4, v11
  v_add3_u32 v10, v10, v11, s27
  s_mul_i32 s26, s25, 36864
  v_lshrrev_b32 v12, 4, v1
  v_mul_u32_u24 v12, 1024, v12
  v_bfe_u32 v13, v1, 2, 2
  v_mul_u32_u24 v13, 128, v13
  v_add_u32 v12, v12, v13
  v_and_b32 v13, 3, v1
  v_mul_u32_u24 v13, 16, v13
  v_add3_u32 v11, v12, v13, s26
  s_add_u32 m0, s26, 0x0
  s_mov_b32 s27, 0x0
  buffer_load_dwordx4 v10, s[8:11], s27 offen  lds
  s_add_u32 m0, s26, 0x400
  s_mov_b32 s27, 0x10000
  buffer_load_dwordx4 v10, s[8:11], s27 offen  lds
  s_add_u32 m0, s26, 0x800
  s_mov_b32 s27, 0x20000
  buffer_load_dwordx4 v10, s[8:11], s27 offen  lds
  s_add_u32 m0, s26, 0xc00
  s_mov_b32 s27, 0x30000
  buffer_load_dwordx4 v10, s[8:11], s27 offen  lds
  s_add_u32 m0, s26, 0x1000
  s_mov_b32 s27, 0x40000
  buffer_load_dwordx4 v10, s[8:11], s27 offen  lds
  s_add_u32 m0, s26, 0x1400
  s_mov_b32 s27, 0x50000
  buffer_load_dwordx4 v10, s[8:11], s27 offen  lds
  s_add_u32 m0, s26, 0x1800
  s_mov_b32 s27, 0x60000
  buffer_load_dwordx4 v10, s[8:11], s27 offen  lds
  s_add_u32 m0, s26, 0x1c00
  s_mov_b32 s27, 0x70000
  buffer_load_dwordx4 v10, s[8:11], s27 offen  lds
  s_add_u32 m0, s26, 0x2000
  s_mov_b32 s27, 0x80000
  buffer_load_dwordx4 v10, s[8:11], s27 offen  lds
  s_add_u32 m0, s26, 0x2400
  s_mov_b32 s27, 0x90000
  buffer_load_dwordx4 v10, s[8:11], s27 offen  lds
  s_add_u32 m0, s26, 0x2800
  s_mov_b32 s27, 0xa0000
  buffer_load_dwordx4 v10, s[8:11], s27 offen  lds
  s_add_u32 m0, s26, 0x2c00
  s_mov_b32 s27, 0xb0000
  buffer_load_dwordx4 v10, s[8:11], s27 offen  lds
  s_add_u32 m0, s26, 0x3000
  s_mov_b32 s27, 0xc0000
  buffer_load_dwordx4 v10, s[8:11], s27 offen  lds
  s_add_u32 m0, s26, 0x3400
  s_mov_b32 s27, 0xd0000
  buffer_load_dwordx4 v10, s[8:11], s27 offen  lds
  s_add_u32 m0, s26, 0x3800
  s_mov_b32 s27, 0xe0000
  buffer_load_dwordx4 v10, s[8:11], s27 offen  lds
  s_add_u32 m0, s26, 0x3c00
  s_mov_b32 s27, 0xf0000
  buffer_load_dwordx4 v10, s[8:11], s27 offen  lds
  s_add_u32 m0, s26, 0x4000
  s_mov_b32 s27, 0x100000
  buffer_load_dwordx4 v10, s[8:11], s27 offen  lds
  s_add_u32 m0, s26, 0x4400
  s_mov_b32 s27, 0x110000
  buffer_load_dwordx4 v10, s[8:11], s27 offen  lds
  s_add_u32 m0, s26, 0x4800
  s_mov_b32 s27, 0x120000
  buffer_load_dwordx4 v10, s[8:11], s27 offen  lds
  s_add_u32 m0, s26, 0x4c00
  s_mov_b32 s27, 0x130000
  buffer_load_dwordx4 v10, s[8:11], s27 offen  lds
  s_add_u32 m0, s26, 0x5000
  s_mov_b32 s27, 0x140000
  buffer_load_dwordx4 v10, s[8:11], s27 offen  lds
  s_add_u32 m0, s26, 0x5400
  s_mov_b32 s27, 0x150000
  buffer_load_dwordx4 v10, s[8:11], s27 offen  lds
  s_add_u32 m0, s26, 0x5800
  s_mov_b32 s27, 0x160000
  buffer_load_dwordx4 v10, s[8:11], s27 offen  lds
  s_add_u32 m0, s26, 0x5c00
  s_mov_b32 s27, 0x170000
  buffer_load_dwordx4 v10, s[8:11], s27 offen  lds
  s_add_u32 m0, s26, 0x6000
  s_mov_b32 s27, 0x180000
  buffer_load_dwordx4 v10, s[8:11], s27 offen  lds
  s_add_u32 m0, s26, 0x6400
  s_mov_b32 s27, 0x190000
  buffer_load_dwordx4 v10, s[8:11], s27 offen  lds
  s_add_u32 m0, s26, 0x6800
  s_mov_b32 s27, 0x1a0000
  buffer_load_dwordx4 v10, s[8:11], s27 offen  lds
  s_add_u32 m0, s26, 0x6c00
  s_mov_b32 s27, 0x1b0000
  buffer_load_dwordx4 v10, s[8:11], s27 offen  lds
  s_add_u32 m0, s26, 0x7000
  s_mov_b32 s27, 0x1c0000
  buffer_load_dwordx4 v10, s[8:11], s27 offen  lds
  s_add_u32 m0, s26, 0x7400
  s_mov_b32 s27, 0x1d0000
  buffer_load_dwordx4 v10, s[8:11], s27 offen  lds
  s_add_u32 m0, s26, 0x7800
  s_mov_b32 s27, 0x1e0000
  buffer_load_dwordx4 v10, s[8:11], s27 offen  lds
  s_add_u32 m0, s26, 0x7c00
  s_mov_b32 s27, 0x1f0000
  buffer_load_dwordx4 v10, s[8:11], s27 offen  lds
  s_add_u32 m0, s26, 0x8000
  s_mov_b32 s27, 0x200000
  buffer_load_dwordx4 v10, s[8:11], s27 offen  lds
  s_add_u32 m0, s26, 0x8400
  s_mov_b32 s27, 0x210000
  buffer_load_dwordx4 v10, s[8:11], s27 offen  lds
  s_add_u32 m0, s26, 0x8800
  s_mov_b32 s27, 0x220000
  buffer_load_dwordx4 v10, s[8:11], s27 offen  lds
  s_add_u32 m0, s26, 0x8c00
  s_mov_b32 s27, 0x230000
  buffer_load_dwordx4 v10, s[8:11], s27 offen  lds
  s_waitcnt vmcnt(32)
  ds_read_b64_tr_b16 v[224:225], v11 offset:0
  ds_read_b64_tr_b16 v[226:227], v11 offset:512
  ds_read_b64_tr_b16 v[228:229], v11 offset:8
  ds_read_b64_tr_b16 v[230:231], v11 offset:520
  ds_read_b64_tr_b16 v[232:233], v11 offset:64
  ds_read_b64_tr_b16 v[234:235], v11 offset:576
  ds_read_b64_tr_b16 v[236:237], v11 offset:72
  ds_read_b64_tr_b16 v[238:239], v11 offset:584
  s_waitcnt lgkmcnt(0)
  s_add_u32 m0, s26, 0x0
  s_mov_b32 s27, 0x240000
  buffer_load_dwordx4 v10, s[8:11], s27 offen  lds
  s_add_u32 m0, s26, 0x400
  s_mov_b32 s27, 0x250000
  buffer_load_dwordx4 v10, s[8:11], s27 offen  lds
  s_add_u32 m0, s26, 0x800
  s_mov_b32 s27, 0x260000
  buffer_load_dwordx4 v10, s[8:11], s27 offen  lds
  s_add_u32 m0, s26, 0xc00
  s_mov_b32 s27, 0x270000
  buffer_load_dwordx4 v10, s[8:11], s27 offen  lds
  s_waitcnt vmcnt(32)
  ds_read_b64_tr_b16 v[240:241], v11 offset:4096
  ds_read_b64_tr_b16 v[242:243], v11 offset:4608
  ds_read_b64_tr_b16 v[244:245], v11 offset:4104
  ds_read_b64_tr_b16 v[246:247], v11 offset:4616
  ds_read_b64_tr_b16 v[248:249], v11 offset:4160
  ds_read_b64_tr_b16 v[250:251], v11 offset:4672
  ds_read_b64_tr_b16 v[252:253], v11 offset:4168
  ds_read_b64_tr_b16 v[254:255], v11 offset:4680
  s_waitcnt lgkmcnt(0)
  s_add_u32 m0, s26, 0x1000
  s_mov_b32 s27, 0x280000
  buffer_load_dwordx4 v10, s[8:11], s27 offen  lds
  s_add_u32 m0, s26, 0x1400
  s_mov_b32 s27, 0x290000
  buffer_load_dwordx4 v10, s[8:11], s27 offen  lds
  s_add_u32 m0, s26, 0x1800
  s_mov_b32 s27, 0x2a0000
  buffer_load_dwordx4 v10, s[8:11], s27 offen  lds
  s_add_u32 m0, s26, 0x1c00
  s_mov_b32 s27, 0x2b0000
  buffer_load_dwordx4 v10, s[8:11], s27 offen  lds
  s_waitcnt vmcnt(32)
  ds_read_b64_tr_b16 a[0:1], v11 offset:8192
  ds_read_b64_tr_b16 a[2:3], v11 offset:8704
  ds_read_b64_tr_b16 a[4:5], v11 offset:8200
  ds_read_b64_tr_b16 a[6:7], v11 offset:8712
  ds_read_b64_tr_b16 a[8:9], v11 offset:8256
  ds_read_b64_tr_b16 a[10:11], v11 offset:8768
  ds_read_b64_tr_b16 a[12:13], v11 offset:8264
  ds_read_b64_tr_b16 a[14:15], v11 offset:8776
  s_waitcnt lgkmcnt(0)
  s_add_u32 m0, s26, 0x2000
  s_mov_b32 s27, 0x2c0000
  buffer_load_dwordx4 v10, s[8:11], s27 offen  lds
  s_add_u32 m0, s26, 0x2400
  s_mov_b32 s27, 0x2d0000
  buffer_load_dwordx4 v10, s[8:11], s27 offen  lds
  s_add_u32 m0, s26, 0x2800
  s_mov_b32 s27, 0x2e0000
  buffer_load_dwordx4 v10, s[8:11], s27 offen  lds
  s_add_u32 m0, s26, 0x2c00
  s_mov_b32 s27, 0x2f0000
  buffer_load_dwordx4 v10, s[8:11], s27 offen  lds
  s_waitcnt vmcnt(32)
  ds_read_b64_tr_b16 a[16:17], v11 offset:12288
  ds_read_b64_tr_b16 a[18:19], v11 offset:12800
  ds_read_b64_tr_b16 a[20:21], v11 offset:12296
  ds_read_b64_tr_b16 a[22:23], v11 offset:12808
  ds_read_b64_tr_b16 a[24:25], v11 offset:12352
  ds_read_b64_tr_b16 a[26:27], v11 offset:12864
  ds_read_b64_tr_b16 a[28:29], v11 offset:12360
  ds_read_b64_tr_b16 a[30:31], v11 offset:12872
  s_waitcnt lgkmcnt(0)
  s_add_u32 m0, s26, 0x3000
  s_mov_b32 s27, 0x300000
  buffer_load_dwordx4 v10, s[8:11], s27 offen  lds
  s_add_u32 m0, s26, 0x3400
  s_mov_b32 s27, 0x310000
  buffer_load_dwordx4 v10, s[8:11], s27 offen  lds
  s_add_u32 m0, s26, 0x3800
  s_mov_b32 s27, 0x320000
  buffer_load_dwordx4 v10, s[8:11], s27 offen  lds
  s_add_u32 m0, s26, 0x3c00
  s_mov_b32 s27, 0x330000
  buffer_load_dwordx4 v10, s[8:11], s27 offen  lds
  s_waitcnt vmcnt(32)
  ds_read_b64_tr_b16 a[32:33], v11 offset:16384
  ds_read_b64_tr_b16 a[34:35], v11 offset:16896
  ds_read_b64_tr_b16 a[36:37], v11 offset:16392
  ds_read_b64_tr_b16 a[38:39], v11 offset:16904
  ds_read_b64_tr_b16 a[40:41], v11 offset:16448
  ds_read_b64_tr_b16 a[42:43], v11 offset:16960
  ds_read_b64_tr_b16 a[44:45], v11 offset:16456
  ds_read_b64_tr_b16 a[46:47], v11 offset:16968
  s_waitcnt lgkmcnt(0)
  s_add_u32 m0, s26, 0x4000
  s_mov_b32 s27, 0x340000
  buffer_load_dwordx4 v10, s[8:11], s27 offen  lds
  s_add_u32 m0, s26, 0x4400
  s_mov_b32 s27, 0x350000
  buffer_load_dwordx4 v10, s[8:11], s27 offen  lds
  s_add_u32 m0, s26, 0x4800
  s_mov_b32 s27, 0x360000
  buffer_load_dwordx4 v10, s[8:11], s27 offen  lds
  s_add_u32 m0, s26, 0x4c00
  s_mov_b32 s27, 0x370000
  buffer_load_dwordx4 v10, s[8:11], s27 offen  lds
  s_waitcnt vmcnt(32)
  ds_read_b64_tr_b16 a[48:49], v11 offset:20480
  ds_read_b64_tr_b16 a[50:51], v11 offset:20992
  ds_read_b64_tr_b16 a[52:53], v11 offset:20488
  ds_read_b64_tr_b16 a[54:55], v11 offset:21000
  ds_read_b64_tr_b16 a[56:57], v11 offset:20544
  ds_read_b64_tr_b16 a[58:59], v11 offset:21056
  ds_read_b64_tr_b16 a[60:61], v11 offset:20552
  ds_read_b64_tr_b16 a[62:63], v11 offset:21064
  s_waitcnt lgkmcnt(0)
  s_add_u32 m0, s26, 0x5000
  s_mov_b32 s27, 0x380000
  buffer_load_dwordx4 v10, s[8:11], s27 offen  lds
  s_add_u32 m0, s26, 0x5400
  s_mov_b32 s27, 0x390000
  buffer_load_dwordx4 v10, s[8:11], s27 offen  lds
  s_add_u32 m0, s26, 0x5800
  s_mov_b32 s27, 0x3a0000
  buffer_load_dwordx4 v10, s[8:11], s27 offen  lds
  s_add_u32 m0, s26, 0x5c00
  s_mov_b32 s27, 0x3b0000
  buffer_load_dwordx4 v10, s[8:11], s27 offen  lds
  s_waitcnt vmcnt(32)
  ds_read_b64_tr_b16 a[64:65], v11 offset:24576
  ds_read_b64_tr_b16 a[66:67], v11 offset:25088
  ds_read_b64_tr_b16 a[68:69], v11 offset:24584
  ds_read_b64_tr_b16 a[70:71], v11 offset:25096
  ds_read_b64_tr_b16 a[72:73], v11 offset:24640
  ds_read_b64_tr_b16 a[74:75], v11 offset:25152
  ds_read_b64_tr_b16 a[76:77], v11 offset:24648
  ds_read_b64_tr_b16 a[78:79], v11 offset:25160
  s_waitcnt lgkmcnt(0)
  s_add_u32 m0, s26, 0x6000
  s_mov_b32 s27, 0x3c0000
  buffer_load_dwordx4 v10, s[8:11], s27 offen  lds
  s_add_u32 m0, s26, 0x6400
  s_mov_b32 s27, 0x3d0000
  buffer_load_dwordx4 v10, s[8:11], s27 offen  lds
  s_add_u32 m0, s26, 0x6800
  s_mov_b32 s27, 0x3e0000
  buffer_load_dwordx4 v10, s[8:11], s27 offen  lds
  s_add_u32 m0, s26, 0x6c00
  s_mov_b32 s27, 0x3f0000
  buffer_load_dwordx4 v10, s[8:11], s27 offen  lds
  s_waitcnt vmcnt(32)
  ds_read_b64_tr_b16 a[80:81], v11 offset:28672
  ds_read_b64_tr_b16 a[82:83], v11 offset:29184
  ds_read_b64_tr_b16 a[84:85], v11 offset:28680
  ds_read_b64_tr_b16 a[86:87], v11 offset:29192
  ds_read_b64_tr_b16 a[88:89], v11 offset:28736
  ds_read_b64_tr_b16 a[90:91], v11 offset:29248
  ds_read_b64_tr_b16 a[92:93], v11 offset:28744
  ds_read_b64_tr_b16 a[94:95], v11 offset:29256
  s_waitcnt lgkmcnt(0)
  s_add_u32 m0, s26, 0x7000
  s_mov_b32 s27, 0x400000
  buffer_load_dwordx4 v10, s[8:11], s27 offen  lds
  s_add_u32 m0, s26, 0x7400
  s_mov_b32 s27, 0x410000
  buffer_load_dwordx4 v10, s[8:11], s27 offen  lds
  s_add_u32 m0, s26, 0x7800
  s_mov_b32 s27, 0x420000
  buffer_load_dwordx4 v10, s[8:11], s27 offen  lds
  s_add_u32 m0, s26, 0x7c00
  s_mov_b32 s27, 0x430000
  buffer_load_dwordx4 v10, s[8:11], s27 offen  lds
  s_waitcnt vmcnt(32)
  ds_read_b64_tr_b16 a[96:97], v11 offset:32768
  ds_read_b64_tr_b16 a[98:99], v11 offset:33280
  ds_read_b64_tr_b16 a[100:101], v11 offset:32776
  ds_read_b64_tr_b16 a[102:103], v11 offset:33288
  ds_read_b64_tr_b16 a[104:105], v11 offset:32832
  ds_read_b64_tr_b16 a[106:107], v11 offset:33344
  ds_read_b64_tr_b16 a[108:109], v11 offset:32840
  ds_read_b64_tr_b16 a[110:111], v11 offset:33352
  s_waitcnt lgkmcnt(0)
  s_add_u32 m0, s26, 0x8000
  s_mov_b32 s27, 0x440000
  buffer_load_dwordx4 v10, s[8:11], s27 offen  lds
  s_add_u32 m0, s26, 0x8400
  s_mov_b32 s27, 0x450000
  buffer_load_dwordx4 v10, s[8:11], s27 offen  lds
  s_add_u32 m0, s26, 0x8800
  s_mov_b32 s27, 0x460000
  buffer_load_dwordx4 v10, s[8:11], s27 offen  lds
  s_add_u32 m0, s26, 0x8c00
  s_mov_b32 s27, 0x470000
  buffer_load_dwordx4 v10, s[8:11], s27 offen  lds
  s_waitcnt vmcnt(32)
  ds_read_b64_tr_b16 a[112:113], v11 offset:0
  ds_read_b64_tr_b16 a[114:115], v11 offset:512
  ds_read_b64_tr_b16 a[116:117], v11 offset:8
  ds_read_b64_tr_b16 a[118:119], v11 offset:520
  ds_read_b64_tr_b16 a[120:121], v11 offset:64
  ds_read_b64_tr_b16 a[122:123], v11 offset:576
  ds_read_b64_tr_b16 a[124:125], v11 offset:72
  ds_read_b64_tr_b16 a[126:127], v11 offset:584
  s_waitcnt vmcnt(28)
  ds_read_b64_tr_b16 a[128:129], v11 offset:4096
  ds_read_b64_tr_b16 a[130:131], v11 offset:4608
  ds_read_b64_tr_b16 a[132:133], v11 offset:4104
  ds_read_b64_tr_b16 a[134:135], v11 offset:4616
  ds_read_b64_tr_b16 a[136:137], v11 offset:4160
  ds_read_b64_tr_b16 a[138:139], v11 offset:4672
  ds_read_b64_tr_b16 a[140:141], v11 offset:4168
  ds_read_b64_tr_b16 a[142:143], v11 offset:4680
  s_waitcnt vmcnt(24)
  ds_read_b64_tr_b16 a[144:145], v11 offset:8192
  ds_read_b64_tr_b16 a[146:147], v11 offset:8704
  ds_read_b64_tr_b16 a[148:149], v11 offset:8200
  ds_read_b64_tr_b16 a[150:151], v11 offset:8712
  ds_read_b64_tr_b16 a[152:153], v11 offset:8256
  ds_read_b64_tr_b16 a[154:155], v11 offset:8768
  ds_read_b64_tr_b16 a[156:157], v11 offset:8264
  ds_read_b64_tr_b16 a[158:159], v11 offset:8776
  s_waitcnt vmcnt(20)
  ds_read_b64_tr_b16 a[160:161], v11 offset:12288
  ds_read_b64_tr_b16 a[162:163], v11 offset:12800
  ds_read_b64_tr_b16 a[164:165], v11 offset:12296
  ds_read_b64_tr_b16 a[166:167], v11 offset:12808
  ds_read_b64_tr_b16 a[168:169], v11 offset:12352
  ds_read_b64_tr_b16 a[170:171], v11 offset:12864
  ds_read_b64_tr_b16 a[172:173], v11 offset:12360
  ds_read_b64_tr_b16 a[174:175], v11 offset:12872
  s_waitcnt vmcnt(16)
  ds_read_b64_tr_b16 a[176:177], v11 offset:16384
  ds_read_b64_tr_b16 a[178:179], v11 offset:16896
  ds_read_b64_tr_b16 a[180:181], v11 offset:16392
  ds_read_b64_tr_b16 a[182:183], v11 offset:16904
  ds_read_b64_tr_b16 a[184:185], v11 offset:16448
  ds_read_b64_tr_b16 a[186:187], v11 offset:16960
  ds_read_b64_tr_b16 a[188:189], v11 offset:16456
  ds_read_b64_tr_b16 a[190:191], v11 offset:16968
  s_waitcnt vmcnt(12)
  ds_read_b64_tr_b16 a[192:193], v11 offset:20480
  ds_read_b64_tr_b16 a[194:195], v11 offset:20992
  ds_read_b64_tr_b16 a[196:197], v11 offset:20488
  ds_read_b64_tr_b16 a[198:199], v11 offset:21000
  ds_read_b64_tr_b16 a[200:201], v11 offset:20544
  ds_read_b64_tr_b16 a[202:203], v11 offset:21056
  ds_read_b64_tr_b16 a[204:205], v11 offset:20552
  ds_read_b64_tr_b16 a[206:207], v11 offset:21064
  s_waitcnt vmcnt(8)
  ds_read_b64_tr_b16 a[208:209], v11 offset:24576
  ds_read_b64_tr_b16 a[210:211], v11 offset:25088
  ds_read_b64_tr_b16 a[212:213], v11 offset:24584
  ds_read_b64_tr_b16 a[214:215], v11 offset:25096
  ds_read_b64_tr_b16 a[216:217], v11 offset:24640
  ds_read_b64_tr_b16 a[218:219], v11 offset:25152
  ds_read_b64_tr_b16 a[220:221], v11 offset:24648
  ds_read_b64_tr_b16 a[222:223], v11 offset:25160
  s_waitcnt vmcnt(4)
  ds_read_b64_tr_b16 a[224:225], v11 offset:28672
  ds_read_b64_tr_b16 a[226:227], v11 offset:29184
  ds_read_b64_tr_b16 a[228:229], v11 offset:28680
  ds_read_b64_tr_b16 a[230:231], v11 offset:29192
  ds_read_b64_tr_b16 a[232:233], v11 offset:28736
  ds_read_b64_tr_b16 a[234:235], v11 offset:29248
  ds_read_b64_tr_b16 a[236:237], v11 offset:28744
  ds_read_b64_tr_b16 a[238:239], v11 offset:29256
  s_waitcnt vmcnt(0)
  ds_read_b64_tr_b16 a[240:241], v11 offset:32768
  ds_read_b64_tr_b16 a[242:243], v11 offset:33280
  ds_read_b64_tr_b16 a[244:245], v11 offset:32776
  ds_read_b64_tr_b16 a[246:247], v11 offset:33288
  ds_read_b64_tr_b16 a[248:249], v11 offset:32832
  ds_read_b64_tr_b16 a[250:251], v11 offset:33344
  ds_read_b64_tr_b16 a[252:253], v11 offset:32840
  ds_read_b64_tr_b16 a[254:255], v11 offset:33352
  s_waitcnt lgkmcnt(0)
  s_mov_b32 s28, 0
L_reg_3:
  v_mov_b32 v8, 0
  buffer_load_dword v9, v8, s[20:23], 0 offen offset:64 sc1
  s_add_u32 s28, s28, 1
  s_cmp_gt_u32 s28, 1048576
  s_cbranch_scc1 L_fail
  s_waitcnt vmcnt(0)
  v_readfirstlane_b32 s67, v9
L_regc_4:
  s_and_b32 s26, s67, 0xffff
  s_cmp_lt_u32 s26, 256
  s_cbranch_scc1 L_reg_3
  s_lshr_b32 s67, s67, 16
  s_barrier
  v_or_b32 v2, 0x10000, v0
  s_mul_i32 s27, s25, 9216
  v_add_u32 v3, s27, v0
  v_mov_b32 v4, v3
  v_and_b32 v7, 1, v1
  v_lshlrev_b32 v7, 2, v7
  s_lshr_b32 s27, s25, 1
  s_lshl_b32 s28, s51, 1
  s_add_u32 s27, s27, s28
  s_lshl_b32 s27, s27, 13
  s_and_b32 s28, s25, 1
  s_lshl_b32 s28, s28, 11
  s_add_u32 s27, s27, s28
  v_add_u32 v9, s27, v0
  s_add_u32 s52, s50, 1
  s_lshl_b32 s52, s52, 24
  s_lshl_b32 s27, s51, 9
  s_lshl_b32 s28, s50, 6
  s_add_u32 s27, s27, s28
  s_lshl_b32 s28, s25, 4
  s_add_u32 s27, s27, s28
  s_add_u32 s53, s27, 0x80000
  s_lshl_b32 s27, s51, 2
  s_add_u32 s27, s27, s25
  s_lshl_b32 s27, s27, 11
  s_add_u32 s55, s27, 0x4000000
  s_cmp_eq_u32 s50, 1
  s_cselect_b32 s55, s55, 0x40000000
  v_mov_b32 v128, -1
  v_mov_b32 v129, -1
  v_mov_b32 v130, -1
  v_mov_b32 v131, -1
  v_mov_b32 v6, 1
  v_mov_b32 v5, 0x40000000
  v_cmp_eq_u32 vcc, 0, v0
  s_nop 1
  v_cndmask_b32 v5, v5, 0, vcc
  s_mov_b32 s43, 0x40000000
  s_mov_b32 s37, s36
  s_lshl_b32 s44, s37, 3
  s_mov_b32 s49, 0
L_poll_5:
  buffer_load_dword v8, v7, s[4:7], s44 offen sc1
  s_waitcnt vmcnt(0)
  v_cmp_eq_u32 vcc, 0, v8
  s_cbranch_vccz L_polld_6
  s_add_u32 s49, s49, 1
  s_cmp_lt_u32 s49, 1048576
  s_cbranch_scc1 L_poll_5
  s_branch L_fail
L_polld_6:
  s_mul_i32 s38, s37, 36864
  s_add_u32 s38, s38, 0x200000
  s_add_u32 s39, s38, 4096
  s_add_u32 s40, s38, 8192
  s_add_u32 s26, s37, 3
  s_min_u32 s26, s26, 63
  s_lshl_b32 s44, s26, 3
  buffer_load_dword v8, v7, s[4:7], s44 offen sc1
  buffer_load_dwordx4 v[76:79], v4, s[4:7], s38 offen offset:0 sc1
  buffer_load_dwordx4 v[80:83], v4, s[4:7], s38 offen offset:1024 sc1
  buffer_load_dwordx4 v[84:87], v4, s[4:7], s38 offen offset:2048 sc1
  buffer_load_dwordx4 v[88:91], v4, s[4:7], s38 offen offset:3072 sc1
  buffer_load_dwordx4 v[92:95], v4, s[4:7], s39 offen offset:0 sc1
  buffer_load_dwordx4 v[96:99], v4, s[4:7], s39 offen offset:1024 sc1
  buffer_load_dwordx4 v[100:103], v4, s[4:7], s39 offen offset:2048 sc1
  buffer_load_dwordx4 v[104:107], v4, s[4:7], s39 offen offset:3072 sc1
  buffer_load_dwordx4 v[108:111], v4, s[4:7], s40 offen offset:0 sc1
  s_waitcnt vmcnt(8)
  ds_write_b128 v3, v[76:79] offset:0
  s_waitcnt vmcnt(7)
  ds_write_b128 v3, v[80:83] offset:1024
  s_waitcnt vmcnt(6)
  ds_write_b128 v3, v[84:87] offset:2048
  s_waitcnt vmcnt(5)
  ds_write_b128 v3, v[88:91] offset:3072
  s_waitcnt vmcnt(4)
  ds_write_b128 v3, v[92:95] offset:4096
  s_waitcnt vmcnt(3)
  ds_write_b128 v3, v[96:99] offset:5120
  s_waitcnt vmcnt(2)
  ds_write_b128 v3, v[100:103] offset:6144
  s_waitcnt vmcnt(1)
  ds_write_b128 v3, v[104:107] offset:7168
  s_waitcnt vmcnt(0)
  ds_write_b128 v3, v[108:111] offset:8192
  s_waitcnt lgkmcnt(0)
  s_barrier
  v_xor_b32 v2, 0x10000, v2
  v_xor_b32 v3, 0x10000, v3
L_qk_top:
  s_lshl_b32 s45, s36, 18
  s_add_u32 s45, s45, s52
  s_add_u32 s46, s45, 4096
  s_lshl_b32 s42, s36, 13
  s_add_u32 s42, s42, s53
  s_lshl_b32 s54, s36, 17
  s_add_u32 s54, s54, s55
  s_cmp_ge_u32 s36, 24
  s_cselect_b32 s54, s54, 0x40000000
  s_add_u32 s37, s36, 3
  s_cmp_ge_u32 s37, 64
  s_cbranch_scc1 L_qk_nopf
  s_waitcnt vmcnt(6)
  v_cmp_eq_u32 vcc, 0, v8
  s_cbranch_vccnz L_qk_nopf
  s_mul_i32 s38, s37, 36864
  s_add_u32 s38, s38, 0x200000
  s_add_u32 s39, s38, 4096
  s_add_u32 s40, s38, 8192
  ds_read_b128 v[44:47], v2 offset:0
  ds_read_b128 v[48:51], v2 offset:18432
  ds_read_b128 v[52:55], v2 offset:1024
  ds_read_b128 v[56:59], v2 offset:19456
  ds_read_b128 v[60:63], v2 offset:2048
  ds_read_b128 v[64:67], v2 offset:20480
  s_waitcnt lgkmcnt(5)
  v_mfma_f32_16x16x32_bf16 v[12:15], v[224:227], v[44:47], 0
  ds_read_b128 v[68:71], v2 offset:3072
  v_mfma_f32_16x16x32_bf16 v[16:19], v[228:231], v[44:47], 0
  ds_read_b128 v[72:75], v2 offset:21504
  v_mfma_f32_16x16x32_bf16 v[20:23], v[232:235], v[44:47], 0
  buffer_load_dwordx4 v[76:79], v4, s[4:7], s38 offen offset:0 sc1
  v_mfma_f32_16x16x32_bf16 v[24:27], v[236:239], v[44:47], 0
  s_waitcnt lgkmcnt(6)
  v_mfma_f32_16x16x32_bf16 v[28:31], v[224:227], v[48:51], 0
  v_mfma_f32_16x16x32_bf16 v[32:35], v[228:231], v[48:51], 0
  v_mfma_f32_16x16x32_bf16 v[36:39], v[232:235], v[48:51], 0
  v_mfma_f32_16x16x32_bf16 v[40:43], v[236:239], v[48:51], 0
  s_waitcnt lgkmcnt(5)
  v_mfma_f32_16x16x32_bf16 v[12:15], v[240:243], v[52:55], v[12:15]
  ds_read_b128 v[44:47], v2 offset:4096
  buffer_load_dwordx4 v[80:83], v4, s[4:7], s38 offen offset:1024 sc1
  v_mfma_f32_16x16x32_bf16 v[16:19], v[244:247], v[52:55], v[16:19]
  ds_read_b128 v[48:51], v2 offset:22528
  v_mfma_f32_16x16x32_bf16 v[20:23], v[248:251], v[52:55], v[20:23]
  v_mfma_f32_16x16x32_bf16 v[24:27], v[252:255], v[52:55], v[24:27]
  s_waitcnt lgkmcnt(6)
  v_mfma_f32_16x16x32_bf16 v[28:31], v[240:243], v[56:59], v[28:31]
  v_mfma_f32_16x16x32_bf16 v[32:35], v[244:247], v[56:59], v[32:35]
  v_mfma_f32_16x16x32_bf16 v[36:39], v[248:251], v[56:59], v[36:39]
  buffer_load_dwordx4 v[84:87], v4, s[4:7], s38 offen offset:2048 sc1
  v_mfma_f32_16x16x32_bf16 v[40:43], v[252:255], v[56:59], v[40:43]
  s_waitcnt lgkmcnt(5)
  v_mfma_f32_16x16x32_bf16 v[12:15], a[0:3], v[60:63], v[12:15]
  ds_read_b128 v[52:55], v2 offset:5120
  v_mfma_f32_16x16x32_bf16 v[16:19], a[4:7], v[60:63], v[16:19]
  ds_read_b128 v[56:59], v2 offset:23552
  v_mfma_f32_16x16x32_bf16 v[20:23], a[8:11], v[60:63], v[20:23]
  v_mfma_f32_16x16x32_bf16 v[24:27], a[12:15], v[60:63], v[24:27]
  s_waitcnt lgkmcnt(6)
  v_mfma_f32_16x16x32_bf16 v[28:31], a[0:3], v[64:67], v[28:31]
  buffer_load_dwordx4 v[88:91], v4, s[4:7], s38 offen offset:3072 sc1
  v_mfma_f32_16x16x32_bf16 v[32:35], a[4:7], v[64:67], v[32:35]
  v_mfma_f32_16x16x32_bf16 v[36:39], a[8:11], v[64:67], v[36:39]
  v_mfma_f32_16x16x32_bf16 v[40:43], a[12:15], v[64:67], v[40:43]
  s_waitcnt lgkmcnt(5)
  v_mfma_f32_16x16x32_bf16 v[12:15], a[16:19], v[68:71], v[12:15]
  ds_read_b128 v[60:63], v2 offset:6144
  v_mfma_f32_16x16x32_bf16 v[16:19], a[20:23], v[68:71], v[16:19]
  ds_read_b128 v[64:67], v2 offset:24576
  v_mfma_f32_16x16x32_bf16 v[20:23], a[24:27], v[68:71], v[20:23]
  buffer_load_dwordx4 v[92:95], v4, s[4:7], s39 offen offset:0 sc1
  v_mfma_f32_16x16x32_bf16 v[24:27], a[28:31], v[68:71], v[24:27]
  s_waitcnt lgkmcnt(6)
  v_mfma_f32_16x16x32_bf16 v[28:31], a[16:19], v[72:75], v[28:31]
  v_mfma_f32_16x16x32_bf16 v[32:35], a[20:23], v[72:75], v[32:35]
  v_mfma_f32_16x16x32_bf16 v[36:39], a[24:27], v[72:75], v[36:39]
  v_mfma_f32_16x16x32_bf16 v[40:43], a[28:31], v[72:75], v[40:43]
  s_waitcnt lgkmcnt(5)
  v_mfma_f32_16x16x32_bf16 v[12:15], a[32:35], v[44:47], v[12:15]
  ds_read_b128 v[68:71], v2 offset:7168
  buffer_load_dwordx4 v[96:99], v4, s[4:7], s39 offen offset:1024 sc1
  v_mfma_f32_16x16x32_bf16 v[16:19], a[36:39], v[44:47], v[16:19]
  ds_read_b128 v[72:75], v2 offset:25600
  v_mfma_f32_16x16x32_bf16 v[20:23], a[40:43], v[44:47], v[20:23]
  v_mfma_f32_16x16x32_bf16 v[24:27], a[44:47], v[44:47], v[24:27]
  s_waitcnt lgkmcnt(6)
  v_mfma_f32_16x16x32_bf16 v[28:31], a[32:35], v[48:51], v[28:31]
  v_mfma_f32_16x16x32_bf16 v[32:35], a[36:39], v[48:51], v[32:35]
  v_mfma_f32_16x16x32_bf16 v[36:39], a[40:43], v[48:51], v[36:39]
  buffer_load_dwordx4 v[100:103], v4, s[4:7], s39 offen offset:2048 sc1
  v_mfma_f32_16x16x32_bf16 v[40:43], a[44:47], v[48:51], v[40:43]
  s_waitcnt lgkmcnt(5)
  v_mfma_f32_16x16x32_bf16 v[12:15], a[48:51], v[52:55], v[12:15]
  ds_read_b128 v[44:47], v2 offset:8192
  v_mfma_f32_16x16x32_bf16 v[16:19], a[52:55], v[52:55], v[16:19]
  ds_read_b128 v[48:51], v2 offset:26624
  v_mfma_f32_16x16x32_bf16 v[20:23], a[56:59], v[52:55], v[20:23]
  v_mfma_f32_16x16x32_bf16 v[24:27], a[60:63], v[52:55], v[24:27]
  s_waitcnt lgkmcnt(6)
  v_mfma_f32_16x16x32_bf16 v[28:31], a[48:51], v[56:59], v[28:31]
  buffer_load_dwordx4 v[104:107], v4, s[4:7], s39 offen offset:3072 sc1
  v_mfma_f32_16x16x32_bf16 v[32:35], a[52:55], v[56:59], v[32:35]
  v_mfma_f32_16x16x32_bf16 v[36:39], a[56:59], v[56:59], v[36:39]
  v_mfma_f32_16x16x32_bf16 v[40:43], a[60:63], v[56:59], v[40:43]
  s_waitcnt lgkmcnt(5)
  v_mfma_f32_16x16x32_bf16 v[12:15], a[64:67], v[60:63], v[12:15]
  ds_read_b128 v[52:55], v2 offset:9216
  v_mfma_f32_16x16x32_bf16 v[16:19], a[68:71], v[60:63], v[16:19]
  ds_read_b128 v[56:59], v2 offset:27648
  v_mfma_f32_16x16x32_bf16 v[20:23], a[72:75], v[60:63], v[20:23]
  buffer_load_dwordx4 v[108:111], v4, s[4:7], s40 offen offset:0 sc1
  v_mfma_f32_16x16x32_bf16 v[24:27], a[76:79], v[60:63], v[24:27]
  s_waitcnt lgkmcnt(6)
  v_mfma_f32_16x16x32_bf16 v[28:31], a[64:67], v[64:67], v[28:31]
  v_mfma_f32_16x16x32_bf16 v[32:35], a[68:71], v[64:67], v[32:35]
  v_mfma_f32_16x16x32_bf16 v[36:39], a[72:75], v[64:67], v[36:39]
  v_mfma_f32_16x16x32_bf16 v[40:43], a[76:79], v[64:67], v[40:43]
  s_waitcnt lgkmcnt(5)
  v_mfma_f32_16x16x32_bf16 v[12:15], a[80:83], v[68:71], v[12:15]
  ds_read_b128 v[60:63], v2 offset:10240
  v_mfma_f32_16x16x32_bf16 v[16:19], a[84:87], v[68:71], v[16:19]
  ds_read_b128 v[64:67], v2 offset:28672
  v_mfma_f32_16x16x32_bf16 v[20:23], a[88:91], v[68:71], v[20:23]
  v_mfma_f32_16x16x32_bf16 v[24:27], a[92:95], v[68:71], v[24:27]
  s_waitcnt lgkmcnt(6)
  v_mfma_f32_16x16x32_bf16 v[28:31], a[80:83], v[72:75], v[28:31]
  s_waitcnt vmcnt(9)
  buffer_store_dword v6, v5, s[4:7], s43 offen sc1
  s_add_u32 s26, s37, 3
  s_min_u32 s26, s26, 63
  s_lshl_b32 s44, s26, 3
  buffer_load_dword v8, v7, s[4:7], s44 offen sc1
  v_mfma_f32_16x16x32_bf16 v[32:35], a[84:87], v[72:75], v[32:35]
  v_mfma_f32_16x16x32_bf16 v[36:39], a[88:91], v[72:75], v[36:39]
  v_mfma_f32_16x16x32_bf16 v[40:43], a[92:95], v[72:75], v[40:43]
  s_waitcnt lgkmcnt(5)
  v_mfma_f32_16x16x32_bf16 v[12:15], a[96:99], v[44:47], v[12:15]
  ds_read_b128 v[68:71], v2 offset:11264
  v_mfma_f32_16x16x32_bf16 v[16:19], a[100:103], v[44:47], v[16:19]
  ds_read_b128 v[72:75], v2 offset:29696
  v_mfma_f32_16x16x32_bf16 v[20:23], a[104:107], v[44:47], v[20:23]
  v_mfma_f32_16x16x32_bf16 v[24:27], a[108:111], v[44:47], v[24:27]
  s_waitcnt lgkmcnt(6)
  v_mfma_f32_16x16x32_bf16 v[28:31], a[96:99], v[48:51], v[28:31]
  v_mfma_f32_16x16x32_bf16 v[32:35], a[100:103], v[48:51], v[32:35]
  v_mfma_f32_16x16x32_bf16 v[36:39], a[104:107], v[48:51], v[36:39]
  v_mfma_f32_16x16x32_bf16 v[40:43], a[108:111], v[48:51], v[40:43]
  s_waitcnt lgkmcnt(5)
  v_mfma_f32_16x16x32_bf16 v[12:15], a[112:115], v[52:55], v[12:15]
  ds_read_b128 v[44:47], v2 offset:12288
  v_mfma_f32_16x16x32_bf16 v[16:19], a[116:119], v[52:55], v[16:19]
  ds_read_b128 v[48:51], v2 offset:30720
  v_mfma_f32_16x16x32_bf16 v[20:23], a[120:123], v[52:55], v[20:23]
  v_mfma_f32_16x16x32_bf16 v[24:27], a[124:127], v[52:55], v[24:27]
  s_waitcnt lgkmcnt(6)
  v_mfma_f32_16x16x32_bf16 v[28:31], a[112:115], v[56:59], v[28:31]
  v_mfma_f32_16x16x32_bf16 v[32:35], a[116:119], v[56:59], v[32:35]
  v_mfma_f32_16x16x32_bf16 v[36:39], a[120:123], v[56:59], v[36:39]
  v_mfma_f32_16x16x32_bf16 v[40:43], a[124:127], v[56:59], v[40:43]
  s_waitcnt lgkmcnt(5)
  v_mfma_f32_16x16x32_bf16 v[12:15], a[128:131], v[60:63], v[12:15]
  ds_read_b128 v[52:55], v2 offset:13312
  v_mfma_f32_16x16x32_bf16 v[16:19], a[132:135], v[60:63], v[16:19]
  ds_read_b128 v[56:59], v2 offset:31744
  v_mfma_f32_16x16x32_bf16 v[20:23], a[136:139], v[60:63], v[20:23]
  v_mfma_f32_16x16x32_bf16 v[24:27], a[140:143], v[60:63], v[24:27]
  s_waitcnt lgkmcnt(6)
  v_mfma_f32_16x16x32_bf16 v[28:31], a[128:131], v[64:67], v[28:31]
  v_mfma_f32_16x16x32_bf16 v[32:35], a[132:135], v[64:67], v[32:35]
  v_mfma_f32_16x16x32_bf16 v[36:39], a[136:139], v[64:67], v[36:39]
  v_mfma_f32_16x16x32_bf16 v[40:43], a[140:143], v[64:67], v[40:43]
  s_waitcnt lgkmcnt(5)
  v_mfma_f32_16x16x32_bf16 v[12:15], a[144:147], v[68:71], v[12:15]
  ds_read_b128 v[60:63], v2 offset:14336
  v_mfma_f32_16x16x32_bf16 v[16:19], a[148:151], v[68:71], v[16:19]
  ds_read_b128 v[64:67], v2 offset:32768
  v_mfma_f32_16x16x32_bf16 v[20:23], a[152:155], v[68:71], v[20:23]
  v_mfma_f32_16x16x32_bf16 v[24:27], a[156:159], v[68:71], v[24:27]
  s_waitcnt lgkmcnt(6)
  v_mfma_f32_16x16x32_bf16 v[28:31], a[144:147], v[72:75], v[28:31]
  v_mfma_f32_16x16x32_bf16 v[32:35], a[148:151], v[72:75], v[32:35]
  v_mfma_f32_16x16x32_bf16 v[36:39], a[152:155], v[72:75], v[36:39]
  v_mfma_f32_16x16x32_bf16 v[40:43], a[156:159], v[72:75], v[40:43]
  s_waitcnt lgkmcnt(5)
  v_mfma_f32_16x16x32_bf16 v[12:15], a[160:163], v[44:47], v[12:15]
  ds_read_b128 v[68:71], v2 offset:15360
  v_mfma_f32_16x16x32_bf16 v[16:19], a[164:167], v[44:47], v[16:19]
  ds_read_b128 v[72:75], v2 offset:33792
  v_mfma_f32_16x16x32_bf16 v[20:23], a[168:171], v[44:47], v[20:23]
  v_mfma_f32_16x16x32_bf16 v[24:27], a[172:175], v[44:47], v[24:27]
  s_waitcnt lgkmcnt(6)
  v_mfma_f32_16x16x32_bf16 v[28:31], a[160:163], v[48:51], v[28:31]
  v_mfma_f32_16x16x32_bf16 v[32:35], a[164:167], v[48:51], v[32:35]
  v_mfma_f32_16x16x32_bf16 v[36:39], a[168:171], v[48:51], v[36:39]
  v_mfma_f32_16x16x32_bf16 v[40:43], a[172:175], v[48:51], v[40:43]
  s_waitcnt lgkmcnt(5)
  v_mfma_f32_16x16x32_bf16 v[12:15], a[176:179], v[52:55], v[12:15]
  ds_read_b128 v[44:47], v2 offset:16384
  v_mfma_f32_16x16x32_bf16 v[16:19], a[180:183], v[52:55], v[16:19]
  ds_read_b128 v[48:51], v2 offset:34816
  v_mfma_f32_16x16x32_bf16 v[20:23], a[184:187], v[52:55], v[20:23]
  v_mfma_f32_16x16x32_bf16 v[24:27], a[188:191], v[52:55], v[24:27]
  s_waitcnt lgkmcnt(6)
  v_mfma_f32_16x16x32_bf16 v[28:31], a[176:179], v[56:59], v[28:31]
  v_mfma_f32_16x16x32_bf16 v[32:35], a[180:183], v[56:59], v[32:35]
  v_mfma_f32_16x16x32_bf16 v[36:39], a[184:187], v[56:59], v[36:39]
  v_mfma_f32_16x16x32_bf16 v[40:43], a[188:191], v[56:59], v[40:43]
  s_waitcnt lgkmcnt(5)
  v_mfma_f32_16x16x32_bf16 v[12:15], a[192:195], v[60:63], v[12:15]
  ds_read_b128 v[52:55], v2 offset:17408
  s_waitcnt vmcnt(10)
  ds_write_b128 v3, v[76:79] offset:0
  v_mfma_f32_16x16x32_bf16 v[16:19], a[196:199], v[60:63], v[16:19]
  ds_read_b128 v[56:59], v2 offset:35840
  v_mfma_f32_16x16x32_bf16 v[20:23], a[200:203], v[60:63], v[20:23]
  s_waitcnt vmcnt(9)
  ds_write_b128 v3, v[80:83] offset:1024
  v_mfma_f32_16x16x32_bf16 v[24:27], a[204:207], v[60:63], v[24:27]
  s_waitcnt lgkmcnt(8)
  v_mfma_f32_16x16x32_bf16 v[28:31], a[192:195], v[64:67], v[28:31]
  s_waitcnt vmcnt(8)
  ds_write_b128 v3, v[84:87] offset:2048
  v_mfma_f32_16x16x32_bf16 v[32:35], a[196:199], v[64:67], v[32:35]
  v_mfma_f32_16x16x32_bf16 v[36:39], a[200:203], v[64:67], v[36:39]
  s_waitcnt vmcnt(7)
  ds_write_b128 v3, v[88:91] offset:3072
  v_mfma_f32_16x16x32_bf16 v[40:43], a[204:207], v[64:67], v[40:43]
  s_waitcnt lgkmcnt(9)
  v_mfma_f32_16x16x32_bf16 v[12:15], a[208:211], v[68:71], v[12:15]
  s_waitcnt vmcnt(6)
  ds_write_b128 v3, v[92:95] offset:4096
  v_mfma_f32_16x16x32_bf16 v[16:19], a[212:215], v[68:71], v[16:19]
  v_mfma_f32_16x16x32_bf16 v[20:23], a[216:219], v[68:71], v[20:23]
  s_waitcnt vmcnt(5)
  ds_write_b128 v3, v[96:99] offset:5120
  v_mfma_f32_16x16x32_bf16 v[24:27], a[220:223], v[68:71], v[24:27]
  s_waitcnt lgkmcnt(10)
  v_mfma_f32_16x16x32_bf16 v[28:31], a[208:211], v[72:75], v[28:31]
  s_waitcnt vmcnt(4)
  ds_write_b128 v3, v[100:103] offset:6144
  v_mfma_f32_16x16x32_bf16 v[32:35], a[212:215], v[72:75], v[32:35]
  v_mfma_f32_16x16x32_bf16 v[36:39], a[216:219], v[72:75], v[36:39]
  s_waitcnt vmcnt(3)
  ds_write_b128 v3, v[104:107] offset:7168
  v_mfma_f32_16x16x32_bf16 v[40:43], a[220:223], v[72:75], v[40:43]
  s_waitcnt lgkmcnt(11)
  v_mfma_f32_16x16x32_bf16 v[12:15], a[224:227], v[44:47], v[12:15]
  s_waitcnt vmcnt(2)
  ds_write_b128 v3, v[108:111] offset:8192
  v_mfma_f32_16x16x32_bf16 v[16:19], a[228:231], v[44:47], v[16:19]
  v_mfma_f32_16x16x32_bf16 v[20:23], a[232:235], v[44:47], v[20:23]
  v_mfma_f32_16x16x32_bf16 v[24:27], a[236:239], v[44:47], v[24:27]
  s_waitcnt lgkmcnt(11)
  v_mfma_f32_16x16x32_bf16 v[28:31], a[224:227], v[48:51], v[28:31]
  v_mfma_f32_16x16x32_bf16 v[32:35], a[228:231], v[48:51], v[32:35]
  v_mfma_f32_16x16x32_bf16 v[36:39], a[232:235], v[48:51], v[36:39]
  v_mfma_f32_16x16x32_bf16 v[40:43], a[236:239], v[48:51], v[40:43]
  s_waitcnt lgkmcnt(10)
  v_mfma_f32_16x16x32_bf16 v[12:15], a[240:243], v[52:55], v[12:15]
  v_mfma_f32_16x16x32_bf16 v[16:19], a[244:247], v[52:55], v[16:19]
  v_mfma_f32_16x16x32_bf16 v[20:23], a[248:251], v[52:55], v[20:23]
  v_mfma_f32_16x16x32_bf16 v[24:27], a[252:255], v[52:55], v[24:27]
  s_waitcnt lgkmcnt(8)
  v_mfma_f32_16x16x32_bf16 v[28:31], a[240:243], v[56:59], v[28:31]
  v_mfma_f32_16x16x32_bf16 v[32:35], a[244:247], v[56:59], v[32:35]
  v_mfma_f32_16x16x32_bf16 v[36:39], a[248:251], v[56:59], v[36:39]
  v_mfma_f32_16x16x32_bf16 v[40:43], a[252:255], v[56:59], v[40:43]
  v_cvt_pk_bf16_f32 v112, v12, v13
  v_cvt_pk_bf16_f32 v113, v14, v15
  v_cvt_pk_bf16_f32 v114, v16, v17
  v_cvt_pk_bf16_f32 v115, v18, v19
  buffer_store_dwordx4 v[112:115], v9, s[4:7], s45 offen offset:0 sc1
  v_cvt_pk_bf16_f32 v116, v20, v21
  v_cvt_pk_bf16_f32 v117, v22, v23
  v_cvt_pk_bf16_f32 v118, v24, v25
  v_cvt_pk_bf16_f32 v119, v26, v27
  buffer_store_dwordx4 v[116:119], v9, s[4:7], s45 offen offset:1024 sc1
  v_cvt_pk_bf16_f32 v120, v28, v29
  v_cvt_pk_bf16_f32 v121, v30, v31
  v_cvt_pk_bf16_f32 v122, v32, v33
  v_cvt_pk_bf16_f32 v123, v34, v35
  buffer_store_dwordx4 v[120:123], v9, s[4:7], s46 offen offset:0 sc1
  v_cvt_pk_bf16_f32 v124, v36, v37
  v_cvt_pk_bf16_f32 v125, v38, v39
  v_cvt_pk_bf16_f32 v126, v40, v41
  v_cvt_pk_bf16_f32 v127, v42, v43
  buffer_store_dwordx4 v[124:127], v9, s[4:7], s46 offen offset:1024 sc1
  buffer_store_dwordx4 v[128:131], v0, s[4:7], s54 offen offset:0 sc1
  buffer_store_dwordx4 v[128:131], v0, s[4:7], s54 offen offset:1024 sc1
  s_mov_b32 s43, s42
  s_mov_b32 s36, s37
  s_waitcnt lgkmcnt(0)
  s_barrier
  v_xor_b32 v2, 0x10000, v2
  v_xor_b32 v3, 0x10000, v3
  s_branch L_qk_top
L_qk_nopf:
  ds_read_b128 v[44:47], v2 offset:0
  ds_read_b128 v[48:51], v2 offset:18432
  ds_read_b128 v[52:55], v2 offset:1024
  ds_read_b128 v[56:59], v2 offset:19456
  ds_read_b128 v[60:63], v2 offset:2048
  ds_read_b128 v[64:67], v2 offset:20480
  s_waitcnt lgkmcnt(5)
  v_mfma_f32_16x16x32_bf16 v[12:15], v[224:227], v[44:47], 0
  ds_read_b128 v[68:71], v2 offset:3072
  v_mfma_f32_16x16x32_bf16 v[16:19], v[228:231], v[44:47], 0
  ds_read_b128 v[72:75], v2 offset:21504
  v_mfma_f32_16x16x32_bf16 v[20:23], v[232:235], v[44:47], 0
  v_mfma_f32_16x16x32_bf16 v[24:27], v[236:239], v[44:47], 0
  s_waitcnt lgkmcnt(6)
  v_mfma_f32_16x16x32_bf16 v[28:31], v[224:227], v[48:51], 0
  v_mfma_f32_16x16x32_bf16 v[32:35], v[228:231], v[48:51], 0
  v_mfma_f32_16x16x32_bf16 v[36:39], v[232:235], v[48:51], 0
  v_mfma_f32_16x16x32_bf16 v[40:43], v[236:239], v[48:51], 0
  s_waitcnt lgkmcnt(5)
  v_mfma_f32_16x16x32_bf16 v[12:15], v[240:243], v[52:55], v[12:15]
  ds_read_b128 v[44:47], v2 offset:4096
  v_mfma_f32_16x16x32_bf16 v[16:19], v[244:247], v[52:55], v[16:19]
  ds_read_b128 v[48:51], v2 offset:22528
  v_mfma_f32_16x16x32_bf16 v[20:23], v[248:251], v[52:55], v[20:23]
  v_mfma_f32_16x16x32_bf16 v[24:27], v[252:255], v[52:55], v[24:27]
  s_waitcnt lgkmcnt(6)
  v_mfma_f32_16x16x32_bf16 v[28:31], v[240:243], v[56:59], v[28:31]
  v_mfma_f32_16x16x32_bf16 v[32:35], v[244:247], v[56:59], v[32:35]
  v_mfma_f32_16x16x32_bf16 v[36:39], v[248:251], v[56:59], v[36:39]
  v_mfma_f32_16x16x32_bf16 v[40:43], v[252:255], v[56:59], v[40:43]
  s_waitcnt lgkmcnt(5)
  v_mfma_f32_16x16x32_bf16 v[12:15], a[0:3], v[60:63], v[12:15]
  ds_read_b128 v[52:55], v2 offset:5120
  v_mfma_f32_16x16x32_bf16 v[16:19], a[4:7], v[60:63], v[16:19]
  ds_read_b128 v[56:59], v2 offset:23552
  v_mfma_f32_16x16x32_bf16 v[20:23], a[8:11], v[60:63], v[20:23]
  v_mfma_f32_16x16x32_bf16 v[24:27], a[12:15], v[60:63], v[24:27]
  s_waitcnt lgkmcnt(6)
  v_mfma_f32_16x16x32_bf16 v[28:31], a[0:3], v[64:67], v[28:31]
  v_mfma_f32_16x16x32_bf16 v[32:35], a[4:7], v[64:67], v[32:35]
  v_mfma_f32_16x16x32_bf16 v[36:39], a[8:11], v[64:67], v[36:39]
  v_mfma_f32_16x16x32_bf16 v[40:43], a[12:15], v[64:67], v[40:43]
  s_waitcnt lgkmcnt(5)
  v_mfma_f32_16x16x32_bf16 v[12:15], a[16:19], v[68:71], v[12:15]
  ds_read_b128 v[60:63], v2 offset:6144
  v_mfma_f32_16x16x32_bf16 v[16:19], a[20:23], v[68:71], v[16:19]
  ds_read_b128 v[64:67], v2 offset:24576
  v_mfma_f32_16x16x32_bf16 v[20:23], a[24:27], v[68:71], v[20:23]
  v_mfma_f32_16x16x32_bf16 v[24:27], a[28:31], v[68:71], v[24:27]
  s_waitcnt lgkmcnt(6)
  v_mfma_f32_16x16x32_bf16 v[28:31], a[16:19], v[72:75], v[28:31]
  v_mfma_f32_16x16x32_bf16 v[32:35], a[20:23], v[72:75], v[32:35]
  v_mfma_f32_16x16x32_bf16 v[36:39], a[24:27], v[72:75], v[36:39]
  v_mfma_f32_16x16x32_bf16 v[40:43], a[28:31], v[72:75], v[40:43]
  s_waitcnt lgkmcnt(5)
  v_mfma_f32_16x16x32_bf16 v[12:15], a[32:35], v[44:47], v[12:15]
  ds_read_b128 v[68:71], v2 offset:7168
  v_mfma_f32_16x16x32_bf16 v[16:19], a[36:39], v[44:47], v[16:19]
  ds_read_b128 v[72:75], v2 offset:25600
  v_mfma_f32_16x16x32_bf16 v[20:23], a[40:43], v[44:47], v[20:23]
  v_mfma_f32_16x16x32_bf16 v[24:27], a[44:47], v[44:47], v[24:27]
  s_waitcnt lgkmcnt(6)
  v_mfma_f32_16x16x32_bf16 v[28:31], a[32:35], v[48:51], v[28:31]
  v_mfma_f32_16x16x32_bf16 v[32:35], a[36:39], v[48:51], v[32:35]
  v_mfma_f32_16x16x32_bf16 v[36:39], a[40:43], v[48:51], v[36:39]
  v_mfma_f32_16x16x32_bf16 v[40:43], a[44:47], v[48:51], v[40:43]
  s_waitcnt lgkmcnt(5)
  v_mfma_f32_16x16x32_bf16 v[12:15], a[48:51], v[52:55], v[12:15]
  ds_read_b128 v[44:47], v2 offset:8192
  s_waitcnt vmcnt(0)
  buffer_store_dword v6, v5, s[4:7], s43 offen sc1
  v_mfma_f32_16x16x32_bf16 v[16:19], a[52:55], v[52:55], v[16:19]
  ds_read_b128 v[48:51], v2 offset:26624
  v_mfma_f32_16x16x32_bf16 v[20:23], a[56:59], v[52:55], v[20:23]
  v_mfma_f32_16x16x32_bf16 v[24:27], a[60:63], v[52:55], v[24:27]
  s_waitcnt lgkmcnt(6)
  v_mfma_f32_16x16x32_bf16 v[28:31], a[48:51], v[56:59], v[28:31]
  v_mfma_f32_16x16x32_bf16 v[32:35], a[52:55], v[56:59], v[32:35]
  v_mfma_f32_16x16x32_bf16 v[36:39], a[56:59], v[56:59], v[36:39]
  v_mfma_f32_16x16x32_bf16 v[40:43], a[60:63], v[56:59], v[40:43]
  s_waitcnt lgkmcnt(5)
  v_mfma_f32_16x16x32_bf16 v[12:15], a[64:67], v[60:63], v[12:15]
  ds_read_b128 v[52:55], v2 offset:9216
  v_mfma_f32_16x16x32_bf16 v[16:19], a[68:71], v[60:63], v[16:19]
  ds_read_b128 v[56:59], v2 offset:27648
  v_mfma_f32_16x16x32_bf16 v[20:23], a[72:75], v[60:63], v[20:23]
  v_mfma_f32_16x16x32_bf16 v[24:27], a[76:79], v[60:63], v[24:27]
  s_waitcnt lgkmcnt(6)
  v_mfma_f32_16x16x32_bf16 v[28:31], a[64:67], v[64:67], v[28:31]
  v_mfma_f32_16x16x32_bf16 v[32:35], a[68:71], v[64:67], v[32:35]
  v_mfma_f32_16x16x32_bf16 v[36:39], a[72:75], v[64:67], v[36:39]
  v_mfma_f32_16x16x32_bf16 v[40:43], a[76:79], v[64:67], v[40:43]
  s_waitcnt lgkmcnt(5)
  v_mfma_f32_16x16x32_bf16 v[12:15], a[80:83], v[68:71], v[12:15]
  ds_read_b128 v[60:63], v2 offset:10240
  v_mfma_f32_16x16x32_bf16 v[16:19], a[84:87], v[68:71], v[16:19]
  ds_read_b128 v[64:67], v2 offset:28672
  v_mfma_f32_16x16x32_bf16 v[20:23], a[88:91], v[68:71], v[20:23]
  v_mfma_f32_16x16x32_bf16 v[24:27], a[92:95], v[68:71], v[24:27]
  s_waitcnt lgkmcnt(6)
  v_mfma_f32_16x16x32_bf16 v[28:31], a[80:83], v[72:75], v[28:31]
  v_mfma_f32_16x16x32_bf16 v[32:35], a[84:87], v[72:75], v[32:35]
  v_mfma_f32_16x16x32_bf16 v[36:39], a[88:91], v[72:75], v[36:39]
  v_mfma_f32_16x16x32_bf16 v[40:43], a[92:95], v[72:75], v[40:43]
  s_waitcnt lgkmcnt(5)
  v_mfma_f32_16x16x32_bf16 v[12:15], a[96:99], v[44:47], v[12:15]
  ds_read_b128 v[68:71], v2 offset:11264
  v_mfma_f32_16x16x32_bf16 v[16:19], a[100:103], v[44:47], v[16:19]
  ds_read_b128 v[72:75], v2 offset:29696
  v_mfma_f32_16x16x32_bf16 v[20:23], a[104:107], v[44:47], v[20:23]
  v_mfma_f32_16x16x32_bf16 v[24:27], a[108:111], v[44:47], v[24:27]
  s_waitcnt lgkmcnt(6)
  v_mfma_f32_16x16x32_bf16 v[28:31], a[96:99], v[48:51], v[28:31]
  v_mfma_f32_16x16x32_bf16 v[32:35], a[100:103], v[48:51], v[32:35]
  v_mfma_f32_16x16x32_bf16 v[36:39], a[104:107], v[48:51], v[36:39]
  v_mfma_f32_16x16x32_bf16 v[40:43], a[108:111], v[48:51], v[40:43]
  s_waitcnt lgkmcnt(5)
  v_mfma_f32_16x16x32_bf16 v[12:15], a[112:115], v[52:55], v[12:15]
  ds_read_b128 v[44:47], v2 offset:12288
  v_mfma_f32_16x16x32_bf16 v[16:19], a[116:119], v[52:55], v[16:19]
  ds_read_b128 v[48:51], v2 offset:30720
  v_mfma_f32_16x16x32_bf16 v[20:23], a[120:123], v[52:55], v[20:23]
  v_mfma_f32_16x16x32_bf16 v[24:27], a[124:127], v[52:55], v[24:27]
  s_waitcnt lgkmcnt(6)
  v_mfma_f32_16x16x32_bf16 v[28:31], a[112:115], v[56:59], v[28:31]
  v_mfma_f32_16x16x32_bf16 v[32:35], a[116:119], v[56:59], v[32:35]
  v_mfma_f32_16x16x32_bf16 v[36:39], a[120:123], v[56:59], v[36:39]
  v_mfma_f32_16x16x32_bf16 v[40:43], a[124:127], v[56:59], v[40:43]
  s_waitcnt lgkmcnt(5)
  v_mfma_f32_16x16x32_bf16 v[12:15], a[128:131], v[60:63], v[12:15]
  ds_read_b128 v[52:55], v2 offset:13312
  v_mfma_f32_16x16x32_bf16 v[16:19], a[132:135], v[60:63], v[16:19]
  ds_read_b128 v[56:59], v2 offset:31744
  v_mfma_f32_16x16x32_bf16 v[20:23], a[136:139], v[60:63], v[20:23]
  v_mfma_f32_16x16x32_bf16 v[24:27], a[140:143], v[60:63], v[24:27]
  s_waitcnt lgkmcnt(6)
  v_mfma_f32_16x16x32_bf16 v[28:31], a[128:131], v[64:67], v[28:31]
  v_mfma_f32_16x16x32_bf16 v[32:35], a[132:135], v[64:67], v[32:35]
  v_mfma_f32_16x16x32_bf16 v[36:39], a[136:139], v[64:67], v[36:39]
  v_mfma_f32_16x16x32_bf16 v[40:43], a[140:143], v[64:67], v[40:43]
  s_waitcnt lgkmcnt(5)
  v_mfma_f32_16x16x32_bf16 v[12:15], a[144:147], v[68:71], v[12:15]
  ds_read_b128 v[60:63], v2 offset:14336
  v_mfma_f32_16x16x32_bf16 v[16:19], a[148:151], v[68:71], v[16:19]
  ds_read_b128 v[64:67], v2 offset:32768
  v_mfma_f32_16x16x32_bf16 v[20:23], a[152:155], v[68:71], v[20:23]
  v_mfma_f32_16x16x32_bf16 v[24:27], a[156:159], v[68:71], v[24:27]
  s_waitcnt lgkmcnt(6)
  v_mfma_f32_16x16x32_bf16 v[28:31], a[144:147], v[72:75], v[28:31]
  v_mfma_f32_16x16x32_bf16 v[32:35], a[148:151], v[72:75], v[32:35]
  v_mfma_f32_16x16x32_bf16 v[36:39], a[152:155], v[72:75], v[36:39]
  v_mfma_f32_16x16x32_bf16 v[40:43], a[156:159], v[72:75], v[40:43]
  s_waitcnt lgkmcnt(5)
  v_mfma_f32_16x16x32_bf16 v[12:15], a[160:163], v[44:47], v[12:15]
  ds_read_b128 v[68:71], v2 offset:15360
  v_mfma_f32_16x16x32_bf16 v[16:19], a[164:167], v[44:47], v[16:19]
  ds_read_b128 v[72:75], v2 offset:33792
  v_mfma_f32_16x16x32_bf16 v[20:23], a[168:171], v[44:47], v[20:23]
  v_mfma_f32_16x16x32_bf16 v[24:27], a[172:175], v[44:47], v[24:27]
  s_waitcnt lgkmcnt(6)
  v_mfma_f32_16x16x32_bf16 v[28:31], a[160:163], v[48:51], v[28:31]
  v_mfma_f32_16x16x32_bf16 v[32:35], a[164:167], v[48:51], v[32:35]
  v_mfma_f32_16x16x32_bf16 v[36:39], a[168:171], v[48:51], v[36:39]
  v_mfma_f32_16x16x32_bf16 v[40:43], a[172:175], v[48:51], v[40:43]
  s_waitcnt lgkmcnt(5)
  v_mfma_f32_16x16x32_bf16 v[12:15], a[176:179], v[52:55], v[12:15]
  ds_read_b128 v[44:47], v2 offset:16384
  v_mfma_f32_16x16x32_bf16 v[16:19], a[180:183], v[52:55], v[16:19]
  ds_read_b128 v[48:51], v2 offset:34816
  v_mfma_f32_16x16x32_bf16 v[20:23], a[184:187], v[52:55], v[20:23]
  v_mfma_f32_16x16x32_bf16 v[24:27], a[188:191], v[52:55], v[24:27]
  s_waitcnt lgkmcnt(6)
  v_mfma_f32_16x16x32_bf16 v[28:31], a[176:179], v[56:59], v[28:31]
  v_mfma_f32_16x16x32_bf16 v[32:35], a[180:183], v[56:59], v[32:35]
  v_mfma_f32_16x16x32_bf16 v[36:39], a[184:187], v[56:59], v[36:39]
  v_mfma_f32_16x16x32_bf16 v[40:43], a[188:191], v[56:59], v[40:43]
  s_waitcnt lgkmcnt(5)
  v_mfma_f32_16x16x32_bf16 v[12:15], a[192:195], v[60:63], v[12:15]
  ds_read_b128 v[52:55], v2 offset:17408
  v_mfma_f32_16x16x32_bf16 v[16:19], a[196:199], v[60:63], v[16:19]
  ds_read_b128 v[56:59], v2 offset:35840
  v_mfma_f32_16x16x32_bf16 v[20:23], a[200:203], v[60:63], v[20:23]
  v_mfma_f32_16x16x32_bf16 v[24:27], a[204:207], v[60:63], v[24:27]
  s_waitcnt lgkmcnt(6)
  v_mfma_f32_16x16x32_bf16 v[28:31], a[192:195], v[64:67], v[28:31]
  v_mfma_f32_16x16x32_bf16 v[32:35], a[196:199], v[64:67], v[32:35]
  v_mfma_f32_16x16x32_bf16 v[36:39], a[200:203], v[64:67], v[36:39]
  v_mfma_f32_16x16x32_bf16 v[40:43], a[204:207], v[64:67], v[40:43]
  s_waitcnt lgkmcnt(5)
  v_mfma_f32_16x16x32_bf16 v[12:15], a[208:211], v[68:71], v[12:15]
  v_mfma_f32_16x16x32_bf16 v[16:19], a[212:215], v[68:71], v[16:19]
  v_mfma_f32_16x16x32_bf16 v[20:23], a[216:219], v[68:71], v[20:23]
  v_mfma_f32_16x16x32_bf16 v[24:27], a[220:223], v[68:71], v[24:27]
  s_waitcnt lgkmcnt(4)
  v_mfma_f32_16x16x32_bf16 v[28:31], a[208:211], v[72:75], v[28:31]
  v_mfma_f32_16x16x32_bf16 v[32:35], a[212:215], v[72:75], v[32:35]
  v_mfma_f32_16x16x32_bf16 v[36:39], a[216:219], v[72:75], v[36:39]
  v_mfma_f32_16x16x32_bf16 v[40:43], a[220:223], v[72:75], v[40:43]
  s_waitcnt lgkmcnt(3)
  v_mfma_f32_16x16x32_bf16 v[12:15], a[224:227], v[44:47], v[12:15]
  v_mfma_f32_16x16x32_bf16 v[16:19], a[228:231], v[44:47], v[16:19]
  v_mfma_f32_16x16x32_bf16 v[20:23], a[232:235], v[44:47], v[20:23]
  v_mfma_f32_16x16x32_bf16 v[24:27], a[236:239], v[44:47], v[24:27]
  s_waitcnt lgkmcnt(2)
  v_mfma_f32_16x16x32_bf16 v[28:31], a[224:227], v[48:51], v[28:31]
  v_mfma_f32_16x16x32_bf16 v[32:35], a[228:231], v[48:51], v[32:35]
  v_mfma_f32_16x16x32_bf16 v[36:39], a[232:235], v[48:51], v[36:39]
  v_mfma_f32_16x16x32_bf16 v[40:43], a[236:239], v[48:51], v[40:43]
  s_waitcnt lgkmcnt(1)
  v_mfma_f32_16x16x32_bf16 v[12:15], a[240:243], v[52:55], v[12:15]
  v_mfma_f32_16x16x32_bf16 v[16:19], a[244:247], v[52:55], v[16:19]
  v_mfma_f32_16x16x32_bf16 v[20:23], a[248:251], v[52:55], v[20:23]
  v_mfma_f32_16x16x32_bf16 v[24:27], a[252:255], v[52:55], v[24:27]
  s_waitcnt lgkmcnt(0)
  v_mfma_f32_16x16x32_bf16 v[28:31], a[240:243], v[56:59], v[28:31]
  v_mfma_f32_16x16x32_bf16 v[32:35], a[244:247], v[56:59], v[32:35]
  v_mfma_f32_16x16x32_bf16 v[36:39], a[248:251], v[56:59], v[36:39]
  v_mfma_f32_16x16x32_bf16 v[40:43], a[252:255], v[56:59], v[40:43]
  v_cvt_pk_bf16_f32 v112, v12, v13
  v_cvt_pk_bf16_f32 v113, v14, v15
  v_cvt_pk_bf16_f32 v114, v16, v17
  v_cvt_pk_bf16_f32 v115, v18, v19
  buffer_store_dwordx4 v[112:115], v9, s[4:7], s45 offen offset:0 sc1
  v_cvt_pk_bf16_f32 v116, v20, v21
  v_cvt_pk_bf16_f32 v117, v22, v23
  v_cvt_pk_bf16_f32 v118, v24, v25
  v_cvt_pk_bf16_f32 v119, v26, v27
  buffer_store_dwordx4 v[116:119], v9, s[4:7], s45 offen offset:1024 sc1
  v_cvt_pk_bf16_f32 v120, v28, v29
  v_cvt_pk_bf16_f32 v121, v30, v31
  v_cvt_pk_bf16_f32 v122, v32, v33
  v_cvt_pk_bf16_f32 v123, v34, v35
  buffer_store_dwordx4 v[120:123], v9, s[4:7], s46 offen offset:0 sc1
  v_cvt_pk_bf16_f32 v124, v36, v37
  v_cvt_pk_bf16_f32 v125, v38, v39
  v_cvt_pk_bf16_f32 v126, v40, v41
  v_cvt_pk_bf16_f32 v127, v42, v43
  buffer_store_dwordx4 v[124:127], v9, s[4:7], s46 offen offset:1024 sc1
  buffer_store_dwordx4 v[128:131], v0, s[4:7], s54 offen offset:0 sc1
  buffer_store_dwordx4 v[128:131], v0, s[4:7], s54 offen offset:1024 sc1
  s_waitcnt vmcnt(0)
  buffer_store_dword v6, v5, s[4:7], s42 offen sc1
  s_mov_b32 s43, 0x40000000
  s_cmp_ge_u32 s37, 64
  s_cbranch_scc1 L_qk_done
  s_lshl_b32 s44, s37, 3
  s_mov_b32 s49, 0
L_poll_7:
  buffer_load_dword v8, v7, s[4:7], s44 offen sc1
  s_waitcnt vmcnt(0)
  v_cmp_eq_u32 vcc, 0, v8
  s_cbranch_vccz L_polld_8
  s_add_u32 s49, s49, 1
  s_cmp_lt_u32 s49, 1048576
  s_cbranch_scc1 L_poll_7
  s_branch L_fail
L_polld_8:
  s_mul_i32 s38, s37, 36864
  s_add_u32 s38, s38, 0x200000
  s_add_u32 s39, s38, 4096
  s_add_u32 s40, s38, 8192
  s_add_u32 s26, s37, 3
  s_min_u32 s26, s26, 63
  s_lshl_b32 s44, s26, 3
  buffer_load_dword v8, v7, s[4:7], s44 offen sc1
  buffer_load_dwordx4 v[76:79], v4, s[4:7], s38 offen offset:0 sc1
  buffer_load_dwordx4 v[80:83], v4, s[4:7], s38 offen offset:1024 sc1
  buffer_load_dwordx4 v[84:87], v4, s[4:7], s38 offen offset:2048 sc1
  buffer_load_dwordx4 v[88:91], v4, s[4:7], s38 offen offset:3072 sc1
  buffer_load_dwordx4 v[92:95], v4, s[4:7], s39 offen offset:0 sc1
  buffer_load_dwordx4 v[96:99], v4, s[4:7], s39 offen offset:1024 sc1
  buffer_load_dwordx4 v[100:103], v4, s[4:7], s39 offen offset:2048 sc1
  buffer_load_dwordx4 v[104:107], v4, s[4:7], s39 offen offset:3072 sc1
  buffer_load_dwordx4 v[108:111], v4, s[4:7], s40 offen offset:0 sc1
  s_waitcnt vmcnt(8)
  ds_write_b128 v3, v[76:79] offset:0
  s_waitcnt vmcnt(7)
  ds_write_b128 v3, v[80:83] offset:1024
  s_waitcnt vmcnt(6)
  ds_write_b128 v3, v[84:87] offset:2048
  s_waitcnt vmcnt(5)
  ds_write_b128 v3, v[88:91] offset:3072
  s_waitcnt vmcnt(4)
  ds_write_b128 v3, v[92:95] offset:4096
  s_waitcnt vmcnt(3)
  ds_write_b128 v3, v[96:99] offset:5120
  s_waitcnt vmcnt(2)
  ds_write_b128 v3, v[100:103] offset:6144
  s_waitcnt vmcnt(1)
  ds_write_b128 v3, v[104:107] offset:7168
  s_waitcnt vmcnt(0)
  ds_write_b128 v3, v[108:111] offset:8192
  s_mov_b32 s36, s37
  s_waitcnt lgkmcnt(0)
  s_barrier
  v_xor_b32 v2, 0x10000, v2
  v_xor_b32 v3, 0x10000, v3
  s_branch L_qk_top
L_qk_done:
  s_branch L_qkv_end
L_qkv_v:
  s_load_dwordx2 s[8:9], s[0:1], 32
  s_mov_b32 s10, 0x480000
  s_mov_b32 s11, 0x20000
  s_waitcnt lgkmcnt(0)
  s_lshl_b32 s27, s51, 9
  s_lshl_b32 s28, s25, 7
  s_add_u32 s27, s27, s28
  v_lshrrev_b32 v10, 3, v1
  v_lshlrev_b32 v10, 13, v10
  v_and_b32 v11, 7, v1
  v_lshlrev_b32 v11, 4, v11
  v_add3_u32 v10, v10, v11, s27
  s_mul_i32 s26, s25, 36864
  v_lshrrev_b32 v12, 4, v1
  v_mul_u32_u24 v12, 1024, v12
  v_bfe_u32 v13, v1, 2, 2
  v_mul_u32_u24 v13, 128, v13
  v_add_u32 v12, v12, v13
  v_and_b32 v13, 3, v1
  v_mul_u32_u24 v13, 8, v13
  v_add3_u32 v11, v12, v13, s26
  s_add_u32 m0, s26, 0x0
  s_mov_b32 s27, 0x0
  buffer_load_dwordx4 v10, s[8:11], s27 offen  lds
  s_add_u32 m0, s26, 0x400
  s_mov_b32 s27, 0x10000
  buffer_load_dwordx4 v10, s[8:11], s27 offen  lds
  s_add_u32 m0, s26, 0x800
  s_mov_b32 s27, 0x20000
  buffer_load_dwordx4 v10, s[8:11], s27 offen  lds
  s_add_u32 m0, s26, 0xc00
  s_mov_b32 s27, 0x30000
  buffer_load_dwordx4 v10, s[8:11], s27 offen  lds
  s_add_u32 m0, s26, 0x1000
  s_mov_b32 s27, 0x40000
  buffer_load_dwordx4 v10, s[8:11], s27 offen  lds
  s_add_u32 m0, s26, 0x1400
  s_mov_b32 s27, 0x50000
  buffer_load_dwordx4 v10, s[8:11], s27 offen  lds
  s_add_u32 m0, s26, 0x1800
  s_mov_b32 s27, 0x60000
  buffer_load_dwordx4 v10, s[8:11], s27 offen  lds
  s_add_u32 m0, s26, 0x1c00
  s_mov_b32 s27, 0x70000
  buffer_load_dwordx4 v10, s[8:11], s27 offen  lds
  s_add_u32 m0, s26, 0x2000
  s_mov_b32 s27, 0x80000
  buffer_load_dwordx4 v10, s[8:11], s27 offen  lds
  s_add_u32 m0, s26, 0x2400
  s_mov_b32 s27, 0x90000
  buffer_load_dwordx4 v10, s[8:11], s27 offen  lds
  s_add_u32 m0, s26, 0x2800
  s_mov_b32 s27, 0xa0000
  buffer_load_dwordx4 v10, s[8:11], s27 offen  lds
  s_add_u32 m0, s26, 0x2c00
  s_mov_b32 s27, 0xb0000
  buffer_load_dwordx4 v10, s[8:11], s27 offen  lds
  s_add_u32 m0, s26, 0x3000
  s_mov_b32 s27, 0xc0000
  buffer_load_dwordx4 v10, s[8:11], s27 offen  lds
  s_add_u32 m0, s26, 0x3400
  s_mov_b32 s27, 0xd0000
  buffer_load_dwordx4 v10, s[8:11], s27 offen  lds
  s_add_u32 m0, s26, 0x3800
  s_mov_b32 s27, 0xe0000
  buffer_load_dwordx4 v10, s[8:11], s27 offen  lds
  s_add_u32 m0, s26, 0x3c00
  s_mov_b32 s27, 0xf0000
  buffer_load_dwordx4 v10, s[8:11], s27 offen  lds
  s_add_u32 m0, s26, 0x4000
  s_mov_b32 s27, 0x100000
  buffer_load_dwordx4 v10, s[8:11], s27 offen  lds
  s_add_u32 m0, s26, 0x4400
  s_mov_b32 s27, 0x110000
  buffer_load_dwordx4 v10, s[8:11], s27 offen  lds
  s_add_u32 m0, s26, 0x4800
  s_mov_b32 s27, 0x120000
  buffer_load_dwordx4 v10, s[8:11], s27 offen  lds
  s_add_u32 m0, s26, 0x4c00
  s_mov_b32 s27, 0x130000
  buffer_load_dwordx4 v10, s[8:11], s27 offen  lds
  s_add_u32 m0, s26, 0x5000
  s_mov_b32 s27, 0x140000
  buffer_load_dwordx4 v10, s[8:11], s27 offen  lds
  s_add_u32 m0, s26, 0x5400
  s_mov_b32 s27, 0x150000
  buffer_load_dwordx4 v10, s[8:11], s27 offen  lds
  s_add_u32 m0, s26, 0x5800
  s_mov_b32 s27, 0x160000
  buffer_load_dwordx4 v10, s[8:11], s27 offen  lds
  s_add_u32 m0, s26, 0x5c00
  s_mov_b32 s27, 0x170000
  buffer_load_dwordx4 v10, s[8:11], s27 offen  lds
  s_add_u32 m0, s26, 0x6000
  s_mov_b32 s27, 0x180000
  buffer_load_dwordx4 v10, s[8:11], s27 offen  lds
  s_add_u32 m0, s26, 0x6400
  s_mov_b32 s27, 0x190000
  buffer_load_dwordx4 v10, s[8:11], s27 offen  lds
  s_add_u32 m0, s26, 0x6800
  s_mov_b32 s27, 0x1a0000
  buffer_load_dwordx4 v10, s[8:11], s27 offen  lds
  s_add_u32 m0, s26, 0x6c00
  s_mov_b32 s27, 0x1b0000
  buffer_load_dwordx4 v10, s[8:11], s27 offen  lds
  s_add_u32 m0, s26, 0x7000
  s_mov_b32 s27, 0x1c0000
  buffer_load_dwordx4 v10, s[8:11], s27 offen  lds
  s_add_u32 m0, s26, 0x7400
  s_mov_b32 s27, 0x1d0000
  buffer_load_dwordx4 v10, s[8:11], s27 offen  lds
  s_add_u32 m0, s26, 0x7800
  s_mov_b32 s27, 0x1e0000
  buffer_load_dwordx4 v10, s[8:11], s27 offen  lds
  s_add_u32 m0, s26, 0x7c00
  s_mov_b32 s27, 0x1f0000
  buffer_load_dwordx4 v10, s[8:11], s27 offen  lds
  s_add_u32 m0, s26, 0x8000
  s_mov_b32 s27, 0x200000
  buffer_load_dwordx4 v10, s[8:11], s27 offen  lds
  s_add_u32 m0, s26, 0x8400
  s_mov_b32 s27, 0x210000
  buffer_load_dwordx4 v10, s[8:11], s27 offen  lds
  s_add_u32 m0, s26, 0x8800
  s_mov_b32 s27, 0x220000
  buffer_load_dwordx4 v10, s[8:11], s27 offen  lds
  s_add_u32 m0, s26, 0x8c00
  s_mov_b32 s27, 0x230000
  buffer_load_dwordx4 v10, s[8:11], s27 offen  lds
  s_waitcnt vmcnt(32)
  ds_read_b64_tr_b16 v[224:225], v11 offset:0
  ds_read_b64_tr_b16 v[226:227], v11 offset:512
  ds_read_b64_tr_b16 v[228:229], v11 offset:32
  ds_read_b64_tr_b16 v[230:231], v11 offset:544
  ds_read_b64_tr_b16 v[232:233], v11 offset:64
  ds_read_b64_tr_b16 v[234:235], v11 offset:576
  ds_read_b64_tr_b16 v[236:237], v11 offset:96
  ds_read_b64_tr_b16 v[238:239], v11 offset:608
  s_waitcnt lgkmcnt(0)
  s_add_u32 m0, s26, 0x0
  s_mov_b32 s27, 0x240000
  buffer_load_dwordx4 v10, s[8:11], s27 offen  lds
  s_add_u32 m0, s26, 0x400
  s_mov_b32 s27, 0x250000
  buffer_load_dwordx4 v10, s[8:11], s27 offen  lds
  s_add_u32 m0, s26, 0x800
  s_mov_b32 s27, 0x260000
  buffer_load_dwordx4 v10, s[8:11], s27 offen  lds
  s_add_u32 m0, s26, 0xc00
  s_mov_b32 s27, 0x270000
  buffer_load_dwordx4 v10, s[8:11], s27 offen  lds
  s_waitcnt vmcnt(32)
  ds_read_b64_tr_b16 v[240:241], v11 offset:4096
  ds_read_b64_tr_b16 v[242:243], v11 offset:4608
  ds_read_b64_tr_b16 v[244:245], v11 offset:4128
  ds_read_b64_tr_b16 v[246:247], v11 offset:4640
  ds_read_b64_tr_b16 v[248:249], v11 offset:4160
  ds_read_b64_tr_b16 v[250:251], v11 offset:4672
  ds_read_b64_tr_b16 v[252:253], v11 offset:4192
  ds_read_b64_tr_b16 v[254:255], v11 offset:4704
  s_waitcnt lgkmcnt(0)
  s_add_u32 m0, s26, 0x1000
  s_mov_b32 s27, 0x280000
  buffer_load_dwordx4 v10, s[8:11], s27 offen  lds
  s_add_u32 m0, s26, 0x1400
  s_mov_b32 s27, 0x290000
  buffer_load_dwordx4 v10, s[8:11], s27 offen  lds
  s_add_u32 m0, s26, 0x1800
  s_mov_b32 s27, 0x2a0000
  buffer_load_dwordx4 v10, s[8:11], s27 offen  lds
  s_add_u32 m0, s26, 0x1c00
  s_mov_b32 s27, 0x2b0000
  buffer_load_dwordx4 v10, s[8:11], s27 offen  lds
  s_waitcnt vmcnt(32)
  ds_read_b64_tr_b16 a[0:1], v11 offset:8192
  ds_read_b64_tr_b16 a[2:3], v11 offset:8704
  ds_read_b64_tr_b16 a[4:5], v11 offset:8224
  ds_read_b64_tr_b16 a[6:7], v11 offset:8736
  ds_read_b64_tr_b16 a[8:9], v11 offset:8256
  ds_read_b64_tr_b16 a[10:11], v11 offset:8768
  ds_read_b64_tr_b16 a[12:13], v11 offset:8288
  ds_read_b64_tr_b16 a[14:15], v11 offset:8800
  s_waitcnt lgkmcnt(0)
  s_add_u32 m0, s26, 0x2000
  s_mov_b32 s27, 0x2c0000
  buffer_load_dwordx4 v10, s[8:11], s27 offen  lds
  s_add_u32 m0, s26, 0x2400
  s_mov_b32 s27, 0x2d0000
  buffer_load_dwordx4 v10, s[8:11], s27 offen  lds
  s_add_u32 m0, s26, 0x2800
  s_mov_b32 s27, 0x2e0000
  buffer_load_dwordx4 v10, s[8:11], s27 offen  lds
  s_add_u32 m0, s26, 0x2c00
  s_mov_b32 s27, 0x2f0000
  buffer_load_dwordx4 v10, s[8:11], s27 offen  lds
  s_waitcnt vmcnt(32)
  ds_read_b64_tr_b16 a[16:17], v11 offset:12288
  ds_read_b64_tr_b16 a[18:19], v11 offset:12800
  ds_read_b64_tr_b16 a[20:21], v11 offset:12320
  ds_read_b64_tr_b16 a[22:23], v11 offset:12832
  ds_read_b64_tr_b16 a[24:25], v11 offset:12352
  ds_read_b64_tr_b16 a[26:27], v11 offset:12864
  ds_read_b64_tr_b16 a[28:29], v11 offset:12384
  ds_read_b64_tr_b16 a[30:31], v11 offset:12896
  s_waitcnt lgkmcnt(0)
  s_add_u32 m0, s26, 0x3000
  s_mov_b32 s27, 0x300000
  buffer_load_dwordx4 v10, s[8:11], s27 offen  lds
  s_add_u32 m0, s26, 0x3400
  s_mov_b32 s27, 0x310000
  buffer_load_dwordx4 v10, s[8:11], s27 offen  lds
  s_add_u32 m0, s26, 0x3800
  s_mov_b32 s27, 0x320000
  buffer_load_dwordx4 v10, s[8:11], s27 offen  lds
  s_add_u32 m0, s26, 0x3c00
  s_mov_b32 s27, 0x330000
  buffer_load_dwordx4 v10, s[8:11], s27 offen  lds
  s_waitcnt vmcnt(32)
  ds_read_b64_tr_b16 a[32:33], v11 offset:16384
  ds_read_b64_tr_b16 a[34:35], v11 offset:16896
  ds_read_b64_tr_b16 a[36:37], v11 offset:16416
  ds_read_b64_tr_b16 a[38:39], v11 offset:16928
  ds_read_b64_tr_b16 a[40:41], v11 offset:16448
  ds_read_b64_tr_b16 a[42:43], v11 offset:16960
  ds_read_b64_tr_b16 a[44:45], v11 offset:16480
  ds_read_b64_tr_b16 a[46:47], v11 offset:16992
  s_waitcnt lgkmcnt(0)
  s_add_u32 m0, s26, 0x4000
  s_mov_b32 s27, 0x340000
  buffer_load_dwordx4 v10, s[8:11], s27 offen  lds
  s_add_u32 m0, s26, 0x4400
  s_mov_b32 s27, 0x350000
  buffer_load_dwordx4 v10, s[8:11], s27 offen  lds
  s_add_u32 m0, s26, 0x4800
  s_mov_b32 s27, 0x360000
  buffer_load_dwordx4 v10, s[8:11], s27 offen  lds
  s_add_u32 m0, s26, 0x4c00
  s_mov_b32 s27, 0x370000
  buffer_load_dwordx4 v10, s[8:11], s27 offen  lds
  s_waitcnt vmcnt(32)
  ds_read_b64_tr_b16 a[48:49], v11 offset:20480
  ds_read_b64_tr_b16 a[50:51], v11 offset:20992
  ds_read_b64_tr_b16 a[52:53], v11 offset:20512
  ds_read_b64_tr_b16 a[54:55], v11 offset:21024
  ds_read_b64_tr_b16 a[56:57], v11 offset:20544
  ds_read_b64_tr_b16 a[58:59], v11 offset:21056
  ds_read_b64_tr_b16 a[60:61], v11 offset:20576
  ds_read_b64_tr_b16 a[62:63], v11 offset:21088
  s_waitcnt lgkmcnt(0)
  s_add_u32 m0, s26, 0x5000
  s_mov_b32 s27, 0x380000
  buffer_load_dwordx4 v10, s[8:11], s27 offen  lds
  s_add_u32 m0, s26, 0x5400
  s_mov_b32 s27, 0x390000
  buffer_load_dwordx4 v10, s[8:11], s27 offen  lds
  s_add_u32 m0, s26, 0x5800
  s_mov_b32 s27, 0x3a0000
  buffer_load_dwordx4 v10, s[8:11], s27 offen  lds
  s_add_u32 m0, s26, 0x5c00
  s_mov_b32 s27, 0x3b0000
  buffer_load_dwordx4 v10, s[8:11], s27 offen  lds
  s_waitcnt vmcnt(32)
  ds_read_b64_tr_b16 a[64:65], v11 offset:24576
  ds_read_b64_tr_b16 a[66:67], v11 offset:25088
  ds_read_b64_tr_b16 a[68:69], v11 offset:24608
  ds_read_b64_tr_b16 a[70:71], v11 offset:25120
  ds_read_b64_tr_b16 a[72:73], v11 offset:24640
  ds_read_b64_tr_b16 a[74:75], v11 offset:25152
  ds_read_b64_tr_b16 a[76:77], v11 offset:24672
  ds_read_b64_tr_b16 a[78:79], v11 offset:25184
  s_waitcnt lgkmcnt(0)
  s_add_u32 m0, s26, 0x6000
  s_mov_b32 s27, 0x3c0000
  buffer_load_dwordx4 v10, s[8:11], s27 offen  lds
  s_add_u32 m0, s26, 0x6400
  s_mov_b32 s27, 0x3d0000
  buffer_load_dwordx4 v10, s[8:11], s27 offen  lds
  s_add_u32 m0, s26, 0x6800
  s_mov_b32 s27, 0x3e0000
  buffer_load_dwordx4 v10, s[8:11], s27 offen  lds
  s_add_u32 m0, s26, 0x6c00
  s_mov_b32 s27, 0x3f0000
  buffer_load_dwordx4 v10, s[8:11], s27 offen  lds
  s_waitcnt vmcnt(32)
  ds_read_b64_tr_b16 a[80:81], v11 offset:28672
  ds_read_b64_tr_b16 a[82:83], v11 offset:29184
  ds_read_b64_tr_b16 a[84:85], v11 offset:28704
  ds_read_b64_tr_b16 a[86:87], v11 offset:29216
  ds_read_b64_tr_b16 a[88:89], v11 offset:28736
  ds_read_b64_tr_b16 a[90:91], v11 offset:29248
  ds_read_b64_tr_b16 a[92:93], v11 offset:28768
  ds_read_b64_tr_b16 a[94:95], v11 offset:29280
  s_waitcnt lgkmcnt(0)
  s_add_u32 m0, s26, 0x7000
  s_mov_b32 s27, 0x400000
  buffer_load_dwordx4 v10, s[8:11], s27 offen  lds
  s_add_u32 m0, s26, 0x7400
  s_mov_b32 s27, 0x410000
  buffer_load_dwordx4 v10, s[8:11], s27 offen  lds
  s_add_u32 m0, s26, 0x7800
  s_mov_b32 s27, 0x420000
  buffer_load_dwordx4 v10, s[8:11], s27 offen  lds
  s_add_u32 m0, s26, 0x7c00
  s_mov_b32 s27, 0x430000
  buffer_load_dwordx4 v10, s[8:11], s27 offen  lds
  s_waitcnt vmcnt(32)
  ds_read_b64_tr_b16 a[96:97], v11 offset:32768
  ds_read_b64_tr_b16 a[98:99], v11 offset:33280
  ds_read_b64_tr_b16 a[100:101], v11 offset:32800
  ds_read_b64_tr_b16 a[102:103], v11 offset:33312
  ds_read_b64_tr_b16 a[104:105], v11 offset:32832
  ds_read_b64_tr_b16 a[106:107], v11 offset:33344
  ds_read_b64_tr_b16 a[108:109], v11 offset:32864
  ds_read_b64_tr_b16 a[110:111], v11 offset:33376
  s_waitcnt lgkmcnt(0)
  s_add_u32 m0, s26, 0x8000
  s_mov_b32 s27, 0x440000
  buffer_load_dwordx4 v10, s[8:11], s27 offen  lds
  s_add_u32 m0, s26, 0x8400
  s_mov_b32 s27, 0x450000
  buffer_load_dwordx4 v10, s[8:11], s27 offen  lds
  s_add_u32 m0, s26, 0x8800
  s_mov_b32 s27, 0x460000
  buffer_load_dwordx4 v10, s[8:11], s27 offen  lds
  s_add_u32 m0, s26, 0x8c00
  s_mov_b32 s27, 0x470000
  buffer_load_dwordx4 v10, s[8:11], s27 offen  lds
  s_waitcnt vmcnt(32)
  ds_read_b64_tr_b16 a[112:113], v11 offset:0
  ds_read_b64_tr_b16 a[114:115], v11 offset:512
  ds_read_b64_tr_b16 a[116:117], v11 offset:32
  ds_read_b64_tr_b16 a[118:119], v11 offset:544
  ds_read_b64_tr_b16 a[120:121], v11 offset:64
  ds_read_b64_tr_b16 a[122:123], v11 offset:576
  ds_read_b64_tr_b16 a[124:125], v11 offset:96
  ds_read_b64_tr_b16 a[126:127], v11 offset:608
  s_waitcnt vmcnt(28)
  ds_read_b64_tr_b16 a[128:129], v11 offset:4096
  ds_read_b64_tr_b16 a[130:131], v11 offset:4608
  ds_read_b64_tr_b16 a[132:133], v11 offset:4128
  ds_read_b64_tr_b16 a[134:135], v11 offset:4640
  ds_read_b64_tr_b16 a[136:137], v11 offset:4160
  ds_read_b64_tr_b16 a[138:139], v11 offset:4672
  ds_read_b64_tr_b16 a[140:141], v11 offset:4192
  ds_read_b64_tr_b16 a[142:143], v11 offset:4704
  s_waitcnt vmcnt(24)
  ds_read_b64_tr_b16 a[144:145], v11 offset:8192
  ds_read_b64_tr_b16 a[146:147], v11 offset:8704
  ds_read_b64_tr_b16 a[148:149], v11 offset:8224
  ds_read_b64_tr_b16 a[150:151], v11 offset:8736
  ds_read_b64_tr_b16 a[152:153], v11 offset:8256
  ds_read_b64_tr_b16 a[154:155], v11 offset:8768
  ds_read_b64_tr_b16 a[156:157], v11 offset:8288
  ds_read_b64_tr_b16 a[158:159], v11 offset:8800
  s_waitcnt vmcnt(20)
  ds_read_b64_tr_b16 a[160:161], v11 offset:12288
  ds_read_b64_tr_b16 a[162:163], v11 offset:12800
  ds_read_b64_tr_b16 a[164:165], v11 offset:12320
  ds_read_b64_tr_b16 a[166:167], v11 offset:12832
  ds_read_b64_tr_b16 a[168:169], v11 offset:12352
  ds_read_b64_tr_b16 a[170:171], v11 offset:12864
  ds_read_b64_tr_b16 a[172:173], v11 offset:12384
  ds_read_b64_tr_b16 a[174:175], v11 offset:12896
  s_waitcnt vmcnt(16)
  ds_read_b64_tr_b16 a[176:177], v11 offset:16384
  ds_read_b64_tr_b16 a[178:179], v11 offset:16896
  ds_read_b64_tr_b16 a[180:181], v11 offset:16416
  ds_read_b64_tr_b16 a[182:183], v11 offset:16928
  ds_read_b64_tr_b16 a[184:185], v11 offset:16448
  ds_read_b64_tr_b16 a[186:187], v11 offset:16960
  ds_read_b64_tr_b16 a[188:189], v11 offset:16480
  ds_read_b64_tr_b16 a[190:191], v11 offset:16992
  s_waitcnt vmcnt(12)
  ds_read_b64_tr_b16 a[192:193], v11 offset:20480
  ds_read_b64_tr_b16 a[194:195], v11 offset:20992
  ds_read_b64_tr_b16 a[196:197], v11 offset:20512
  ds_read_b64_tr_b16 a[198:199], v11 offset:21024
  ds_read_b64_tr_b16 a[200:201], v11 offset:20544
  ds_read_b64_tr_b16 a[202:203], v11 offset:21056
  ds_read_b64_tr_b16 a[204:205], v11 offset:20576
  ds_read_b64_tr_b16 a[206:207], v11 offset:21088
  s_waitcnt vmcnt(8)
  ds_read_b64_tr_b16 a[208:209], v11 offset:24576
  ds_read_b64_tr_b16 a[210:211], v11 offset:25088
  ds_read_b64_tr_b16 a[212:213], v11 offset:24608
  ds_read_b64_tr_b16 a[214:215], v11 offset:25120
  ds_read_b64_tr_b16 a[216:217], v11 offset:24640
  ds_read_b64_tr_b16 a[218:219], v11 offset:25152
  ds_read_b64_tr_b16 a[220:221], v11 offset:24672
  ds_read_b64_tr_b16 a[222:223], v11 offset:25184
  s_waitcnt vmcnt(4)
  ds_read_b64_tr_b16 a[224:225], v11 offset:28672
  ds_read_b64_tr_b16 a[226:227], v11 offset:29184
  ds_read_b64_tr_b16 a[228:229], v11 offset:28704
  ds_read_b64_tr_b16 a[230:231], v11 offset:29216
  ds_read_b64_tr_b16 a[232:233], v11 offset:28736
  ds_read_b64_tr_b16 a[234:235], v11 offset:29248
  ds_read_b64_tr_b16 a[236:237], v11 offset:28768
  ds_read_b64_tr_b16 a[238:239], v11 offset:29280
  s_waitcnt vmcnt(0)
  ds_read_b64_tr_b16 a[240:241], v11 offset:32768
  ds_read_b64_tr_b16 a[242:243], v11 offset:33280
  ds_read_b64_tr_b16 a[244:245], v11 offset:32800
  ds_read_b64_tr_b16 a[246:247], v11 offset:33312
  ds_read_b64_tr_b16 a[248:249], v11 offset:32832
  ds_read_b64_tr_b16 a[250:251], v11 offset:33344
  ds_read_b64_tr_b16 a[252:253], v11 offset:32864
  ds_read_b64_tr_b16 a[254:255], v11 offset:33376
  s_waitcnt lgkmcnt(0)
  s_mov_b32 s28, 0
L_reg_9:
  v_mov_b32 v8, 0
  buffer_load_dword v9, v8, s[20:23], 0 offen offset:64 sc1
  s_add_u32 s28, s28, 1
  s_cmp_gt_u32 s28, 1048576
  s_cbranch_scc1 L_fail
  s_waitcnt vmcnt(0)
  v_readfirstlane_b32 s67, v9
L_regc_10:
  s_and_b32 s26, s67, 0xffff
  s_cmp_lt_u32 s26, 256
  s_cbranch_scc1 L_reg_9
  s_lshr_b32 s67, s67, 16
  s_barrier
  v_or_b32 v2, 0x10000, v0
  s_mul_i32 s27, s25, 9216
  v_add_u32 v3, s27, v0
  v_mov_b32 v4, v3
  v_and_b32 v7, 1, v1
  v_lshlrev_b32 v7, 2, v7
  s_lshr_b32 s27, s25, 1
  s_lshl_b32 s28, s51, 1
  s_add_u32 s27, s27, s28
  s_lshl_b32 s27, s27, 13
  s_and_b32 s28, s25, 1
  s_lshl_b32 s28, s28, 12
  s_add_u32 s27, s27, s28
  v_add_u32 v9, s27, v0
  s_add_u32 s52, s50, 1
  s_lshl_b32 s52, s52, 24
  s_lshl_b32 s27, s51, 9
  s_lshl_b32 s28, s50, 6
  s_add_u32 s27, s27, s28
  s_lshl_b32 s28, s25, 4
  s_add_u32 s27, s27, s28
  s_add_u32 s53, s27, 0x80000
  s_lshl_b32 s27, s51, 2
  s_add_u32 s27, s27, s25
  s_lshl_b32 s27, s27, 11
  s_add_u32 s55, s27, 0x4800000
  v_mov_b32 v128, -1
  v_mov_b32 v129, -1
  v_mov_b32 v130, -1
  v_mov_b32 v131, -1
  v_mov_b32 v6, 1
  v_mov_b32 v5, 0x40000000
  v_cmp_eq_u32 vcc, 0, v0
  s_nop 1
  v_cndmask_b32 v5, v5, 0, vcc
  s_mov_b32 s43, 0x40000000
  s_mov_b32 s37, s36
  s_lshl_b32 s44, s37, 3
  s_mov_b32 s49, 0
L_poll_11:
  buffer_load_dword v8, v7, s[4:7], s44 offen sc1
  s_waitcnt vmcnt(0)
  v_cmp_eq_u32 vcc, 0, v8
  s_cbranch_vccz L_polld_12
  s_add_u32 s49, s49, 1
  s_cmp_lt_u32 s49, 1048576
  s_cbranch_scc1 L_poll_11
  s_branch L_fail
L_polld_12:
  s_mul_i32 s38, s37, 36864
  s_add_u32 s38, s38, 0x200000
  s_add_u32 s39, s38, 4096
  s_add_u32 s40, s38, 8192
  s_add_u32 s26, s37, 3
  s_min_u32 s26, s26, 63
  s_lshl_b32 s44, s26, 3
  buffer_load_dword v8, v7, s[4:7], s44 offen sc1
  buffer_load_dwordx4 v[76:79], v4, s[4:7], s38 offen offset:0 sc1
  buffer_load_dwordx4 v[80:83], v4, s[4:7], s38 offen offset:1024 sc1
  buffer_load_dwordx4 v[84:87], v4, s[4:7], s38 offen offset:2048 sc1
  buffer_load_dwordx4 v[88:91], v4, s[4:7], s38 offen offset:3072 sc1
  buffer_load_dwordx4 v[92:95], v4, s[4:7], s39 offen offset:0 sc1
  buffer_load_dwordx4 v[96:99], v4, s[4:7], s39 offen offset:1024 sc1
  buffer_load_dwordx4 v[100:103], v4, s[4:7], s39 offen offset:2048 sc1
  buffer_load_dwordx4 v[104:107], v4, s[4:7], s39 offen offset:3072 sc1
  buffer_load_dwordx4 v[108:111], v4, s[4:7], s40 offen offset:0 sc1
  s_waitcnt vmcnt(8)
  ds_write_b128 v3, v[76:79] offset:0
  s_waitcnt vmcnt(7)
  ds_write_b128 v3, v[80:83] offset:1024
  s_waitcnt vmcnt(6)
  ds_write_b128 v3, v[84:87] offset:2048
  s_waitcnt vmcnt(5)
  ds_write_b128 v3, v[88:91] offset:3072
  s_waitcnt vmcnt(4)
  ds_write_b128 v3, v[92:95] offset:4096
  s_waitcnt vmcnt(3)
  ds_write_b128 v3, v[96:99] offset:5120
  s_waitcnt vmcnt(2)
  ds_write_b128 v3, v[100:103] offset:6144
  s_waitcnt vmcnt(1)
  ds_write_b128 v3, v[104:107] offset:7168
  s_waitcnt vmcnt(0)
  ds_write_b128 v3, v[108:111] offset:8192
  s_waitcnt lgkmcnt(0)
  s_barrier
  v_xor_b32 v2, 0x10000, v2
  v_xor_b32 v3, 0x10000, v3
L_vv_top:
  s_lshl_b32 s45, s36, 18
  s_add_u32 s45, s45, s52
  s_add_u32 s46, s45, 4096
  s_lshl_b32 s42, s36, 13
  s_add_u32 s42, s42, s53
  s_lshl_b32 s54, s36, 17
  s_add_u32 s54, s54, s55
  s_cmp_ge_u32 s36, 24
  s_cselect_b32 s54, s54, 0x40000000
  s_add_u32 s37, s36, 3
  s_cmp_ge_u32 s37, 64
  s_cbranch_scc1 L_vv_nopf
  s_waitcnt vmcnt(6)
  v_cmp_eq_u32 vcc, 0, v8
  s_cbranch_vccnz L_vv_nopf
  s_mul_i32 s38, s37, 36864
  s_add_u32 s38, s38, 0x200000
  s_add_u32 s39, s38, 4096
  s_add_u32 s40, s38, 8192
  ds_read_b128 v[44:47], v2 offset:0
  ds_read_b128 v[48:51], v2 offset:18432
  ds_read_b128 v[52:55], v2 offset:1024
  ds_read_b128 v[56:59], v2 offset:19456
  ds_read_b128 v[60:63], v2 offset:2048
  ds_read_b128 v[64:67], v2 offset:20480
  s_waitcnt lgkmcnt(5)
  v_mfma_f32_16x16x32_bf16 v[12:15], v[44:47], v[224:227], 0
  ds_read_b128 v[68:71], v2 offset:3072
  v_mfma_f32_16x16x32_bf16 v[16:19], v[44:47], v[228:231], 0
  ds_read_b128 v[72:75], v2 offset:21504
  v_mfma_f32_16x16x32_bf16 v[20:23], v[44:47], v[232:235], 0
  buffer_load_dwordx4 v[76:79], v4, s[4:7], s38 offen offset:0 sc1
  v_mfma_f32_16x16x32_bf16 v[24:27], v[44:47], v[236:239], 0
  s_waitcnt lgkmcnt(6)
  v_mfma_f32_16x16x32_bf16 v[28:31], v[48:51], v[224:227], 0
  v_mfma_f32_16x16x32_bf16 v[32:35], v[48:51], v[228:231], 0
  v_mfma_f32_16x16x32_bf16 v[36:39], v[48:51], v[232:235], 0
  v_mfma_f32_16x16x32_bf16 v[40:43], v[48:51], v[236:239], 0
  s_waitcnt lgkmcnt(5)
  v_mfma_f32_16x16x32_bf16 v[12:15], v[52:55], v[240:243], v[12:15]
  ds_read_b128 v[44:47], v2 offset:4096
  buffer_load_dwordx4 v[80:83], v4, s[4:7], s38 offen offset:1024 sc1
  v_mfma_f32_16x16x32_bf16 v[16:19], v[52:55], v[244:247], v[16:19]
  ds_read_b128 v[48:51], v2 offset:22528
  v_mfma_f32_16x16x32_bf16 v[20:23], v[52:55], v[248:251], v[20:23]
  v_mfma_f32_16x16x32_bf16 v[24:27], v[52:55], v[252:255], v[24:27]
  s_waitcnt lgkmcnt(6)
  v_mfma_f32_16x16x32_bf16 v[28:31], v[56:59], v[240:243], v[28:31]
  v_mfma_f32_16x16x32_bf16 v[32:35], v[56:59], v[244:247], v[32:35]
  v_mfma_f32_16x16x32_bf16 v[36:39], v[56:59], v[248:251], v[36:39]
  buffer_load_dwordx4 v[84:87], v4, s[4:7], s38 offen offset:2048 sc1
  v_mfma_f32_16x16x32_bf16 v[40:43], v[56:59], v[252:255], v[40:43]
  s_waitcnt lgkmcnt(5)
  v_mfma_f32_16x16x32_bf16 v[12:15], v[60:63], a[0:3], v[12:15]
  ds_read_b128 v[52:55], v2 offset:5120
  v_mfma_f32_16x16x32_bf16 v[16:19], v[60:63], a[4:7], v[16:19]
  ds_read_b128 v[56:59], v2 offset:23552
  v_mfma_f32_16x16x32_bf16 v[20:23], v[60:63], a[8:11], v[20:23]
  v_mfma_f32_16x16x32_bf16 v[24:27], v[60:63], a[12:15], v[24:27]
  s_waitcnt lgkmcnt(6)
  v_mfma_f32_16x16x32_bf16 v[28:31], v[64:67], a[0:3], v[28:31]
  buffer_load_dwordx4 v[88:91], v4, s[4:7], s38 offen offset:3072 sc1
  v_mfma_f32_16x16x32_bf16 v[32:35], v[64:67], a[4:7], v[32:35]
  v_mfma_f32_16x16x32_bf16 v[36:39], v[64:67], a[8:11], v[36:39]
  v_mfma_f32_16x16x32_bf16 v[40:43], v[64:67], a[12:15], v[40:43]
  s_waitcnt lgkmcnt(5)
  v_mfma_f32_16x16x32_bf16 v[12:15], v[68:71], a[16:19], v[12:15]
  ds_read_b128 v[60:63], v2 offset:6144
  v_mfma_f32_16x16x32_bf16 v[16:19], v[68:71], a[20:23], v[16:19]
  ds_read_b128 v[64:67], v2 offset:24576
  v_mfma_f32_16x16x32_bf16 v[20:23], v[68:71], a[24:27], v[20:23]
  buffer_load_dwordx4 v[92:95], v4, s[4:7], s39 offen offset:0 sc1
  v_mfma_f32_16x16x32_bf16 v[24:27], v[68:71], a[28:31], v[24:27]
  s_waitcnt lgkmcnt(6)
  v_mfma_f32_16x16x32_bf16 v[28:31], v[72:75], a[16:19], v[28:31]
  v_mfma_f32_16x16x32_bf16 v[32:35], v[72:75], a[20:23], v[32:35]
  v_mfma_f32_16x16x32_bf16 v[36:39], v[72:75], a[24:27], v[36:39]
  v_mfma_f32_16x16x32_bf16 v[40:43], v[72:75], a[28:31], v[40:43]
  s_waitcnt lgkmcnt(5)
  v_mfma_f32_16x16x32_bf16 v[12:15], v[44:47], a[32:35], v[12:15]
  ds_read_b128 v[68:71], v2 offset:7168
  buffer_load_dwordx4 v[96:99], v4, s[4:7], s39 offen offset:1024 sc1
  v_mfma_f32_16x16x32_bf16 v[16:19], v[44:47], a[36:39], v[16:19]
  ds_read_b128 v[72:75], v2 offset:25600
  v_mfma_f32_16x16x32_bf16 v[20:23], v[44:47], a[40:43], v[20:23]
  v_mfma_f32_16x16x32_bf16 v[24:27], v[44:47], a[44:47], v[24:27]
  s_waitcnt lgkmcnt(6)
  v_mfma_f32_16x16x32_bf16 v[28:31], v[48:51], a[32:35], v[28:31]
  v_mfma_f32_16x16x32_bf16 v[32:35], v[48:51], a[36:39], v[32:35]
  v_mfma_f32_16x16x32_bf16 v[36:39], v[48:51], a[40:43], v[36:39]
  buffer_load_dwordx4 v[100:103], v4, s[4:7], s39 offen offset:2048 sc1
  v_mfma_f32_16x16x32_bf16 v[40:43], v[48:51], a[44:47], v[40:43]
  s_waitcnt lgkmcnt(5)
  v_mfma_f32_16x16x32_bf16 v[12:15], v[52:55], a[48:51], v[12:15]
  ds_read_b128 v[44:47], v2 offset:8192
  v_mfma_f32_16x16x32_bf16 v[16:19], v[52:55], a[52:55], v[16:19]
  ds_read_b128 v[48:51], v2 offset:26624
  v_mfma_f32_16x16x32_bf16 v[20:23], v[52:55], a[56:59], v[20:23]
  v_mfma_f32_16x16x32_bf16 v[24:27], v[52:55], a[60:63], v[24:27]
  s_waitcnt lgkmcnt(6)
  v_mfma_f32_16x16x32_bf16 v[28:31], v[56:59], a[48:51], v[28:31]
  buffer_load_dwordx4 v[104:107], v4, s[4:7], s39 offen offset:3072 sc1
  v_mfma_f32_16x16x32_bf16 v[32:35], v[56:59], a[52:55], v[32:35]
  v_mfma_f32_16x16x32_bf16 v[36:39], v[56:59], a[56:59], v[36:39]
  v_mfma_f32_16x16x32_bf16 v[40:43], v[56:59], a[60:63], v[40:43]
  s_waitcnt lgkmcnt(5)
  v_mfma_f32_16x16x32_bf16 v[12:15], v[60:63], a[64:67], v[12:15]
  ds_read_b128 v[52:55], v2 offset:9216
  v_mfma_f32_16x16x32_bf16 v[16:19], v[60:63], a[68:71], v[16:19]
  ds_read_b128 v[56:59], v2 offset:27648
  v_mfma_f32_16x16x32_bf16 v[20:23], v[60:63], a[72:75], v[20:23]
  buffer_load_dwordx4 v[108:111], v4, s[4:7], s40 offen offset:0 sc1
  v_mfma_f32_16x16x32_bf16 v[24:27], v[60:63], a[76:79], v[24:27]
  s_waitcnt lgkmcnt(6)
  v_mfma_f32_16x16x32_bf16 v[28:31], v[64:67], a[64:67], v[28:31]
  v_mfma_f32_16x16x32_bf16 v[32:35], v[64:67], a[68:71], v[32:35]
  v_mfma_f32_16x16x32_bf16 v[36:39], v[64:67], a[72:75], v[36:39]
  v_mfma_f32_16x16x32_bf16 v[40:43], v[64:67], a[76:79], v[40:43]
  s_waitcnt lgkmcnt(5)
  v_mfma_f32_16x16x32_bf16 v[12:15], v[68:71], a[80:83], v[12:15]
  ds_read_b128 v[60:63], v2 offset:10240
  v_mfma_f32_16x16x32_bf16 v[16:19], v[68:71], a[84:87], v[16:19]
  ds_read_b128 v[64:67], v2 offset:28672
  v_mfma_f32_16x16x32_bf16 v[20:23], v[68:71], a[88:91], v[20:23]
  v_mfma_f32_16x16x32_bf16 v[24:27], v[68:71], a[92:95], v[24:27]
  s_waitcnt lgkmcnt(6)
  v_mfma_f32_16x16x32_bf16 v[28:31], v[72:75], a[80:83], v[28:31]
  s_waitcnt vmcnt(9)
  buffer_store_dword v6, v5, s[4:7], s43 offen sc1
  s_add_u32 s26, s37, 3
  s_min_u32 s26, s26, 63
  s_lshl_b32 s44, s26, 3
  buffer_load_dword v8, v7, s[4:7], s44 offen sc1
  v_mfma_f32_16x16x32_bf16 v[32:35], v[72:75], a[84:87], v[32:35]
  v_mfma_f32_16x16x32_bf16 v[36:39], v[72:75], a[88:91], v[36:39]
  v_mfma_f32_16x16x32_bf16 v[40:43], v[72:75], a[92:95], v[40:43]
  s_waitcnt lgkmcnt(5)
  v_mfma_f32_16x16x32_bf16 v[12:15], v[44:47], a[96:99], v[12:15]
  ds_read_b128 v[68:71], v2 offset:11264
  v_mfma_f32_16x16x32_bf16 v[16:19], v[44:47], a[100:103], v[16:19]
  ds_read_b128 v[72:75], v2 offset:29696
  v_mfma_f32_16x16x32_bf16 v[20:23], v[44:47], a[104:107], v[20:23]
  v_mfma_f32_16x16x32_bf16 v[24:27], v[44:47], a[108:111], v[24:27]
  s_waitcnt lgkmcnt(6)
  v_mfma_f32_16x16x32_bf16 v[28:31], v[48:51], a[96:99], v[28:31]
  v_mfma_f32_16x16x32_bf16 v[32:35], v[48:51], a[100:103], v[32:35]
  v_mfma_f32_16x16x32_bf16 v[36:39], v[48:51], a[104:107], v[36:39]
  v_mfma_f32_16x16x32_bf16 v[40:43], v[48:51], a[108:111], v[40:43]
  s_waitcnt lgkmcnt(5)
  v_mfma_f32_16x16x32_bf16 v[12:15], v[52:55], a[112:115], v[12:15]
  ds_read_b128 v[44:47], v2 offset:12288
  v_mfma_f32_16x16x32_bf16 v[16:19], v[52:55], a[116:119], v[16:19]
  ds_read_b128 v[48:51], v2 offset:30720
  v_mfma_f32_16x16x32_bf16 v[20:23], v[52:55], a[120:123], v[20:23]
  v_mfma_f32_16x16x32_bf16 v[24:27], v[52:55], a[124:127], v[24:27]
  s_waitcnt lgkmcnt(6)
  v_mfma_f32_16x16x32_bf16 v[28:31], v[56:59], a[112:115], v[28:31]
  v_mfma_f32_16x16x32_bf16 v[32:35], v[56:59], a[116:119], v[32:35]
  v_mfma_f32_16x16x32_bf16 v[36:39], v[56:59], a[120:123], v[36:39]
  v_mfma_f32_16x16x32_bf16 v[40:43], v[56:59], a[124:127], v[40:43]
  s_waitcnt lgkmcnt(5)
  v_mfma_f32_16x16x32_bf16 v[12:15], v[60:63], a[128:131], v[12:15]
  ds_read_b128 v[52:55], v2 offset:13312
  v_mfma_f32_16x16x32_bf16 v[16:19], v[60:63], a[132:135], v[16:19]
  ds_read_b128 v[56:59], v2 offset:31744
  v_mfma_f32_16x16x32_bf16 v[20:23], v[60:63], a[136:139], v[20:23]
  v_mfma_f32_16x16x32_bf16 v[24:27], v[60:63], a[140:143], v[24:27]
  s_waitcnt lgkmcnt(6)
  v_mfma_f32_16x16x32_bf16 v[28:31], v[64:67], a[128:131], v[28:31]
  v_mfma_f32_16x16x32_bf16 v[32:35], v[64:67], a[132:135], v[32:35]
  v_mfma_f32_16x16x32_bf16 v[36:39], v[64:67], a[136:139], v[36:39]
  v_mfma_f32_16x16x32_bf16 v[40:43], v[64:67], a[140:143], v[40:43]
  s_waitcnt lgkmcnt(5)
  v_mfma_f32_16x16x32_bf16 v[12:15], v[68:71], a[144:147], v[12:15]
  ds_read_b128 v[60:63], v2 offset:14336
  v_mfma_f32_16x16x32_bf16 v[16:19], v[68:71], a[148:151], v[16:19]
  ds_read_b128 v[64:67], v2 offset:32768
  v_mfma_f32_16x16x32_bf16 v[20:23], v[68:71], a[152:155], v[20:23]
  v_mfma_f32_16x16x32_bf16 v[24:27], v[68:71], a[156:159], v[24:27]
  s_waitcnt lgkmcnt(6)
  v_mfma_f32_16x16x32_bf16 v[28:31], v[72:75], a[144:147], v[28:31]
  v_mfma_f32_16x16x32_bf16 v[32:35], v[72:75], a[148:151], v[32:35]
  v_mfma_f32_16x16x32_bf16 v[36:39], v[72:75], a[152:155], v[36:39]
  v_mfma_f32_16x16x32_bf16 v[40:43], v[72:75], a[156:159], v[40:43]
  s_waitcnt lgkmcnt(5)
  v_mfma_f32_16x16x32_bf16 v[12:15], v[44:47], a[160:163], v[12:15]
  ds_read_b128 v[68:71], v2 offset:15360
  v_mfma_f32_16x16x32_bf16 v[16:19], v[44:47], a[164:167], v[16:19]
  ds_read_b128 v[72:75], v2 offset:33792
  v_mfma_f32_16x16x32_bf16 v[20:23], v[44:47], a[168:171], v[20:23]
  v_mfma_f32_16x16x32_bf16 v[24:27], v[44:47], a[172:175], v[24:27]
  s_waitcnt lgkmcnt(6)
  v_mfma_f32_16x16x32_bf16 v[28:31], v[48:51], a[160:163], v[28:31]
  v_mfma_f32_16x16x32_bf16 v[32:35], v[48:51], a[164:167], v[32:35]
  v_mfma_f32_16x16x32_bf16 v[36:39], v[48:51], a[168:171], v[36:39]
  v_mfma_f32_16x16x32_bf16 v[40:43], v[48:51], a[172:175], v[40:43]
  s_waitcnt lgkmcnt(5)
  v_mfma_f32_16x16x32_bf16 v[12:15], v[52:55], a[176:179], v[12:15]
  ds_read_b128 v[44:47], v2 offset:16384
  v_mfma_f32_16x16x32_bf16 v[16:19], v[52:55], a[180:183], v[16:19]
  ds_read_b128 v[48:51], v2 offset:34816
  v_mfma_f32_16x16x32_bf16 v[20:23], v[52:55], a[184:187], v[20:23]
  v_mfma_f32_16x16x32_bf16 v[24:27], v[52:55], a[188:191], v[24:27]
  s_waitcnt lgkmcnt(6)
  v_mfma_f32_16x16x32_bf16 v[28:31], v[56:59], a[176:179], v[28:31]
  v_mfma_f32_16x16x32_bf16 v[32:35], v[56:59], a[180:183], v[32:35]
  v_mfma_f32_16x16x32_bf16 v[36:39], v[56:59], a[184:187], v[36:39]
  v_mfma_f32_16x16x32_bf16 v[40:43], v[56:59], a[188:191], v[40:43]
  s_waitcnt lgkmcnt(5)
  v_mfma_f32_16x16x32_bf16 v[12:15], v[60:63], a[192:195], v[12:15]
  ds_read_b128 v[52:55], v2 offset:17408
  s_waitcnt vmcnt(10)
  ds_write_b128 v3, v[76:79] offset:0
  v_mfma_f32_16x16x32_bf16 v[16:19], v[60:63], a[196:199], v[16:19]
  ds_read_b128 v[56:59], v2 offset:35840
  v_mfma_f32_16x16x32_bf16 v[20:23], v[60:63], a[200:203], v[20:23]
  s_waitcnt vmcnt(9)
  ds_write_b128 v3, v[80:83] offset:1024
  v_mfma_f32_16x16x32_bf16 v[24:27], v[60:63], a[204:207], v[24:27]
  s_waitcnt lgkmcnt(8)
  v_mfma_f32_16x16x32_bf16 v[28:31], v[64:67], a[192:195], v[28:31]
  s_waitcnt vmcnt(8)
  ds_write_b128 v3, v[84:87] offset:2048
  v_mfma_f32_16x16x32_bf16 v[32:35], v[64:67], a[196:199], v[32:35]
  v_mfma_f32_16x16x32_bf16 v[36:39], v[64:67], a[200:203], v[36:39]
  s_waitcnt vmcnt(7)
  ds_write_b128 v3, v[88:91] offset:3072
  v_mfma_f32_16x16x32_bf16 v[40:43], v[64:67], a[204:207], v[40:43]
  s_waitcnt lgkmcnt(9)
  v_mfma_f32_16x16x32_bf16 v[12:15], v[68:71], a[208:211], v[12:15]
  s_waitcnt vmcnt(6)
  ds_write_b128 v3, v[92:95] offset:4096
  v_mfma_f32_16x16x32_bf16 v[16:19], v[68:71], a[212:215], v[16:19]
  v_mfma_f32_16x16x32_bf16 v[20:23], v[68:71], a[216:219], v[20:23]
  s_waitcnt vmcnt(5)
  ds_write_b128 v3, v[96:99] offset:5120
  v_mfma_f32_16x16x32_bf16 v[24:27], v[68:71], a[220:223], v[24:27]
  s_waitcnt lgkmcnt(10)
  v_mfma_f32_16x16x32_bf16 v[28:31], v[72:75], a[208:211], v[28:31]
  s_waitcnt vmcnt(4)
  ds_write_b128 v3, v[100:103] offset:6144
  v_mfma_f32_16x16x32_bf16 v[32:35], v[72:75], a[212:215], v[32:35]
  v_mfma_f32_16x16x32_bf16 v[36:39], v[72:75], a[216:219], v[36:39]
  s_waitcnt vmcnt(3)
  ds_write_b128 v3, v[104:107] offset:7168
  v_mfma_f32_16x16x32_bf16 v[40:43], v[72:75], a[220:223], v[40:43]
  s_waitcnt lgkmcnt(11)
  v_mfma_f32_16x16x32_bf16 v[12:15], v[44:47], a[224:227], v[12:15]
  s_waitcnt vmcnt(2)
  ds_write_b128 v3, v[108:111] offset:8192
  v_mfma_f32_16x16x32_bf16 v[16:19], v[44:47], a[228:231], v[16:19]
  v_mfma_f32_16x16x32_bf16 v[20:23], v[44:47], a[232:235], v[20:23]
  v_mfma_f32_16x16x32_bf16 v[24:27], v[44:47], a[236:239], v[24:27]
  s_waitcnt lgkmcnt(11)
  v_mfma_f32_16x16x32_bf16 v[28:31], v[48:51], a[224:227], v[28:31]
  v_mfma_f32_16x16x32_bf16 v[32:35], v[48:51], a[228:231], v[32:35]
  v_mfma_f32_16x16x32_bf16 v[36:39], v[48:51], a[232:235], v[36:39]
  v_mfma_f32_16x16x32_bf16 v[40:43], v[48:51], a[236:239], v[40:43]
  s_waitcnt lgkmcnt(10)
  v_mfma_f32_16x16x32_bf16 v[12:15], v[52:55], a[240:243], v[12:15]
  v_mfma_f32_16x16x32_bf16 v[16:19], v[52:55], a[244:247], v[16:19]
  v_mfma_f32_16x16x32_bf16 v[20:23], v[52:55], a[248:251], v[20:23]
  v_mfma_f32_16x16x32_bf16 v[24:27], v[52:55], a[252:255], v[24:27]
  s_waitcnt lgkmcnt(8)
  v_mfma_f32_16x16x32_bf16 v[28:31], v[56:59], a[240:243], v[28:31]
  v_mfma_f32_16x16x32_bf16 v[32:35], v[56:59], a[244:247], v[32:35]
  v_mfma_f32_16x16x32_bf16 v[36:39], v[56:59], a[248:251], v[36:39]
  v_mfma_f32_16x16x32_bf16 v[40:43], v[56:59], a[252:255], v[40:43]
  v_cvt_pk_bf16_f32 v112, v12, v13
  v_cvt_pk_bf16_f32 v113, v28, v29
  v_cvt_pk_bf16_f32 v114, v14, v15
  v_cvt_pk_bf16_f32 v115, v30, v31
  buffer_store_dwordx4 v[112:115], v9, s[4:7], s45 offen offset:0 sc1
  v_cvt_pk_bf16_f32 v116, v16, v17
  v_cvt_pk_bf16_f32 v117, v32, v33
  v_cvt_pk_bf16_f32 v118, v18, v19
  v_cvt_pk_bf16_f32 v119, v34, v35
  buffer_store_dwordx4 v[116:119], v9, s[4:7], s45 offen offset:1024 sc1
  v_cvt_pk_bf16_f32 v120, v20, v21
  v_cvt_pk_bf16_f32 v121, v36, v37
  v_cvt_pk_bf16_f32 v122, v22, v23
  v_cvt_pk_bf16_f32 v123, v38, v39
  buffer_store_dwordx4 v[120:123], v9, s[4:7], s45 offen offset:2048 sc1
  v_cvt_pk_bf16_f32 v124, v24, v25
  v_cvt_pk_bf16_f32 v125, v40, v41
  v_cvt_pk_bf16_f32 v126, v26, v27
  v_cvt_pk_bf16_f32 v127, v42, v43
  buffer_store_dwordx4 v[124:127], v9, s[4:7], s45 offen offset:3072 sc1
  buffer_store_dwordx4 v[128:131], v0, s[4:7], s54 offen offset:0 sc1
  buffer_store_dwordx4 v[128:131], v0, s[4:7], s54 offen offset:1024 sc1
  s_mov_b32 s43, s42
  s_mov_b32 s36, s37
  s_waitcnt lgkmcnt(0)
  s_barrier
  v_xor_b32 v2, 0x10000, v2
  v_xor_b32 v3, 0x10000, v3
  s_branch L_vv_top
L_vv_nopf:
  ds_read_b128 v[44:47], v2 offset:0
  ds_read_b128 v[48:51], v2 offset:18432
  ds_read_b128 v[52:55], v2 offset:1024
  ds_read_b128 v[56:59], v2 offset:19456
  ds_read_b128 v[60:63], v2 offset:2048
  ds_read_b128 v[64:67], v2 offset:20480
  s_waitcnt lgkmcnt(5)
  v_mfma_f32_16x16x32_bf16 v[12:15], v[44:47], v[224:227], 0
  ds_read_b128 v[68:71], v2 offset:3072
  v_mfma_f32_16x16x32_bf16 v[16:19], v[44:47], v[228:231], 0
  ds_read_b128 v[72:75], v2 offset:21504
  v_mfma_f32_16x16x32_bf16 v[20:23], v[44:47], v[232:235], 0
  v_mfma_f32_16x16x32_bf16 v[24:27], v[44:47], v[236:239], 0
  s_waitcnt lgkmcnt(6)
  v_mfma_f32_16x16x32_bf16 v[28:31], v[48:51], v[224:227], 0
  v_mfma_f32_16x16x32_bf16 v[32:35], v[48:51], v[228:231], 0
  v_mfma_f32_16x16x32_bf16 v[36:39], v[48:51], v[232:235], 0
  v_mfma_f32_16x16x32_bf16 v[40:43], v[48:51], v[236:239], 0
  s_waitcnt lgkmcnt(5)
  v_mfma_f32_16x16x32_bf16 v[12:15], v[52:55], v[240:243], v[12:15]
  ds_read_b128 v[44:47], v2 offset:4096
  v_mfma_f32_16x16x32_bf16 v[16:19], v[52:55], v[244:247], v[16:19]
  ds_read_b128 v[48:51], v2 offset:22528
  v_mfma_f32_16x16x32_bf16 v[20:23], v[52:55], v[248:251], v[20:23]
  v_mfma_f32_16x16x32_bf16 v[24:27], v[52:55], v[252:255], v[24:27]
  s_waitcnt lgkmcnt(6)
  v_mfma_f32_16x16x32_bf16 v[28:31], v[56:59], v[240:243], v[28:31]
  v_mfma_f32_16x16x32_bf16 v[32:35], v[56:59], v[244:247], v[32:35]
  v_mfma_f32_16x16x32_bf16 v[36:39], v[56:59], v[248:251], v[36:39]
  v_mfma_f32_16x16x32_bf16 v[40:43], v[56:59], v[252:255], v[40:43]
  s_waitcnt lgkmcnt(5)
  v_mfma_f32_16x16x32_bf16 v[12:15], v[60:63], a[0:3], v[12:15]
  ds_read_b128 v[52:55], v2 offset:5120
  v_mfma_f32_16x16x32_bf16 v[16:19], v[60:63], a[4:7], v[16:19]
  ds_read_b128 v[56:59], v2 offset:23552
  v_mfma_f32_16x16x32_bf16 v[20:23], v[60:63], a[8:11], v[20:23]
  v_mfma_f32_16x16x32_bf16 v[24:27], v[60:63], a[12:15], v[24:27]
  s_waitcnt lgkmcnt(6)
  v_mfma_f32_16x16x32_bf16 v[28:31], v[64:67], a[0:3], v[28:31]
  v_mfma_f32_16x16x32_bf16 v[32:35], v[64:67], a[4:7], v[32:35]
  v_mfma_f32_16x16x32_bf16 v[36:39], v[64:67], a[8:11], v[36:39]
  v_mfma_f32_16x16x32_bf16 v[40:43], v[64:67], a[12:15], v[40:43]
  s_waitcnt lgkmcnt(5)
  v_mfma_f32_16x16x32_bf16 v[12:15], v[68:71], a[16:19], v[12:15]
  ds_read_b128 v[60:63], v2 offset:6144
  v_mfma_f32_16x16x32_bf16 v[16:19], v[68:71], a[20:23], v[16:19]
  ds_read_b128 v[64:67], v2 offset:24576
  v_mfma_f32_16x16x32_bf16 v[20:23], v[68:71], a[24:27], v[20:23]
  v_mfma_f32_16x16x32_bf16 v[24:27], v[68:71], a[28:31], v[24:27]
  s_waitcnt lgkmcnt(6)
  v_mfma_f32_16x16x32_bf16 v[28:31], v[72:75], a[16:19], v[28:31]
  v_mfma_f32_16x16x32_bf16 v[32:35], v[72:75], a[20:23], v[32:35]
  v_mfma_f32_16x16x32_bf16 v[36:39], v[72:75], a[24:27], v[36:39]
  v_mfma_f32_16x16x32_bf16 v[40:43], v[72:75], a[28:31], v[40:43]
  s_waitcnt lgkmcnt(5)
  v_mfma_f32_16x16x32_bf16 v[12:15], v[44:47], a[32:35], v[12:15]
  ds_read_b128 v[68:71], v2 offset:7168
  v_mfma_f32_16x16x32_bf16 v[16:19], v[44:47], a[36:39], v[16:19]
  ds_read_b128 v[72:75], v2 offset:25600
  v_mfma_f32_16x16x32_bf16 v[20:23], v[44:47], a[40:43], v[20:23]
  v_mfma_f32_16x16x32_bf16 v[24:27], v[44:47], a[44:47], v[24:27]
  s_waitcnt lgkmcnt(6)
  v_mfma_f32_16x16x32_bf16 v[28:31], v[48:51], a[32:35], v[28:31]
  v_mfma_f32_16x16x32_bf16 v[32:35], v[48:51], a[36:39], v[32:35]
  v_mfma_f32_16x16x32_bf16 v[36:39], v[48:51], a[40:43], v[36:39]
  v_mfma_f32_16x16x32_bf16 v[40:43], v[48:51], a[44:47], v[40:43]
  s_waitcnt lgkmcnt(5)
  v_mfma_f32_16x16x32_bf16 v[12:15], v[52:55], a[48:51], v[12:15]
  ds_read_b128 v[44:47], v2 offset:8192
  s_waitcnt vmcnt(0)
  buffer_store_dword v6, v5, s[4:7], s43 offen sc1
  v_mfma_f32_16x16x32_bf16 v[16:19], v[52:55], a[52:55], v[16:19]
  ds_read_b128 v[48:51], v2 offset:26624
  v_mfma_f32_16x16x32_bf16 v[20:23], v[52:55], a[56:59], v[20:23]
  v_mfma_f32_16x16x32_bf16 v[24:27], v[52:55], a[60:63], v[24:27]
  s_waitcnt lgkmcnt(6)
  v_mfma_f32_16x16x32_bf16 v[28:31], v[56:59], a[48:51], v[28:31]
  v_mfma_f32_16x16x32_bf16 v[32:35], v[56:59], a[52:55], v[32:35]
  v_mfma_f32_16x16x32_bf16 v[36:39], v[56:59], a[56:59], v[36:39]
  v_mfma_f32_16x16x32_bf16 v[40:43], v[56:59], a[60:63], v[40:43]
  s_waitcnt lgkmcnt(5)
  v_mfma_f32_16x16x32_bf16 v[12:15], v[60:63], a[64:67], v[12:15]
  ds_read_b128 v[52:55], v2 offset:9216
  v_mfma_f32_16x16x32_bf16 v[16:19], v[60:63], a[68:71], v[16:19]
  ds_read_b128 v[56:59], v2 offset:27648
  v_mfma_f32_16x16x32_bf16 v[20:23], v[60:63], a[72:75], v[20:23]
  v_mfma_f32_16x16x32_bf16 v[24:27], v[60:63], a[76:79], v[24:27]
  s_waitcnt lgkmcnt(6)
  v_mfma_f32_16x16x32_bf16 v[28:31], v[64:67], a[64:67], v[28:31]
  v_mfma_f32_16x16x32_bf16 v[32:35], v[64:67], a[68:71], v[32:35]
  v_mfma_f32_16x16x32_bf16 v[36:39], v[64:67], a[72:75], v[36:39]
  v_mfma_f32_16x16x32_bf16 v[40:43], v[64:67], a[76:79], v[40:43]
  s_waitcnt lgkmcnt(5)
  v_mfma_f32_16x16x32_bf16 v[12:15], v[68:71], a[80:83], v[12:15]
  ds_read_b128 v[60:63], v2 offset:10240
  v_mfma_f32_16x16x32_bf16 v[16:19], v[68:71], a[84:87], v[16:19]
  ds_read_b128 v[64:67], v2 offset:28672
  v_mfma_f32_16x16x32_bf16 v[20:23], v[68:71], a[88:91], v[20:23]
  v_mfma_f32_16x16x32_bf16 v[24:27], v[68:71], a[92:95], v[24:27]
  s_waitcnt lgkmcnt(6)
  v_mfma_f32_16x16x32_bf16 v[28:31], v[72:75], a[80:83], v[28:31]
  v_mfma_f32_16x16x32_bf16 v[32:35], v[72:75], a[84:87], v[32:35]
  v_mfma_f32_16x16x32_bf16 v[36:39], v[72:75], a[88:91], v[36:39]
  v_mfma_f32_16x16x32_bf16 v[40:43], v[72:75], a[92:95], v[40:43]
  s_waitcnt lgkmcnt(5)
  v_mfma_f32_16x16x32_bf16 v[12:15], v[44:47], a[96:99], v[12:15]
  ds_read_b128 v[68:71], v2 offset:11264
  v_mfma_f32_16x16x32_bf16 v[16:19], v[44:47], a[100:103], v[16:19]
  ds_read_b128 v[72:75], v2 offset:29696
  v_mfma_f32_16x16x32_bf16 v[20:23], v[44:47], a[104:107], v[20:23]
  v_mfma_f32_16x16x32_bf16 v[24:27], v[44:47], a[108:111], v[24:27]
  s_waitcnt lgkmcnt(6)
  v_mfma_f32_16x16x32_bf16 v[28:31], v[48:51], a[96:99], v[28:31]
  v_mfma_f32_16x16x32_bf16 v[32:35], v[48:51], a[100:103], v[32:35]
  v_mfma_f32_16x16x32_bf16 v[36:39], v[48:51], a[104:107], v[36:39]
  v_mfma_f32_16x16x32_bf16 v[40:43], v[48:51], a[108:111], v[40:43]
  s_waitcnt lgkmcnt(5)
  v_mfma_f32_16x16x32_bf16 v[12:15], v[52:55], a[112:115], v[12:15]
  ds_read_b128 v[44:47], v2 offset:12288
  v_mfma_f32_16x16x32_bf16 v[16:19], v[52:55], a[116:119], v[16:19]
  ds_read_b128 v[48:51], v2 offset:30720
  v_mfma_f32_16x16x32_bf16 v[20:23], v[52:55], a[120:123], v[20:23]
  v_mfma_f32_16x16x32_bf16 v[24:27], v[52:55], a[124:127], v[24:27]
  s_waitcnt lgkmcnt(6)
  v_mfma_f32_16x16x32_bf16 v[28:31], v[56:59], a[112:115], v[28:31]
  v_mfma_f32_16x16x32_bf16 v[32:35], v[56:59], a[116:119], v[32:35]
  v_mfma_f32_16x16x32_bf16 v[36:39], v[56:59], a[120:123], v[36:39]
  v_mfma_f32_16x16x32_bf16 v[40:43], v[56:59], a[124:127], v[40:43]
  s_waitcnt lgkmcnt(5)
  v_mfma_f32_16x16x32_bf16 v[12:15], v[60:63], a[128:131], v[12:15]
  ds_read_b128 v[52:55], v2 offset:13312
  v_mfma_f32_16x16x32_bf16 v[16:19], v[60:63], a[132:135], v[16:19]
  ds_read_b128 v[56:59], v2 offset:31744
  v_mfma_f32_16x16x32_bf16 v[20:23], v[60:63], a[136:139], v[20:23]
  v_mfma_f32_16x16x32_bf16 v[24:27], v[60:63], a[140:143], v[24:27]
  s_waitcnt lgkmcnt(6)
  v_mfma_f32_16x16x32_bf16 v[28:31], v[64:67], a[128:131], v[28:31]
  v_mfma_f32_16x16x32_bf16 v[32:35], v[64:67], a[132:135], v[32:35]
  v_mfma_f32_16x16x32_bf16 v[36:39], v[64:67], a[136:139], v[36:39]
  v_mfma_f32_16x16x32_bf16 v[40:43], v[64:67], a[140:143], v[40:43]
  s_waitcnt lgkmcnt(5)
  v_mfma_f32_16x16x32_bf16 v[12:15], v[68:71], a[144:147], v[12:15]
  ds_read_b128 v[60:63], v2 offset:14336
  v_mfma_f32_16x16x32_bf16 v[16:19], v[68:71], a[148:151], v[16:19]
  ds_read_b128 v[64:67], v2 offset:32768
  v_mfma_f32_16x16x32_bf16 v[20:23], v[68:71], a[152:155], v[20:23]
  v_mfma_f32_16x16x32_bf16 v[24:27], v[68:71], a[156:159], v[24:27]
  s_waitcnt lgkmcnt(6)
  v_mfma_f32_16x16x32_bf16 v[28:31], v[72:75], a[144:147], v[28:31]
  v_mfma_f32_16x16x32_bf16 v[32:35], v[72:75], a[148:151], v[32:35]
  v_mfma_f32_16x16x32_bf16 v[36:39], v[72:75], a[152:155], v[36:39]
  v_mfma_f32_16x16x32_bf16 v[40:43], v[72:75], a[156:159], v[40:43]
  s_waitcnt lgkmcnt(5)
  v_mfma_f32_16x16x32_bf16 v[12:15], v[44:47], a[160:163], v[12:15]
  ds_read_b128 v[68:71], v2 offset:15360
  v_mfma_f32_16x16x32_bf16 v[16:19], v[44:47], a[164:167], v[16:19]
  ds_read_b128 v[72:75], v2 offset:33792
  v_mfma_f32_16x16x32_bf16 v[20:23], v[44:47], a[168:171], v[20:23]
  v_mfma_f32_16x16x32_bf16 v[24:27], v[44:47], a[172:175], v[24:27]
  s_waitcnt lgkmcnt(6)
  v_mfma_f32_16x16x32_bf16 v[28:31], v[48:51], a[160:163], v[28:31]
  v_mfma_f32_16x16x32_bf16 v[32:35], v[48:51], a[164:167], v[32:35]
  v_mfma_f32_16x16x32_bf16 v[36:39], v[48:51], a[168:171], v[36:39]
  v_mfma_f32_16x16x32_bf16 v[40:43], v[48:51], a[172:175], v[40:43]
  s_waitcnt lgkmcnt(5)
  v_mfma_f32_16x16x32_bf16 v[12:15], v[52:55], a[176:179], v[12:15]
  ds_read_b128 v[44:47], v2 offset:16384
  v_mfma_f32_16x16x32_bf16 v[16:19], v[52:55], a[180:183], v[16:19]
  ds_read_b128 v[48:51], v2 offset:34816
  v_mfma_f32_16x16x32_bf16 v[20:23], v[52:55], a[184:187], v[20:23]
  v_mfma_f32_16x16x32_bf16 v[24:27], v[52:55], a[188:191], v[24:27]
  s_waitcnt lgkmcnt(6)
  v_mfma_f32_16x16x32_bf16 v[28:31], v[56:59], a[176:179], v[28:31]
  v_mfma_f32_16x16x32_bf16 v[32:35], v[56:59], a[180:183], v[32:35]
  v_mfma_f32_16x16x32_bf16 v[36:39], v[56:59], a[184:187], v[36:39]
  v_mfma_f32_16x16x32_bf16 v[40:43], v[56:59], a[188:191], v[40:43]
  s_waitcnt lgkmcnt(5)
  v_mfma_f32_16x16x32_bf16 v[12:15], v[60:63], a[192:195], v[12:15]
  ds_read_b128 v[52:55], v2 offset:17408
  v_mfma_f32_16x16x32_bf16 v[16:19], v[60:63], a[196:199], v[16:19]
  ds_read_b128 v[56:59], v2 offset:35840
  v_mfma_f32_16x16x32_bf16 v[20:23], v[60:63], a[200:203], v[20:23]
  v_mfma_f32_16x16x32_bf16 v[24:27], v[60:63], a[204:207], v[24:27]
  s_waitcnt lgkmcnt(6)
  v_mfma_f32_16x16x32_bf16 v[28:31], v[64:67], a[192:195], v[28:31]
  v_mfma_f32_16x16x32_bf16 v[32:35], v[64:67], a[196:199], v[32:35]
  v_mfma_f32_16x16x32_bf16 v[36:39], v[64:67], a[200:203], v[36:39]
  v_mfma_f32_16x16x32_bf16 v[40:43], v[64:67], a[204:207], v[40:43]
  s_waitcnt lgkmcnt(5)
  v_mfma_f32_16x16x32_bf16 v[12:15], v[68:71], a[208:211], v[12:15]
  v_mfma_f32_16x16x32_bf16 v[16:19], v[68:71], a[212:215], v[16:19]
  v_mfma_f32_16x16x32_bf16 v[20:23], v[68:71], a[216:219], v[20:23]
  v_mfma_f32_16x16x32_bf16 v[24:27], v[68:71], a[220:223], v[24:27]
  s_waitcnt lgkmcnt(4)
  v_mfma_f32_16x16x32_bf16 v[28:31], v[72:75], a[208:211], v[28:31]
  v_mfma_f32_16x16x32_bf16 v[32:35], v[72:75], a[212:215], v[32:35]
  v_mfma_f32_16x16x32_bf16 v[36:39], v[72:75], a[216:219], v[36:39]
  v_mfma_f32_16x16x32_bf16 v[40:43], v[72:75], a[220:223], v[40:43]
  s_waitcnt lgkmcnt(3)
  v_mfma_f32_16x16x32_bf16 v[12:15], v[44:47], a[224:227], v[12:15]
  v_mfma_f32_16x16x32_bf16 v[16:19], v[44:47], a[228:231], v[16:19]
  v_mfma_f32_16x16x32_bf16 v[20:23], v[44:47], a[232:235], v[20:23]
  v_mfma_f32_16x16x32_bf16 v[24:27], v[44:47], a[236:239], v[24:27]
  s_waitcnt lgkmcnt(2)
  v_mfma_f32_16x16x32_bf16 v[28:31], v[48:51], a[224:227], v[28:31]
  v_mfma_f32_16x16x32_bf16 v[32:35], v[48:51], a[228:231], v[32:35]
  v_mfma_f32_16x16x32_bf16 v[36:39], v[48:51], a[232:235], v[36:39]
  v_mfma_f32_16x16x32_bf16 v[40:43], v[48:51], a[236:239], v[40:43]
  s_waitcnt lgkmcnt(1)
  v_mfma_f32_16x16x32_bf16 v[12:15], v[52:55], a[240:243], v[12:15]
  v_mfma_f32_16x16x32_bf16 v[16:19], v[52:55], a[244:247], v[16:19]
  v_mfma_f32_16x16x32_bf16 v[20:23], v[52:55], a[248:251], v[20:23]
  v_mfma_f32_16x16x32_bf16 v[24:27], v[52:55], a[252:255], v[24:27]
  s_waitcnt lgkmcnt(0)
  v_mfma_f32_16x16x32_bf16 v[28:31], v[56:59], a[240:243], v[28:31]
  v_mfma_f32_16x16x32_bf16 v[32:35], v[56:59], a[244:247], v[32:35]
  v_mfma_f32_16x16x32_bf16 v[36:39], v[56:59], a[248:251], v[36:39]
  v_mfma_f32_16x16x32_bf16 v[40:43], v[56:59], a[252:255], v[40:43]
  v_cvt_pk_bf16_f32 v112, v12, v13
  v_cvt_pk_bf16_f32 v113, v28, v29
  v_cvt_pk_bf16_f32 v114, v14, v15
  v_cvt_pk_bf16_f32 v115, v30, v31
  buffer_store_dwordx4 v[112:115], v9, s[4:7], s45 offen offset:0 sc1
  v_cvt_pk_bf16_f32 v116, v16, v17
  v_cvt_pk_bf16_f32 v117, v32, v33
  v_cvt_pk_bf16_f32 v118, v18, v19
  v_cvt_pk_bf16_f32 v119, v34, v35
  buffer_store_dwordx4 v[116:119], v9, s[4:7], s45 offen offset:1024 sc1
  v_cvt_pk_bf16_f32 v120, v20, v21
  v_cvt_pk_bf16_f32 v121, v36, v37
  v_cvt_pk_bf16_f32 v122, v22, v23
  v_cvt_pk_bf16_f32 v123, v38, v39
  buffer_store_dwordx4 v[120:123], v9, s[4:7], s45 offen offset:2048 sc1
  v_cvt_pk_bf16_f32 v124, v24, v25
  v_cvt_pk_bf16_f32 v125, v40, v41
  v_cvt_pk_bf16_f32 v126, v26, v27
  v_cvt_pk_bf16_f32 v127, v42, v43
  buffer_store_dwordx4 v[124:127], v9, s[4:7], s45 offen offset:3072 sc1
  buffer_store_dwordx4 v[128:131], v0, s[4:7], s54 offen offset:0 sc1
  buffer_store_dwordx4 v[128:131], v0, s[4:7], s54 offen offset:1024 sc1
  s_waitcnt vmcnt(0)
  buffer_store_dword v6, v5, s[4:7], s42 offen sc1
  s_mov_b32 s43, 0x40000000
  s_cmp_ge_u32 s37, 64
  s_cbranch_scc1 L_vv_done
  s_lshl_b32 s44, s37, 3
  s_mov_b32 s49, 0
L_poll_13:
  buffer_load_dword v8, v7, s[4:7], s44 offen sc1
  s_waitcnt vmcnt(0)
  v_cmp_eq_u32 vcc, 0, v8
  s_cbranch_vccz L_polld_14
  s_add_u32 s49, s49, 1
  s_cmp_lt_u32 s49, 1048576
  s_cbranch_scc1 L_poll_13
  s_branch L_fail
L_polld_14:
  s_mul_i32 s38, s37, 36864
  s_add_u32 s38, s38, 0x200000
  s_add_u32 s39, s38, 4096
  s_add_u32 s40, s38, 8192
  s_add_u32 s26, s37, 3
  s_min_u32 s26, s26, 63
  s_lshl_b32 s44, s26, 3
  buffer_load_dword v8, v7, s[4:7], s44 offen sc1
  buffer_load_dwordx4 v[76:79], v4, s[4:7], s38 offen offset:0 sc1
  buffer_load_dwordx4 v[80:83], v4, s[4:7], s38 offen offset:1024 sc1
  buffer_load_dwordx4 v[84:87], v4, s[4:7], s38 offen offset:2048 sc1
  buffer_load_dwordx4 v[88:91], v4, s[4:7], s38 offen offset:3072 sc1
  buffer_load_dwordx4 v[92:95], v4, s[4:7], s39 offen offset:0 sc1
  buffer_load_dwordx4 v[96:99], v4, s[4:7], s39 offen offset:1024 sc1
  buffer_load_dwordx4 v[100:103], v4, s[4:7], s39 offen offset:2048 sc1
  buffer_load_dwordx4 v[104:107], v4, s[4:7], s39 offen offset:3072 sc1
  buffer_load_dwordx4 v[108:111], v4, s[4:7], s40 offen offset:0 sc1
  s_waitcnt vmcnt(8)
  ds_write_b128 v3, v[76:79] offset:0
  s_waitcnt vmcnt(7)
  ds_write_b128 v3, v[80:83] offset:1024
  s_waitcnt vmcnt(6)
  ds_write_b128 v3, v[84:87] offset:2048
  s_waitcnt vmcnt(5)
  ds_write_b128 v3, v[88:91] offset:3072
  s_waitcnt vmcnt(4)
  ds_write_b128 v3, v[92:95] offset:4096
  s_waitcnt vmcnt(3)
  ds_write_b128 v3, v[96:99] offset:5120
  s_waitcnt vmcnt(2)
  ds_write_b128 v3, v[100:103] offset:6144
  s_waitcnt vmcnt(1)
  ds_write_b128 v3, v[104:107] offset:7168
  s_waitcnt vmcnt(0)
  ds_write_b128 v3, v[108:111] offset:8192
  s_mov_b32 s36, s37
  s_waitcnt lgkmcnt(0)
  s_barrier
  v_xor_b32 v2, 0x10000, v2
  v_xor_b32 v3, 0x10000, v3
  s_branch L_vv_top
L_vv_done:
L_qkv_end:
  s_mov_b32 s24, s69
L_p2:
  v_lshrrev_b32 v1, 4, v0
  s_barrier
  s_cmp_lt_u32 s24, 48
  s_cbranch_scc1 L_role_bc
  s_sub_u32 s24, s24, 48
  s_cmp_lt_u32 s24, 72
  s_cbranch_scc1 L_role_dd
  s_sub_u32 s24, s24, 72
  s_cmp_lt_u32 s24, 36
  s_cbranch_scc1 L_role_ee
  s_sub_u32 s24, s24, 36
  s_cmp_lt_u32 s24, 18
  s_cbranch_scc1 L_role_r1
  s_sub_u32 s24, s24, 18
  s_cmp_lt_u32 s24, 18
  s_cbranch_scc1 L_role_r2
  s_sub_u32 s24, s24, 18
  s_branch L_exit
L_role_bc:
  s_mov_b32 s28, 0
L_reg_15:
  v_mov_b32 v8, 0
  buffer_load_dword v9, v8, s[20:23], 0 offen offset:64 sc1
  s_add_u32 s28, s28, 1
  s_cmp_gt_u32 s28, 1048576
  s_cbranch_scc1 L_fail
  s_waitcnt vmcnt(0)
  v_readfirstlane_b32 s67, v9
L_regc_16:
  s_and_b32 s26, s67, 0xffff
  s_cmp_lt_u32 s26, 256
  s_cbranch_scc1 L_reg_15
  s_lshr_b32 s67, s67, 16
  v_mov_b32 v2, 0
  s_mov_b32 s26, 0x0
  s_mov_b32 s27, 0
L_poll_17:
  buffer_load_dword v3, v2, s[4:7], s26 offen sc1
  s_waitcnt vmcnt(0)
  v_cmp_eq_u32 vcc, 0, v3
  s_cbranch_vccz L_polld_18
  s_add_u32 s27, s27, 1
  s_cmp_lt_u32 s27, 1048576
  s_cbranch_scc1 L_poll_17
  s_branch L_fail
L_polld_18:
  s_mul_i32 s50, s24, 1366
  s_lshr_b32 s50, s50, 12
  s_mul_i32 s36, s50, 3
  s_sub_u32 s36, s24, s36
  s_load_dwordx2 s[8:9], s[0:1], 40
  s_mov_b32 s10, 0x480000
  s_mov_b32 s11, 0x20000
  s_waitcnt lgkmcnt(0)
  s_mul_i32 s29, s25, 9
  s_add_u32 s29, s29, 1
  s_lshr_b32 s29, s29, 1
  s_lshr_b32 s30, s25, 1
  s_mul_i32 s30, s30, 9
  s_add_u32 s30, s30, 4
  s_mul_i32 s27, s50, 294912
  s_lshl_b32 s28, s30, 6
  s_add_u32 s28, s28, s27
  v_lshrrev_b32 v21, 2, v1
  v_mul_u32_u24 v21, 1152, v21
  v_and_b32 v22, 3, v1
  v_lshlrev_b32 v22, 4, v22
  v_add3_u32 v21, v21, v22, s28
  s_lshl_b32 s28, s29, 6
  s_add_u32 s28, s28, s27
  v_lshrrev_b32 v20, 4, v1
  v_mul_u32_u24 v20, 1152, v20
  v_and_b32 v22, 15, v1
  v_lshlrev_b32 v22, 4, v22
  v_add3_u32 v20, v20, v22, s28
  s_mul_i32 s26, s25, 40960
  v_lshrrev_b32 v24, 4, v1
  v_mul_u32_u24 v24, 1024, v24
  v_bfe_u32 v25, v1, 2, 2
  v_mul_u32_u24 v25, 256, v25
  v_add_u32 v24, v24, v25
  v_and_b32 v25, 3, v1
  v_mul_u32_u24 v25, 16, v25
  v_add3_u32 v22, v24, v25, s26
  v_lshrrev_b32 v24, 4, v1
  v_mul_u32_u24 v24, 256, v24
  v_bfe_u32 v25, v1, 2, 2
  v_mul_u32_u24 v25, 64, v25
  v_add_u32 v24, v24, v25
  v_and_b32 v25, 3, v1
  v_mul_u32_u24 v25, 16, v25
  v_add3_u32 v23, v24, v25, s26
  s_and_b32 s27, s25, 1
  s_lshl_b32 s27, s27, 3
  v_add_u32 v23, s27, v23
  s_lshl_b32 s29, s29, 10
  v_add_u32 v9, s29, v0
  s_lshl_b32 s30, s30, 10
  s_lshl_b32 s27, s27, 6
  s_add_u32 s30, s30, s27
  v_lshrrev_b32 v10, 1, v0
  v_add_u32 v10, s30, v10
  s_add_u32 m0, s26, 0x0
  s_mov_b32 s27, 0x0
  buffer_load_dwordx4 v20, s[8:11], s27 offen  lds
  s_add_u32 m0, s26, 0x400
  s_mov_b32 s27, 0x1200
  buffer_load_dwordx4 v20, s[8:11], s27 offen  lds
  s_add_u32 m0, s26, 0x800
  s_mov_b32 s27, 0x2400
  buffer_load_dwordx4 v20, s[8:11], s27 offen  lds
  s_add_u32 m0, s26, 0xc00
  s_mov_b32 s27, 0x3600
  buffer_load_dwordx4 v20, s[8:11], s27 offen  lds
  s_add_u32 m0, s26, 0x1000
  s_mov_b32 s27, 0x4800
  buffer_load_dwordx4 v20, s[8:11], s27 offen  lds
  s_add_u32 m0, s26, 0x1400
  s_mov_b32 s27, 0x5a00
  buffer_load_dwordx4 v20, s[8:11], s27 offen  lds
  s_add_u32 m0, s26, 0x1800
  s_mov_b32 s27, 0x6c00
  buffer_load_dwordx4 v20, s[8:11], s27 offen  lds
  s_add_u32 m0, s26, 0x1c00
  s_mov_b32 s27, 0x7e00
  buffer_load_dwordx4 v20, s[8:11], s27 offen  lds
  s_add_u32 m0, s26, 0x2000
  s_mov_b32 s27, 0x0
  buffer_load_dwordx4 v21, s[8:11], s27 offen  lds
  s_add_u32 m0, s26, 0x2400
  s_mov_b32 s27, 0x4800
  buffer_load_dwordx4 v21, s[8:11], s27 offen  lds
  s_add_u32 m0, s26, 0x2800
  s_mov_b32 s27, 0x9000
  buffer_load_dwordx4 v20, s[8:11], s27 offen  lds
  s_add_u32 m0, s26, 0x2c00
  s_mov_b32 s27, 0xa200
  buffer_load_dwordx4 v20, s[8:11], s27 offen  lds
  s_add_u32 m0, s26, 0x3000
  s_mov_b32 s27, 0xb400
  buffer_load_dwordx4 v20, s[8:11], s27 offen  lds
  s_add_u32 m0, s26, 0x3400
  s_mov_b32 s27, 0xc600
  buffer_load_dwordx4 v20, s[8:11], s27 offen  lds
  s_add_u32 m0, s26, 0x3800
  s_mov_b32 s27, 0xd800
  buffer_load_dwordx4 v20, s[8:11], s27 offen  lds
  s_add_u32 m0, s26, 0x3c00
  s_mov_b32 s27, 0xea00
  buffer_load_dwordx4 v20, s[8:11], s27 offen  lds
  s_add_u32 m0, s26, 0x4000
  s_mov_b32 s27, 0xfc00
  buffer_load_dwordx4 v20, s[8:11], s27 offen  lds
  s_add_u32 m0, s26, 0x4400
  s_mov_b32 s27, 0x10e00
  buffer_load_dwordx4 v20, s[8:11], s27 offen  lds
  s_add_u32 m0, s26, 0x4800
  s_mov_b32 s27, 0x9000
  buffer_load_dwordx4 v21, s[8:11], s27 offen  lds
  s_add_u32 m0, s26, 0x4c00
  s_mov_b32 s27, 0xd800
  buffer_load_dwordx4 v21, s[8:11], s27 offen  lds
  s_add_u32 m0, s26, 0x5000
  s_mov_b32 s27, 0x12000
  buffer_load_dwordx4 v20, s[8:11], s27 offen  lds
  s_add_u32 m0, s26, 0x5400
  s_mov_b32 s27, 0x13200
  buffer_load_dwordx4 v20, s[8:11], s27 offen  lds
  s_add_u32 m0, s26, 0x5800
  s_mov_b32 s27, 0x14400
  buffer_load_dwordx4 v20, s[8:11], s27 offen  lds
  s_add_u32 m0, s26, 0x5c00
  s_mov_b32 s27, 0x15600
  buffer_load_dwordx4 v20, s[8:11], s27 offen  lds
  s_add_u32 m0, s26, 0x6000
  s_mov_b32 s27, 0x16800
  buffer_load_dwordx4 v20, s[8:11], s27 offen  lds
  s_add_u32 m0, s26, 0x6400
  s_mov_b32 s27, 0x17a00
  buffer_load_dwordx4 v20, s[8:11], s27 offen  lds
  s_add_u32 m0, s26, 0x6800
  s_mov_b32 s27, 0x18c00
  buffer_load_dwordx4 v20, s[8:11], s27 offen  lds
  s_add_u32 m0, s26, 0x6c00
  s_mov_b32 s27, 0x19e00
  buffer_load_dwordx4 v20, s[8:11], s27 offen  lds
  s_add_u32 m0, s26, 0x7000
  s_mov_b32 s27, 0x12000
  buffer_load_dwordx4 v21, s[8:11], s27 offen  lds
  s_add_u32 m0, s26, 0x7400
  s_mov_b32 s27, 0x16800
  buffer_load_dwordx4 v21, s[8:11], s27 offen  lds
  s_add_u32 m0, s26, 0x7800
  s_mov_b32 s27, 0x1b000
  buffer_load_dwordx4 v20, s[8:11], s27 offen  lds
  s_add_u32 m0, s26, 0x7c00
  s_mov_b32 s27, 0x1c200
  buffer_load_dwordx4 v20, s[8:11], s27 offen  lds
  s_add_u32 m0, s26, 0x8000
  s_mov_b32 s27, 0x1d400
  buffer_load_dwordx4 v20, s[8:11], s27 offen  lds
  s_add_u32 m0, s26, 0x8400
  s_mov_b32 s27, 0x1e600
  buffer_load_dwordx4 v20, s[8:11], s27 offen  lds
  s_add_u32 m0, s26, 0x8800
  s_mov_b32 s27, 0x1f800
  buffer_load_dwordx4 v20, s[8:11], s27 offen  lds
  s_add_u32 m0, s26, 0x8c00
  s_mov_b32 s27, 0x20a00
  buffer_load_dwordx4 v20, s[8:11], s27 offen  lds
  s_add_u32 m0, s26, 0x9000
  s_mov_b32 s27, 0x21c00
  buffer_load_dwordx4 v20, s[8:11], s27 offen  lds
  s_add_u32 m0, s26, 0x9400
  s_mov_b32 s27, 0x22e00
  buffer_load_dwordx4 v20, s[8:11], s27 offen  lds
  s_add_u32 m0, s26, 0x9800
  s_mov_b32 s27, 0x1b000
  buffer_load_dwordx4 v21, s[8:11], s27 offen  lds
  s_add_u32 m0, s26, 0x9c00
  s_mov_b32 s27, 0x1f800
  buffer_load_dwordx4 v21, s[8:11], s27 offen  lds
  s_waitcnt vmcnt(30)
  ds_read_b64_tr_b16 v[224:225], v22 offset:0
  ds_read_b64_tr_b16 v[226:227], v22 offset:4096
  ds_read_b64_tr_b16 v[228:229], v22 offset:8
  ds_read_b64_tr_b16 v[230:231], v22 offset:4104
  ds_read_b64_tr_b16 v[232:233], v22 offset:64
  ds_read_b64_tr_b16 v[234:235], v22 offset:4160
  ds_read_b64_tr_b16 v[236:237], v22 offset:72
  ds_read_b64_tr_b16 v[238:239], v22 offset:4168
  ds_read_b64_tr_b16 v[240:241], v22 offset:128
  ds_read_b64_tr_b16 v[242:243], v22 offset:4224
  ds_read_b64_tr_b16 v[244:245], v22 offset:136
  ds_read_b64_tr_b16 v[246:247], v22 offset:4232
  ds_read_b64_tr_b16 v[248:249], v22 offset:192
  ds_read_b64_tr_b16 v[250:251], v22 offset:4288
  ds_read_b64_tr_b16 v[252:253], v22 offset:200
  ds_read_b64_tr_b16 v[254:255], v22 offset:4296
  ds_read_b64_tr_b16 a[0:1], v23 offset:8192
  ds_read_b64_tr_b16 a[2:3], v23 offset:9216
  s_waitcnt lgkmcnt(0)
  s_add_u32 m0, s26, 0x0
  s_mov_b32 s27, 0x24000
  buffer_load_dwordx4 v20, s[8:11], s27 offen  lds
  s_add_u32 m0, s26, 0x400
  s_mov_b32 s27, 0x25200
  buffer_load_dwordx4 v20, s[8:11], s27 offen  lds
  s_add_u32 m0, s26, 0x800
  s_mov_b32 s27, 0x26400
  buffer_load_dwordx4 v20, s[8:11], s27 offen  lds
  s_add_u32 m0, s26, 0xc00
  s_mov_b32 s27, 0x27600
  buffer_load_dwordx4 v20, s[8:11], s27 offen  lds
  s_add_u32 m0, s26, 0x1000
  s_mov_b32 s27, 0x28800
  buffer_load_dwordx4 v20, s[8:11], s27 offen  lds
  s_add_u32 m0, s26, 0x1400
  s_mov_b32 s27, 0x29a00
  buffer_load_dwordx4 v20, s[8:11], s27 offen  lds
  s_add_u32 m0, s26, 0x1800
  s_mov_b32 s27, 0x2ac00
  buffer_load_dwordx4 v20, s[8:11], s27 offen  lds
  s_add_u32 m0, s26, 0x1c00
  s_mov_b32 s27, 0x2be00
  buffer_load_dwordx4 v20, s[8:11], s27 offen  lds
  s_add_u32 m0, s26, 0x2000
  s_mov_b32 s27, 0x24000
  buffer_load_dwordx4 v21, s[8:11], s27 offen  lds
  s_add_u32 m0, s26, 0x2400
  s_mov_b32 s27, 0x28800
  buffer_load_dwordx4 v21, s[8:11], s27 offen  lds
  s_waitcnt vmcnt(30)
  ds_read_b64_tr_b16 a[4:5], v22 offset:10240
  ds_read_b64_tr_b16 a[6:7], v22 offset:14336
  ds_read_b64_tr_b16 a[8:9], v22 offset:10248
  ds_read_b64_tr_b16 a[10:11], v22 offset:14344
  ds_read_b64_tr_b16 a[12:13], v22 offset:10304
  ds_read_b64_tr_b16 a[14:15], v22 offset:14400
  ds_read_b64_tr_b16 a[16:17], v22 offset:10312
  ds_read_b64_tr_b16 a[18:19], v22 offset:14408
  ds_read_b64_tr_b16 a[20:21], v22 offset:10368
  ds_read_b64_tr_b16 a[22:23], v22 offset:14464
  ds_read_b64_tr_b16 a[24:25], v22 offset:10376
  ds_read_b64_tr_b16 a[26:27], v22 offset:14472
  ds_read_b64_tr_b16 a[28:29], v22 offset:10432
  ds_read_b64_tr_b16 a[30:31], v22 offset:14528
  ds_read_b64_tr_b16 a[32:33], v22 offset:10440
  ds_read_b64_tr_b16 a[34:35], v22 offset:14536
  ds_read_b64_tr_b16 a[36:37], v23 offset:18432
  ds_read_b64_tr_b16 a[38:39], v23 offset:19456
  s_waitcnt lgkmcnt(0)
  s_add_u32 m0, s26, 0x2800
  s_mov_b32 s27, 0x2d000
  buffer_load_dwordx4 v20, s[8:11], s27 offen  lds
  s_add_u32 m0, s26, 0x2c00
  s_mov_b32 s27, 0x2e200
  buffer_load_dwordx4 v20, s[8:11], s27 offen  lds
  s_add_u32 m0, s26, 0x3000
  s_mov_b32 s27, 0x2f400
  buffer_load_dwordx4 v20, s[8:11], s27 offen  lds
  s_add_u32 m0, s26, 0x3400
  s_mov_b32 s27, 0x30600
  buffer_load_dwordx4 v20, s[8:11], s27 offen  lds
  s_add_u32 m0, s26, 0x3800
  s_mov_b32 s27, 0x31800
  buffer_load_dwordx4 v20, s[8:11], s27 offen  lds
  s_add_u32 m0, s26, 0x3c00
  s_mov_b32 s27, 0x32a00
  buffer_load_dwordx4 v20, s[8:11], s27 offen  lds
  s_add_u32 m0, s26, 0x4000
  s_mov_b32 s27, 0x33c00
  buffer_load_dwordx4 v20, s[8:11], s27 offen  lds
  s_add_u32 m0, s26, 0x4400
  s_mov_b32 s27, 0x34e00
  buffer_load_dwordx4 v20, s[8:11], s27 offen  lds
  s_add_u32 m0, s26, 0x4800
  s_mov_b32 s27, 0x2d000
  buffer_load_dwordx4 v21, s[8:11], s27 offen  lds
  s_add_u32 m0, s26, 0x4c00
  s_mov_b32 s27, 0x31800
  buffer_load_dwordx4 v21, s[8:11], s27 offen  lds
  s_waitcnt vmcnt(30)
  ds_read_b64_tr_b16 a[40:41], v22 offset:20480
  ds_read_b64_tr_b16 a[42:43], v22 offset:24576
  ds_read_b64_tr_b16 a[44:45], v22 offset:20488
  ds_read_b64_tr_b16 a[46:47], v22 offset:24584
  ds_read_b64_tr_b16 a[48:49], v22 offset:20544
  ds_read_b64_tr_b16 a[50:51], v22 offset:24640
  ds_read_b64_tr_b16 a[52:53], v22 offset:20552
  ds_read_b64_tr_b16 a[54:55], v22 offset:24648
  ds_read_b64_tr_b16 a[56:57], v22 offset:20608
  ds_read_b64_tr_b16 a[58:59], v22 offset:24704
  ds_read_b64_tr_b16 a[60:61], v22 offset:20616
  ds_read_b64_tr_b16 a[62:63], v22 offset:24712
  ds_read_b64_tr_b16 a[64:65], v22 offset:20672
  ds_read_b64_tr_b16 a[66:67], v22 offset:24768
  ds_read_b64_tr_b16 a[68:69], v22 offset:20680
  ds_read_b64_tr_b16 a[70:71], v22 offset:24776
  ds_read_b64_tr_b16 a[72:73], v23 offset:28672
  ds_read_b64_tr_b16 a[74:75], v23 offset:29696
  s_waitcnt lgkmcnt(0)
  s_add_u32 m0, s26, 0x5000
  s_mov_b32 s27, 0x36000
  buffer_load_dwordx4 v20, s[8:11], s27 offen  lds
  s_add_u32 m0, s26, 0x5400
  s_mov_b32 s27, 0x37200
  buffer_load_dwordx4 v20, s[8:11], s27 offen  lds
  s_add_u32 m0, s26, 0x5800
  s_mov_b32 s27, 0x38400
  buffer_load_dwordx4 v20, s[8:11], s27 offen  lds
  s_add_u32 m0, s26, 0x5c00
  s_mov_b32 s27, 0x39600
  buffer_load_dwordx4 v20, s[8:11], s27 offen  lds
  s_add_u32 m0, s26, 0x6000
  s_mov_b32 s27, 0x3a800
  buffer_load_dwordx4 v20, s[8:11], s27 offen  lds
  s_add_u32 m0, s26, 0x6400
  s_mov_b32 s27, 0x3ba00
  buffer_load_dwordx4 v20, s[8:11], s27 offen  lds
  s_add_u32 m0, s26, 0x6800
  s_mov_b32 s27, 0x3cc00
  buffer_load_dwordx4 v20, s[8:11], s27 offen  lds
  s_add_u32 m0, s26, 0x6c00
  s_mov_b32 s27, 0x3de00
  buffer_load_dwordx4 v20, s[8:11], s27 offen  lds
  s_add_u32 m0, s26, 0x7000
  s_mov_b32 s27, 0x36000
  buffer_load_dwordx4 v21, s[8:11], s27 offen  lds
  s_add_u32 m0, s26, 0x7400
  s_mov_b32 s27, 0x3a800
  buffer_load_dwordx4 v21, s[8:11], s27 offen  lds
  s_waitcnt vmcnt(30)
  ds_read_b64_tr_b16 a[76:77], v22 offset:30720
  ds_read_b64_tr_b16 a[78:79], v22 offset:34816
  ds_read_b64_tr_b16 a[80:81], v22 offset:30728
  ds_read_b64_tr_b16 a[82:83], v22 offset:34824
  ds_read_b64_tr_b16 a[84:85], v22 offset:30784
  ds_read_b64_tr_b16 a[86:87], v22 offset:34880
  ds_read_b64_tr_b16 a[88:89], v22 offset:30792
  ds_read_b64_tr_b16 a[90:91], v22 offset:34888
  ds_read_b64_tr_b16 a[92:93], v22 offset:30848
  ds_read_b64_tr_b16 a[94:95], v22 offset:34944
  ds_read_b64_tr_b16 a[96:97], v22 offset:30856
  ds_read_b64_tr_b16 a[98:99], v22 offset:34952
  ds_read_b64_tr_b16 a[100:101], v22 offset:30912
  ds_read_b64_tr_b16 a[102:103], v22 offset:35008
  ds_read_b64_tr_b16 a[104:105], v22 offset:30920
  ds_read_b64_tr_b16 a[106:107], v22 offset:35016
  ds_read_b64_tr_b16 a[108:109], v23 offset:38912
  ds_read_b64_tr_b16 a[110:111], v23 offset:39936
  s_waitcnt lgkmcnt(0)
  s_add_u32 m0, s26, 0x7800
  s_mov_b32 s27, 0x3f000
  buffer_load_dwordx4 v20, s[8:11], s27 offen  lds
  s_add_u32 m0, s26, 0x7c00
  s_mov_b32 s27, 0x40200
  buffer_load_dwordx4 v20, s[8:11], s27 offen  lds
  s_add_u32 m0, s26, 0x8000
  s_mov_b32 s27, 0x41400
  buffer_load_dwordx4 v20, s[8:11], s27 offen  lds
  s_add_u32 m0, s26, 0x8400
  s_mov_b32 s27, 0x42600
  buffer_load_dwordx4 v20, s[8:11], s27 offen  lds
  s_add_u32 m0, s26, 0x8800
  s_mov_b32 s27, 0x43800
  buffer_load_dwordx4 v20, s[8:11], s27 offen  lds
  s_add_u32 m0, s26, 0x8c00
  s_mov_b32 s27, 0x44a00
  buffer_load_dwordx4 v20, s[8:11], s27 offen  lds
  s_add_u32 m0, s26, 0x9000
  s_mov_b32 s27, 0x45c00
  buffer_load_dwordx4 v20, s[8:11], s27 offen  lds
  s_add_u32 m0, s26, 0x9400
  s_mov_b32 s27, 0x46e00
  buffer_load_dwordx4 v20, s[8:11], s27 offen  lds
  s_add_u32 m0, s26, 0x9800
  s_mov_b32 s27, 0x3f000
  buffer_load_dwordx4 v21, s[8:11], s27 offen  lds
  s_add_u32 m0, s26, 0x9c00
  s_mov_b32 s27, 0x43800
  buffer_load_dwordx4 v21, s[8:11], s27 offen  lds
  s_waitcnt vmcnt(30)
  ds_read_b64_tr_b16 a[112:113], v22 offset:0
  ds_read_b64_tr_b16 a[114:115], v22 offset:4096
  ds_read_b64_tr_b16 a[116:117], v22 offset:8
  ds_read_b64_tr_b16 a[118:119], v22 offset:4104
  ds_read_b64_tr_b16 a[120:121], v22 offset:64
  ds_read_b64_tr_b16 a[122:123], v22 offset:4160
  ds_read_b64_tr_b16 a[124:125], v22 offset:72
  ds_read_b64_tr_b16 a[126:127], v22 offset:4168
  ds_read_b64_tr_b16 a[128:129], v22 offset:128
  ds_read_b64_tr_b16 a[130:131], v22 offset:4224
  ds_read_b64_tr_b16 a[132:133], v22 offset:136
  ds_read_b64_tr_b16 a[134:135], v22 offset:4232
  ds_read_b64_tr_b16 a[136:137], v22 offset:192
  ds_read_b64_tr_b16 a[138:139], v22 offset:4288
  ds_read_b64_tr_b16 a[140:141], v22 offset:200
  ds_read_b64_tr_b16 a[142:143], v22 offset:4296
  ds_read_b64_tr_b16 a[144:145], v23 offset:8192
  ds_read_b64_tr_b16 a[146:147], v23 offset:9216
  s_waitcnt vmcnt(20)
  ds_read_b64_tr_b16 a[148:149], v22 offset:10240
  ds_read_b64_tr_b16 a[150:151], v22 offset:14336
  ds_read_b64_tr_b16 a[152:153], v22 offset:10248
  ds_read_b64_tr_b16 a[154:155], v22 offset:14344
  ds_read_b64_tr_b16 a[156:157], v22 offset:10304
  ds_read_b64_tr_b16 a[158:159], v22 offset:14400
  ds_read_b64_tr_b16 a[160:161], v22 offset:10312
  ds_read_b64_tr_b16 a[162:163], v22 offset:14408
  ds_read_b64_tr_b16 a[164:165], v22 offset:10368
  ds_read_b64_tr_b16 a[166:167], v22 offset:14464
  ds_read_b64_tr_b16 a[168:169], v22 offset:10376
  ds_read_b64_tr_b16 a[170:171], v22 offset:14472
  ds_read_b64_tr_b16 a[172:173], v22 offset:10432
  ds_read_b64_tr_b16 a[174:175], v22 offset:14528
  ds_read_b64_tr_b16 a[176:177], v22 offset:10440
  ds_read_b64_tr_b16 a[178:179], v22 offset:14536
  ds_read_b64_tr_b16 a[180:181], v23 offset:18432
  ds_read_b64_tr_b16 a[182:183], v23 offset:19456
  s_waitcnt vmcnt(10)
  ds_read_b64_tr_b16 a[184:185], v22 offset:20480
  ds_read_b64_tr_b16 a[186:187], v22 offset:24576
  ds_read_b64_tr_b16 a[188:189], v22 offset:20488
  ds_read_b64_tr_b16 a[190:191], v22 offset:24584
  ds_read_b64_tr_b16 a[192:193], v22 offset:20544
  ds_read_b64_tr_b16 a[194:195], v22 offset:24640
  ds_read_b64_tr_b16 a[196:197], v22 offset:20552
  ds_read_b64_tr_b16 a[198:199], v22 offset:24648
  ds_read_b64_tr_b16 a[200:201], v22 offset:20608
  ds_read_b64_tr_b16 a[202:203], v22 offset:24704
  ds_read_b64_tr_b16 a[204:205], v22 offset:20616
  ds_read_b64_tr_b16 a[206:207], v22 offset:24712
  ds_read_b64_tr_b16 a[208:209], v22 offset:20672
  ds_read_b64_tr_b16 a[210:211], v22 offset:24768
  ds_read_b64_tr_b16 a[212:213], v22 offset:20680
  ds_read_b64_tr_b16 a[214:215], v22 offset:24776
  ds_read_b64_tr_b16 a[216:217], v23 offset:28672
  ds_read_b64_tr_b16 a[218:219], v23 offset:29696
  s_waitcnt vmcnt(0)
  ds_read_b64_tr_b16 a[220:221], v22 offset:30720
  ds_read_b64_tr_b16 a[222:223], v22 offset:34816
  ds_read_b64_tr_b16 a[224:225], v22 offset:30728
  ds_read_b64_tr_b16 a[226:227], v22 offset:34824
  ds_read_b64_tr_b16 a[228:229], v22 offset:30784
  ds_read_b64_tr_b16 a[230:231], v22 offset:34880
  ds_read_b64_tr_b16 a[232:233], v22 offset:30792
  ds_read_b64_tr_b16 a[234:235], v22 offset:34888
  ds_read_b64_tr_b16 a[236:237], v22 offset:30848
  ds_read_b64_tr_b16 a[238:239], v22 offset:34944
  ds_read_b64_tr_b16 a[240:241], v22 offset:30856
  ds_read_b64_tr_b16 a[242:243], v22 offset:34952
  ds_read_b64_tr_b16 a[244:245], v22 offset:30912
  ds_read_b64_tr_b16 a[246:247], v22 offset:35008
  ds_read_b64_tr_b16 a[248:249], v22 offset:30920
  ds_read_b64_tr_b16 a[250:251], v22 offset:35016
  ds_read_b64_tr_b16 a[252:253], v23 offset:38912
  ds_read_b64_tr_b16 a[254:255], v23 offset:39936
  s_waitcnt lgkmcnt(0)
  s_mov_b32 s28, 0
L_reg_19:
  v_mov_b32 v26, 0
  buffer_load_dword v27, v26, s[20:23], 0 offen offset:64 sc1
  s_add_u32 s28, s28, 1
  s_cmp_gt_u32 s28, 1048576
  s_cbranch_scc1 L_fail
  s_waitcnt vmcnt(0)
  v_readfirstlane_b32 s67, v27
L_regc_20:
  s_and_b32 s26, s67, 0xffff
  s_cmp_lt_u32 s26, 256
  s_cbranch_scc1 L_reg_19
  s_lshr_b32 s67, s67, 16
  s_barrier
  s_lshr_b32 s27, s25, 1
  s_and_b32 s28, s25, 1
  s_lshl_b32 s51, s50, 1
  s_add_u32 s51, s51, s27
  s_lshl_b32 s52, s28, 12
  s_add_u32 s52, s52, 0x1000000
  s_lshl_b32 s29, s28, 1
  s_add_u32 s29, s29, s27
  s_lshl_b32 s29, s29, 12
  v_mov_b32 v2, v0
  v_add_u32 v3, s29, v0
  v_lshrrev_b32 v4, 1, v0
  v_bfi_b32 v11, 31, v0, v4
  v_min_u32 v7, 208, v0
  s_mov_b32 s60, 0x3e0293ee
  s_mov_b32 s61, 0x3e0293ee
  v_and_b32 v20, 15, v1
  s_lshl_b32 s28, s28, 4
  v_add_u32 v20, s28, v20
  v_lshrrev_b32 v21, 4, v1
  v_lshlrev_b32 v21, 2, v21
  v_sub_u32 v20, v20, v21
  v_mov_b32 v21, 0xf149f2ca
  v_cmp_gt_i32 vcc, 0, v20
  s_nop 1
  v_cndmask_b32 v12, 0, v21, vcc
  v_cmp_gt_i32 vcc, 1, v20
  s_nop 1
  v_cndmask_b32 v13, 0, v21, vcc
  v_cmp_gt_i32 vcc, 2, v20
  s_nop 1
  v_cndmask_b32 v14, 0, v21, vcc
  v_cmp_gt_i32 vcc, 3, v20
  s_nop 1
  v_cndmask_b32 v15, 0, v21, vcc
  v_cmp_gt_i32 vcc, 16, v20
  s_nop 1
  v_cndmask_b32 v16, 0, v21, vcc
  v_cmp_gt_i32 vcc, 17, v20
  s_nop 1
  v_cndmask_b32 v17, 0, v21, vcc
  v_cmp_gt_i32 vcc, 18, v20
  s_nop 1
  v_cndmask_b32 v18, 0, v21, vcc
  v_cmp_gt_i32 vcc, 19, v20
  s_nop 1
  v_cndmask_b32 v19, 0, v21, vcc
  v_mov_b32 v6, 1
  v_mov_b32 v5, 0x40000000
  v_cmp_eq_u32 vcc, 0, v0
  s_nop 1
  v_cndmask_b32 v5, v5, 0, vcc
  s_mov_b32 s43, 0x40000000
  s_mov_b32 s37, s36
  s_lshl_b32 s44, s37, 13
  s_lshl_b32 s27, s50, 9
  s_add_u32 s44, s44, s27
  s_add_u32 s44, s44, 0x80000
  s_mov_b32 s49, 0
L_poll_21:
  buffer_load_dword v8, v7, s[4:7], s44 offen sc1
  s_waitcnt vmcnt(0)
  v_cmp_eq_u32 vcc, 0, v8
  s_cbranch_vccz L_polld_22
  s_add_u32 s49, s49, 1
  s_cmp_lt_u32 s49, 1048576
  s_cbranch_scc1 L_poll_21
  s_branch L_fail
L_polld_22:
  s_lshl_b32 s58, s37, 5
  s_add_u32 s58, s58, s51
  s_lshl_b32 s56, s58, 13
  s_lshl_b32 s58, s58, 12
  s_add_u32 s54, s56, 0x2000000
  s_add_u32 s55, s56, 0x2001000
  s_add_u32 s53, s56, s52
  s_add_u32 s57, s56, 0x3001000
  s_add_u32 s56, s56, 0x3000000
  s_add_u32 s59, s58, 0x4800000
  s_add_u32 s58, s58, 0x4000000
  s_add_u32 s26, s37, 3
  s_min_u32 s26, s26, 23
  s_lshl_b32 s44, s26, 13
  s_lshl_b32 s27, s50, 9
  s_add_u32 s44, s44, s27
  s_add_u32 s44, s44, 0x80000
  buffer_load_dword v8, v7, s[4:7], s44 offen sc1
  buffer_load_dwordx4 v[20:23], v0, s[4:7], s53 offen offset:0 sc1
  buffer_load_dwordx4 v[36:39], v0, s[4:7], s54 offen offset:0 sc1
  buffer_load_dwordx4 v[52:55], v0, s[4:7], s55 offen offset:0 sc1
  buffer_load_dwordx4 v[68:71], v11, s[4:7], s58 offen offset:0 sc1
  buffer_load_dwordx4 v[24:27], v0, s[4:7], s53 offen offset:1024 sc1
  buffer_load_dwordx4 v[40:43], v0, s[4:7], s54 offen offset:1024 sc1
  buffer_load_dwordx4 v[56:59], v0, s[4:7], s55 offen offset:1024 sc1
  buffer_load_dwordx4 v[72:75], v11, s[4:7], s58 offen offset:1024 sc1
  buffer_load_dwordx4 v[28:31], v0, s[4:7], s53 offen offset:2048 sc1
  buffer_load_dwordx4 v[44:47], v0, s[4:7], s54 offen offset:2048 sc1
  buffer_load_dwordx4 v[60:63], v0, s[4:7], s55 offen offset:2048 sc1
  buffer_load_dwordx4 v[76:79], v11, s[4:7], s58 offen offset:2048 sc1
  buffer_load_dwordx4 v[32:35], v0, s[4:7], s53 offen offset:3072 sc1
  buffer_load_dwordx4 v[48:51], v0, s[4:7], s54 offen offset:3072 sc1
  buffer_load_dwordx4 v[64:67], v0, s[4:7], s55 offen offset:3072 sc1
  buffer_load_dwordx4 v[80:83], v11, s[4:7], s58 offen offset:3072 sc1
  buffer_load_dwordx4 v[84:87], v0, s[4:7], s56 offen offset:0 sc1
  buffer_load_dwordx2 v[116:117], v4, s[4:7], s59 offen offset:0 sc1
  buffer_load_dwordx4 v[88:91], v0, s[4:7], s56 offen offset:1024 sc1
  buffer_load_dwordx4 v[92:95], v0, s[4:7], s56 offen offset:2048 sc1
  buffer_load_dwordx2 v[118:119], v4, s[4:7], s59 offen offset:1024 sc1
  buffer_load_dwordx4 v[96:99], v0, s[4:7], s56 offen offset:3072 sc1
  buffer_load_dwordx4 v[100:103], v0, s[4:7], s57 offen offset:0 sc1
  buffer_load_dwordx2 v[120:121], v4, s[4:7], s59 offen offset:2048 sc1
  buffer_load_dwordx4 v[104:107], v0, s[4:7], s57 offen offset:1024 sc1
  buffer_load_dwordx4 v[108:111], v0, s[4:7], s57 offen offset:2048 sc1
  buffer_load_dwordx2 v[122:123], v4, s[4:7], s59 offen offset:3072 sc1
  buffer_load_dwordx4 v[112:115], v0, s[4:7], s57 offen offset:3072 sc1
  v_xor_b32 v2, 0x10000, v2
  v_xor_b32 v3, 0x10000, v3
L_bc_top:
  s_waitcnt vmcnt(26)
  v_mfma_f32_16x16x32_bf16 v[132:135], v[36:39], v[20:23], v[12:15]
  v_mov_b32 v186, 0
  s_waitcnt vmcnt(25)
  v_mfma_f32_16x16x32_bf16 v[136:139], v[52:55], v[20:23], v[16:19]
  s_waitcnt vmcnt(24)
  v_mfma_f32_16x16x32_bf16 v[140:143], v[68:71], v[20:23], 0
  s_waitcnt vmcnt(22)
  v_mfma_f32_16x16x32_bf16 v[132:135], v[40:43], v[24:27], v[132:135]
  v_mov_b32 v185, 0
  s_waitcnt vmcnt(21)
  v_mfma_f32_16x16x32_bf16 v[136:139], v[56:59], v[24:27], v[136:139]
  s_waitcnt vmcnt(20)
  v_mfma_f32_16x16x32_bf16 v[140:143], v[72:75], v[24:27], v[140:143]
  s_waitcnt vmcnt(18)
  v_mfma_f32_16x16x32_bf16 v[132:135], v[44:47], v[28:31], v[132:135]
  v_mov_b32 v195, 0x3f803f80
  s_waitcnt vmcnt(17)
  v_mfma_f32_16x16x32_bf16 v[136:139], v[60:63], v[28:31], v[136:139]
  s_waitcnt vmcnt(16)
  v_mfma_f32_16x16x32_bf16 v[140:143], v[76:79], v[28:31], v[140:143]
  s_waitcnt vmcnt(14)
  v_mfma_f32_16x16x32_bf16 v[132:135], v[48:51], v[32:35], v[132:135]
  v_mov_b32 v194, 0x3f803f80
  s_waitcnt vmcnt(13)
  v_mfma_f32_16x16x32_bf16 v[136:139], v[64:67], v[32:35], v[136:139]
  s_waitcnt vmcnt(12)
  v_mfma_f32_16x16x32_bf16 v[140:143], v[80:83], v[32:35], v[140:143]
  v_mov_b32 v192, 0x3f803f80
  v_mov_b32 v193, 0x3f803f80
  v_max3_f32 v200, v132, v133, v134
  s_nop 0
  v_max3_f32 v201, v135, v136, v137
  v_max3_f32 v200, v200, v138, v139
  s_nop 1
  v_max3_f32 v201, v201, v140, v141
  v_max_f32 v200, v200, v201
  v_mov_b32 v201, v200
  s_nop 1
  v_permlane32_swap_b32 v200, v201
  v_max_f32 v200, v200, v201
  v_mov_b32 v201, v200
  s_nop 1
  v_permlane16_swap_b32 v200, v201
  v_max_f32 v200, v200, v201
  v_mul_f32 v200, s60, v200
  v_pk_fma_f32 v[132:133], v[132:133], s[60:61], v[200:201] op_sel_hi:[1,1,0] neg_lo:[0,0,1] neg_hi:[0,0,1]
  v_pk_fma_f32 v[134:135], v[134:135], s[60:61], v[200:201] op_sel_hi:[1,1,0] neg_lo:[0,0,1] neg_hi:[0,0,1]
  v_pk_fma_f32 v[136:137], v[136:137], s[60:61], v[200:201] op_sel_hi:[1,1,0] neg_lo:[0,0,1] neg_hi:[0,0,1]
  v_pk_fma_f32 v[138:139], v[138:139], s[60:61], v[200:201] op_sel_hi:[1,1,0] neg_lo:[0,0,1] neg_hi:[0,0,1]
  v_pk_fma_f32 v[140:141], v[140:141], s[60:61], v[200:201] op_sel_hi:[1,1,0] neg_lo:[0,0,1] neg_hi:[0,0,1]
  v_exp_f32 v132, v132
  v_exp_f32 v133, v133
  v_exp_f32 v134, v134
  v_exp_f32 v135, v135
  v_exp_f32 v136, v136
  v_exp_f32 v137, v137
  v_exp_f32 v138, v138
  v_exp_f32 v139, v139
  v_exp_f32 v140, v140
  v_exp_f32 v141, v141
  v_cvt_pk_bf16_f32 v180, v132, v133
  v_cvt_pk_bf16_f32 v181, v136, v137
  v_cvt_pk_bf16_f32 v182, v134, v135
  v_cvt_pk_bf16_f32 v184, v140, v141
  v_cvt_pk_bf16_f32 v183, v138, v139
  v_cvt_pk_bf16_f32 v187, v140, v141
  s_nop 0
  v_mfma_f32_16x16x32_bf16 v[176:179], v[192:195], v[180:183], 0
  s_waitcnt vmcnt(11)
  v_mfma_f32_16x16x32_bf16 v[144:147], v[84:87], v[180:183], 0
  s_waitcnt vmcnt(9)
  v_mfma_f32_16x16x32_bf16 v[148:151], v[88:91], v[180:183], 0
  s_waitcnt vmcnt(8)
  v_mfma_f32_16x16x32_bf16 v[152:155], v[92:95], v[180:183], 0
  v_mfma_f32_16x16x16_bf16 v[176:179], v[192:193], v[184:185], v[176:179]
  s_waitcnt vmcnt(6)
  v_mfma_f32_16x16x32_bf16 v[156:159], v[96:99], v[180:183], 0
  s_waitcnt vmcnt(5)
  v_mfma_f32_16x16x32_bf16 v[160:163], v[100:103], v[180:183], 0
  s_waitcnt vmcnt(3)
  v_mfma_f32_16x16x32_bf16 v[164:167], v[104:107], v[180:183], 0
  s_waitcnt vmcnt(2)
  v_mfma_f32_16x16x32_bf16 v[168:171], v[108:111], v[180:183], 0
  s_waitcnt vmcnt(0)
  v_mfma_f32_16x16x32_bf16 v[172:175], v[112:115], v[180:183], 0
  v_rcp_f32 v200, v176
  v_mfma_f32_16x16x16_bf16 v[144:147], v[116:117], v[184:185], v[144:147]
  v_mfma_f32_16x16x16_bf16 v[148:151], v[116:117], v[186:187], v[148:151]
  v_mfma_f32_16x16x16_bf16 v[152:155], v[118:119], v[184:185], v[152:155]
  v_mfma_f32_16x16x16_bf16 v[156:159], v[118:119], v[186:187], v[156:159]
  v_mfma_f32_16x16x16_bf16 v[160:163], v[120:121], v[184:185], v[160:163]
  v_mfma_f32_16x16x16_bf16 v[164:167], v[120:121], v[186:187], v[164:167]
  v_mfma_f32_16x16x16_bf16 v[168:171], v[122:123], v[184:185], v[168:171]
  v_mfma_f32_16x16x16_bf16 v[172:175], v[122:123], v[186:187], v[172:175]
  v_pk_mul_f32 v[144:145], v[144:145], v[200:201] op_sel_hi:[1,0]
  v_pk_mul_f32 v[146:147], v[146:147], v[200:201] op_sel_hi:[1,0]
  v_cvt_pk_bf16_f32 v144, v144, v145
  v_cvt_pk_bf16_f32 v145, v146, v147
  v_pk_mul_f32 v[148:149], v[148:149], v[200:201] op_sel_hi:[1,0]
  v_pk_mul_f32 v[150:151], v[150:151], v[200:201] op_sel_hi:[1,0]
  v_cvt_pk_bf16_f32 v146, v148, v149
  v_cvt_pk_bf16_f32 v147, v150, v151
  ds_write_b128 v3, v[144:147] offset:0
  v_pk_mul_f32 v[152:153], v[152:153], v[200:201] op_sel_hi:[1,0]
  v_pk_mul_f32 v[154:155], v[154:155], v[200:201] op_sel_hi:[1,0]
  v_cvt_pk_bf16_f32 v148, v152, v153
  v_cvt_pk_bf16_f32 v149, v154, v155
  v_pk_mul_f32 v[156:157], v[156:157], v[200:201] op_sel_hi:[1,0]
  v_pk_mul_f32 v[158:159], v[158:159], v[200:201] op_sel_hi:[1,0]
  v_cvt_pk_bf16_f32 v150, v156, v157
  v_cvt_pk_bf16_f32 v151, v158, v159
  ds_write_b128 v3, v[148:151] offset:1024
  v_pk_mul_f32 v[160:161], v[160:161], v[200:201] op_sel_hi:[1,0]
  v_pk_mul_f32 v[162:163], v[162:163], v[200:201] op_sel_hi:[1,0]
  v_cvt_pk_bf16_f32 v152, v160, v161
  v_cvt_pk_bf16_f32 v153, v162, v163
  v_pk_mul_f32 v[164:165], v[164:165], v[200:201] op_sel_hi:[1,0]
  v_pk_mul_f32 v[166:167], v[166:167], v[200:201] op_sel_hi:[1,0]
  v_cvt_pk_bf16_f32 v154, v164, v165
  v_cvt_pk_bf16_f32 v155, v166, v167
  ds_write_b128 v3, v[152:155] offset:2048
  v_pk_mul_f32 v[168:169], v[168:169], v[200:201] op_sel_hi:[1,0]
  v_pk_mul_f32 v[170:171], v[170:171], v[200:201] op_sel_hi:[1,0]
  v_cvt_pk_bf16_f32 v156, v168, v169
  v_cvt_pk_bf16_f32 v157, v170, v171
  v_pk_mul_f32 v[172:173], v[172:173], v[200:201] op_sel_hi:[1,0]
  v_pk_mul_f32 v[174:175], v[174:175], v[200:201] op_sel_hi:[1,0]
  v_cvt_pk_bf16_f32 v158, v172, v173
  v_cvt_pk_bf16_f32 v159, v174, v175
  ds_write_b128 v3, v[156:159] offset:3072
  s_waitcnt lgkmcnt(0)
  s_barrier
  s_lshl_b32 s45, s36, 5
  s_add_u32 s45, s45, s50
  s_mul_i32 s45, s45, 18432
  s_add_u32 s45, s45, 0x6400000
  s_add_u32 s46, s45, 294912
  s_lshl_b32 s42, s36, 4
  s_add_u32 s42, s42, s50
  s_lshl_b32 s42, s42, 2
  s_add_u32 s42, s42, s25
  s_lshl_b32 s42, s42, 2
  s_add_u32 s42, s42, 0x30000
  s_add_u32 s37, s36, 3
  s_cmp_ge_u32 s37, 24
  s_cbranch_scc1 L_bc_nopf
  v_cmp_eq_u32 vcc, 0, v8
  s_cbranch_vccnz L_bc_nopf
  s_lshl_b32 s58, s37, 5
  s_add_u32 s58, s58, s51
  s_lshl_b32 s56, s58, 13
  s_lshl_b32 s58, s58, 12
  s_add_u32 s54, s56, 0x2000000
  s_add_u32 s55, s56, 0x2001000
  s_add_u32 s53, s56, s52
  s_add_u32 s57, s56, 0x3001000
  s_add_u32 s56, s56, 0x3000000
  s_add_u32 s59, s58, 0x4800000
  s_add_u32 s58, s58, 0x4000000
  buffer_load_dwordx4 v[20:23], v0, s[4:7], s53 offen offset:0 sc1
  buffer_load_dwordx4 v[36:39], v0, s[4:7], s54 offen offset:0 sc1
  buffer_load_dwordx4 v[52:55], v0, s[4:7], s55 offen offset:0 sc1
  buffer_load_dwordx4 v[68:71], v11, s[4:7], s58 offen offset:0 sc1
  buffer_load_dwordx4 v[24:27], v0, s[4:7], s53 offen offset:1024 sc1
  buffer_load_dwordx4 v[40:43], v0, s[4:7], s54 offen offset:1024 sc1
  buffer_load_dwordx4 v[56:59], v0, s[4:7], s55 offen offset:1024 sc1
  buffer_load_dwordx4 v[72:75], v11, s[4:7], s58 offen offset:1024 sc1
  buffer_load_dwordx4 v[28:31], v0, s[4:7], s53 offen offset:2048 sc1
  buffer_load_dwordx4 v[44:47], v0, s[4:7], s54 offen offset:2048 sc1
  buffer_load_dwordx4 v[60:63], v0, s[4:7], s55 offen offset:2048 sc1
  buffer_load_dwordx4 v[76:79], v11, s[4:7], s58 offen offset:2048 sc1
  buffer_load_dwordx4 v[32:35], v0, s[4:7], s53 offen offset:3072 sc1
  buffer_load_dwordx4 v[48:51], v0, s[4:7], s54 offen offset:3072 sc1
  buffer_load_dwordx4 v[64:67], v0, s[4:7], s55 offen offset:3072 sc1
  buffer_load_dwordx4 v[80:83], v11, s[4:7], s58 offen offset:3072 sc1
  buffer_load_dwordx4 v[84:87], v0, s[4:7], s56 offen offset:0 sc1
  buffer_load_dwordx2 v[116:117], v4, s[4:7], s59 offen offset:0 sc1
  buffer_load_dwordx4 v[88:91], v0, s[4:7], s56 offen offset:1024 sc1
  buffer_load_dwordx4 v[92:95], v0, s[4:7], s56 offen offset:2048 sc1
  buffer_load_dwordx2 v[118:119], v4, s[4:7], s59 offen offset:1024 sc1
  buffer_load_dwordx4 v[96:99], v0, s[4:7], s56 offen offset:3072 sc1
  buffer_load_dwordx4 v[100:103], v0, s[4:7], s57 offen offset:0 sc1
  buffer_load_dwordx2 v[120:121], v4, s[4:7], s59 offen offset:2048 sc1
  buffer_load_dwordx4 v[104:107], v0, s[4:7], s57 offen offset:1024 sc1
  buffer_load_dwordx4 v[108:111], v0, s[4:7], s57 offen offset:2048 sc1
  buffer_load_dwordx2 v[122:123], v4, s[4:7], s59 offen offset:3072 sc1
  buffer_load_dwordx4 v[112:115], v0, s[4:7], s57 offen offset:3072 sc1
  ds_read_b128 v[204:207], v2 offset:0
  ds_read_b128 v[208:211], v2 offset:8192
  ds_read_b128 v[212:215], v2 offset:1024
  ds_read_b128 v[216:219], v2 offset:9216
  s_waitcnt lgkmcnt(3)
  v_mfma_f32_16x16x32_bf16 v[132:135], v[224:227], v[204:207], 0
  ds_read_b128 v[220:223], v2 offset:2048
  v_mfma_f32_16x16x32_bf16 v[136:139], v[228:231], v[204:207], 0
  v_mfma_f32_16x16x32_bf16 v[140:143], v[232:235], v[204:207], 0
  v_mfma_f32_16x16x32_bf16 v[144:147], v[236:239], v[204:207], 0
  v_mfma_f32_16x16x32_bf16 v[148:151], v[240:243], v[204:207], 0
  s_waitcnt vmcnt(28)
  buffer_store_dword v6, v5, s[4:7], s43 offen sc1
  s_add_u32 s26, s37, 3
  s_min_u32 s26, s26, 23
  s_lshl_b32 s44, s26, 13
  s_lshl_b32 s27, s50, 9
  s_add_u32 s44, s44, s27
  s_add_u32 s44, s44, 0x80000
  buffer_load_dword v8, v7, s[4:7], s44 offen sc1
  v_mfma_f32_16x16x32_bf16 v[152:155], v[244:247], v[204:207], 0
  v_mfma_f32_16x16x32_bf16 v[156:159], v[248:251], v[204:207], 0
  v_mfma_f32_16x16x32_bf16 v[160:163], v[252:255], v[204:207], 0
  v_mfma_f32_16x16x32_bf16 v[164:167], a[0:3], v[204:207], 0
  s_waitcnt lgkmcnt(3)
  v_mfma_f32_16x16x32_bf16 v[168:171], v[224:227], v[208:211], 0
  ds_read_b128 v[204:207], v2 offset:10240
  v_mfma_f32_16x16x32_bf16 v[172:175], v[228:231], v[208:211], 0
  v_mfma_f32_16x16x32_bf16 v[176:179], v[232:235], v[208:211], 0
  v_mfma_f32_16x16x32_bf16 v[180:183], v[236:239], v[208:211], 0
  v_mfma_f32_16x16x32_bf16 v[184:187], v[240:243], v[208:211], 0
  v_mfma_f32_16x16x32_bf16 v[188:191], v[244:247], v[208:211], 0
  v_mfma_f32_16x16x32_bf16 v[192:195], v[248:251], v[208:211], 0
  v_mfma_f32_16x16x32_bf16 v[196:199], v[252:255], v[208:211], 0
  v_mfma_f32_16x16x32_bf16 v[200:203], a[0:3], v[208:211], 0
  s_waitcnt lgkmcnt(3)
  v_mfma_f32_16x16x32_bf16 v[132:135], a[4:7], v[212:215], v[132:135]
  ds_read_b128 v[208:211], v2 offset:3072
  v_mfma_f32_16x16x32_bf16 v[136:139], a[8:11], v[212:215], v[136:139]
  v_mfma_f32_16x16x32_bf16 v[140:143], a[12:15], v[212:215], v[140:143]
  v_mfma_f32_16x16x32_bf16 v[144:147], a[16:19], v[212:215], v[144:147]
  v_mfma_f32_16x16x32_bf16 v[148:151], a[20:23], v[212:215], v[148:151]
  v_mfma_f32_16x16x32_bf16 v[152:155], a[24:27], v[212:215], v[152:155]
  v_mfma_f32_16x16x32_bf16 v[156:159], a[28:31], v[212:215], v[156:159]
  v_mfma_f32_16x16x32_bf16 v[160:163], a[32:35], v[212:215], v[160:163]
  v_mfma_f32_16x16x32_bf16 v[164:167], a[36:39], v[212:215], v[164:167]
  s_waitcnt lgkmcnt(3)
  v_mfma_f32_16x16x32_bf16 v[168:171], a[4:7], v[216:219], v[168:171]
  ds_read_b128 v[212:215], v2 offset:11264
  v_mfma_f32_16x16x32_bf16 v[172:175], a[8:11], v[216:219], v[172:175]
  v_mfma_f32_16x16x32_bf16 v[176:179], a[12:15], v[216:219], v[176:179]
  v_mfma_f32_16x16x32_bf16 v[180:183], a[16:19], v[216:219], v[180:183]
  v_mfma_f32_16x16x32_bf16 v[184:187], a[20:23], v[216:219], v[184:187]
  v_mfma_f32_16x16x32_bf16 v[188:191], a[24:27], v[216:219], v[188:191]
  v_mfma_f32_16x16x32_bf16 v[192:195], a[28:31], v[216:219], v[192:195]
  v_mfma_f32_16x16x32_bf16 v[196:199], a[32:35], v[216:219], v[196:199]
  v_mfma_f32_16x16x32_bf16 v[200:203], a[36:39], v[216:219], v[200:203]
  s_waitcnt lgkmcnt(3)
  v_mfma_f32_16x16x32_bf16 v[132:135], a[40:43], v[220:223], v[132:135]
  ds_read_b128 v[216:219], v2 offset:4096
  v_mfma_f32_16x16x32_bf16 v[136:139], a[44:47], v[220:223], v[136:139]
  v_mfma_f32_16x16x32_bf16 v[140:143], a[48:51], v[220:223], v[140:143]
  v_mfma_f32_16x16x32_bf16 v[144:147], a[52:55], v[220:223], v[144:147]
  v_mfma_f32_16x16x32_bf16 v[148:151], a[56:59], v[220:223], v[148:151]
  v_mfma_f32_16x16x32_bf16 v[152:155], a[60:63], v[220:223], v[152:155]
  v_mfma_f32_16x16x32_bf16 v[156:159], a[64:67], v[220:223], v[156:159]
  v_mfma_f32_16x16x32_bf16 v[160:163], a[68:71], v[220:223], v[160:163]
  v_mfma_f32_16x16x32_bf16 v[164:167], a[72:75], v[220:223], v[164:167]
  s_waitcnt lgkmcnt(3)
  v_mfma_f32_16x16x32_bf16 v[168:171], a[40:43], v[204:207], v[168:171]
  ds_read_b128 v[220:223], v2 offset:12288
  v_mfma_f32_16x16x32_bf16 v[172:175], a[44:47], v[204:207], v[172:175]
  v_mfma_f32_16x16x32_bf16 v[176:179], a[48:51], v[204:207], v[176:179]
  v_mfma_f32_16x16x32_bf16 v[180:183], a[52:55], v[204:207], v[180:183]
  v_mfma_f32_16x16x32_bf16 v[184:187], a[56:59], v[204:207], v[184:187]
  v_mfma_f32_16x16x32_bf16 v[188:191], a[60:63], v[204:207], v[188:191]
  v_mfma_f32_16x16x32_bf16 v[192:195], a[64:67], v[204:207], v[192:195]
  v_mfma_f32_16x16x32_bf16 v[196:199], a[68:71], v[204:207], v[196:199]
  v_mfma_f32_16x16x32_bf16 v[200:203], a[72:75], v[204:207], v[200:203]
  s_waitcnt lgkmcnt(3)
  v_mfma_f32_16x16x32_bf16 v[132:135], a[76:79], v[208:211], v[132:135]
  ds_read_b128 v[204:207], v2 offset:5120
  v_mfma_f32_16x16x32_bf16 v[136:139], a[80:83], v[208:211], v[136:139]
  v_mfma_f32_16x16x32_bf16 v[140:143], a[84:87], v[208:211], v[140:143]
  v_mfma_f32_16x16x32_bf16 v[144:147], a[88:91], v[208:211], v[144:147]
  v_mfma_f32_16x16x32_bf16 v[148:151], a[92:95], v[208:211], v[148:151]
  v_mfma_f32_16x16x32_bf16 v[152:155], a[96:99], v[208:211], v[152:155]
  v_mfma_f32_16x16x32_bf16 v[156:159], a[100:103], v[208:211], v[156:159]
  v_mfma_f32_16x16x32_bf16 v[160:163], a[104:107], v[208:211], v[160:163]
  v_mfma_f32_16x16x32_bf16 v[164:167], a[108:111], v[208:211], v[164:167]
  s_waitcnt lgkmcnt(3)
  v_mfma_f32_16x16x32_bf16 v[168:171], a[76:79], v[212:215], v[168:171]
  ds_read_b128 v[208:211], v2 offset:13312
  v_mfma_f32_16x16x32_bf16 v[172:175], a[80:83], v[212:215], v[172:175]
  v_mfma_f32_16x16x32_bf16 v[176:179], a[84:87], v[212:215], v[176:179]
  v_mfma_f32_16x16x32_bf16 v[180:183], a[88:91], v[212:215], v[180:183]
  v_mfma_f32_16x16x32_bf16 v[184:187], a[92:95], v[212:215], v[184:187]
  v_mfma_f32_16x16x32_bf16 v[188:191], a[96:99], v[212:215], v[188:191]
  v_mfma_f32_16x16x32_bf16 v[192:195], a[100:103], v[212:215], v[192:195]
  v_mfma_f32_16x16x32_bf16 v[196:199], a[104:107], v[212:215], v[196:199]
  v_mfma_f32_16x16x32_bf16 v[200:203], a[108:111], v[212:215], v[200:203]
  s_waitcnt lgkmcnt(3)
  v_mfma_f32_16x16x32_bf16 v[132:135], a[112:115], v[216:219], v[132:135]
  ds_read_b128 v[212:215], v2 offset:6144
  v_mfma_f32_16x16x32_bf16 v[136:139], a[116:119], v[216:219], v[136:139]
  v_mfma_f32_16x16x32_bf16 v[140:143], a[120:123], v[216:219], v[140:143]
  v_mfma_f32_16x16x32_bf16 v[144:147], a[124:127], v[216:219], v[144:147]
  v_mfma_f32_16x16x32_bf16 v[148:151], a[128:131], v[216:219], v[148:151]
  v_mfma_f32_16x16x32_bf16 v[152:155], a[132:135], v[216:219], v[152:155]
  v_mfma_f32_16x16x32_bf16 v[156:159], a[136:139], v[216:219], v[156:159]
  v_mfma_f32_16x16x32_bf16 v[160:163], a[140:143], v[216:219], v[160:163]
  v_mfma_f32_16x16x32_bf16 v[164:167], a[144:147], v[216:219], v[164:167]
  s_waitcnt lgkmcnt(3)
  v_mfma_f32_16x16x32_bf16 v[168:171], a[112:115], v[220:223], v[168:171]
  ds_read_b128 v[216:219], v2 offset:14336
  v_mfma_f32_16x16x32_bf16 v[172:175], a[116:119], v[220:223], v[172:175]
  v_mfma_f32_16x16x32_bf16 v[176:179], a[120:123], v[220:223], v[176:179]
  v_mfma_f32_16x16x32_bf16 v[180:183], a[124:127], v[220:223], v[180:183]
  v_mfma_f32_16x16x32_bf16 v[184:187], a[128:131], v[220:223], v[184:187]
  v_mfma_f32_16x16x32_bf16 v[188:191], a[132:135], v[220:223], v[188:191]
  v_mfma_f32_16x16x32_bf16 v[192:195], a[136:139], v[220:223], v[192:195]
  v_mfma_f32_16x16x32_bf16 v[196:199], a[140:143], v[220:223], v[196:199]
  v_mfma_f32_16x16x32_bf16 v[200:203], a[144:147], v[220:223], v[200:203]
  s_waitcnt lgkmcnt(3)
  v_mfma_f32_16x16x32_bf16 v[132:135], a[148:151], v[204:207], v[132:135]
  ds_read_b128 v[220:223], v2 offset:7168
  v_mfma_f32_16x16x32_bf16 v[136:139], a[152:155], v[204:207], v[136:139]
  v_mfma_f32_16x16x32_bf16 v[140:143], a[156:159], v[204:207], v[140:143]
  v_mfma_f32_16x16x32_bf16 v[144:147], a[160:163], v[204:207], v[144:147]
  v_mfma_f32_16x16x32_bf16 v[148:151], a[164:167], v[204:207], v[148:151]
  v_mfma_f32_16x16x32_bf16 v[152:155], a[168:171], v[204:207], v[152:155]
  v_mfma_f32_16x16x32_bf16 v[156:159], a[172:175], v[204:207], v[156:159]
  v_mfma_f32_16x16x32_bf16 v[160:163], a[176:179], v[204:207], v[160:163]
  v_mfma_f32_16x16x32_bf16 v[164:167], a[180:183], v[204:207], v[164:167]
  s_waitcnt lgkmcnt(3)
  v_mfma_f32_16x16x32_bf16 v[168:171], a[148:151], v[208:211], v[168:171]
  ds_read_b128 v[204:207], v2 offset:15360
  v_mfma_f32_16x16x32_bf16 v[172:175], a[152:155], v[208:211], v[172:175]
  v_mfma_f32_16x16x32_bf16 v[176:179], a[156:159], v[208:211], v[176:179]
  v_mfma_f32_16x16x32_bf16 v[180:183], a[160:163], v[208:211], v[180:183]
  v_mfma_f32_16x16x32_bf16 v[184:187], a[164:167], v[208:211], v[184:187]
  v_mfma_f32_16x16x32_bf16 v[188:191], a[168:171], v[208:211], v[188:191]
  v_mfma_f32_16x16x32_bf16 v[192:195], a[172:175], v[208:211], v[192:195]
  v_mfma_f32_16x16x32_bf16 v[196:199], a[176:179], v[208:211], v[196:199]
  v_mfma_f32_16x16x32_bf16 v[200:203], a[180:183], v[208:211], v[200:203]
  s_waitcnt lgkmcnt(3)
  v_mfma_f32_16x16x32_bf16 v[132:135], a[184:187], v[212:215], v[132:135]
  v_mfma_f32_16x16x32_bf16 v[136:139], a[188:191], v[212:215], v[136:139]
  v_mfma_f32_16x16x32_bf16 v[140:143], a[192:195], v[212:215], v[140:143]
  v_mfma_f32_16x16x32_bf16 v[144:147], a[196:199], v[212:215], v[144:147]
  v_mfma_f32_16x16x32_bf16 v[148:151], a[200:203], v[212:215], v[148:151]
  v_mfma_f32_16x16x32_bf16 v[152:155], a[204:207], v[212:215], v[152:155]
  v_mfma_f32_16x16x32_bf16 v[156:159], a[208:211], v[212:215], v[156:159]
  v_mfma_f32_16x16x32_bf16 v[160:163], a[212:215], v[212:215], v[160:163]
  v_mfma_f32_16x16x32_bf16 v[164:167], a[216:219], v[212:215], v[164:167]
  s_waitcnt lgkmcnt(2)
  v_mfma_f32_16x16x32_bf16 v[168:171], a[184:187], v[216:219], v[168:171]
  v_mfma_f32_16x16x32_bf16 v[172:175], a[188:191], v[216:219], v[172:175]
  v_mfma_f32_16x16x32_bf16 v[176:179], a[192:195], v[216:219], v[176:179]
  v_mfma_f32_16x16x32_bf16 v[180:183], a[196:199], v[216:219], v[180:183]
  v_mfma_f32_16x16x32_bf16 v[184:187], a[200:203], v[216:219], v[184:187]
  v_mfma_f32_16x16x32_bf16 v[188:191], a[204:207], v[216:219], v[188:191]
  v_mfma_f32_16x16x32_bf16 v[192:195], a[208:211], v[216:219], v[192:195]
  v_mfma_f32_16x16x32_bf16 v[196:199], a[212:215], v[216:219], v[196:199]
  v_mfma_f32_16x16x32_bf16 v[200:203], a[216:219], v[216:219], v[200:203]
  s_waitcnt lgkmcnt(1)
  v_mfma_f32_16x16x32_bf16 v[132:135], a[220:223], v[220:223], v[132:135]
  v_mfma_f32_16x16x32_bf16 v[136:139], a[224:227], v[220:223], v[136:139]
  v_mfma_f32_16x16x32_bf16 v[140:143], a[228:231], v[220:223], v[140:143]
  v_mfma_f32_16x16x32_bf16 v[144:147], a[232:235], v[220:223], v[144:147]
  v_mfma_f32_16x16x32_bf16 v[148:151], a[236:239], v[220:223], v[148:151]
  v_mfma_f32_16x16x32_bf16 v[152:155], a[240:243], v[220:223], v[152:155]
  v_mfma_f32_16x16x32_bf16 v[156:159], a[244:247], v[220:223], v[156:159]
  v_mfma_f32_16x16x32_bf16 v[160:163], a[248:251], v[220:223], v[160:163]
  v_mfma_f32_16x16x32_bf16 v[164:167], a[252:255], v[220:223], v[164:167]
  s_waitcnt lgkmcnt(0)
  v_mfma_f32_16x16x32_bf16 v[168:171], a[220:223], v[204:207], v[168:171]
  v_mfma_f32_16x16x32_bf16 v[172:175], a[224:227], v[204:207], v[172:175]
  v_mfma_f32_16x16x32_bf16 v[176:179], a[228:231], v[204:207], v[176:179]
  v_mfma_f32_16x16x32_bf16 v[180:183], a[232:235], v[204:207], v[180:183]
  v_mfma_f32_16x16x32_bf16 v[184:187], a[236:239], v[204:207], v[184:187]
  v_mfma_f32_16x16x32_bf16 v[188:191], a[240:243], v[204:207], v[188:191]
  v_mfma_f32_16x16x32_bf16 v[192:195], a[244:247], v[204:207], v[192:195]
  v_mfma_f32_16x16x32_bf16 v[196:199], a[248:251], v[204:207], v[196:199]
  v_mfma_f32_16x16x32_bf16 v[200:203], a[252:255], v[204:207], v[200:203]
  s_cmp_ge_u32 s36, 40
  s_cbranch_scc1 L_arm_23
  v_mov_b32 v204, -1
  v_mov_b32 v205, -1
  v_mov_b32 v206, -1
  v_mov_b32 v207, -1
  s_add_u32 s34, s45, 0xd80000
  s_add_u32 s35, s46, 0xd80000
  buffer_store_dwordx4 v[204:207], v9, s[4:7], s34 offen offset:0 sc1
  buffer_store_dwordx4 v[204:207], v9, s[4:7], s34 offen offset:1024 sc1
  buffer_store_dwordx4 v[204:207], v9, s[4:7], s34 offen offset:2048 sc1
  buffer_store_dwordx4 v[204:207], v9, s[4:7], s34 offen offset:3072 sc1
  buffer_store_dwordx2 v[204:205], v10, s[4:7], s34 offen sc1
  buffer_store_dwordx4 v[204:207], v9, s[4:7], s35 offen offset:0 sc1
  buffer_store_dwordx4 v[204:207], v9, s[4:7], s35 offen offset:1024 sc1
  buffer_store_dwordx4 v[204:207], v9, s[4:7], s35 offen offset:2048 sc1
  buffer_store_dwordx4 v[204:207], v9, s[4:7], s35 offen offset:3072 sc1
  buffer_store_dwordx2 v[204:205], v10, s[4:7], s35 offen sc1
L_arm_23:
  v_cvt_pk_bf16_f32 v132, v132, v133
  v_cvt_pk_bf16_f32 v133, v134, v135
  v_min_u32 v132, -2, v132
  v_cvt_pk_bf16_f32 v134, v136, v137
  v_cvt_pk_bf16_f32 v135, v138, v139
  buffer_store_dwordx4 v[132:135], v9, s[4:7], s45 offen offset:0 sc1
  v_cvt_pk_bf16_f32 v140, v140, v141
  v_cvt_pk_bf16_f32 v141, v142, v143
  v_min_u32 v140, -2, v140
  v_cvt_pk_bf16_f32 v142, v144, v145
  v_cvt_pk_bf16_f32 v143, v146, v147
  buffer_store_dwordx4 v[140:143], v9, s[4:7], s45 offen offset:1024 sc1
  v_cvt_pk_bf16_f32 v148, v148, v149
  v_cvt_pk_bf16_f32 v149, v150, v151
  v_min_u32 v148, -2, v148
  v_cvt_pk_bf16_f32 v150, v152, v153
  v_cvt_pk_bf16_f32 v151, v154, v155
  buffer_store_dwordx4 v[148:151], v9, s[4:7], s45 offen offset:2048 sc1
  v_cvt_pk_bf16_f32 v156, v156, v157
  v_cvt_pk_bf16_f32 v157, v158, v159
  v_min_u32 v156, -2, v156
  v_cvt_pk_bf16_f32 v158, v160, v161
  v_cvt_pk_bf16_f32 v159, v162, v163
  buffer_store_dwordx4 v[156:159], v9, s[4:7], s45 offen offset:3072 sc1
  v_cvt_pk_bf16_f32 v164, v164, v165
  v_cvt_pk_bf16_f32 v165, v166, v167
  v_min_u32 v164, -2, v164
  buffer_store_dwordx2 v[164:165], v10, s[4:7], s45 offen sc1
  v_cvt_pk_bf16_f32 v168, v168, v169
  v_cvt_pk_bf16_f32 v169, v170, v171
  v_min_u32 v168, -2, v168
  v_cvt_pk_bf16_f32 v170, v172, v173
  v_cvt_pk_bf16_f32 v171, v174, v175
  buffer_store_dwordx4 v[168:171], v9, s[4:7], s46 offen offset:0 sc1
  v_cvt_pk_bf16_f32 v176, v176, v177
  v_cvt_pk_bf16_f32 v177, v178, v179
  v_min_u32 v176, -2, v176
  v_cvt_pk_bf16_f32 v178, v180, v181
  v_cvt_pk_bf16_f32 v179, v182, v183
  buffer_store_dwordx4 v[176:179], v9, s[4:7], s46 offen offset:1024 sc1
  v_cvt_pk_bf16_f32 v184, v184, v185
  v_cvt_pk_bf16_f32 v185, v186, v187
  v_min_u32 v184, -2, v184
  v_cvt_pk_bf16_f32 v186, v188, v189
  v_cvt_pk_bf16_f32 v187, v190, v191
  buffer_store_dwordx4 v[184:187], v9, s[4:7], s46 offen offset:2048 sc1
  v_cvt_pk_bf16_f32 v192, v192, v193
  v_cvt_pk_bf16_f32 v193, v194, v195
  v_min_u32 v192, -2, v192
  v_cvt_pk_bf16_f32 v194, v196, v197
  v_cvt_pk_bf16_f32 v195, v198, v199
  buffer_store_dwordx4 v[192:195], v9, s[4:7], s46 offen offset:3072 sc1
  v_cvt_pk_bf16_f32 v200, v200, v201
  v_cvt_pk_bf16_f32 v201, v202, v203
  v_min_u32 v200, -2, v200
  buffer_store_dwordx2 v[200:201], v10, s[4:7], s46 offen sc1
  s_mov_b32 s43, s42
  s_mov_b32 s36, s37
  v_xor_b32 v2, 0x10000, v2
  v_xor_b32 v3, 0x10000, v3
  s_branch L_bc_top
L_bc_nopf:
  ds_read_b128 v[204:207], v2 offset:0
  ds_read_b128 v[208:211], v2 offset:8192
  ds_read_b128 v[212:215], v2 offset:1024
  ds_read_b128 v[216:219], v2 offset:9216
  s_waitcnt lgkmcnt(3)
  v_mfma_f32_16x16x32_bf16 v[132:135], v[224:227], v[204:207], 0
  ds_read_b128 v[220:223], v2 offset:2048
  v_mfma_f32_16x16x32_bf16 v[136:139], v[228:231], v[204:207], 0
  v_mfma_f32_16x16x32_bf16 v[140:143], v[232:235], v[204:207], 0
  v_mfma_f32_16x16x32_bf16 v[144:147], v[236:239], v[204:207], 0
  v_mfma_f32_16x16x32_bf16 v[148:151], v[240:243], v[204:207], 0
  s_waitcnt vmcnt(0)
  buffer_store_dword v6, v5, s[4:7], s43 offen sc1
  v_mfma_f32_16x16x32_bf16 v[152:155], v[244:247], v[204:207], 0
  v_mfma_f32_16x16x32_bf16 v[156:159], v[248:251], v[204:207], 0
  v_mfma_f32_16x16x32_bf16 v[160:163], v[252:255], v[204:207], 0
  v_mfma_f32_16x16x32_bf16 v[164:167], a[0:3], v[204:207], 0
  s_waitcnt lgkmcnt(3)
  v_mfma_f32_16x16x32_bf16 v[168:171], v[224:227], v[208:211], 0
  ds_read_b128 v[204:207], v2 offset:10240
  v_mfma_f32_16x16x32_bf16 v[172:175], v[228:231], v[208:211], 0
  v_mfma_f32_16x16x32_bf16 v[176:179], v[232:235], v[208:211], 0
  v_mfma_f32_16x16x32_bf16 v[180:183], v[236:239], v[208:211], 0
  v_mfma_f32_16x16x32_bf16 v[184:187], v[240:243], v[208:211], 0
  v_mfma_f32_16x16x32_bf16 v[188:191], v[244:247], v[208:211], 0
  v_mfma_f32_16x16x32_bf16 v[192:195], v[248:251], v[208:211], 0
  v_mfma_f32_16x16x32_bf16 v[196:199], v[252:255], v[208:211], 0
  v_mfma_f32_16x16x32_bf16 v[200:203], a[0:3], v[208:211], 0
  s_waitcnt lgkmcnt(3)
  v_mfma_f32_16x16x32_bf16 v[132:135], a[4:7], v[212:215], v[132:135]
  ds_read_b128 v[208:211], v2 offset:3072
  v_mfma_f32_16x16x32_bf16 v[136:139], a[8:11], v[212:215], v[136:139]
  v_mfma_f32_16x16x32_bf16 v[140:143], a[12:15], v[212:215], v[140:143]
  v_mfma_f32_16x16x32_bf16 v[144:147], a[16:19], v[212:215], v[144:147]
  v_mfma_f32_16x16x32_bf16 v[148:151], a[20:23], v[212:215], v[148:151]
  v_mfma_f32_16x16x32_bf16 v[152:155], a[24:27], v[212:215], v[152:155]
  v_mfma_f32_16x16x32_bf16 v[156:159], a[28:31], v[212:215], v[156:159]
  v_mfma_f32_16x16x32_bf16 v[160:163], a[32:35], v[212:215], v[160:163]
  v_mfma_f32_16x16x32_bf16 v[164:167], a[36:39], v[212:215], v[164:167]
  s_waitcnt lgkmcnt(3)
  v_mfma_f32_16x16x32_bf16 v[168:171], a[4:7], v[216:219], v[168:171]
  ds_read_b128 v[212:215], v2 offset:11264
  v_mfma_f32_16x16x32_bf16 v[172:175], a[8:11], v[216:219], v[172:175]
  v_mfma_f32_16x16x32_bf16 v[176:179], a[12:15], v[216:219], v[176:179]
  v_mfma_f32_16x16x32_bf16 v[180:183], a[16:19], v[216:219], v[180:183]
  v_mfma_f32_16x16x32_bf16 v[184:187], a[20:23], v[216:219], v[184:187]
  v_mfma_f32_16x16x32_bf16 v[188:191], a[24:27], v[216:219], v[188:191]
  v_mfma_f32_16x16x32_bf16 v[192:195], a[28:31], v[216:219], v[192:195]
  v_mfma_f32_16x16x32_bf16 v[196:199], a[32:35], v[216:219], v[196:199]
  v_mfma_f32_16x16x32_bf16 v[200:203], a[36:39], v[216:219], v[200:203]
  s_waitcnt lgkmcnt(3)
  v_mfma_f32_16x16x32_bf16 v[132:135], a[40:43], v[220:223], v[132:135]
  ds_read_b128 v[216:219], v2 offset:4096
  v_mfma_f32_16x16x32_bf16 v[136:139], a[44:47], v[220:223], v[136:139]
  v_mfma_f32_16x16x32_bf16 v[140:143], a[48:51], v[220:223], v[140:143]
  v_mfma_f32_16x16x32_bf16 v[144:147], a[52:55], v[220:223], v[144:147]
  v_mfma_f32_16x16x32_bf16 v[148:151], a[56:59], v[220:223], v[148:151]
  v_mfma_f32_16x16x32_bf16 v[152:155], a[60:63], v[220:223], v[152:155]
  v_mfma_f32_16x16x32_bf16 v[156:159], a[64:67], v[220:223], v[156:159]
  v_mfma_f32_16x16x32_bf16 v[160:163], a[68:71], v[220:223], v[160:163]
  v_mfma_f32_16x16x32_bf16 v[164:167], a[72:75], v[220:223], v[164:167]
  s_waitcnt lgkmcnt(3)
  v_mfma_f32_16x16x32_bf16 v[168:171], a[40:43], v[204:207], v[168:171]
  ds_read_b128 v[220:223], v2 offset:12288
  v_mfma_f32_16x16x32_bf16 v[172:175], a[44:47], v[204:207], v[172:175]
  v_mfma_f32_16x16x32_bf16 v[176:179], a[48:51], v[204:207], v[176:179]
  v_mfma_f32_16x16x32_bf16 v[180:183], a[52:55], v[204:207], v[180:183]
  v_mfma_f32_16x16x32_bf16 v[184:187], a[56:59], v[204:207], v[184:187]
  v_mfma_f32_16x16x32_bf16 v[188:191], a[60:63], v[204:207], v[188:191]
  v_mfma_f32_16x16x32_bf16 v[192:195], a[64:67], v[204:207], v[192:195]
  v_mfma_f32_16x16x32_bf16 v[196:199], a[68:71], v[204:207], v[196:199]
  v_mfma_f32_16x16x32_bf16 v[200:203], a[72:75], v[204:207], v[200:203]
  s_waitcnt lgkmcnt(3)
  v_mfma_f32_16x16x32_bf16 v[132:135], a[76:79], v[208:211], v[132:135]
  ds_read_b128 v[204:207], v2 offset:5120
  v_mfma_f32_16x16x32_bf16 v[136:139], a[80:83], v[208:211], v[136:139]
  v_mfma_f32_16x16x32_bf16 v[140:143], a[84:87], v[208:211], v[140:143]
  v_mfma_f32_16x16x32_bf16 v[144:147], a[88:91], v[208:211], v[144:147]
  v_mfma_f32_16x16x32_bf16 v[148:151], a[92:95], v[208:211], v[148:151]
  v_mfma_f32_16x16x32_bf16 v[152:155], a[96:99], v[208:211], v[152:155]
  v_mfma_f32_16x16x32_bf16 v[156:159], a[100:103], v[208:211], v[156:159]
  v_mfma_f32_16x16x32_bf16 v[160:163], a[104:107], v[208:211], v[160:163]
  v_mfma_f32_16x16x32_bf16 v[164:167], a[108:111], v[208:211], v[164:167]
  s_waitcnt lgkmcnt(3)
  v_mfma_f32_16x16x32_bf16 v[168:171], a[76:79], v[212:215], v[168:171]
  ds_read_b128 v[208:211], v2 offset:13312
  v_mfma_f32_16x16x32_bf16 v[172:175], a[80:83], v[212:215], v[172:175]
  v_mfma_f32_16x16x32_bf16 v[176:179], a[84:87], v[212:215], v[176:179]
  v_mfma_f32_16x16x32_bf16 v[180:183], a[88:91], v[212:215], v[180:183]
  v_mfma_f32_16x16x32_bf16 v[184:187], a[92:95], v[212:215], v[184:187]
  v_mfma_f32_16x16x32_bf16 v[188:191], a[96:99], v[212:215], v[188:191]
  v_mfma_f32_16x16x32_bf16 v[192:195], a[100:103], v[212:215], v[192:195]
  v_mfma_f32_16x16x32_bf16 v[196:199], a[104:107], v[212:215], v[196:199]
  v_mfma_f32_16x16x32_bf16 v[200:203], a[108:111], v[212:215], v[200:203]
  s_waitcnt lgkmcnt(3)
  v_mfma_f32_16x16x32_bf16 v[132:135], a[112:115], v[216:219], v[132:135]
  ds_read_b128 v[212:215], v2 offset:6144
  v_mfma_f32_16x16x32_bf16 v[136:139], a[116:119], v[216:219], v[136:139]
  v_mfma_f32_16x16x32_bf16 v[140:143], a[120:123], v[216:219], v[140:143]
  v_mfma_f32_16x16x32_bf16 v[144:147], a[124:127], v[216:219], v[144:147]
  v_mfma_f32_16x16x32_bf16 v[148:151], a[128:131], v[216:219], v[148:151]
  v_mfma_f32_16x16x32_bf16 v[152:155], a[132:135], v[216:219], v[152:155]
  v_mfma_f32_16x16x32_bf16 v[156:159], a[136:139], v[216:219], v[156:159]
  v_mfma_f32_16x16x32_bf16 v[160:163], a[140:143], v[216:219], v[160:163]
  v_mfma_f32_16x16x32_bf16 v[164:167], a[144:147], v[216:219], v[164:167]
  s_waitcnt lgkmcnt(3)
  v_mfma_f32_16x16x32_bf16 v[168:171], a[112:115], v[220:223], v[168:171]
  ds_read_b128 v[216:219], v2 offset:14336
  v_mfma_f32_16x16x32_bf16 v[172:175], a[116:119], v[220:223], v[172:175]
  v_mfma_f32_16x16x32_bf16 v[176:179], a[120:123], v[220:223], v[176:179]
  v_mfma_f32_16x16x32_bf16 v[180:183], a[124:127], v[220:223], v[180:183]
  v_mfma_f32_16x16x32_bf16 v[184:187], a[128:131], v[220:223], v[184:187]
  v_mfma_f32_16x16x32_bf16 v[188:191], a[132:135], v[220:223], v[188:191]
  v_mfma_f32_16x16x32_bf16 v[192:195], a[136:139], v[220:223], v[192:195]
  v_mfma_f32_16x16x32_bf16 v[196:199], a[140:143], v[220:223], v[196:199]
  v_mfma_f32_16x16x32_bf16 v[200:203], a[144:147], v[220:223], v[200:203]
  s_waitcnt lgkmcnt(3)
  v_mfma_f32_16x16x32_bf16 v[132:135], a[148:151], v[204:207], v[132:135]
  ds_read_b128 v[220:223], v2 offset:7168
  v_mfma_f32_16x16x32_bf16 v[136:139], a[152:155], v[204:207], v[136:139]
  v_mfma_f32_16x16x32_bf16 v[140:143], a[156:159], v[204:207], v[140:143]
  v_mfma_f32_16x16x32_bf16 v[144:147], a[160:163], v[204:207], v[144:147]
  v_mfma_f32_16x16x32_bf16 v[148:151], a[164:167], v[204:207], v[148:151]
  v_mfma_f32_16x16x32_bf16 v[152:155], a[168:171], v[204:207], v[152:155]
  v_mfma_f32_16x16x32_bf16 v[156:159], a[172:175], v[204:207], v[156:159]
  v_mfma_f32_16x16x32_bf16 v[160:163], a[176:179], v[204:207], v[160:163]
  v_mfma_f32_16x16x32_bf16 v[164:167], a[180:183], v[204:207], v[164:167]
  s_waitcnt lgkmcnt(3)
  v_mfma_f32_16x16x32_bf16 v[168:171], a[148:151], v[208:211], v[168:171]
  ds_read_b128 v[204:207], v2 offset:15360
  v_mfma_f32_16x16x32_bf16 v[172:175], a[152:155], v[208:211], v[172:175]
  v_mfma_f32_16x16x32_bf16 v[176:179], a[156:159], v[208:211], v[176:179]
  v_mfma_f32_16x16x32_bf16 v[180:183], a[160:163], v[208:211], v[180:183]
  v_mfma_f32_16x16x32_bf16 v[184:187], a[164:167], v[208:211], v[184:187]
  v_mfma_f32_16x16x32_bf16 v[188:191], a[168:171], v[208:211], v[188:191]
  v_mfma_f32_16x16x32_bf16 v[192:195], a[172:175], v[208:211], v[192:195]
  v_mfma_f32_16x16x32_bf16 v[196:199], a[176:179], v[208:211], v[196:199]
  v_mfma_f32_16x16x32_bf16 v[200:203], a[180:183], v[208:211], v[200:203]
  s_waitcnt lgkmcnt(3)
  v_mfma_f32_16x16x32_bf16 v[132:135], a[184:187], v[212:215], v[132:135]
  v_mfma_f32_16x16x32_bf16 v[136:139], a[188:191], v[212:215], v[136:139]
  v_mfma_f32_16x16x32_bf16 v[140:143], a[192:195], v[212:215], v[140:143]
  v_mfma_f32_16x16x32_bf16 v[144:147], a[196:199], v[212:215], v[144:147]
  v_mfma_f32_16x16x32_bf16 v[148:151], a[200:203], v[212:215], v[148:151]
  v_mfma_f32_16x16x32_bf16 v[152:155], a[204:207], v[212:215], v[152:155]
  v_mfma_f32_16x16x32_bf16 v[156:159], a[208:211], v[212:215], v[156:159]
  v_mfma_f32_16x16x32_bf16 v[160:163], a[212:215], v[212:215], v[160:163]
  v_mfma_f32_16x16x32_bf16 v[164:167], a[216:219], v[212:215], v[164:167]
  s_waitcnt lgkmcnt(2)
  v_mfma_f32_16x16x32_bf16 v[168:171], a[184:187], v[216:219], v[168:171]
  v_mfma_f32_16x16x32_bf16 v[172:175], a[188:191], v[216:219], v[172:175]
  v_mfma_f32_16x16x32_bf16 v[176:179], a[192:195], v[216:219], v[176:179]
  v_mfma_f32_16x16x32_bf16 v[180:183], a[196:199], v[216:219], v[180:183]
  v_mfma_f32_16x16x32_bf16 v[184:187], a[200:203], v[216:219], v[184:187]
  v_mfma_f32_16x16x32_bf16 v[188:191], a[204:207], v[216:219], v[188:191]
  v_mfma_f32_16x16x32_bf16 v[192:195], a[208:211], v[216:219], v[192:195]
  v_mfma_f32_16x16x32_bf16 v[196:199], a[212:215], v[216:219], v[196:199]
  v_mfma_f32_16x16x32_bf16 v[200:203], a[216:219], v[216:219], v[200:203]
  s_waitcnt lgkmcnt(1)
  v_mfma_f32_16x16x32_bf16 v[132:135], a[220:223], v[220:223], v[132:135]
  v_mfma_f32_16x16x32_bf16 v[136:139], a[224:227], v[220:223], v[136:139]
  v_mfma_f32_16x16x32_bf16 v[140:143], a[228:231], v[220:223], v[140:143]
  v_mfma_f32_16x16x32_bf16 v[144:147], a[232:235], v[220:223], v[144:147]
  v_mfma_f32_16x16x32_bf16 v[148:151], a[236:239], v[220:223], v[148:151]
  v_mfma_f32_16x16x32_bf16 v[152:155], a[240:243], v[220:223], v[152:155]
  v_mfma_f32_16x16x32_bf16 v[156:159], a[244:247], v[220:223], v[156:159]
  v_mfma_f32_16x16x32_bf16 v[160:163], a[248:251], v[220:223], v[160:163]
  v_mfma_f32_16x16x32_bf16 v[164:167], a[252:255], v[220:223], v[164:167]
  s_waitcnt lgkmcnt(0)
  v_mfma_f32_16x16x32_bf16 v[168:171], a[220:223], v[204:207], v[168:171]
  v_mfma_f32_16x16x32_bf16 v[172:175], a[224:227], v[204:207], v[172:175]
  v_mfma_f32_16x16x32_bf16 v[176:179], a[228:231], v[204:207], v[176:179]
  v_mfma_f32_16x16x32_bf16 v[180:183], a[232:235], v[204:207], v[180:183]
  v_mfma_f32_16x16x32_bf16 v[184:187], a[236:239], v[204:207], v[184:187]
  v_mfma_f32_16x16x32_bf16 v[188:191], a[240:243], v[204:207], v[188:191]
  v_mfma_f32_16x16x32_bf16 v[192:195], a[244:247], v[204:207], v[192:195]
  v_mfma_f32_16x16x32_bf16 v[196:199], a[248:251], v[204:207], v[196:199]
  v_mfma_f32_16x16x32_bf16 v[200:203], a[252:255], v[204:207], v[200:203]
  s_cmp_ge_u32 s36, 40
  s_cbranch_scc1 L_arm_24
  v_mov_b32 v204, -1
  v_mov_b32 v205, -1
  v_mov_b32 v206, -1
  v_mov_b32 v207, -1
  s_add_u32 s34, s45, 0xd80000
  s_add_u32 s35, s46, 0xd80000
  buffer_store_dwordx4 v[204:207], v9, s[4:7], s34 offen offset:0 sc1
  buffer_store_dwordx4 v[204:207], v9, s[4:7], s34 offen offset:1024 sc1
  buffer_store_dwordx4 v[204:207], v9, s[4:7], s34 offen offset:2048 sc1
  buffer_store_dwordx4 v[204:207], v9, s[4:7], s34 offen offset:3072 sc1
  buffer_store_dwordx2 v[204:205], v10, s[4:7], s34 offen sc1
  buffer_store_dwordx4 v[204:207], v9, s[4:7], s35 offen offset:0 sc1
  buffer_store_dwordx4 v[204:207], v9, s[4:7], s35 offen offset:1024 sc1
  buffer_store_dwordx4 v[204:207], v9, s[4:7], s35 offen offset:2048 sc1
  buffer_store_dwordx4 v[204:207], v9, s[4:7], s35 offen offset:3072 sc1
  buffer_store_dwordx2 v[204:205], v10, s[4:7], s35 offen sc1
L_arm_24:
  v_cvt_pk_bf16_f32 v132, v132, v133
  v_cvt_pk_bf16_f32 v133, v134, v135
  v_min_u32 v132, -2, v132
  v_cvt_pk_bf16_f32 v134, v136, v137
  v_cvt_pk_bf16_f32 v135, v138, v139
  buffer_store_dwordx4 v[132:135], v9, s[4:7], s45 offen offset:0 sc1
  v_cvt_pk_bf16_f32 v140, v140, v141
  v_cvt_pk_bf16_f32 v141, v142, v143
  v_min_u32 v140, -2, v140
  v_cvt_pk_bf16_f32 v142, v144, v145
  v_cvt_pk_bf16_f32 v143, v146, v147
  buffer_store_dwordx4 v[140:143], v9, s[4:7], s45 offen offset:1024 sc1
  v_cvt_pk_bf16_f32 v148, v148, v149
  v_cvt_pk_bf16_f32 v149, v150, v151
  v_min_u32 v148, -2, v148
  v_cvt_pk_bf16_f32 v150, v152, v153
  v_cvt_pk_bf16_f32 v151, v154, v155
  buffer_store_dwordx4 v[148:151], v9, s[4:7], s45 offen offset:2048 sc1
  v_cvt_pk_bf16_f32 v156, v156, v157
  v_cvt_pk_bf16_f32 v157, v158, v159
  v_min_u32 v156, -2, v156
  v_cvt_pk_bf16_f32 v158, v160, v161
  v_cvt_pk_bf16_f32 v159, v162, v163
  buffer_store_dwordx4 v[156:159], v9, s[4:7], s45 offen offset:3072 sc1
  v_cvt_pk_bf16_f32 v164, v164, v165
  v_cvt_pk_bf16_f32 v165, v166, v167
  v_min_u32 v164, -2, v164
  buffer_store_dwordx2 v[164:165], v10, s[4:7], s45 offen sc1
  v_cvt_pk_bf16_f32 v168, v168, v169
  v_cvt_pk_bf16_f32 v169, v170, v171
  v_min_u32 v168, -2, v168
  v_cvt_pk_bf16_f32 v170, v172, v173
  v_cvt_pk_bf16_f32 v171, v174, v175
  buffer_store_dwordx4 v[168:171], v9, s[4:7], s46 offen offset:0 sc1
  v_cvt_pk_bf16_f32 v176, v176, v177
  v_cvt_pk_bf16_f32 v177, v178, v179
  v_min_u32 v176, -2, v176
  v_cvt_pk_bf16_f32 v178, v180, v181
  v_cvt_pk_bf16_f32 v179, v182, v183
  buffer_store_dwordx4 v[176:179], v9, s[4:7], s46 offen offset:1024 sc1
  v_cvt_pk_bf16_f32 v184, v184, v185
  v_cvt_pk_bf16_f32 v185, v186, v187
  v_min_u32 v184, -2, v184
  v_cvt_pk_bf16_f32 v186, v188, v189
  v_cvt_pk_bf16_f32 v187, v190, v191
  buffer_store_dwordx4 v[184:187], v9, s[4:7], s46 offen offset:2048 sc1
  v_cvt_pk_bf16_f32 v192, v192, v193
  v_cvt_pk_bf16_f32 v193, v194, v195
  v_min_u32 v192, -2, v192
  v_cvt_pk_bf16_f32 v194, v196, v197
  v_cvt_pk_bf16_f32 v195, v198, v199
  buffer_store_dwordx4 v[192:195], v9, s[4:7], s46 offen offset:3072 sc1
  v_cvt_pk_bf16_f32 v200, v200, v201
  v_cvt_pk_bf16_f32 v201, v202, v203
  v_min_u32 v200, -2, v200
  buffer_store_dwordx2 v[200:201], v10, s[4:7], s46 offen sc1
  s_waitcnt vmcnt(0)
  buffer_store_dword v6, v5, s[4:7], s42 offen sc1
  s_mov_b32 s43, 0x40000000
  s_cmp_ge_u32 s37, 24
  s_cbranch_scc1 L_bc_done
  s_lshl_b32 s44, s37, 13
  s_lshl_b32 s27, s50, 9
  s_add_u32 s44, s44, s27
  s_add_u32 s44, s44, 0x80000
  s_mov_b32 s49, 0
L_poll_25:
  buffer_load_dword v8, v7, s[4:7], s44 offen sc1
  s_waitcnt vmcnt(0)
  v_cmp_eq_u32 vcc, 0, v8
  s_cbranch_vccz L_polld_26
  s_add_u32 s49, s49, 1
  s_cmp_lt_u32 s49, 1048576
  s_cbranch_scc1 L_poll_25
  s_branch L_fail
L_polld_26:
  s_lshl_b32 s58, s37, 5
  s_add_u32 s58, s58, s51
  s_lshl_b32 s56, s58, 13
  s_lshl_b32 s58, s58, 12
  s_add_u32 s54, s56, 0x2000000
  s_add_u32 s55, s56, 0x2001000
  s_add_u32 s53, s56, s52
  s_add_u32 s57, s56, 0x3001000
  s_add_u32 s56, s56, 0x3000000
  s_add_u32 s59, s58, 0x4800000
  s_add_u32 s58, s58, 0x4000000
  s_add_u32 s26, s37, 3
  s_min_u32 s26, s26, 23
  s_lshl_b32 s44, s26, 13
  s_lshl_b32 s27, s50, 9
  s_add_u32 s44, s44, s27
  s_add_u32 s44, s44, 0x80000
  buffer_load_dword v8, v7, s[4:7], s44 offen sc1
  buffer_load_dwordx4 v[20:23], v0, s[4:7], s53 offen offset:0 sc1
  buffer_load_dwordx4 v[36:39], v0, s[4:7], s54 offen offset:0 sc1
  buffer_load_dwordx4 v[52:55], v0, s[4:7], s55 offen offset:0 sc1
  buffer_load_dwordx4 v[68:71], v11, s[4:7], s58 offen offset:0 sc1
  buffer_load_dwordx4 v[24:27], v0, s[4:7], s53 offen offset:1024 sc1
  buffer_load_dwordx4 v[40:43], v0, s[4:7], s54 offen offset:1024 sc1
  buffer_load_dwordx4 v[56:59], v0, s[4:7], s55 offen offset:1024 sc1
  buffer_load_dwordx4 v[72:75], v11, s[4:7], s58 offen offset:1024 sc1
  buffer_load_dwordx4 v[28:31], v0, s[4:7], s53 offen offset:2048 sc1
  buffer_load_dwordx4 v[44:47], v0, s[4:7], s54 offen offset:2048 sc1
  buffer_load_dwordx4 v[60:63], v0, s[4:7], s55 offen offset:2048 sc1
  buffer_load_dwordx4 v[76:79], v11, s[4:7], s58 offen offset:2048 sc1
  buffer_load_dwordx4 v[32:35], v0, s[4:7], s53 offen offset:3072 sc1
  buffer_load_dwordx4 v[48:51], v0, s[4:7], s54 offen offset:3072 sc1
  buffer_load_dwordx4 v[64:67], v0, s[4:7], s55 offen offset:3072 sc1
  buffer_load_dwordx4 v[80:83], v11, s[4:7], s58 offen offset:3072 sc1
  buffer_load_dwordx4 v[84:87], v0, s[4:7], s56 offen offset:0 sc1
  buffer_load_dwordx2 v[116:117], v4, s[4:7], s59 offen offset:0 sc1
  buffer_load_dwordx4 v[88:91], v0, s[4:7], s56 offen offset:1024 sc1
  buffer_load_dwordx4 v[92:95], v0, s[4:7], s56 offen offset:2048 sc1
  buffer_load_dwordx2 v[118:119], v4, s[4:7], s59 offen offset:1024 sc1
  buffer_load_dwordx4 v[96:99], v0, s[4:7], s56 offen offset:3072 sc1
  buffer_load_dwordx4 v[100:103], v0, s[4:7], s57 offen offset:0 sc1
  buffer_load_dwordx2 v[120:121], v4, s[4:7], s59 offen offset:2048 sc1
  buffer_load_dwordx4 v[104:107], v0, s[4:7], s57 offen offset:1024 sc1
  buffer_load_dwordx4 v[108:111], v0, s[4:7], s57 offen offset:2048 sc1
  buffer_load_dwordx2 v[122:123], v4, s[4:7], s59 offen offset:3072 sc1
  buffer_load_dwordx4 v[112:115], v0, s[4:7], s57 offen offset:3072 sc1
  s_mov_b32 s36, s37
  v_xor_b32 v2, 0x10000, v2
  v_xor_b32 v3, 0x10000, v3
  s_branch L_bc_top
L_bc_done:
  s_mov_b32 s36, s37
  v_lshrrev_b32 v7, 8, v0
  v_mul_u32_u24 v7, 3, v7
  s_add_u32 s26, s36, 0
  v_add_u32 v7, s26, v7
  v_min_u32 v7, 63, v7
  v_and_b32 v8, 0xff, v0
  v_min_u32 v8, 176, v8
  v_lshl_add_u32 v7, v7, 13, v8
  s_lshl_b32 s44, s50, 9
  s_add_u32 s44, s44, 0x80000
  s_mov_b32 s49, 0
L_poll_27:
  buffer_load_dword v8, v7, s[4:7], s44 offen sc1
  s_waitcnt vmcnt(0)
  v_cmp_eq_u32 vcc, 0, v8
  s_cbranch_vccz L_polld_28
  s_add_u32 s49, s49, 1
  s_cmp_lt_u32 s49, 1048576
  s_cbranch_scc1 L_poll_27
  s_branch L_fail
L_polld_28:
  v_lshrrev_b32 v7, 8, v0
  v_mul_u32_u24 v7, 3, v7
  s_add_u32 s26, s36, 12
  v_add_u32 v7, s26, v7
  v_min_u32 v7, 63, v7
  v_and_b32 v8, 0xff, v0
  v_min_u32 v8, 176, v8
  v_lshl_add_u32 v7, v7, 13, v8
  s_lshl_b32 s44, s50, 9
  s_add_u32 s44, s44, 0x80000
  s_mov_b32 s49, 0
L_poll_29:
  buffer_load_dword v8, v7, s[4:7], s44 offen sc1
  s_waitcnt vmcnt(0)
  v_cmp_eq_u32 vcc, 0, v8
  s_cbranch_vccz L_polld_30
  s_add_u32 s49, s49, 1
  s_cmp_lt_u32 s49, 1048576
  s_cbranch_scc1 L_poll_29
  s_branch L_fail
L_polld_30:
  v_lshrrev_b32 v7, 8, v0
  v_mul_u32_u24 v7, 3, v7
  s_add_u32 s26, s36, 24
  v_add_u32 v7, s26, v7
  v_min_u32 v7, 63, v7
  v_and_b32 v8, 0xff, v0
  v_min_u32 v8, 176, v8
  v_lshl_add_u32 v7, v7, 13, v8
  s_lshl_b32 s44, s50, 9
  s_add_u32 s44, s44, 0x80000
  s_mov_b32 s49, 0
L_poll_31:
  buffer_load_dword v8, v7, s[4:7], s44 offen sc1
  s_waitcnt vmcnt(0)
  v_cmp_eq_u32 vcc, 0, v8
  s_cbranch_vccz L_polld_32
  s_add_u32 s49, s49, 1
  s_cmp_lt_u32 s49, 1048576
  s_cbranch_scc1 L_poll_31
  s_branch L_fail
L_polld_32:
  v_lshrrev_b32 v7, 8, v0
  v_mul_u32_u24 v7, 3, v7
  s_add_u32 s26, s36, 36
  v_add_u32 v7, s26, v7
  v_min_u32 v7, 63, v7
  v_and_b32 v8, 0xff, v0
  v_min_u32 v8, 176, v8
  v_lshl_add_u32 v7, v7, 13, v8
  s_lshl_b32 s44, s50, 9
  s_add_u32 s44, s44, 0x80000
  s_mov_b32 s49, 0
L_poll_33:
  buffer_load_dword v8, v7, s[4:7], s44 offen sc1
  s_waitcnt vmcnt(0)
  v_cmp_eq_u32 vcc, 0, v8
  s_cbranch_vccz L_polld_34
  s_add_u32 s49, s49, 1
  s_cmp_lt_u32 s49, 1048576
  s_cbranch_scc1 L_poll_33
  s_branch L_fail
L_polld_34:
  s_lshl_b32 s58, s36, 5
  s_add_u32 s58, s58, s51
  s_lshl_b32 s56, s58, 13
  s_lshl_b32 s58, s58, 12
  s_add_u32 s54, s56, 0x2000000
  s_add_u32 s55, s56, 0x2001000
  s_add_u32 s53, s56, s52
  s_add_u32 s57, s56, 0x3001000
  s_add_u32 s56, s56, 0x3000000
  s_add_u32 s59, s58, 0x4800000
  s_add_u32 s58, s58, 0x4000000
  buffer_load_dwordx4 v[20:23], v0, s[4:7], s53 offen offset:0 sc1
  buffer_load_dwordx4 v[36:39], v0, s[4:7], s54 offen offset:0 sc1
  buffer_load_dwordx4 v[52:55], v0, s[4:7], s55 offen offset:0 sc1
  buffer_load_dwordx4 v[24:27], v0, s[4:7], s53 offen offset:1024 sc1
  buffer_load_dwordx4 v[40:43], v0, s[4:7], s54 offen offset:1024 sc1
  buffer_load_dwordx4 v[56:59], v0, s[4:7], s55 offen offset:1024 sc1
  buffer_load_dwordx4 v[28:31], v0, s[4:7], s53 offen offset:2048 sc1
  buffer_load_dwordx4 v[44:47], v0, s[4:7], s54 offen offset:2048 sc1
  buffer_load_dwordx4 v[60:63], v0, s[4:7], s55 offen offset:2048 sc1
  buffer_load_dwordx4 v[32:35], v0, s[4:7], s53 offen offset:3072 sc1
  buffer_load_dwordx4 v[48:51], v0, s[4:7], s54 offen offset:3072 sc1
  buffer_load_dwordx4 v[64:67], v0, s[4:7], s55 offen offset:3072 sc1
  buffer_load_dwordx4 v[84:87], v0, s[4:7], s56 offen offset:0 sc1
  buffer_load_dwordx4 v[88:91], v0, s[4:7], s56 offen offset:1024 sc1
  buffer_load_dwordx4 v[92:95], v0, s[4:7], s56 offen offset:2048 sc1
  buffer_load_dwordx4 v[96:99], v0, s[4:7], s56 offen offset:3072 sc1
  buffer_load_dwordx4 v[100:103], v0, s[4:7], s57 offen offset:0 sc1
  buffer_load_dwordx4 v[104:107], v0, s[4:7], s57 offen offset:1024 sc1
  buffer_load_dwordx4 v[108:111], v0, s[4:7], s57 offen offset:2048 sc1
  buffer_load_dwordx4 v[112:115], v0, s[4:7], s57 offen offset:3072 sc1
L_bc_tail:
  s_mov_b32 s49, 0
L_spin_35:
  s_mov_b64 exec, 0x1
L_spind_37:
  buffer_load_dword v8, v11, s[4:7], s58 offen offset:0 sc1
  s_add_u32 s49, s49, 1
  s_cmp_ge_u32 s49, 1048576
  s_cbranch_scc1 L_fail
  s_waitcnt vmcnt(0)
  v_cmp_eq_u32 vcc, -1, v8
  s_cbranch_vccnz L_spind_37
  s_mov_b64 exec, -1
  buffer_load_dwordx4 v[68:71], v11, s[4:7], s58 offen offset:0 sc1
  buffer_load_dwordx4 v[72:75], v11, s[4:7], s58 offen offset:1024 sc1
  buffer_load_dwordx4 v[76:79], v11, s[4:7], s58 offen offset:2048 sc1
  buffer_load_dwordx4 v[80:83], v11, s[4:7], s58 offen offset:3072 sc1
  buffer_load_dwordx2 v[116:117], v4, s[4:7], s59 offen offset:0 sc1
  buffer_load_dwordx2 v[118:119], v4, s[4:7], s59 offen offset:1024 sc1
  buffer_load_dwordx2 v[120:121], v4, s[4:7], s59 offen offset:2048 sc1
  buffer_load_dwordx2 v[122:123], v4, s[4:7], s59 offen offset:3072 sc1
  s_add_u32 s49, s49, 1
  s_cmp_ge_u32 s49, 1048576
  s_cbranch_scc1 L_fail
  s_waitcnt vmcnt(6)
  v_max_u32 v8, v68, v72
  s_waitcnt vmcnt(4)
  v_max3_u32 v8, v8, v76, v80
  s_waitcnt vmcnt(2)
  v_max3_u32 v8, v8, v116, v118
  s_waitcnt vmcnt(0)
  v_max3_u32 v8, v8, v120, v122
  v_cmp_eq_u32 vcc, -1, v8
  s_cbranch_vccnz L_spin_35
L_spinc_36:
  v_xor_b32 v2, 0x10000, v2
  v_xor_b32 v3, 0x10000, v3
  v_mfma_f32_16x16x32_bf16 v[132:135], v[36:39], v[20:23], v[12:15]
  v_mov_b32 v186, 0
  v_mfma_f32_16x16x32_bf16 v[136:139], v[52:55], v[20:23], v[16:19]
  v_mfma_f32_16x16x32_bf16 v[140:143], v[68:71], v[20:23], 0
  v_mfma_f32_16x16x32_bf16 v[132:135], v[40:43], v[24:27], v[132:135]
  v_mov_b32 v185, 0
  v_mfma_f32_16x16x32_bf16 v[136:139], v[56:59], v[24:27], v[136:139]
  v_mfma_f32_16x16x32_bf16 v[140:143], v[72:75], v[24:27], v[140:143]
  v_mfma_f32_16x16x32_bf16 v[132:135], v[44:47], v[28:31], v[132:135]
  v_mov_b32 v195, 0x3f803f80
  v_mfma_f32_16x16x32_bf16 v[136:139], v[60:63], v[28:31], v[136:139]
  v_mfma_f32_16x16x32_bf16 v[140:143], v[76:79], v[28:31], v[140:143]
  v_mfma_f32_16x16x32_bf16 v[132:135], v[48:51], v[32:35], v[132:135]
  v_mov_b32 v194, 0x3f803f80
  v_mfma_f32_16x16x32_bf16 v[136:139], v[64:67], v[32:35], v[136:139]
  v_mfma_f32_16x16x32_bf16 v[140:143], v[80:83], v[32:35], v[140:143]
  v_mov_b32 v192, 0x3f803f80
  v_mov_b32 v193, 0x3f803f80
  v_max3_f32 v200, v132, v133, v134
  s_nop 0
  v_max3_f32 v201, v135, v136, v137
  v_max3_f32 v200, v200, v138, v139
  s_nop 1
  v_max3_f32 v201, v201, v140, v141
  v_max_f32 v200, v200, v201
  v_mov_b32 v201, v200
  s_nop 1
  v_permlane32_swap_b32 v200, v201
  v_max_f32 v200, v200, v201
  v_mov_b32 v201, v200
  s_nop 1
  v_permlane16_swap_b32 v200, v201
  v_max_f32 v200, v200, v201
  v_mul_f32 v200, s60, v200
  v_pk_fma_f32 v[132:133], v[132:133], s[60:61], v[200:201] op_sel_hi:[1,1,0] neg_lo:[0,0,1] neg_hi:[0,0,1]
  v_pk_fma_f32 v[134:135], v[134:135], s[60:61], v[200:201] op_sel_hi:[1,1,0] neg_lo:[0,0,1] neg_hi:[0,0,1]
  v_pk_fma_f32 v[136:137], v[136:137], s[60:61], v[200:201] op_sel_hi:[1,1,0] neg_lo:[0,0,1] neg_hi:[0,0,1]
  v_pk_fma_f32 v[138:139], v[138:139], s[60:61], v[200:201] op_sel_hi:[1,1,0] neg_lo:[0,0,1] neg_hi:[0,0,1]
  v_pk_fma_f32 v[140:141], v[140:141], s[60:61], v[200:201] op_sel_hi:[1,1,0] neg_lo:[0,0,1] neg_hi:[0,0,1]
  v_exp_f32 v132, v132
  v_exp_f32 v133, v133
  v_exp_f32 v134, v134
  v_exp_f32 v135, v135
  v_exp_f32 v136, v136
  v_exp_f32 v137, v137
  v_exp_f32 v138, v138
  v_exp_f32 v139, v139
  v_exp_f32 v140, v140
  v_exp_f32 v141, v141
  v_cvt_pk_bf16_f32 v180, v132, v133
  v_cvt_pk_bf16_f32 v181, v136, v137
  v_cvt_pk_bf16_f32 v182, v134, v135
  v_cvt_pk_bf16_f32 v184, v140, v141
  v_cvt_pk_bf16_f32 v183, v138, v139
  v_cvt_pk_bf16_f32 v187, v140, v141
  s_nop 0
  v_mfma_f32_16x16x32_bf16 v[176:179], v[192:195], v[180:183], 0
  v_mfma_f32_16x16x32_bf16 v[144:147], v[84:87], v[180:183], 0
  v_mfma_f32_16x16x32_bf16 v[148:151], v[88:91], v[180:183], 0
  v_mfma_f32_16x16x32_bf16 v[152:155], v[92:95], v[180:183], 0
  v_mfma_f32_16x16x16_bf16 v[176:179], v[192:193], v[184:185], v[176:179]
  v_mfma_f32_16x16x32_bf16 v[156:159], v[96:99], v[180:183], 0
  v_mfma_f32_16x16x32_bf16 v[160:163], v[100:103], v[180:183], 0
  v_mfma_f32_16x16x32_bf16 v[164:167], v[104:107], v[180:183], 0
  v_mfma_f32_16x16x32_bf16 v[168:171], v[108:111], v[180:183], 0
  v_mfma_f32_16x16x32_bf16 v[172:175], v[112:115], v[180:183], 0
  v_rcp_f32 v200, v176
  v_mfma_f32_16x16x16_bf16 v[144:147], v[116:117], v[184:185], v[144:147]
  v_mfma_f32_16x16x16_bf16 v[148:151], v[116:117], v[186:187], v[148:151]
  v_mfma_f32_16x16x16_bf16 v[152:155], v[118:119], v[184:185], v[152:155]
  v_mfma_f32_16x16x16_bf16 v[156:159], v[118:119], v[186:187], v[156:159]
  v_mfma_f32_16x16x16_bf16 v[160:163], v[120:121], v[184:185], v[160:163]
  v_mfma_f32_16x16x16_bf16 v[164:167], v[120:121], v[186:187], v[164:167]
  v_mfma_f32_16x16x16_bf16 v[168:171], v[122:123], v[184:185], v[168:171]
  v_mfma_f32_16x16x16_bf16 v[172:175], v[122:123], v[186:187], v[172:175]
  v_pk_mul_f32 v[144:145], v[144:145], v[200:201] op_sel_hi:[1,0]
  v_pk_mul_f32 v[146:147], v[146:147], v[200:201] op_sel_hi:[1,0]
  v_cvt_pk_bf16_f32 v144, v144, v145
  v_cvt_pk_bf16_f32 v145, v146, v147
  v_pk_mul_f32 v[148:149], v[148:149], v[200:201] op_sel_hi:[1,0]
  v_pk_mul_f32 v[150:151], v[150:151], v[200:201] op_sel_hi:[1,0]
  v_cvt_pk_bf16_f32 v146, v148, v149
  v_cvt_pk_bf16_f32 v147, v150, v151
  ds_write_b128 v3, v[144:147] offset:0
  v_pk_mul_f32 v[152:153], v[152:153], v[200:201] op_sel_hi:[1,0]
  v_pk_mul_f32 v[154:155], v[154:155], v[200:201] op_sel_hi:[1,0]
  v_cvt_pk_bf16_f32 v148, v152, v153
  v_cvt_pk_bf16_f32 v149, v154, v155
  v_pk_mul_f32 v[156:157], v[156:157], v[200:201] op_sel_hi:[1,0]
  v_pk_mul_f32 v[158:159], v[158:159], v[200:201] op_sel_hi:[1,0]
  v_cvt_pk_bf16_f32 v150, v156, v157
  v_cvt_pk_bf16_f32 v151, v158, v159
  ds_write_b128 v3, v[148:151] offset:1024
  v_pk_mul_f32 v[160:161], v[160:161], v[200:201] op_sel_hi:[1,0]
  v_pk_mul_f32 v[162:163], v[162:163], v[200:201] op_sel_hi:[1,0]
  v_cvt_pk_bf16_f32 v152, v160, v161
  v_cvt_pk_bf16_f32 v153, v162, v163
  v_pk_mul_f32 v[164:165], v[164:165], v[200:201] op_sel_hi:[1,0]
  v_pk_mul_f32 v[166:167], v[166:167], v[200:201] op_sel_hi:[1,0]
  v_cvt_pk_bf16_f32 v154, v164, v165
  v_cvt_pk_bf16_f32 v155, v166, v167
  ds_write_b128 v3, v[152:155] offset:2048
  v_pk_mul_f32 v[168:169], v[168:169], v[200:201] op_sel_hi:[1,0]
  v_pk_mul_f32 v[170:171], v[170:171], v[200:201] op_sel_hi:[1,0]
  v_cvt_pk_bf16_f32 v156, v168, v169
  v_cvt_pk_bf16_f32 v157, v170, v171
  v_pk_mul_f32 v[172:173], v[172:173], v[200:201] op_sel_hi:[1,0]
  v_pk_mul_f32 v[174:175], v[174:175], v[200:201] op_sel_hi:[1,0]
  v_cvt_pk_bf16_f32 v158, v172, v173
  v_cvt_pk_bf16_f32 v159, v174, v175
  ds_write_b128 v3, v[156:159] offset:3072
  s_waitcnt lgkmcnt(0)
  s_barrier
  s_lshl_b32 s45, s36, 5
  s_add_u32 s45, s45, s50
  s_mul_i32 s45, s45, 18432
  s_add_u32 s45, s45, 0x6400000
  s_add_u32 s46, s45, 294912
  s_lshl_b32 s42, s36, 4
  s_add_u32 s42, s42, s50
  s_lshl_b32 s42, s42, 2
  s_add_u32 s42, s42, s25
  s_lshl_b32 s42, s42, 2
  s_add_u32 s42, s42, 0x30000
  s_cmp_ge_u32 s36, 62
  s_cbranch_scc1 L_bc_half
  s_add_u32 s36, s36, 3
  s_cmp_eq_u32 s36, 64
  s_cselect_b32 s37, 1, 0
  s_sub_u32 s36, s36, s37
  s_cmp_lt_u32 s36, 61
  s_cbranch_scc1 L_bc_joint
  ds_read_b128 v[168:171], v2 offset:0
  ds_read_b128 v[172:175], v2 offset:1024
  ds_read_b128 v[176:179], v2 offset:2048
  ds_read_b128 v[180:183], v2 offset:3072
  ds_read_b128 v[184:187], v2 offset:4096
  ds_read_b128 v[188:191], v2 offset:5120
  ds_read_b128 v[192:195], v2 offset:6144
  ds_read_b128 v[196:199], v2 offset:7168
  s_waitcnt lgkmcnt(7)
  v_mfma_f32_16x16x32_bf16 v[132:135], v[224:227], v[168:171], 0
  v_mfma_f32_16x16x32_bf16 v[136:139], v[228:231], v[168:171], 0
  s_lshl_b32 s58, s36, 5
  s_waitcnt lgkmcnt(6)
  v_mfma_f32_16x16x32_bf16 v[132:135], a[4:7], v[172:175], v[132:135]
  s_add_u32 s58, s58, s51
  v_mfma_f32_16x16x32_bf16 v[136:139], a[8:11], v[172:175], v[136:139]
  s_lshl_b32 s56, s58, 13
  s_waitcnt lgkmcnt(5)
  v_mfma_f32_16x16x32_bf16 v[132:135], a[40:43], v[176:179], v[132:135]
  s_lshl_b32 s58, s58, 12
  v_mfma_f32_16x16x32_bf16 v[136:139], a[44:47], v[176:179], v[136:139]
  s_add_u32 s54, s56, 0x2000000
  s_waitcnt lgkmcnt(4)
  v_mfma_f32_16x16x32_bf16 v[132:135], a[76:79], v[180:183], v[132:135]
  s_add_u32 s55, s56, 0x2001000
  v_mfma_f32_16x16x32_bf16 v[136:139], a[80:83], v[180:183], v[136:139]
  s_add_u32 s53, s56, s52
  s_waitcnt lgkmcnt(3)
  v_mfma_f32_16x16x32_bf16 v[132:135], a[112:115], v[184:187], v[132:135]
  s_add_u32 s57, s56, 0x3001000
  v_mfma_f32_16x16x32_bf16 v[136:139], a[116:119], v[184:187], v[136:139]
  s_add_u32 s56, s56, 0x3000000
  s_waitcnt lgkmcnt(2)
  v_mfma_f32_16x16x32_bf16 v[132:135], a[148:151], v[188:191], v[132:135]
  s_add_u32 s59, s58, 0x4800000
  v_mfma_f32_16x16x32_bf16 v[136:139], a[152:155], v[188:191], v[136:139]
  s_add_u32 s58, s58, 0x4000000
  s_waitcnt lgkmcnt(1)
  v_mfma_f32_16x16x32_bf16 v[132:135], a[184:187], v[192:195], v[132:135]
  s_cmp_lt_u32 s36, 64
  v_mfma_f32_16x16x32_bf16 v[136:139], a[188:191], v[192:195], v[136:139]
  s_cselect_b32 s53, s53, 0x40000000
  s_waitcnt lgkmcnt(0)
  v_mfma_f32_16x16x32_bf16 v[132:135], a[220:223], v[196:199], v[132:135]
  s_cselect_b32 s54, s54, 0x40000000
  v_mfma_f32_16x16x32_bf16 v[136:139], a[224:227], v[196:199], v[136:139]
  s_cselect_b32 s55, s55, 0x40000000
  v_mfma_f32_16x16x32_bf16 v[140:143], v[232:235], v[168:171], 0
  s_cselect_b32 s56, s56, 0x40000000
  v_mfma_f32_16x16x32_bf16 v[144:147], v[236:239], v[168:171], 0
  s_cselect_b32 s57, s57, 0x40000000
  v_mfma_f32_16x16x32_bf16 v[140:143], a[12:15], v[172:175], v[140:143]
  buffer_load_dwordx4 v[20:23], v0, s[4:7], s53 offen offset:0 sc1
  v_mfma_f32_16x16x32_bf16 v[144:147], a[16:19], v[172:175], v[144:147]
  v_mfma_f32_16x16x32_bf16 v[140:143], a[48:51], v[176:179], v[140:143]
  v_mfma_f32_16x16x32_bf16 v[144:147], a[52:55], v[176:179], v[144:147]
  v_cvt_pk_bf16_f32 v132, v132, v133
  v_mfma_f32_16x16x32_bf16 v[140:143], a[84:87], v[180:183], v[140:143]
  v_mfma_f32_16x16x32_bf16 v[144:147], a[88:91], v[180:183], v[144:147]
  v_cvt_pk_bf16_f32 v133, v134, v135
  buffer_load_dwordx4 v[36:39], v0, s[4:7], s54 offen offset:0 sc1
  v_mfma_f32_16x16x32_bf16 v[140:143], a[120:123], v[184:187], v[140:143]
  v_mfma_f32_16x16x32_bf16 v[144:147], a[124:127], v[184:187], v[144:147]
  v_min_u32 v132, -2, v132
  v_mfma_f32_16x16x32_bf16 v[140:143], a[156:159], v[188:191], v[140:143]
  v_mfma_f32_16x16x32_bf16 v[144:147], a[160:163], v[188:191], v[144:147]
  v_cvt_pk_bf16_f32 v134, v136, v137
  v_mfma_f32_16x16x32_bf16 v[140:143], a[192:195], v[192:195], v[140:143]
  buffer_load_dwordx4 v[52:55], v0, s[4:7], s55 offen offset:0 sc1
  v_mfma_f32_16x16x32_bf16 v[144:147], a[196:199], v[192:195], v[144:147]
  v_cvt_pk_bf16_f32 v135, v138, v139
  v_mfma_f32_16x16x32_bf16 v[140:143], a[228:231], v[196:199], v[140:143]
  v_mfma_f32_16x16x32_bf16 v[144:147], a[232:235], v[196:199], v[144:147]
  buffer_store_dwordx4 v[132:135], v9, s[4:7], s45 offen offset:0 sc1
  v_mfma_f32_16x16x32_bf16 v[148:151], v[240:243], v[168:171], 0
  v_mfma_f32_16x16x32_bf16 v[152:155], v[244:247], v[168:171], 0
  buffer_load_dwordx4 v[24:27], v0, s[4:7], s53 offen offset:1024 sc1
  v_mfma_f32_16x16x32_bf16 v[148:151], a[20:23], v[172:175], v[148:151]
  v_mfma_f32_16x16x32_bf16 v[152:155], a[24:27], v[172:175], v[152:155]
  v_mfma_f32_16x16x32_bf16 v[148:151], a[56:59], v[176:179], v[148:151]
  v_mfma_f32_16x16x32_bf16 v[152:155], a[60:63], v[176:179], v[152:155]
  v_cvt_pk_bf16_f32 v140, v140, v141
  v_mfma_f32_16x16x32_bf16 v[148:151], a[92:95], v[180:183], v[148:151]
  buffer_load_dwordx4 v[40:43], v0, s[4:7], s54 offen offset:1024 sc1
  v_mfma_f32_16x16x32_bf16 v[152:155], a[96:99], v[180:183], v[152:155]
  v_cvt_pk_bf16_f32 v141, v142, v143
  v_mfma_f32_16x16x32_bf16 v[148:151], a[128:131], v[184:187], v[148:151]
  v_mfma_f32_16x16x32_bf16 v[152:155], a[132:135], v[184:187], v[152:155]
  v_min_u32 v140, -2, v140
  v_mfma_f32_16x16x32_bf16 v[148:151], a[164:167], v[188:191], v[148:151]
  v_mfma_f32_16x16x32_bf16 v[152:155], a[168:171], v[188:191], v[152:155]
  v_cvt_pk_bf16_f32 v142, v144, v145
  buffer_load_dwordx4 v[56:59], v0, s[4:7], s55 offen offset:1024 sc1
  v_mfma_f32_16x16x32_bf16 v[148:151], a[200:203], v[192:195], v[148:151]
  v_mfma_f32_16x16x32_bf16 v[152:155], a[204:207], v[192:195], v[152:155]
  v_cvt_pk_bf16_f32 v143, v146, v147
  v_mfma_f32_16x16x32_bf16 v[148:151], a[236:239], v[196:199], v[148:151]
  v_mfma_f32_16x16x32_bf16 v[152:155], a[240:243], v[196:199], v[152:155]
  buffer_store_dwordx4 v[140:143], v9, s[4:7], s45 offen offset:1024 sc1
  v_mfma_f32_16x16x32_bf16 v[156:159], v[248:251], v[168:171], 0
  ds_read_b128 v[204:207], v2 offset:8192
  buffer_load_dwordx4 v[28:31], v0, s[4:7], s53 offen offset:2048 sc1
  v_mfma_f32_16x16x32_bf16 v[160:163], v[252:255], v[168:171], 0
  v_mfma_f32_16x16x32_bf16 v[156:159], a[28:31], v[172:175], v[156:159]
  ds_read_b128 v[208:211], v2 offset:9216
  v_mfma_f32_16x16x32_bf16 v[160:163], a[32:35], v[172:175], v[160:163]
  v_mfma_f32_16x16x32_bf16 v[156:159], a[64:67], v[176:179], v[156:159]
  ds_read_b128 v[212:215], v2 offset:10240
  v_mfma_f32_16x16x32_bf16 v[160:163], a[68:71], v[176:179], v[160:163]
  v_cvt_pk_bf16_f32 v148, v148, v149
  buffer_load_dwordx4 v[44:47], v0, s[4:7], s54 offen offset:2048 sc1
  v_mfma_f32_16x16x32_bf16 v[156:159], a[100:103], v[180:183], v[156:159]
  ds_read_b128 v[216:219], v2 offset:11264
  v_mfma_f32_16x16x32_bf16 v[160:163], a[104:107], v[180:183], v[160:163]
  v_cvt_pk_bf16_f32 v149, v150, v151
  v_mfma_f32_16x16x32_bf16 v[156:159], a[136:139], v[184:187], v[156:159]
  ds_read_b128 v[220:223], v2 offset:12288
  v_mfma_f32_16x16x32_bf16 v[160:163], a[140:143], v[184:187], v[160:163]
  v_min_u32 v148, -2, v148
  v_mfma_f32_16x16x32_bf16 v[156:159], a[172:175], v[188:191], v[156:159]
  ds_read_b128 v[200:203], v2 offset:13312
  buffer_load_dwordx4 v[60:63], v0, s[4:7], s55 offen offset:2048 sc1
  v_mfma_f32_16x16x32_bf16 v[160:163], a[176:179], v[188:191], v[160:163]
  v_cvt_pk_bf16_f32 v150, v152, v153
  v_mfma_f32_16x16x32_bf16 v[156:159], a[208:211], v[192:195], v[156:159]
  v_mfma_f32_16x16x32_bf16 v[160:163], a[212:215], v[192:195], v[160:163]
  v_cvt_pk_bf16_f32 v151, v154, v155
  v_mfma_f32_16x16x32_bf16 v[156:159], a[244:247], v[196:199], v[156:159]
  v_mfma_f32_16x16x32_bf16 v[160:163], a[248:251], v[196:199], v[160:163]
  buffer_store_dwordx4 v[148:151], v9, s[4:7], s45 offen offset:2048 sc1
  buffer_load_dwordx4 v[32:35], v0, s[4:7], s53 offen offset:3072 sc1
  v_mfma_f32_16x16x32_bf16 v[164:167], a[0:3], v[168:171], 0
  v_mfma_f32_16x16x32_bf16 v[164:167], a[36:39], v[172:175], v[164:167]
  v_mfma_f32_16x16x32_bf16 v[164:167], a[72:75], v[176:179], v[164:167]
  v_cvt_pk_bf16_f32 v156, v156, v157
  v_mfma_f32_16x16x32_bf16 v[164:167], a[108:111], v[180:183], v[164:167]
  v_cvt_pk_bf16_f32 v157, v158, v159
  v_mfma_f32_16x16x32_bf16 v[164:167], a[144:147], v[184:187], v[164:167]
  v_min_u32 v156, -2, v156
  buffer_load_dwordx4 v[48:51], v0, s[4:7], s54 offen offset:3072 sc1
  v_mfma_f32_16x16x32_bf16 v[164:167], a[180:183], v[188:191], v[164:167]
  v_cvt_pk_bf16_f32 v158, v160, v161
  v_mfma_f32_16x16x32_bf16 v[164:167], a[216:219], v[192:195], v[164:167]
  v_cvt_pk_bf16_f32 v159, v162, v163
  ds_read_b128 v[168:171], v2 offset:14336
  v_mfma_f32_16x16x32_bf16 v[164:167], a[252:255], v[196:199], v[164:167]
  buffer_store_dwordx4 v[156:159], v9, s[4:7], s45 offen offset:3072 sc1
  ds_read_b128 v[172:175], v2 offset:15360
  s_waitcnt lgkmcnt(7)
  v_mfma_f32_16x16x32_bf16 v[132:135], v[224:227], v[204:207], 0
  v_mfma_f32_16x16x32_bf16 v[136:139], v[228:231], v[204:207], 0
  buffer_load_dwordx4 v[64:67], v0, s[4:7], s55 offen offset:3072 sc1
  s_waitcnt lgkmcnt(6)
  v_mfma_f32_16x16x32_bf16 v[132:135], a[4:7], v[208:211], v[132:135]
  v_mfma_f32_16x16x32_bf16 v[136:139], a[8:11], v[208:211], v[136:139]
  s_waitcnt lgkmcnt(5)
  v_mfma_f32_16x16x32_bf16 v[132:135], a[40:43], v[212:215], v[132:135]
  v_mfma_f32_16x16x32_bf16 v[136:139], a[44:47], v[212:215], v[136:139]
  v_cvt_pk_bf16_f32 v164, v164, v165
  s_waitcnt lgkmcnt(4)
  v_mfma_f32_16x16x32_bf16 v[132:135], a[76:79], v[216:219], v[132:135]
  buffer_load_dwordx4 v[84:87], v0, s[4:7], s56 offen offset:0 sc1
  v_mfma_f32_16x16x32_bf16 v[136:139], a[80:83], v[216:219], v[136:139]
  v_cvt_pk_bf16_f32 v165, v166, v167
  s_waitcnt lgkmcnt(3)
  v_mfma_f32_16x16x32_bf16 v[132:135], a[112:115], v[220:223], v[132:135]
  v_mfma_f32_16x16x32_bf16 v[136:139], a[116:119], v[220:223], v[136:139]
  v_min_u32 v164, -2, v164
  s_waitcnt lgkmcnt(2)
  v_mfma_f32_16x16x32_bf16 v[132:135], a[148:151], v[200:203], v[132:135]
  v_mfma_f32_16x16x32_bf16 v[136:139], a[152:155], v[200:203], v[136:139]
  buffer_store_dwordx2 v[164:165], v10, s[4:7], s45 offen sc1
  buffer_load_dwordx4 v[88:91], v0, s[4:7], s56 offen offset:1024 sc1
  s_waitcnt lgkmcnt(1)
  v_mfma_f32_16x16x32_bf16 v[132:135], a[184:187], v[168:171], v[132:135]
  v_mfma_f32_16x16x32_bf16 v[136:139], a[188:191], v[168:171], v[136:139]
  s_waitcnt lgkmcnt(0)
  v_mfma_f32_16x16x32_bf16 v[132:135], a[220:223], v[172:175], v[132:135]
  v_mfma_f32_16x16x32_bf16 v[136:139], a[224:227], v[172:175], v[136:139]
  v_mfma_f32_16x16x32_bf16 v[140:143], v[232:235], v[204:207], 0
  buffer_load_dwordx4 v[92:95], v0, s[4:7], s56 offen offset:2048 sc1
  v_mfma_f32_16x16x32_bf16 v[144:147], v[236:239], v[204:207], 0
  v_mfma_f32_16x16x32_bf16 v[140:143], a[12:15], v[208:211], v[140:143]
  v_mfma_f32_16x16x32_bf16 v[144:147], a[16:19], v[208:211], v[144:147]
  v_mfma_f32_16x16x32_bf16 v[140:143], a[48:51], v[212:215], v[140:143]
  v_mfma_f32_16x16x32_bf16 v[144:147], a[52:55], v[212:215], v[144:147]
  v_cvt_pk_bf16_f32 v132, v132, v133
  buffer_load_dwordx4 v[96:99], v0, s[4:7], s56 offen offset:3072 sc1
  v_mfma_f32_16x16x32_bf16 v[140:143], a[84:87], v[216:219], v[140:143]
  v_mfma_f32_16x16x32_bf16 v[144:147], a[88:91], v[216:219], v[144:147]
  v_cvt_pk_bf16_f32 v133, v134, v135
  v_mfma_f32_16x16x32_bf16 v[140:143], a[120:123], v[220:223], v[140:143]
  v_mfma_f32_16x16x32_bf16 v[144:147], a[124:127], v[220:223], v[144:147]
  v_min_u32 v132, -2, v132
  v_mfma_f32_16x16x32_bf16 v[140:143], a[156:159], v[200:203], v[140:143]
  buffer_load_dwordx4 v[100:103], v0, s[4:7], s57 offen offset:0 sc1
  v_mfma_f32_16x16x32_bf16 v[144:147], a[160:163], v[200:203], v[144:147]
  v_cvt_pk_bf16_f32 v134, v136, v137
  v_mfma_f32_16x16x32_bf16 v[140:143], a[192:195], v[168:171], v[140:143]
  v_mfma_f32_16x16x32_bf16 v[144:147], a[196:199], v[168:171], v[144:147]
  v_cvt_pk_bf16_f32 v135, v138, v139
  v_mfma_f32_16x16x32_bf16 v[140:143], a[228:231], v[172:175], v[140:143]
  v_mfma_f32_16x16x32_bf16 v[144:147], a[232:235], v[172:175], v[144:147]
  buffer_store_dwordx4 v[132:135], v9, s[4:7], s46 offen offset:0 sc1
  buffer_load_dwordx4 v[104:107], v0, s[4:7], s57 offen offset:1024 sc1
  v_mfma_f32_16x16x32_bf16 v[148:151], v[240:243], v[204:207], 0
  v_mfma_f32_16x16x32_bf16 v[152:155], v[244:247], v[204:207], 0
  v_mfma_f32_16x16x32_bf16 v[148:151], a[20:23], v[208:211], v[148:151]
  v_mfma_f32_16x16x32_bf16 v[152:155], a[24:27], v[208:211], v[152:155]
  v_mfma_f32_16x16x32_bf16 v[148:151], a[56:59], v[212:215], v[148:151]
  buffer_load_dwordx4 v[108:111], v0, s[4:7], s57 offen offset:2048 sc1
  v_mfma_f32_16x16x32_bf16 v[152:155], a[60:63], v[212:215], v[152:155]
  v_cvt_pk_bf16_f32 v140, v140, v141
  v_mfma_f32_16x16x32_bf16 v[148:151], a[92:95], v[216:219], v[148:151]
  v_mfma_f32_16x16x32_bf16 v[152:155], a[96:99], v[216:219], v[152:155]
  v_cvt_pk_bf16_f32 v141, v142, v143
  v_mfma_f32_16x16x32_bf16 v[148:151], a[128:131], v[220:223], v[148:151]
  v_mfma_f32_16x16x32_bf16 v[152:155], a[132:135], v[220:223], v[152:155]
  v_min_u32 v140, -2, v140
  buffer_load_dwordx4 v[112:115], v0, s[4:7], s57 offen offset:3072 sc1
  v_mfma_f32_16x16x32_bf16 v[148:151], a[164:167], v[200:203], v[148:151]
  v_mfma_f32_16x16x32_bf16 v[152:155], a[168:171], v[200:203], v[152:155]
  v_cvt_pk_bf16_f32 v142, v144, v145
  v_mfma_f32_16x16x32_bf16 v[148:151], a[200:203], v[168:171], v[148:151]
  v_mfma_f32_16x16x32_bf16 v[152:155], a[204:207], v[168:171], v[152:155]
  v_cvt_pk_bf16_f32 v143, v146, v147
  v_mfma_f32_16x16x32_bf16 v[148:151], a[236:239], v[172:175], v[148:151]
  v_mfma_f32_16x16x32_bf16 v[152:155], a[240:243], v[172:175], v[152:155]
  buffer_store_dwordx4 v[140:143], v9, s[4:7], s46 offen offset:1024 sc1
  v_mfma_f32_16x16x32_bf16 v[156:159], v[248:251], v[204:207], 0
  v_mfma_f32_16x16x32_bf16 v[160:163], v[252:255], v[204:207], 0
  v_mfma_f32_16x16x32_bf16 v[156:159], a[28:31], v[208:211], v[156:159]
  v_mfma_f32_16x16x32_bf16 v[160:163], a[32:35], v[208:211], v[160:163]
  v_mfma_f32_16x16x32_bf16 v[156:159], a[64:67], v[212:215], v[156:159]
  v_mfma_f32_16x16x32_bf16 v[160:163], a[68:71], v[212:215], v[160:163]
  v_cvt_pk_bf16_f32 v148, v148, v149
  v_mfma_f32_16x16x32_bf16 v[156:159], a[100:103], v[216:219], v[156:159]
  v_mfma_f32_16x16x32_bf16 v[160:163], a[104:107], v[216:219], v[160:163]
  v_cvt_pk_bf16_f32 v149, v150, v151
  v_mfma_f32_16x16x32_bf16 v[156:159], a[136:139], v[220:223], v[156:159]
  v_mfma_f32_16x16x32_bf16 v[160:163], a[140:143], v[220:223], v[160:163]
  v_min_u32 v148, -2, v148
  v_mfma_f32_16x16x32_bf16 v[156:159], a[172:175], v[200:203], v[156:159]
  v_mfma_f32_16x16x32_bf16 v[160:163], a[176:179], v[200:203], v[160:163]
  v_cvt_pk_bf16_f32 v150, v152, v153
  v_mfma_f32_16x16x32_bf16 v[156:159], a[208:211], v[168:171], v[156:159]
  v_mfma_f32_16x16x32_bf16 v[160:163], a[212:215], v[168:171], v[160:163]
  v_cvt_pk_bf16_f32 v151, v154, v155
  v_mfma_f32_16x16x32_bf16 v[156:159], a[244:247], v[172:175], v[156:159]
  v_mfma_f32_16x16x32_bf16 v[160:163], a[248:251], v[172:175], v[160:163]
  buffer_store_dwordx4 v[148:151], v9, s[4:7], s46 offen offset:2048 sc1
  v_mfma_f32_16x16x32_bf16 v[164:167], a[0:3], v[204:207], 0
  v_mfma_f32_16x16x32_bf16 v[164:167], a[36:39], v[208:211], v[164:167]
  v_mfma_f32_16x16x32_bf16 v[164:167], a[72:75], v[212:215], v[164:167]
  v_cvt_pk_bf16_f32 v156, v156, v157
  v_mfma_f32_16x16x32_bf16 v[164:167], a[108:111], v[216:219], v[164:167]
  v_cvt_pk_bf16_f32 v157, v158, v159
  v_mfma_f32_16x16x32_bf16 v[164:167], a[144:147], v[220:223], v[164:167]
  v_min_u32 v156, -2, v156
  v_mfma_f32_16x16x32_bf16 v[164:167], a[180:183], v[200:203], v[164:167]
  v_cvt_pk_bf16_f32 v158, v160, v161
  v_mfma_f32_16x16x32_bf16 v[164:167], a[216:219], v[168:171], v[164:167]
  v_cvt_pk_bf16_f32 v159, v162, v163
  v_mfma_f32_16x16x32_bf16 v[164:167], a[252:255], v[172:175], v[164:167]
  buffer_store_dwordx4 v[156:159], v9, s[4:7], s46 offen offset:3072 sc1
  s_nop 6
  v_cvt_pk_bf16_f32 v164, v164, v165
  v_cvt_pk_bf16_f32 v165, v166, v167
  v_min_u32 v164, -2, v164
  buffer_store_dwordx2 v[164:165], v10, s[4:7], s46 offen sc1
  s_branch L_bc_tail
L_bc_joint:
  ds_read_b128 v[204:207], v2 offset:0
  ds_read_b128 v[208:211], v2 offset:8192
  ds_read_b128 v[212:215], v2 offset:1024
  ds_read_b128 v[216:219], v2 offset:9216
  s_waitcnt lgkmcnt(3)
  v_mfma_f32_16x16x32_bf16 v[132:135], v[224:227], v[204:207], 0
  ds_read_b128 v[220:223], v2 offset:2048
  v_mfma_f32_16x16x32_bf16 v[136:139], v[228:231], v[204:207], 0
  s_lshl_b32 s58, s36, 5
  v_mfma_f32_16x16x32_bf16 v[140:143], v[232:235], v[204:207], 0
  s_add_u32 s58, s58, s51
  v_mfma_f32_16x16x32_bf16 v[144:147], v[236:239], v[204:207], 0
  s_lshl_b32 s56, s58, 13
  v_mfma_f32_16x16x32_bf16 v[148:151], v[240:243], v[204:207], 0
  s_lshl_b32 s58, s58, 12
  v_mfma_f32_16x16x32_bf16 v[152:155], v[244:247], v[204:207], 0
  s_add_u32 s54, s56, 0x2000000
  v_mfma_f32_16x16x32_bf16 v[156:159], v[248:251], v[204:207], 0
  s_add_u32 s55, s56, 0x2001000
  v_mfma_f32_16x16x32_bf16 v[160:163], v[252:255], v[204:207], 0
  s_add_u32 s53, s56, s52
  v_mfma_f32_16x16x32_bf16 v[164:167], a[0:3], v[204:207], 0
  s_add_u32 s57, s56, 0x3001000
  s_waitcnt lgkmcnt(3)
  v_mfma_f32_16x16x32_bf16 v[168:171], v[224:227], v[208:211], 0
  ds_read_b128 v[204:207], v2 offset:10240
  s_add_u32 s56, s56, 0x3000000
  v_mfma_f32_16x16x32_bf16 v[172:175], v[228:231], v[208:211], 0
  s_add_u32 s59, s58, 0x4800000
  v_mfma_f32_16x16x32_bf16 v[176:179], v[232:235], v[208:211], 0
  s_add_u32 s58, s58, 0x4000000
  v_mfma_f32_16x16x32_bf16 v[180:183], v[236:239], v[208:211], 0
  s_cmp_lt_u32 s36, 64
  v_mfma_f32_16x16x32_bf16 v[184:187], v[240:243], v[208:211], 0
  s_cselect_b32 s53, s53, 0x40000000
  v_mfma_f32_16x16x32_bf16 v[188:191], v[244:247], v[208:211], 0
  s_cselect_b32 s54, s54, 0x40000000
  v_mfma_f32_16x16x32_bf16 v[192:195], v[248:251], v[208:211], 0
  s_cselect_b32 s55, s55, 0x40000000
  v_mfma_f32_16x16x32_bf16 v[196:199], v[252:255], v[208:211], 0
  s_cselect_b32 s56, s56, 0x40000000
  v_mfma_f32_16x16x32_bf16 v[200:203], a[0:3], v[208:211], 0
  s_cselect_b32 s57, s57, 0x40000000
  s_waitcnt lgkmcnt(3)
  v_mfma_f32_16x16x32_bf16 v[132:135], a[4:7], v[212:215], v[132:135]
  ds_read_b128 v[208:211], v2 offset:3072
  buffer_load_dwordx4 v[20:23], v0, s[4:7], s53 offen offset:0 sc1
  v_mfma_f32_16x16x32_bf16 v[136:139], a[8:11], v[212:215], v[136:139]
  v_mfma_f32_16x16x32_bf16 v[140:143], a[12:15], v[212:215], v[140:143]
  v_mfma_f32_16x16x32_bf16 v[144:147], a[16:19], v[212:215], v[144:147]
  v_mfma_f32_16x16x32_bf16 v[148:151], a[20:23], v[212:215], v[148:151]
  v_mfma_f32_16x16x32_bf16 v[152:155], a[24:27], v[212:215], v[152:155]
  buffer_load_dwordx4 v[36:39], v0, s[4:7], s54 offen offset:0 sc1
  v_mfma_f32_16x16x32_bf16 v[156:159], a[28:31], v[212:215], v[156:159]
  v_mfma_f32_16x16x32_bf16 v[160:163], a[32:35], v[212:215], v[160:163]
  v_mfma_f32_16x16x32_bf16 v[164:167], a[36:39], v[212:215], v[164:167]
  s_waitcnt lgkmcnt(3)
  v_mfma_f32_16x16x32_bf16 v[168:171], a[4:7], v[216:219], v[168:171]
  ds_read_b128 v[212:215], v2 offset:11264
  v_mfma_f32_16x16x32_bf16 v[172:175], a[8:11], v[216:219], v[172:175]
  buffer_load_dwordx4 v[52:55], v0, s[4:7], s55 offen offset:0 sc1
  v_mfma_f32_16x16x32_bf16 v[176:179], a[12:15], v[216:219], v[176:179]
  v_mfma_f32_16x16x32_bf16 v[180:183], a[16:19], v[216:219], v[180:183]
  v_mfma_f32_16x16x32_bf16 v[184:187], a[20:23], v[216:219], v[184:187]
  v_mfma_f32_16x16x32_bf16 v[188:191], a[24:27], v[216:219], v[188:191]
  v_mfma_f32_16x16x32_bf16 v[192:195], a[28:31], v[216:219], v[192:195]
  buffer_load_dwordx4 v[24:27], v0, s[4:7], s53 offen offset:1024 sc1
  v_mfma_f32_16x16x32_bf16 v[196:199], a[32:35], v[216:219], v[196:199]
  v_mfma_f32_16x16x32_bf16 v[200:203], a[36:39], v[216:219], v[200:203]
  s_waitcnt lgkmcnt(3)
  v_mfma_f32_16x16x32_bf16 v[132:135], a[40:43], v[220:223], v[132:135]
  ds_read_b128 v[216:219], v2 offset:4096
  v_mfma_f32_16x16x32_bf16 v[136:139], a[44:47], v[220:223], v[136:139]
  v_mfma_f32_16x16x32_bf16 v[140:143], a[48:51], v[220:223], v[140:143]
  buffer_load_dwordx4 v[40:43], v0, s[4:7], s54 offen offset:1024 sc1
  v_mfma_f32_16x16x32_bf16 v[144:147], a[52:55], v[220:223], v[144:147]
  v_mfma_f32_16x16x32_bf16 v[148:151], a[56:59], v[220:223], v[148:151]
  v_mfma_f32_16x16x32_bf16 v[152:155], a[60:63], v[220:223], v[152:155]
  v_mfma_f32_16x16x32_bf16 v[156:159], a[64:67], v[220:223], v[156:159]
  v_mfma_f32_16x16x32_bf16 v[160:163], a[68:71], v[220:223], v[160:163]
  buffer_load_dwordx4 v[56:59], v0, s[4:7], s55 offen offset:1024 sc1
  v_mfma_f32_16x16x32_bf16 v[164:167], a[72:75], v[220:223], v[164:167]
  s_waitcnt lgkmcnt(3)
  v_mfma_f32_16x16x32_bf16 v[168:171], a[40:43], v[204:207], v[168:171]
  ds_read_b128 v[220:223], v2 offset:12288
  v_mfma_f32_16x16x32_bf16 v[172:175], a[44:47], v[204:207], v[172:175]
  v_mfma_f32_16x16x32_bf16 v[176:179], a[48:51], v[204:207], v[176:179]
  v_mfma_f32_16x16x32_bf16 v[180:183], a[52:55], v[204:207], v[180:183]
  buffer_load_dwordx4 v[28:31], v0, s[4:7], s53 offen offset:2048 sc1
  v_mfma_f32_16x16x32_bf16 v[184:187], a[56:59], v[204:207], v[184:187]
  v_mfma_f32_16x16x32_bf16 v[188:191], a[60:63], v[204:207], v[188:191]
  v_mfma_f32_16x16x32_bf16 v[192:195], a[64:67], v[204:207], v[192:195]
  v_mfma_f32_16x16x32_bf16 v[196:199], a[68:71], v[204:207], v[196:199]
  v_mfma_f32_16x16x32_bf16 v[200:203], a[72:75], v[204:207], v[200:203]
  buffer_load_dwordx4 v[44:47], v0, s[4:7], s54 offen offset:2048 sc1
  s_waitcnt lgkmcnt(3)
  v_mfma_f32_16x16x32_bf16 v[132:135], a[76:79], v[208:211], v[132:135]
  ds_read_b128 v[204:207], v2 offset:5120
  v_mfma_f32_16x16x32_bf16 v[136:139], a[80:83], v[208:211], v[136:139]
  v_mfma_f32_16x16x32_bf16 v[140:143], a[84:87], v[208:211], v[140:143]
  v_mfma_f32_16x16x32_bf16 v[144:147], a[88:91], v[208:211], v[144:147]
  v_mfma_f32_16x16x32_bf16 v[148:151], a[92:95], v[208:211], v[148:151]
  buffer_load_dwordx4 v[60:63], v0, s[4:7], s55 offen offset:2048 sc1
  v_mfma_f32_16x16x32_bf16 v[152:155], a[96:99], v[208:211], v[152:155]
  v_mfma_f32_16x16x32_bf16 v[156:159], a[100:103], v[208:211], v[156:159]
  v_mfma_f32_16x16x32_bf16 v[160:163], a[104:107], v[208:211], v[160:163]
  v_mfma_f32_16x16x32_bf16 v[164:167], a[108:111], v[208:211], v[164:167]
  s_waitcnt lgkmcnt(3)
  v_mfma_f32_16x16x32_bf16 v[168:171], a[76:79], v[212:215], v[168:171]
  ds_read_b128 v[208:211], v2 offset:13312
  buffer_load_dwordx4 v[32:35], v0, s[4:7], s53 offen offset:3072 sc1
  v_mfma_f32_16x16x32_bf16 v[172:175], a[80:83], v[212:215], v[172:175]
  v_mfma_f32_16x16x32_bf16 v[176:179], a[84:87], v[212:215], v[176:179]
  v_mfma_f32_16x16x32_bf16 v[180:183], a[88:91], v[212:215], v[180:183]
  v_mfma_f32_16x16x32_bf16 v[184:187], a[92:95], v[212:215], v[184:187]
  v_mfma_f32_16x16x32_bf16 v[188:191], a[96:99], v[212:215], v[188:191]
  buffer_load_dwordx4 v[48:51], v0, s[4:7], s54 offen offset:3072 sc1
  v_mfma_f32_16x16x32_bf16 v[192:195], a[100:103], v[212:215], v[192:195]
  v_mfma_f32_16x16x32_bf16 v[196:199], a[104:107], v[212:215], v[196:199]
  v_mfma_f32_16x16x32_bf16 v[200:203], a[108:111], v[212:215], v[200:203]
  s_waitcnt lgkmcnt(3)
  v_mfma_f32_16x16x32_bf16 v[132:135], a[112:115], v[216:219], v[132:135]
  ds_read_b128 v[212:215], v2 offset:6144
  v_mfma_f32_16x16x32_bf16 v[136:139], a[116:119], v[216:219], v[136:139]
  buffer_load_dwordx4 v[64:67], v0, s[4:7], s55 offen offset:3072 sc1
  v_mfma_f32_16x16x32_bf16 v[140:143], a[120:123], v[216:219], v[140:143]
  v_mfma_f32_16x16x32_bf16 v[144:147], a[124:127], v[216:219], v[144:147]
  v_mfma_f32_16x16x32_bf16 v[148:151], a[128:131], v[216:219], v[148:151]
  v_mfma_f32_16x16x32_bf16 v[152:155], a[132:135], v[216:219], v[152:155]
  v_mfma_f32_16x16x32_bf16 v[156:159], a[136:139], v[216:219], v[156:159]
  buffer_load_dwordx4 v[84:87], v0, s[4:7], s56 offen offset:0 sc1
  v_mfma_f32_16x16x32_bf16 v[160:163], a[140:143], v[216:219], v[160:163]
  v_mfma_f32_16x16x32_bf16 v[164:167], a[144:147], v[216:219], v[164:167]
  s_waitcnt lgkmcnt(3)
  v_mfma_f32_16x16x32_bf16 v[168:171], a[112:115], v[220:223], v[168:171]
  ds_read_b128 v[216:219], v2 offset:14336
  v_mfma_f32_16x16x32_bf16 v[172:175], a[116:119], v[220:223], v[172:175]
  v_mfma_f32_16x16x32_bf16 v[176:179], a[120:123], v[220:223], v[176:179]
  buffer_load_dwordx4 v[88:91], v0, s[4:7], s56 offen offset:1024 sc1
  v_mfma_f32_16x16x32_bf16 v[180:183], a[124:127], v[220:223], v[180:183]
  v_mfma_f32_16x16x32_bf16 v[184:187], a[128:131], v[220:223], v[184:187]
  v_mfma_f32_16x16x32_bf16 v[188:191], a[132:135], v[220:223], v[188:191]
  v_mfma_f32_16x16x32_bf16 v[192:195], a[136:139], v[220:223], v[192:195]
  v_mfma_f32_16x16x32_bf16 v[196:199], a[140:143], v[220:223], v[196:199]
  buffer_load_dwordx4 v[92:95], v0, s[4:7], s56 offen offset:2048 sc1
  v_mfma_f32_16x16x32_bf16 v[200:203], a[144:147], v[220:223], v[200:203]
  s_waitcnt lgkmcnt(3)
  v_mfma_f32_16x16x32_bf16 v[132:135], a[148:151], v[204:207], v[132:135]
  ds_read_b128 v[220:223], v2 offset:7168
  v_mfma_f32_16x16x32_bf16 v[136:139], a[152:155], v[204:207], v[136:139]
  v_mfma_f32_16x16x32_bf16 v[140:143], a[156:159], v[204:207], v[140:143]
  v_mfma_f32_16x16x32_bf16 v[144:147], a[160:163], v[204:207], v[144:147]
  buffer_load_dwordx4 v[96:99], v0, s[4:7], s56 offen offset:3072 sc1
  v_mfma_f32_16x16x32_bf16 v[148:151], a[164:167], v[204:207], v[148:151]
  v_mfma_f32_16x16x32_bf16 v[152:155], a[168:171], v[204:207], v[152:155]
  v_mfma_f32_16x16x32_bf16 v[156:159], a[172:175], v[204:207], v[156:159]
  v_mfma_f32_16x16x32_bf16 v[160:163], a[176:179], v[204:207], v[160:163]
  v_mfma_f32_16x16x32_bf16 v[164:167], a[180:183], v[204:207], v[164:167]
  buffer_load_dwordx4 v[100:103], v0, s[4:7], s57 offen offset:0 sc1
  s_waitcnt lgkmcnt(3)
  v_mfma_f32_16x16x32_bf16 v[168:171], a[148:151], v[208:211], v[168:171]
  ds_read_b128 v[204:207], v2 offset:15360
  v_mfma_f32_16x16x32_bf16 v[172:175], a[152:155], v[208:211], v[172:175]
  v_mfma_f32_16x16x32_bf16 v[176:179], a[156:159], v[208:211], v[176:179]
  v_mfma_f32_16x16x32_bf16 v[180:183], a[160:163], v[208:211], v[180:183]
  v_mfma_f32_16x16x32_bf16 v[184:187], a[164:167], v[208:211], v[184:187]
  buffer_load_dwordx4 v[104:107], v0, s[4:7], s57 offen offset:1024 sc1
  v_mfma_f32_16x16x32_bf16 v[188:191], a[168:171], v[208:211], v[188:191]
  v_mfma_f32_16x16x32_bf16 v[192:195], a[172:175], v[208:211], v[192:195]
  v_mfma_f32_16x16x32_bf16 v[196:199], a[176:179], v[208:211], v[196:199]
  v_mfma_f32_16x16x32_bf16 v[200:203], a[180:183], v[208:211], v[200:203]
  s_waitcnt lgkmcnt(3)
  v_mfma_f32_16x16x32_bf16 v[132:135], a[184:187], v[212:215], v[132:135]
  buffer_load_dwordx4 v[108:111], v0, s[4:7], s57 offen offset:2048 sc1
  v_mfma_f32_16x16x32_bf16 v[136:139], a[188:191], v[212:215], v[136:139]
  v_mfma_f32_16x16x32_bf16 v[140:143], a[192:195], v[212:215], v[140:143]
  v_mfma_f32_16x16x32_bf16 v[144:147], a[196:199], v[212:215], v[144:147]
  v_mfma_f32_16x16x32_bf16 v[148:151], a[200:203], v[212:215], v[148:151]
  v_mfma_f32_16x16x32_bf16 v[152:155], a[204:207], v[212:215], v[152:155]
  buffer_load_dwordx4 v[112:115], v0, s[4:7], s57 offen offset:3072 sc1
  v_mfma_f32_16x16x32_bf16 v[156:159], a[208:211], v[212:215], v[156:159]
  v_mfma_f32_16x16x32_bf16 v[160:163], a[212:215], v[212:215], v[160:163]
  v_mfma_f32_16x16x32_bf16 v[164:167], a[216:219], v[212:215], v[164:167]
  s_waitcnt lgkmcnt(2)
  v_mfma_f32_16x16x32_bf16 v[168:171], a[184:187], v[216:219], v[168:171]
  v_mfma_f32_16x16x32_bf16 v[172:175], a[188:191], v[216:219], v[172:175]
  v_mfma_f32_16x16x32_bf16 v[176:179], a[192:195], v[216:219], v[176:179]
  v_mfma_f32_16x16x32_bf16 v[180:183], a[196:199], v[216:219], v[180:183]
  v_mfma_f32_16x16x32_bf16 v[184:187], a[200:203], v[216:219], v[184:187]
  v_mfma_f32_16x16x32_bf16 v[188:191], a[204:207], v[216:219], v[188:191]
  v_mfma_f32_16x16x32_bf16 v[192:195], a[208:211], v[216:219], v[192:195]
  v_mfma_f32_16x16x32_bf16 v[196:199], a[212:215], v[216:219], v[196:199]
  v_mfma_f32_16x16x32_bf16 v[200:203], a[216:219], v[216:219], v[200:203]
  s_waitcnt lgkmcnt(1)
  v_mfma_f32_16x16x32_bf16 v[132:135], a[220:223], v[220:223], v[132:135]
  v_mfma_f32_16x16x32_bf16 v[136:139], a[224:227], v[220:223], v[136:139]
  v_mfma_f32_16x16x32_bf16 v[140:143], a[228:231], v[220:223], v[140:143]
  v_mfma_f32_16x16x32_bf16 v[144:147], a[232:235], v[220:223], v[144:147]
  v_mfma_f32_16x16x32_bf16 v[148:151], a[236:239], v[220:223], v[148:151]
  v_mfma_f32_16x16x32_bf16 v[152:155], a[240:243], v[220:223], v[152:155]
  v_mfma_f32_16x16x32_bf16 v[156:159], a[244:247], v[220:223], v[156:159]
  v_mfma_f32_16x16x32_bf16 v[160:163], a[248:251], v[220:223], v[160:163]
  v_mfma_f32_16x16x32_bf16 v[164:167], a[252:255], v[220:223], v[164:167]
  s_waitcnt lgkmcnt(0)
  v_mfma_f32_16x16x32_bf16 v[168:171], a[220:223], v[204:207], v[168:171]
  v_mfma_f32_16x16x32_bf16 v[172:175], a[224:227], v[204:207], v[172:175]
  v_mfma_f32_16x16x32_bf16 v[176:179], a[228:231], v[204:207], v[176:179]
  v_mfma_f32_16x16x32_bf16 v[180:183], a[232:235], v[204:207], v[180:183]
  v_mfma_f32_16x16x32_bf16 v[184:187], a[236:239], v[204:207], v[184:187]
  v_mfma_f32_16x16x32_bf16 v[188:191], a[240:243], v[204:207], v[188:191]
  v_mfma_f32_16x16x32_bf16 v[192:195], a[244:247], v[204:207], v[192:195]
  v_mfma_f32_16x16x32_bf16 v[196:199], a[248:251], v[204:207], v[196:199]
  v_mfma_f32_16x16x32_bf16 v[200:203], a[252:255], v[204:207], v[200:203]
  s_cmp_ge_u32 s36, 43
  s_cbranch_scc1 L_arm_38
  v_mov_b32 v204, -1
  v_mov_b32 v205, -1
  v_mov_b32 v206, -1
  v_mov_b32 v207, -1
  s_add_u32 s34, s45, 0xd80000
  s_add_u32 s35, s46, 0xd80000
  s_cmp_eq_u32 s36, 42
  s_cselect_b32 s35, 0x40000000, s35
  buffer_store_dwordx4 v[204:207], v9, s[4:7], s34 offen offset:0 sc1
  buffer_store_dwordx4 v[204:207], v9, s[4:7], s34 offen offset:1024 sc1
  buffer_store_dwordx4 v[204:207], v9, s[4:7], s34 offen offset:2048 sc1
  buffer_store_dwordx4 v[204:207], v9, s[4:7], s34 offen offset:3072 sc1
  buffer_store_dwordx2 v[204:205], v10, s[4:7], s34 offen sc1
  buffer_store_dwordx4 v[204:207], v9, s[4:7], s35 offen offset:0 sc1
  buffer_store_dwordx4 v[204:207], v9, s[4:7], s35 offen offset:1024 sc1
  buffer_store_dwordx4 v[204:207], v9, s[4:7], s35 offen offset:2048 sc1
  buffer_store_dwordx4 v[204:207], v9, s[4:7], s35 offen offset:3072 sc1
  buffer_store_dwordx2 v[204:205], v10, s[4:7], s35 offen sc1
L_arm_38:
  s_cmp_lg_u32 s36, 40
  s_cbranch_scc1 L_bc_noarm
  s_add_u32 s34, s46, 0xea0000
  buffer_store_dwordx4 v[204:207], v9, s[4:7], s34 offen offset:0 sc1
  buffer_store_dwordx4 v[204:207], v9, s[4:7], s34 offen offset:1024 sc1
  buffer_store_dwordx4 v[204:207], v9, s[4:7], s34 offen offset:2048 sc1
  buffer_store_dwordx4 v[204:207], v9, s[4:7], s34 offen offset:3072 sc1
  buffer_store_dwordx2 v[204:205], v10, s[4:7], s34 offen sc1
L_bc_noarm:
  v_cvt_pk_bf16_f32 v132, v132, v133
  v_cvt_pk_bf16_f32 v133, v134, v135
  v_min_u32 v132, -2, v132
  v_cvt_pk_bf16_f32 v134, v136, v137
  v_cvt_pk_bf16_f32 v135, v138, v139
  buffer_store_dwordx4 v[132:135], v9, s[4:7], s45 offen offset:0 sc1
  v_cvt_pk_bf16_f32 v140, v140, v141
  v_cvt_pk_bf16_f32 v141, v142, v143
  v_min_u32 v140, -2, v140
  v_cvt_pk_bf16_f32 v142, v144, v145
  v_cvt_pk_bf16_f32 v143, v146, v147
  buffer_store_dwordx4 v[140:143], v9, s[4:7], s45 offen offset:1024 sc1
  v_cvt_pk_bf16_f32 v148, v148, v149
  v_cvt_pk_bf16_f32 v149, v150, v151
  v_min_u32 v148, -2, v148
  v_cvt_pk_bf16_f32 v150, v152, v153
  v_cvt_pk_bf16_f32 v151, v154, v155
  buffer_store_dwordx4 v[148:151], v9, s[4:7], s45 offen offset:2048 sc1
  v_cvt_pk_bf16_f32 v156, v156, v157
  v_cvt_pk_bf16_f32 v157, v158, v159
  v_min_u32 v156, -2, v156
  v_cvt_pk_bf16_f32 v158, v160, v161
  v_cvt_pk_bf16_f32 v159, v162, v163
  buffer_store_dwordx4 v[156:159], v9, s[4:7], s45 offen offset:3072 sc1
  v_cvt_pk_bf16_f32 v164, v164, v165
  v_cvt_pk_bf16_f32 v165, v166, v167
  v_min_u32 v164, -2, v164
  buffer_store_dwordx2 v[164:165], v10, s[4:7], s45 offen sc1
  v_cvt_pk_bf16_f32 v168, v168, v169
  v_cvt_pk_bf16_f32 v169, v170, v171
  v_min_u32 v168, -2, v168
  v_cvt_pk_bf16_f32 v170, v172, v173
  v_cvt_pk_bf16_f32 v171, v174, v175
  buffer_store_dwordx4 v[168:171], v9, s[4:7], s46 offen offset:0 sc1
  v_cvt_pk_bf16_f32 v176, v176, v177
  v_cvt_pk_bf16_f32 v177, v178, v179
  v_min_u32 v176, -2, v176
  v_cvt_pk_bf16_f32 v178, v180, v181
  v_cvt_pk_bf16_f32 v179, v182, v183
  buffer_store_dwordx4 v[176:179], v9, s[4:7], s46 offen offset:1024 sc1
  v_cvt_pk_bf16_f32 v184, v184, v185
  v_cvt_pk_bf16_f32 v185, v186, v187
  v_min_u32 v184, -2, v184
  v_cvt_pk_bf16_f32 v186, v188, v189
  v_cvt_pk_bf16_f32 v187, v190, v191
  buffer_store_dwordx4 v[184:187], v9, s[4:7], s46 offen offset:2048 sc1
  v_cvt_pk_bf16_f32 v192, v192, v193
  v_cvt_pk_bf16_f32 v193, v194, v195
  v_min_u32 v192, -2, v192
  v_cvt_pk_bf16_f32 v194, v196, v197
  v_cvt_pk_bf16_f32 v195, v198, v199
  buffer_store_dwordx4 v[192:195], v9, s[4:7], s46 offen offset:3072 sc1
  v_cvt_pk_bf16_f32 v200, v200, v201
  v_cvt_pk_bf16_f32 v201, v202, v203
  v_min_u32 v200, -2, v200
  buffer_store_dwordx2 v[200:201], v10, s[4:7], s46 offen sc1
  s_cmp_lt_u32 s36, 64
  s_cbranch_scc1 L_bc_tail
  s_branch L_bc_out
L_bc_half:
  s_cmp_eq_u32 s37, 1
  s_cselect_b32 s45, s46, s45
  s_lshl_b32 s26, s37, 13
  v_add_u32 v2, s26, v2
  ds_read_b128 v[20:23], v2 offset:0
  ds_read_b128 v[24:27], v2 offset:1024
  ds_read_b128 v[28:31], v2 offset:2048
  ds_read_b128 v[32:35], v2 offset:3072
  ds_read_b128 v[36:39], v2 offset:4096
  ds_read_b128 v[40:43], v2 offset:5120
  ds_read_b128 v[44:47], v2 offset:6144
  ds_read_b128 v[48:51], v2 offset:7168
  s_waitcnt lgkmcnt(7)
  v_mfma_f32_16x16x32_bf16 v[132:135], v[224:227], v[20:23], 0
  v_mfma_f32_16x16x32_bf16 v[136:139], v[228:231], v[20:23], 0
  s_waitcnt lgkmcnt(6)
  v_mfma_f32_16x16x32_bf16 v[132:135], a[4:7], v[24:27], v[132:135]
  v_mfma_f32_16x16x32_bf16 v[136:139], a[8:11], v[24:27], v[136:139]
  s_waitcnt lgkmcnt(5)
  v_mfma_f32_16x16x32_bf16 v[132:135], a[40:43], v[28:31], v[132:135]
  v_mfma_f32_16x16x32_bf16 v[136:139], a[44:47], v[28:31], v[136:139]
  s_waitcnt lgkmcnt(4)
  v_mfma_f32_16x16x32_bf16 v[132:135], a[76:79], v[32:35], v[132:135]
  v_mfma_f32_16x16x32_bf16 v[136:139], a[80:83], v[32:35], v[136:139]
  s_waitcnt lgkmcnt(3)
  v_mfma_f32_16x16x32_bf16 v[132:135], a[112:115], v[36:39], v[132:135]
  v_mfma_f32_16x16x32_bf16 v[136:139], a[116:119], v[36:39], v[136:139]
  s_waitcnt lgkmcnt(2)
  v_mfma_f32_16x16x32_bf16 v[132:135], a[148:151], v[40:43], v[132:135]
  v_mfma_f32_16x16x32_bf16 v[136:139], a[152:155], v[40:43], v[136:139]
  s_waitcnt lgkmcnt(1)
  v_mfma_f32_16x16x32_bf16 v[132:135], a[184:187], v[44:47], v[132:135]
  v_mfma_f32_16x16x32_bf16 v[136:139], a[188:191], v[44:47], v[136:139]
  s_waitcnt lgkmcnt(0)
  v_mfma_f32_16x16x32_bf16 v[132:135], a[220:223], v[48:51], v[132:135]
  v_mfma_f32_16x16x32_bf16 v[136:139], a[224:227], v[48:51], v[136:139]
  v_mfma_f32_16x16x32_bf16 v[140:143], v[232:235], v[20:23], 0
  v_mfma_f32_16x16x32_bf16 v[144:147], v[236:239], v[20:23], 0
  v_mfma_f32_16x16x32_bf16 v[140:143], a[12:15], v[24:27], v[140:143]
  v_mfma_f32_16x16x32_bf16 v[144:147], a[16:19], v[24:27], v[144:147]
  v_mfma_f32_16x16x32_bf16 v[140:143], a[48:51], v[28:31], v[140:143]
  v_mfma_f32_16x16x32_bf16 v[144:147], a[52:55], v[28:31], v[144:147]
  v_cvt_pk_bf16_f32 v132, v132, v133
  v_mfma_f32_16x16x32_bf16 v[140:143], a[84:87], v[32:35], v[140:143]
  v_mfma_f32_16x16x32_bf16 v[144:147], a[88:91], v[32:35], v[144:147]
  v_cvt_pk_bf16_f32 v133, v134, v135
  v_mfma_f32_16x16x32_bf16 v[140:143], a[120:123], v[36:39], v[140:143]
  v_mfma_f32_16x16x32_bf16 v[144:147], a[124:127], v[36:39], v[144:147]
  v_min_u32 v132, -2, v132
  v_mfma_f32_16x16x32_bf16 v[140:143], a[156:159], v[40:43], v[140:143]
  v_mfma_f32_16x16x32_bf16 v[144:147], a[160:163], v[40:43], v[144:147]
  v_cvt_pk_bf16_f32 v134, v136, v137
  v_mfma_f32_16x16x32_bf16 v[140:143], a[192:195], v[44:47], v[140:143]
  v_mfma_f32_16x16x32_bf16 v[144:147], a[196:199], v[44:47], v[144:147]
  v_cvt_pk_bf16_f32 v135, v138, v139
  v_mfma_f32_16x16x32_bf16 v[140:143], a[228:231], v[48:51], v[140:143]
  v_mfma_f32_16x16x32_bf16 v[144:147], a[232:235], v[48:51], v[144:147]
  buffer_store_dwordx4 v[132:135], v9, s[4:7], s45 offen offset:0 sc1
  v_mfma_f32_16x16x32_bf16 v[148:151], v[240:243], v[20:23], 0
  v_mfma_f32_16x16x32_bf16 v[152:155], v[244:247], v[20:23], 0
  v_mfma_f32_16x16x32_bf16 v[148:151], a[20:23], v[24:27], v[148:151]
  v_mfma_f32_16x16x32_bf16 v[152:155], a[24:27], v[24:27], v[152:155]
  v_mfma_f32_16x16x32_bf16 v[148:151], a[56:59], v[28:31], v[148:151]
  v_mfma_f32_16x16x32_bf16 v[152:155], a[60:63], v[28:31], v[152:155]
  v_cvt_pk_bf16_f32 v140, v140, v141
  v_mfma_f32_16x16x32_bf16 v[148:151], a[92:95], v[32:35], v[148:151]
  v_mfma_f32_16x16x32_bf16 v[152:155], a[96:99], v[32:35], v[152:155]
  v_cvt_pk_bf16_f32 v141, v142, v143
  v_mfma_f32_16x16x32_bf16 v[148:151], a[128:131], v[36:39], v[148:151]
  v_mfma_f32_16x16x32_bf16 v[152:155], a[132:135], v[36:39], v[152:155]
  v_min_u32 v140, -2, v140
  v_mfma_f32_16x16x32_bf16 v[148:151], a[164:167], v[40:43], v[148:151]
  v_mfma_f32_16x16x32_bf16 v[152:155], a[168:171], v[40:43], v[152:155]
  v_cvt_pk_bf16_f32 v142, v144, v145
  v_mfma_f32_16x16x32_bf16 v[148:151], a[200:203], v[44:47], v[148:151]
  v_mfma_f32_16x16x32_bf16 v[152:155], a[204:207], v[44:47], v[152:155]
  v_cvt_pk_bf16_f32 v143, v146, v147
  v_mfma_f32_16x16x32_bf16 v[148:151], a[236:239], v[48:51], v[148:151]
  v_mfma_f32_16x16x32_bf16 v[152:155], a[240:243], v[48:51], v[152:155]
  buffer_store_dwordx4 v[140:143], v9, s[4:7], s45 offen offset:1024 sc1
  v_mfma_f32_16x16x32_bf16 v[156:159], v[248:251], v[20:23], 0
  v_mfma_f32_16x16x32_bf16 v[160:163], v[252:255], v[20:23], 0
  v_mfma_f32_16x16x32_bf16 v[156:159], a[28:31], v[24:27], v[156:159]
  v_mfma_f32_16x16x32_bf16 v[160:163], a[32:35], v[24:27], v[160:163]
  v_mfma_f32_16x16x32_bf16 v[156:159], a[64:67], v[28:31], v[156:159]
  v_mfma_f32_16x16x32_bf16 v[160:163], a[68:71], v[28:31], v[160:163]
  v_cvt_pk_bf16_f32 v148, v148, v149
  v_mfma_f32_16x16x32_bf16 v[156:159], a[100:103], v[32:35], v[156:159]
  v_mfma_f32_16x16x32_bf16 v[160:163], a[104:107], v[32:35], v[160:163]
  v_cvt_pk_bf16_f32 v149, v150, v151
  v_mfma_f32_16x16x32_bf16 v[156:159], a[136:139], v[36:39], v[156:159]
  v_mfma_f32_16x16x32_bf16 v[160:163], a[140:143], v[36:39], v[160:163]
  v_min_u32 v148, -2, v148
  v_mfma_f32_16x16x32_bf16 v[156:159], a[172:175], v[40:43], v[156:159]
  v_mfma_f32_16x16x32_bf16 v[160:163], a[176:179], v[40:43], v[160:163]
  v_cvt_pk_bf16_f32 v150, v152, v153
  v_mfma_f32_16x16x32_bf16 v[156:159], a[208:211], v[44:47], v[156:159]
  v_mfma_f32_16x16x32_bf16 v[160:163], a[212:215], v[44:47], v[160:163]
  v_cvt_pk_bf16_f32 v151, v154, v155
  v_mfma_f32_16x16x32_bf16 v[156:159], a[244:247], v[48:51], v[156:159]
  v_mfma_f32_16x16x32_bf16 v[160:163], a[248:251], v[48:51], v[160:163]
  buffer_store_dwordx4 v[148:151], v9, s[4:7], s45 offen offset:2048 sc1
  v_mfma_f32_16x16x32_bf16 v[164:167], a[0:3], v[20:23], 0
  v_mfma_f32_16x16x32_bf16 v[164:167], a[36:39], v[24:27], v[164:167]
  v_mfma_f32_16x16x32_bf16 v[164:167], a[72:75], v[28:31], v[164:167]
  v_cvt_pk_bf16_f32 v156, v156, v157
  v_mfma_f32_16x16x32_bf16 v[164:167], a[108:111], v[32:35], v[164:167]
  v_cvt_pk_bf16_f32 v157, v158, v159
  v_mfma_f32_16x16x32_bf16 v[164:167], a[144:147], v[36:39], v[164:167]
  v_min_u32 v156, -2, v156
  v_mfma_f32_16x16x32_bf16 v[164:167], a[180:183], v[40:43], v[164:167]
  v_cvt_pk_bf16_f32 v158, v160, v161
  v_mfma_f32_16x16x32_bf16 v[164:167], a[216:219], v[44:47], v[164:167]
  v_cvt_pk_bf16_f32 v159, v162, v163
  v_mfma_f32_16x16x32_bf16 v[164:167], a[252:255], v[48:51], v[164:167]
  buffer_store_dwordx4 v[156:159], v9, s[4:7], s45 offen offset:3072 sc1
  s_nop 6
  v_cvt_pk_bf16_f32 v164, v164, v165
  v_cvt_pk_bf16_f32 v165, v166, v167
  v_min_u32 v164, -2, v164
  buffer_store_dwordx2 v[164:165], v10, s[4:7], s45 offen sc1
  s_cmp_eq_u32 s36, 62
  s_mov_b32 s36, 63
  s_mov_b32 s37, 1
  s_cbranch_scc1 L_bc_half
L_bc_out:
  s_branch L_exit
L_role_dd:
  s_and_b32 s36, s24, 1
  s_lshr_b32 s50, s24, 1
  s_mov_b32 s26, 0x2102102
  s_mov_b32 s27, 0x1
  s_lshr_b32 s28, s24, 1
  s_bitcmp1_b64 s[26:27], s28
  s_cselect_b32 s26, 1, 0
  s_add_u32 s50, s50, s26
  s_mov_b32 s26, 0x4204204
  s_mov_b32 s27, 0x2
  s_lshr_b32 s28, s24, 1
  s_bitcmp1_b64 s[26:27], s28
  s_cselect_b32 s26, 1, 0
  s_sub_u32 s50, s50, s26
  s_load_dwordx2 s[8:9], s[0:1], 64
  s_mov_b32 s10, 0x510000
  s_mov_b32 s11, 0x20000
  s_load_dwordx2 s[12:13], s[0:1], 72
  s_mov_b32 s14, 0x510000
  s_mov_b32 s15, 0x20000
  s_waitcnt lgkmcnt(0)
  s_lshl_b32 s50, s50, 2
  s_add_u32 s50, s50, s25
  s_lshl_b32 s27, s50, 6
  v_lshrrev_b32 v20, 2, v1
  v_mul_u32_u24 v20, 9216, v20
  v_and_b32 v21, 3, v1
  v_lshlrev_b32 v21, 4, v21
  v_add3_u32 v20, v20, v21, s27
  s_mul_i32 s26, s25, 36864
  v_lshrrev_b32 v22, 4, v1
  v_mul_u32_u24 v22, 512, v22
  v_bfe_u32 v23, v1, 2, 2
  v_mul_u32_u24 v23, 64, v23
  v_add_u32 v22, v22, v23
  v_and_b32 v23, 3, v1
  v_mul_u32_u24 v23, 16, v23
  v_add3_u32 v21, v22, v23, s26
  s_add_u32 m0, s26, 0x0
  s_mov_b32 s27, 0x0
  buffer_load_dwordx4 v20, s[8:11], s27 offen  lds
  s_add_u32 m0, s26, 0x400
  s_mov_b32 s27, 0x24000
  buffer_load_dwordx4 v20, s[8:11], s27 offen  lds
  s_add_u32 m0, s26, 0x800
  s_mov_b32 s27, 0x0
  buffer_load_dwordx4 v20, s[12:15], s27 offen  lds
  s_add_u32 m0, s26, 0xc00
  s_mov_b32 s27, 0x24000
  buffer_load_dwordx4 v20, s[12:15], s27 offen  lds
  s_add_u32 m0, s26, 0x1000
  s_mov_b32 s27, 0x48000
  buffer_load_dwordx4 v20, s[8:11], s27 offen  lds
  s_add_u32 m0, s26, 0x1400
  s_mov_b32 s27, 0x6c000
  buffer_load_dwordx4 v20, s[8:11], s27 offen  lds
  s_add_u32 m0, s26, 0x1800
  s_mov_b32 s27, 0x48000
  buffer_load_dwordx4 v20, s[12:15], s27 offen  lds
  s_add_u32 m0, s26, 0x1c00
  s_mov_b32 s27, 0x6c000
  buffer_load_dwordx4 v20, s[12:15], s27 offen  lds
  s_add_u32 m0, s26, 0x2000
  s_mov_b32 s27, 0x90000
  buffer_load_dwordx4 v20, s[8:11], s27 offen  lds
  s_add_u32 m0, s26, 0x2400
  s_mov_b32 s27, 0xb4000
  buffer_load_dwordx4 v20, s[8:11], s27 offen  lds
  s_add_u32 m0, s26, 0x2800
  s_mov_b32 s27, 0x90000
  buffer_load_dwordx4 v20, s[12:15], s27 offen  lds
  s_add_u32 m0, s26, 0x2c00
  s_mov_b32 s27, 0xb4000
  buffer_load_dwordx4 v20, s[12:15], s27 offen  lds
  s_add_u32 m0, s26, 0x3000
  s_mov_b32 s27, 0xd8000
  buffer_load_dwordx4 v20, s[8:11], s27 offen  lds
  s_add_u32 m0, s26, 0x3400
  s_mov_b32 s27, 0xfc000
  buffer_load_dwordx4 v20, s[8:11], s27 offen  lds
  s_add_u32 m0, s26, 0x3800
  s_mov_b32 s27, 0xd8000
  buffer_load_dwordx4 v20, s[12:15], s27 offen  lds
  s_add_u32 m0, s26, 0x3c00
  s_mov_b32 s27, 0xfc000
  buffer_load_dwordx4 v20, s[12:15], s27 offen  lds
  s_add_u32 m0, s26, 0x4000
  s_mov_b32 s27, 0x120000
  buffer_load_dwordx4 v20, s[8:11], s27 offen  lds
  s_add_u32 m0, s26, 0x4400
  s_mov_b32 s27, 0x144000
  buffer_load_dwordx4 v20, s[8:11], s27 offen  lds
  s_add_u32 m0, s26, 0x4800
  s_mov_b32 s27, 0x120000
  buffer_load_dwordx4 v20, s[12:15], s27 offen  lds
  s_add_u32 m0, s26, 0x4c00
  s_mov_b32 s27, 0x144000
  buffer_load_dwordx4 v20, s[12:15], s27 offen  lds
  s_add_u32 m0, s26, 0x5000
  s_mov_b32 s27, 0x168000
  buffer_load_dwordx4 v20, s[8:11], s27 offen  lds
  s_add_u32 m0, s26, 0x5400
  s_mov_b32 s27, 0x18c000
  buffer_load_dwordx4 v20, s[8:11], s27 offen  lds
  s_add_u32 m0, s26, 0x5800
  s_mov_b32 s27, 0x168000
  buffer_load_dwordx4 v20, s[12:15], s27 offen  lds
  s_add_u32 m0, s26, 0x5c00
  s_mov_b32 s27, 0x18c000
  buffer_load_dwordx4 v20, s[12:15], s27 offen  lds
  s_add_u32 m0, s26, 0x6000
  s_mov_b32 s27, 0x1b0000
  buffer_load_dwordx4 v20, s[8:11], s27 offen  lds
  s_add_u32 m0, s26, 0x6400
  s_mov_b32 s27, 0x1d4000
  buffer_load_dwordx4 v20, s[8:11], s27 offen  lds
  s_add_u32 m0, s26, 0x6800
  s_mov_b32 s27, 0x1b0000
  buffer_load_dwordx4 v20, s[12:15], s27 offen  lds
  s_add_u32 m0, s26, 0x6c00
  s_mov_b32 s27, 0x1d4000
  buffer_load_dwordx4 v20, s[12:15], s27 offen  lds
  s_add_u32 m0, s26, 0x7000
  s_mov_b32 s27, 0x1f8000
  buffer_load_dwordx4 v20, s[8:11], s27 offen  lds
  s_add_u32 m0, s26, 0x7400
  s_mov_b32 s27, 0x21c000
  buffer_load_dwordx4 v20, s[8:11], s27 offen  lds
  s_add_u32 m0, s26, 0x7800
  s_mov_b32 s27, 0x1f8000
  buffer_load_dwordx4 v20, s[12:15], s27 offen  lds
  s_add_u32 m0, s26, 0x7c00
  s_mov_b32 s27, 0x21c000
  buffer_load_dwordx4 v20, s[12:15], s27 offen  lds
  s_add_u32 m0, s26, 0x8000
  s_mov_b32 s27, 0x240000
  buffer_load_dwordx4 v20, s[8:11], s27 offen  lds
  s_add_u32 m0, s26, 0x8400
  s_mov_b32 s27, 0x264000
  buffer_load_dwordx4 v20, s[8:11], s27 offen  lds
  s_add_u32 m0, s26, 0x8800
  s_mov_b32 s27, 0x240000
  buffer_load_dwordx4 v20, s[12:15], s27 offen  lds
  s_add_u32 m0, s26, 0x8c00
  s_mov_b32 s27, 0x264000
  buffer_load_dwordx4 v20, s[12:15], s27 offen  lds
  s_waitcnt vmcnt(32)
  ds_read_b64_tr_b16 v[224:225], v21 offset:0
  ds_read_b64_tr_b16 v[226:227], v21 offset:256
  ds_read_b64_tr_b16 v[228:229], v21 offset:8
  ds_read_b64_tr_b16 v[230:231], v21 offset:264
  ds_read_b64_tr_b16 v[232:233], v21 offset:2048
  ds_read_b64_tr_b16 v[234:235], v21 offset:2304
  ds_read_b64_tr_b16 v[236:237], v21 offset:2056
  ds_read_b64_tr_b16 v[238:239], v21 offset:2312
  s_waitcnt lgkmcnt(0)
  s_add_u32 m0, s26, 0x0
  s_mov_b32 s27, 0x288000
  buffer_load_dwordx4 v20, s[8:11], s27 offen  lds
  s_add_u32 m0, s26, 0x400
  s_mov_b32 s27, 0x2ac000
  buffer_load_dwordx4 v20, s[8:11], s27 offen  lds
  s_add_u32 m0, s26, 0x800
  s_mov_b32 s27, 0x288000
  buffer_load_dwordx4 v20, s[12:15], s27 offen  lds
  s_add_u32 m0, s26, 0xc00
  s_mov_b32 s27, 0x2ac000
  buffer_load_dwordx4 v20, s[12:15], s27 offen  lds
  s_waitcnt vmcnt(32)
  ds_read_b64_tr_b16 v[240:241], v21 offset:4096
  ds_read_b64_tr_b16 v[242:243], v21 offset:4352
  ds_read_b64_tr_b16 v[244:245], v21 offset:4104
  ds_read_b64_tr_b16 v[246:247], v21 offset:4360
  ds_read_b64_tr_b16 v[248:249], v21 offset:6144
  ds_read_b64_tr_b16 v[250:251], v21 offset:6400
  ds_read_b64_tr_b16 v[252:253], v21 offset:6152
  ds_read_b64_tr_b16 v[254:255], v21 offset:6408
  s_waitcnt lgkmcnt(0)
  s_add_u32 m0, s26, 0x1000
  s_mov_b32 s27, 0x2d0000
  buffer_load_dwordx4 v20, s[8:11], s27 offen  lds
  s_add_u32 m0, s26, 0x1400
  s_mov_b32 s27, 0x2f4000
  buffer_load_dwordx4 v20, s[8:11], s27 offen  lds
  s_add_u32 m0, s26, 0x1800
  s_mov_b32 s27, 0x2d0000
  buffer_load_dwordx4 v20, s[12:15], s27 offen  lds
  s_add_u32 m0, s26, 0x1c00
  s_mov_b32 s27, 0x2f4000
  buffer_load_dwordx4 v20, s[12:15], s27 offen  lds
  s_waitcnt vmcnt(32)
  ds_read_b64_tr_b16 a[0:1], v21 offset:8192
  ds_read_b64_tr_b16 a[2:3], v21 offset:8448
  ds_read_b64_tr_b16 a[4:5], v21 offset:8200
  ds_read_b64_tr_b16 a[6:7], v21 offset:8456
  ds_read_b64_tr_b16 a[8:9], v21 offset:10240
  ds_read_b64_tr_b16 a[10:11], v21 offset:10496
  ds_read_b64_tr_b16 a[12:13], v21 offset:10248
  ds_read_b64_tr_b16 a[14:15], v21 offset:10504
  s_waitcnt lgkmcnt(0)
  s_add_u32 m0, s26, 0x2000
  s_mov_b32 s27, 0x318000
  buffer_load_dwordx4 v20, s[8:11], s27 offen  lds
  s_add_u32 m0, s26, 0x2400
  s_mov_b32 s27, 0x33c000
  buffer_load_dwordx4 v20, s[8:11], s27 offen  lds
  s_add_u32 m0, s26, 0x2800
  s_mov_b32 s27, 0x318000
  buffer_load_dwordx4 v20, s[12:15], s27 offen  lds
  s_add_u32 m0, s26, 0x2c00
  s_mov_b32 s27, 0x33c000
  buffer_load_dwordx4 v20, s[12:15], s27 offen  lds
  s_waitcnt vmcnt(32)
  ds_read_b64_tr_b16 a[16:17], v21 offset:12288
  ds_read_b64_tr_b16 a[18:19], v21 offset:12544
  ds_read_b64_tr_b16 a[20:21], v21 offset:12296
  ds_read_b64_tr_b16 a[22:23], v21 offset:12552
  ds_read_b64_tr_b16 a[24:25], v21 offset:14336
  ds_read_b64_tr_b16 a[26:27], v21 offset:14592
  ds_read_b64_tr_b16 a[28:29], v21 offset:14344
  ds_read_b64_tr_b16 a[30:31], v21 offset:14600
  s_waitcnt lgkmcnt(0)
  s_add_u32 m0, s26, 0x3000
  s_mov_b32 s27, 0x360000
  buffer_load_dwordx4 v20, s[8:11], s27 offen  lds
  s_add_u32 m0, s26, 0x3400
  s_mov_b32 s27, 0x384000
  buffer_load_dwordx4 v20, s[8:11], s27 offen  lds
  s_add_u32 m0, s26, 0x3800
  s_mov_b32 s27, 0x360000
  buffer_load_dwordx4 v20, s[12:15], s27 offen  lds
  s_add_u32 m0, s26, 0x3c00
  s_mov_b32 s27, 0x384000
  buffer_load_dwordx4 v20, s[12:15], s27 offen  lds
  s_waitcnt vmcnt(32)
  ds_read_b64_tr_b16 a[32:33], v21 offset:16384
  ds_read_b64_tr_b16 a[34:35], v21 offset:16640
  ds_read_b64_tr_b16 a[36:37], v21 offset:16392
  ds_read_b64_tr_b16 a[38:39], v21 offset:16648
  ds_read_b64_tr_b16 a[40:41], v21 offset:18432
  ds_read_b64_tr_b16 a[42:43], v21 offset:18688
  ds_read_b64_tr_b16 a[44:45], v21 offset:18440
  ds_read_b64_tr_b16 a[46:47], v21 offset:18696
  s_waitcnt lgkmcnt(0)
  s_add_u32 m0, s26, 0x4000
  s_mov_b32 s27, 0x3a8000
  buffer_load_dwordx4 v20, s[8:11], s27 offen  lds
  s_add_u32 m0, s26, 0x4400
  s_mov_b32 s27, 0x3cc000
  buffer_load_dwordx4 v20, s[8:11], s27 offen  lds
  s_add_u32 m0, s26, 0x4800
  s_mov_b32 s27, 0x3a8000
  buffer_load_dwordx4 v20, s[12:15], s27 offen  lds
  s_add_u32 m0, s26, 0x4c00
  s_mov_b32 s27, 0x3cc000
  buffer_load_dwordx4 v20, s[12:15], s27 offen  lds
  s_waitcnt vmcnt(32)
  ds_read_b64_tr_b16 a[48:49], v21 offset:20480
  ds_read_b64_tr_b16 a[50:51], v21 offset:20736
  ds_read_b64_tr_b16 a[52:53], v21 offset:20488
  ds_read_b64_tr_b16 a[54:55], v21 offset:20744
  ds_read_b64_tr_b16 a[56:57], v21 offset:22528
  ds_read_b64_tr_b16 a[58:59], v21 offset:22784
  ds_read_b64_tr_b16 a[60:61], v21 offset:22536
  ds_read_b64_tr_b16 a[62:63], v21 offset:22792
  s_waitcnt lgkmcnt(0)
  s_add_u32 m0, s26, 0x5000
  s_mov_b32 s27, 0x3f0000
  buffer_load_dwordx4 v20, s[8:11], s27 offen  lds
  s_add_u32 m0, s26, 0x5400
  s_mov_b32 s27, 0x414000
  buffer_load_dwordx4 v20, s[8:11], s27 offen  lds
  s_add_u32 m0, s26, 0x5800
  s_mov_b32 s27, 0x3f0000
  buffer_load_dwordx4 v20, s[12:15], s27 offen  lds
  s_add_u32 m0, s26, 0x5c00
  s_mov_b32 s27, 0x414000
  buffer_load_dwordx4 v20, s[12:15], s27 offen  lds
  s_waitcnt vmcnt(32)
  ds_read_b64_tr_b16 a[64:65], v21 offset:24576
  ds_read_b64_tr_b16 a[66:67], v21 offset:24832
  ds_read_b64_tr_b16 a[68:69], v21 offset:24584
  ds_read_b64_tr_b16 a[70:71], v21 offset:24840
  ds_read_b64_tr_b16 a[72:73], v21 offset:26624
  ds_read_b64_tr_b16 a[74:75], v21 offset:26880
  ds_read_b64_tr_b16 a[76:77], v21 offset:26632
  ds_read_b64_tr_b16 a[78:79], v21 offset:26888
  s_waitcnt lgkmcnt(0)
  s_add_u32 m0, s26, 0x6000
  s_mov_b32 s27, 0x438000
  buffer_load_dwordx4 v20, s[8:11], s27 offen  lds
  s_add_u32 m0, s26, 0x6400
  s_mov_b32 s27, 0x45c000
  buffer_load_dwordx4 v20, s[8:11], s27 offen  lds
  s_add_u32 m0, s26, 0x6800
  s_mov_b32 s27, 0x438000
  buffer_load_dwordx4 v20, s[12:15], s27 offen  lds
  s_add_u32 m0, s26, 0x6c00
  s_mov_b32 s27, 0x45c000
  buffer_load_dwordx4 v20, s[12:15], s27 offen  lds
  s_waitcnt vmcnt(32)
  ds_read_b64_tr_b16 a[80:81], v21 offset:28672
  ds_read_b64_tr_b16 a[82:83], v21 offset:28928
  ds_read_b64_tr_b16 a[84:85], v21 offset:28680
  ds_read_b64_tr_b16 a[86:87], v21 offset:28936
  ds_read_b64_tr_b16 a[88:89], v21 offset:30720
  ds_read_b64_tr_b16 a[90:91], v21 offset:30976
  ds_read_b64_tr_b16 a[92:93], v21 offset:30728
  ds_read_b64_tr_b16 a[94:95], v21 offset:30984
  s_waitcnt lgkmcnt(0)
  s_add_u32 m0, s26, 0x7000
  s_mov_b32 s27, 0x480000
  buffer_load_dwordx4 v20, s[8:11], s27 offen  lds
  s_add_u32 m0, s26, 0x7400
  s_mov_b32 s27, 0x4a4000
  buffer_load_dwordx4 v20, s[8:11], s27 offen  lds
  s_add_u32 m0, s26, 0x7800
  s_mov_b32 s27, 0x480000
  buffer_load_dwordx4 v20, s[12:15], s27 offen  lds
  s_add_u32 m0, s26, 0x7c00
  s_mov_b32 s27, 0x4a4000
  buffer_load_dwordx4 v20, s[12:15], s27 offen  lds
  s_waitcnt vmcnt(32)
  ds_read_b64_tr_b16 a[96:97], v21 offset:32768
  ds_read_b64_tr_b16 a[98:99], v21 offset:33024
  ds_read_b64_tr_b16 a[100:101], v21 offset:32776
  ds_read_b64_tr_b16 a[102:103], v21 offset:33032
  ds_read_b64_tr_b16 a[104:105], v21 offset:34816
  ds_read_b64_tr_b16 a[106:107], v21 offset:35072
  ds_read_b64_tr_b16 a[108:109], v21 offset:34824
  ds_read_b64_tr_b16 a[110:111], v21 offset:35080
  s_waitcnt lgkmcnt(0)
  s_add_u32 m0, s26, 0x8000
  s_mov_b32 s27, 0x4c8000
  buffer_load_dwordx4 v20, s[8:11], s27 offen  lds
  s_add_u32 m0, s26, 0x8400
  s_mov_b32 s27, 0x4ec000
  buffer_load_dwordx4 v20, s[8:11], s27 offen  lds
  s_add_u32 m0, s26, 0x8800
  s_mov_b32 s27, 0x4c8000
  buffer_load_dwordx4 v20, s[12:15], s27 offen  lds
  s_add_u32 m0, s26, 0x8c00
  s_mov_b32 s27, 0x4ec000
  buffer_load_dwordx4 v20, s[12:15], s27 offen  lds
  s_waitcnt vmcnt(32)
  ds_read_b64_tr_b16 a[112:113], v21 offset:0
  ds_read_b64_tr_b16 a[114:115], v21 offset:256
  ds_read_b64_tr_b16 a[116:117], v21 offset:8
  ds_read_b64_tr_b16 a[118:119], v21 offset:264
  ds_read_b64_tr_b16 a[120:121], v21 offset:2048
  ds_read_b64_tr_b16 a[122:123], v21 offset:2304
  ds_read_b64_tr_b16 a[124:125], v21 offset:2056
  ds_read_b64_tr_b16 a[126:127], v21 offset:2312
  s_waitcnt vmcnt(28)
  ds_read_b64_tr_b16 a[128:129], v21 offset:4096
  ds_read_b64_tr_b16 a[130:131], v21 offset:4352
  ds_read_b64_tr_b16 a[132:133], v21 offset:4104
  ds_read_b64_tr_b16 a[134:135], v21 offset:4360
  ds_read_b64_tr_b16 a[136:137], v21 offset:6144
  ds_read_b64_tr_b16 a[138:139], v21 offset:6400
  ds_read_b64_tr_b16 a[140:141], v21 offset:6152
  ds_read_b64_tr_b16 a[142:143], v21 offset:6408
  s_waitcnt vmcnt(24)
  ds_read_b64_tr_b16 a[144:145], v21 offset:8192
  ds_read_b64_tr_b16 a[146:147], v21 offset:8448
  ds_read_b64_tr_b16 a[148:149], v21 offset:8200
  ds_read_b64_tr_b16 a[150:151], v21 offset:8456
  ds_read_b64_tr_b16 a[152:153], v21 offset:10240
  ds_read_b64_tr_b16 a[154:155], v21 offset:10496
  ds_read_b64_tr_b16 a[156:157], v21 offset:10248
  ds_read_b64_tr_b16 a[158:159], v21 offset:10504
  s_waitcnt vmcnt(20)
  ds_read_b64_tr_b16 a[160:161], v21 offset:12288
  ds_read_b64_tr_b16 a[162:163], v21 offset:12544
  ds_read_b64_tr_b16 a[164:165], v21 offset:12296
  ds_read_b64_tr_b16 a[166:167], v21 offset:12552
  ds_read_b64_tr_b16 a[168:169], v21 offset:14336
  ds_read_b64_tr_b16 a[170:171], v21 offset:14592
  ds_read_b64_tr_b16 a[172:173], v21 offset:14344
  ds_read_b64_tr_b16 a[174:175], v21 offset:14600
  s_waitcnt vmcnt(16)
  ds_read_b64_tr_b16 a[176:177], v21 offset:16384
  ds_read_b64_tr_b16 a[178:179], v21 offset:16640
  ds_read_b64_tr_b16 a[180:181], v21 offset:16392
  ds_read_b64_tr_b16 a[182:183], v21 offset:16648
  ds_read_b64_tr_b16 a[184:185], v21 offset:18432
  ds_read_b64_tr_b16 a[186:187], v21 offset:18688
  ds_read_b64_tr_b16 a[188:189], v21 offset:18440
  ds_read_b64_tr_b16 a[190:191], v21 offset:18696
  s_waitcnt vmcnt(12)
  ds_read_b64_tr_b16 a[192:193], v21 offset:20480
  ds_read_b64_tr_b16 a[194:195], v21 offset:20736
  ds_read_b64_tr_b16 a[196:197], v21 offset:20488
  ds_read_b64_tr_b16 a[198:199], v21 offset:20744
  ds_read_b64_tr_b16 a[200:201], v21 offset:22528
  ds_read_b64_tr_b16 a[202:203], v21 offset:22784
  ds_read_b64_tr_b16 a[204:205], v21 offset:22536
  ds_read_b64_tr_b16 a[206:207], v21 offset:22792
  s_waitcnt vmcnt(8)
  ds_read_b64_tr_b16 a[208:209], v21 offset:24576
  ds_read_b64_tr_b16 a[210:211], v21 offset:24832
  ds_read_b64_tr_b16 a[212:213], v21 offset:24584
  ds_read_b64_tr_b16 a[214:215], v21 offset:24840
  ds_read_b64_tr_b16 a[216:217], v21 offset:26624
  ds_read_b64_tr_b16 a[218:219], v21 offset:26880
  ds_read_b64_tr_b16 a[220:221], v21 offset:26632
  ds_read_b64_tr_b16 a[222:223], v21 offset:26888
  s_waitcnt vmcnt(4)
  ds_read_b64_tr_b16 a[224:225], v21 offset:28672
  ds_read_b64_tr_b16 a[226:227], v21 offset:28928
  ds_read_b64_tr_b16 a[228:229], v21 offset:28680
  ds_read_b64_tr_b16 a[230:231], v21 offset:28936
  ds_read_b64_tr_b16 a[232:233], v21 offset:30720
  ds_read_b64_tr_b16 a[234:235], v21 offset:30976
  ds_read_b64_tr_b16 a[236:237], v21 offset:30728
  ds_read_b64_tr_b16 a[238:239], v21 offset:30984
  s_waitcnt vmcnt(0)
  ds_read_b64_tr_b16 a[240:241], v21 offset:32768
  ds_read_b64_tr_b16 a[242:243], v21 offset:33024
  ds_read_b64_tr_b16 a[244:245], v21 offset:32776
  ds_read_b64_tr_b16 a[246:247], v21 offset:33032
  ds_read_b64_tr_b16 a[248:249], v21 offset:34816
  ds_read_b64_tr_b16 a[250:251], v21 offset:35072
  ds_read_b64_tr_b16 a[252:253], v21 offset:34824
  ds_read_b64_tr_b16 a[254:255], v21 offset:35080
  s_waitcnt lgkmcnt(0)
  s_mov_b32 s28, 0
L_reg_39:
  v_mov_b32 v26, 0
  buffer_load_dword v27, v26, s[20:23], 0 offen offset:64 sc1
  s_add_u32 s28, s28, 1
  s_cmp_gt_u32 s28, 1048576
  s_cbranch_scc1 L_fail
  s_waitcnt vmcnt(0)
  v_readfirstlane_b32 s67, v27
L_regc_40:
  s_and_b32 s26, s67, 0xffff
  s_cmp_lt_u32 s26, 256
  s_cbranch_scc1 L_reg_39
  s_lshr_b32 s67, s67, 16
  s_barrier
  v_mov_b32 v28, 0x3f803f80
  v_mov_b32 v29, 0x3f803f80
  v_mov_b32 v30, 0x3f803f80
  v_mov_b32 v31, 0x3f803f80
  s_nop 1
  v_mfma_f32_16x16x32_bf16 v[64:67], v[224:227], v[28:31], 0
  v_mfma_f32_16x16x32_bf16 v[68:71], v[228:231], v[28:31], 0
  v_mfma_f32_16x16x32_bf16 v[72:75], v[232:235], v[28:31], 0
  v_mfma_f32_16x16x32_bf16 v[76:79], v[236:239], v[28:31], 0
  v_mfma_f32_16x16x32_bf16 v[64:67], v[240:243], v[28:31], v[64:67]
  v_mfma_f32_16x16x32_bf16 v[68:71], v[244:247], v[28:31], v[68:71]
  v_mfma_f32_16x16x32_bf16 v[72:75], v[248:251], v[28:31], v[72:75]
  v_mfma_f32_16x16x32_bf16 v[76:79], v[252:255], v[28:31], v[76:79]
  v_mfma_f32_16x16x32_bf16 v[64:67], a[0:3], v[28:31], v[64:67]
  v_mfma_f32_16x16x32_bf16 v[68:71], a[4:7], v[28:31], v[68:71]
  v_mfma_f32_16x16x32_bf16 v[72:75], a[8:11], v[28:31], v[72:75]
  v_mfma_f32_16x16x32_bf16 v[76:79], a[12:15], v[28:31], v[76:79]
  v_mfma_f32_16x16x32_bf16 v[64:67], a[16:19], v[28:31], v[64:67]
  v_mfma_f32_16x16x32_bf16 v[68:71], a[20:23], v[28:31], v[68:71]
  v_mfma_f32_16x16x32_bf16 v[72:75], a[24:27], v[28:31], v[72:75]
  v_mfma_f32_16x16x32_bf16 v[76:79], a[28:31], v[28:31], v[76:79]
  v_mfma_f32_16x16x32_bf16 v[64:67], a[32:35], v[28:31], v[64:67]
  v_mfma_f32_16x16x32_bf16 v[68:71], a[36:39], v[28:31], v[68:71]
  v_mfma_f32_16x16x32_bf16 v[72:75], a[40:43], v[28:31], v[72:75]
  v_mfma_f32_16x16x32_bf16 v[76:79], a[44:47], v[28:31], v[76:79]
  v_mfma_f32_16x16x32_bf16 v[64:67], a[48:51], v[28:31], v[64:67]
  v_mfma_f32_16x16x32_bf16 v[68:71], a[52:55], v[28:31], v[68:71]
  v_mfma_f32_16x16x32_bf16 v[72:75], a[56:59], v[28:31], v[72:75]
  v_mfma_f32_16x16x32_bf16 v[76:79], a[60:63], v[28:31], v[76:79]
  v_mfma_f32_16x16x32_bf16 v[64:67], a[64:67], v[28:31], v[64:67]
  v_mfma_f32_16x16x32_bf16 v[68:71], a[68:71], v[28:31], v[68:71]
  v_mfma_f32_16x16x32_bf16 v[72:75], a[72:75], v[28:31], v[72:75]
  v_mfma_f32_16x16x32_bf16 v[76:79], a[76:79], v[28:31], v[76:79]
  v_mfma_f32_16x16x32_bf16 v[64:67], a[80:83], v[28:31], v[64:67]
  v_mfma_f32_16x16x32_bf16 v[68:71], a[84:87], v[28:31], v[68:71]
  v_mfma_f32_16x16x32_bf16 v[72:75], a[88:91], v[28:31], v[72:75]
  v_mfma_f32_16x16x32_bf16 v[76:79], a[92:95], v[28:31], v[76:79]
  v_mfma_f32_16x16x32_bf16 v[64:67], a[96:99], v[28:31], v[64:67]
  v_mfma_f32_16x16x32_bf16 v[68:71], a[100:103], v[28:31], v[68:71]
  v_mfma_f32_16x16x32_bf16 v[72:75], a[104:107], v[28:31], v[72:75]
  v_mfma_f32_16x16x32_bf16 v[76:79], a[108:111], v[28:31], v[76:79]
  v_mfma_f32_16x16x32_bf16 v[64:67], a[112:115], v[28:31], v[64:67]
  v_mfma_f32_16x16x32_bf16 v[68:71], a[116:119], v[28:31], v[68:71]
  v_mfma_f32_16x16x32_bf16 v[72:75], a[120:123], v[28:31], v[72:75]
  v_mfma_f32_16x16x32_bf16 v[76:79], a[124:127], v[28:31], v[76:79]
  v_mfma_f32_16x16x32_bf16 v[64:67], a[128:131], v[28:31], v[64:67]
  v_mfma_f32_16x16x32_bf16 v[68:71], a[132:135], v[28:31], v[68:71]
  v_mfma_f32_16x16x32_bf16 v[72:75], a[136:139], v[28:31], v[72:75]
  v_mfma_f32_16x16x32_bf16 v[76:79], a[140:143], v[28:31], v[76:79]
  v_mfma_f32_16x16x32_bf16 v[64:67], a[144:147], v[28:31], v[64:67]
  v_mfma_f32_16x16x32_bf16 v[68:71], a[148:151], v[28:31], v[68:71]
  v_mfma_f32_16x16x32_bf16 v[72:75], a[152:155], v[28:31], v[72:75]
  v_mfma_f32_16x16x32_bf16 v[76:79], a[156:159], v[28:31], v[76:79]
  v_mfma_f32_16x16x32_bf16 v[64:67], a[160:163], v[28:31], v[64:67]
  v_mfma_f32_16x16x32_bf16 v[68:71], a[164:167], v[28:31], v[68:71]
  v_mfma_f32_16x16x32_bf16 v[72:75], a[168:171], v[28:31], v[72:75]
  v_mfma_f32_16x16x32_bf16 v[76:79], a[172:175], v[28:31], v[76:79]
  v_mfma_f32_16x16x32_bf16 v[64:67], a[176:179], v[28:31], v[64:67]
  v_mfma_f32_16x16x32_bf16 v[68:71], a[180:183], v[28:31], v[68:71]
  v_mfma_f32_16x16x32_bf16 v[72:75], a[184:187], v[28:31], v[72:75]
  v_mfma_f32_16x16x32_bf16 v[76:79], a[188:191], v[28:31], v[76:79]
  v_mfma_f32_16x16x32_bf16 v[64:67], a[192:195], v[28:31], v[64:67]
  v_mfma_f32_16x16x32_bf16 v[68:71], a[196:199], v[28:31], v[68:71]
  v_mfma_f32_16x16x32_bf16 v[72:75], a[200:203], v[28:31], v[72:75]
  v_mfma_f32_16x16x32_bf16 v[76:79], a[204:207], v[28:31], v[76:79]
  v_mfma_f32_16x16x32_bf16 v[64:67], a[208:211], v[28:31], v[64:67]
  v_mfma_f32_16x16x32_bf16 v[68:71], a[212:215], v[28:31], v[68:71]
  v_mfma_f32_16x16x32_bf16 v[72:75], a[216:219], v[28:31], v[72:75]
  v_mfma_f32_16x16x32_bf16 v[76:79], a[220:223], v[28:31], v[76:79]
  v_mfma_f32_16x16x32_bf16 v[64:67], a[224:227], v[28:31], v[64:67]
  v_mfma_f32_16x16x32_bf16 v[68:71], a[228:231], v[28:31], v[68:71]
  v_mfma_f32_16x16x32_bf16 v[72:75], a[232:235], v[28:31], v[72:75]
  v_mfma_f32_16x16x32_bf16 v[76:79], a[236:239], v[28:31], v[76:79]
  v_mfma_f32_16x16x32_bf16 v[64:67], a[240:243], v[28:31], v[64:67]
  v_mfma_f32_16x16x32_bf16 v[68:71], a[244:247], v[28:31], v[68:71]
  v_mfma_f32_16x16x32_bf16 v[72:75], a[248:251], v[28:31], v[72:75]
  v_mfma_f32_16x16x32_bf16 v[76:79], a[252:255], v[28:31], v[76:79]
  v_or_b32 v2, 0x10000, v0
  s_mul_i32 s27, s25, 4096
  v_add_u32 v3, s27, v0
  v_mov_b32 v4, v3
  s_min_u32 s27, s25, 1
  s_lshl_b32 s27, s27, 10
  v_add_u32 v3, s27, v3
  v_mov_b32 v4, v3
  v_min_u32 v7, 17, v1
  v_lshlrev_b32 v7, 2, v7
  v_lshlrev_b32 v9, 3, v1
  v_mov_b32 v10, 0x40000000
  v_cmp_gt_u32 vcc, 32, v1
  s_nop 1
  v_cndmask_b32 v10, v10, v9, vcc
  v_cndmask_b32 v11, 0, 1.0, vcc
  v_mov_b32 v172, -1
  v_mov_b32 v173, -1
  v_mov_b32 v174, -1
  v_mov_b32 v175, -1
  v_mov_b32 v113, 0x8ff0
  v_cmp_eq_u32 vcc, 16, v0
  s_nop 1
  v_cndmask_b32 v113, 0, v113, vcc
  v_add_u32 v112, v113, v4
  v_mov_b32 v113, 0x40000000
  v_cmp_gt_u32 vcc, 32, v0
  s_nop 1
  v_cndmask_b32 v112, v113, v112, vcc
  v_mov_b32 v113, -1
  s_mov_b32 s57, 0
  v_lshlrev_b32 v114, 3, v0
  s_branch L_dd_spin0
.p2align 6
L_dd_deep0:
  s_waitcnt lgkmcnt(0)
  s_barrier
  v_xor_b32 v2, 0x10000, v2
  v_xor_b32 v3, 0x10000, v3
  ds_read_b128 v[28:31], v2 offset:0
  ds_read_b128 v[32:35], v2 offset:1024
  ds_read_b128 v[40:43], v2 offset:3072
  ds_read_b128 v[36:39], v2 offset:2048
  s_waitcnt lgkmcnt(3)
  v_mfma_f32_16x16x32_bf16 v[12:15], v[224:227], v[28:31], 0
  ds_read_b128 v[180:183], v2 offset:5120
  v_mfma_f32_16x16x32_bf16 v[16:19], v[228:231], v[28:31], 0
  ds_read_b128 v[176:179], v2 offset:4096
  s_add_u32 s37, s36, 2
  v_add_f32 v100, v80, v82
  v_mfma_f32_16x16x32_bf16 v[20:23], v[232:235], v[28:31], 0
  s_add_u32 s55, s36, 4
  v_add_f32 v101, v84, v86
  v_fmac_f32 v148, v64, v164
  v_mfma_f32_16x16x32_bf16 v[24:27], v[236:239], v[28:31], 0
  s_mul_i32 s38, s55, 18432
  v_add_f32 v102, v81, v83
  v_fmac_f32 v149, v65, v164
  s_waitcnt lgkmcnt(4)
  v_mfma_f32_16x16x32_bf16 v[12:15], v[240:243], v[32:35], v[12:15]
  s_add_u32 s38, s38, 0x480000
  v_add_f32 v103, v85, v87
  v_fmac_f32 v150, v66, v164
  v_fmac_f32 v151, v67, v164
  v_mfma_f32_16x16x32_bf16 v[16:19], v[244:247], v[32:35], v[16:19]
  s_lshl_b32 s51, s55, 12
  v_add_f32 v100, v100, v88
  v_fmac_f32 v152, v68, v164
  v_mfma_f32_16x16x32_bf16 v[20:23], v[248:251], v[32:35], v[20:23]
  s_add_u32 s51, s51, 0x700000
  v_add_f32 v102, v102, v89
  v_fmac_f32 v153, v69, v164
  v_mfma_f32_16x16x32_bf16 v[24:27], v[252:255], v[32:35], v[24:27]
  s_sub_u32 s56, s38, 0x9000
  v_add_f32 v100, v100, v101
  s_waitcnt lgkmcnt(2)
  v_mfma_f32_16x16x32_bf16 v[12:15], a[0:3], v[36:39], v[12:15]
  ds_read_b128 v[32:35], v2 offset:7168
  s_cmp_lt_u32 s55, 100
  v_add_f32 v102, v102, v103
  v_mfma_f32_16x16x32_bf16 v[16:19], a[4:7], v[36:39], v[16:19]
  ds_read_b128 v[28:31], v2 offset:6144
  s_cselect_b32 s54, 1, 0
  v_mov_b32 v101, v100
  v_fmac_f32 v154, v70, v164
  v_mfma_f32_16x16x32_bf16 v[20:23], a[8:11], v[36:39], v[20:23]
  s_cselect_b32 s38, s38, 0x40000000
  v_permlane32_swap_b32 v100, v101
  v_mfma_f32_16x16x32_bf16 v[24:27], a[12:15], v[36:39], v[24:27]
  s_cselect_b32 s51, s51, 0x40000000
  v_add_f32 v100, v100, v101
  v_fmac_f32 v155, v71, v164
  v_mfma_f32_16x16x32_bf16 v[12:15], a[16:19], v[40:43], v[12:15]
  s_add_u32 s39, s38, 4096
  v_mov_b32 v101, v100
  v_fmac_f32 v156, v72, v164
  v_mfma_f32_16x16x32_bf16 v[16:19], a[20:23], v[40:43], v[16:19]
  v_permlane16_swap_b32 v100, v101
  v_fmac_f32 v157, v73, v164
  v_mfma_f32_16x16x32_bf16 v[20:23], a[24:27], v[40:43], v[20:23]
  v_add_f32 v100, v100, v101
  buffer_load_dwordx4 v[44:47], v4, s[4:7], s38 offen offset:0 sc1
  v_mfma_f32_16x16x32_bf16 v[24:27], a[28:31], v[40:43], v[24:27]
  v_mul_f32 v101, 0xbd638e39, v100
  v_fmac_f32 v158, v74, v164
  s_waitcnt lgkmcnt(2)
  v_mfma_f32_16x16x32_bf16 v[12:15], a[32:35], v[176:179], v[12:15]
  ds_read_b128 v[40:43], v2 offset:9216
  v_add_f32 v80, v80, v101
  v_fmac_f32 v159, v75, v164
  v_mfma_f32_16x16x32_bf16 v[16:19], a[36:39], v[176:179], v[16:19]
  ds_read_b128 v[36:39], v2 offset:8192
  v_add_f32 v82, v82, v101
  v_fmac_f32 v160, v76, v164
  v_mfma_f32_16x16x32_bf16 v[20:23], a[40:43], v[176:179], v[20:23]
  v_add_f32 v84, v84, v101
  v_fmac_f32 v161, v77, v164
  v_fmac_f32 v162, v78, v164
  v_mfma_f32_16x16x32_bf16 v[24:27], a[44:47], v[176:179], v[24:27]
  v_add_f32 v86, v86, v101
  buffer_load_dwordx4 v[48:51], v4, s[4:7], s38 offen offset:1024 sc1
  v_mfma_f32_16x16x32_bf16 v[12:15], a[48:51], v[180:183], v[12:15]
  v_add_f32 v88, v88, v101
  v_fmac_f32 v163, v79, v164
  v_max_f32 v148, 0, v148
  v_mfma_f32_16x16x32_bf16 v[16:19], a[52:55], v[180:183], v[16:19]
  v_mul_f32 v88, v88, v11
  v_max_f32 v149, 0, v149
  v_max_f32 v150, 0, v150
  v_mfma_f32_16x16x32_bf16 v[20:23], a[56:59], v[180:183], v[20:23]
  v_mul_f32 v103, v80, v80
  v_max_f32 v151, 0, v151
  v_max_f32 v152, 0, v152
  v_mfma_f32_16x16x32_bf16 v[24:27], a[60:63], v[180:183], v[24:27]
  v_fmac_f32 v103, v82, v82
  v_max_f32 v153, 0, v153
  s_waitcnt lgkmcnt(2)
  v_mfma_f32_16x16x32_bf16 v[12:15], a[64:67], v[28:31], v[12:15]
  ds_read_b128 v[180:183], v2 offset:11264
  v_fmac_f32 v103, v84, v84
  v_max_f32 v154, 0, v154
  v_max_f32 v155, 0, v155
  v_mfma_f32_16x16x32_bf16 v[16:19], a[68:71], v[28:31], v[16:19]
  ds_read_b128 v[176:179], v2 offset:10240
  v_fmac_f32 v103, v86, v86
  v_mul_f32 v156, v156, v166
  v_mfma_f32_16x16x32_bf16 v[20:23], a[72:75], v[28:31], v[20:23]
  v_fmac_f32 v103, v88, v88
  v_mul_f32 v157, v157, v166
  v_mul_f32 v158, v158, v166
  v_mfma_f32_16x16x32_bf16 v[24:27], a[76:79], v[28:31], v[24:27]
  buffer_load_dwordx4 v[52:55], v4, s[4:7], s38 offen offset:2048 sc1
  v_mfma_f32_16x16x32_bf16 v[12:15], a[80:83], v[32:35], v[12:15]
  v_mul_f32 v159, v159, v166
  v_mul_f32 v160, v160, v166
  v_fmac_f32 v102, 0x3d000000, v103
  v_mfma_f32_16x16x32_bf16 v[16:19], a[84:87], v[32:35], v[16:19]
  v_mul_f32 v161, v161, v166
  v_mul_f32 v162, v162, v166
  v_mov_b32 v101, v102
  v_mfma_f32_16x16x32_bf16 v[20:23], a[88:91], v[32:35], v[20:23]
  v_mul_f32 v163, v163, v166
  v_mul_f32 v148, v148, v156
  v_mfma_f32_16x16x32_bf16 v[24:27], a[92:95], v[32:35], v[24:27]
  v_mul_f32 v149, v149, v157
  v_mul_f32 v150, v150, v158
  s_waitcnt lgkmcnt(2)
  v_mfma_f32_16x16x32_bf16 v[12:15], a[96:99], v[36:39], v[12:15]
  ds_read_b128 v[32:35], v2 offset:13312
  v_mul_f32 v151, v151, v159
  v_mul_f32 v152, v152, v160
  v_mfma_f32_16x16x32_bf16 v[16:19], a[100:103], v[36:39], v[16:19]
  ds_read_b128 v[28:31], v2 offset:12288
  v_mul_f32 v153, v153, v161
  v_mul_f32 v154, v154, v162
  v_mfma_f32_16x16x32_bf16 v[20:23], a[104:107], v[36:39], v[20:23]
  buffer_load_dwordx4 v[56:59], v4, s[4:7], s38 offen offset:3072 sc1
  v_mul_f32 v155, v155, v163
  v_mfma_f32_16x16x32_bf16 v[24:27], a[108:111], v[36:39], v[24:27]
  v_cvt_pk_bf16_f32 v168, v148, v149
  v_cvt_pk_bf16_f32 v169, v150, v151
  v_mfma_f32_16x16x32_bf16 v[12:15], a[112:115], v[40:43], v[12:15]
  v_cvt_pk_bf16_f32 v170, v152, v153
  v_cvt_pk_bf16_f32 v171, v154, v155
  v_mfma_f32_16x16x32_bf16 v[16:19], a[116:119], v[40:43], v[16:19]
  v_min_u32 v168, -2, v168
  v_permlane32_swap_b32 v102, v101
  v_mfma_f32_16x16x32_bf16 v[20:23], a[120:123], v[40:43], v[20:23]
  buffer_load_dwordx4 v[60:63], v4, s[4:7], s39 offen offset:0 sc1
  v_mfma_f32_16x16x32_bf16 v[24:27], a[124:127], v[40:43], v[24:27]
  v_add_f32 v102, v102, v101
  s_waitcnt lgkmcnt(2)
  v_mfma_f32_16x16x32_bf16 v[12:15], a[128:131], v[176:179], v[12:15]
  ds_read_b128 v[40:43], v2 offset:15360
  v_mov_b32 v101, v102
  v_mfma_f32_16x16x32_bf16 v[16:19], a[132:135], v[176:179], v[16:19]
  ds_read_b128 v[36:39], v2 offset:14336
  v_permlane16_swap_b32 v102, v101
  v_mfma_f32_16x16x32_bf16 v[20:23], a[136:139], v[176:179], v[20:23]
  buffer_load_dwordx2 v[80:81], v9, s[4:7], s51 offen offset:0 sc1
  v_mfma_f32_16x16x32_bf16 v[24:27], a[140:143], v[176:179], v[24:27]
  v_add_f32 v102, v102, v101
  v_mfma_f32_16x16x32_bf16 v[12:15], a[144:147], v[180:183], v[12:15]
  s_waitcnt vmcnt(6)
  buffer_load_dwordx2 v[82:83], v9, s[4:7], s51 offen offset:512 sc1
  v_mfma_f32_16x16x32_bf16 v[16:19], a[148:151], v[180:183], v[16:19]
  v_max_u32 v8, v136, v138
  v_max3_u32 v8, v8, v140, v142
  v_mul_f32 v100, 0xbae38e39, v100
  v_mfma_f32_16x16x32_bf16 v[20:23], a[152:155], v[180:183], v[20:23]
  buffer_load_dwordx2 v[84:85], v9, s[4:7], s51 offen offset:1024 sc1
  v_mfma_f32_16x16x32_bf16 v[24:27], a[156:159], v[180:183], v[24:27]
  v_max3_u32 v8, v8, v144, v116
  v_max3_u32 v8, v8, v120, v124
  s_waitcnt lgkmcnt(2)
  v_mfma_f32_16x16x32_bf16 v[12:15], a[160:163], v[28:31], v[12:15]
  ds_read_b128 v[180:183], v2 offset:17408
  v_max3_u32 v8, v8, v128, v132
  v_cmp_eq_u32 vcc, -1, v8
  v_mfma_f32_16x16x32_bf16 v[16:19], a[164:167], v[28:31], v[16:19]
  ds_read_b128 v[176:179], v2 offset:16384
  buffer_load_dwordx2 v[86:87], v9, s[4:7], s51 offen offset:1536 sc1
  v_mfma_f32_16x16x32_bf16 v[20:23], a[168:171], v[28:31], v[20:23]
  ds_write_b128 v3, v[116:119] offset:0
  v_mfma_f32_16x16x32_bf16 v[24:27], a[172:175], v[28:31], v[24:27]
  buffer_load_dwordx2 v[88:89], v10, s[4:7], s51 offen offset:2048 sc1
  v_mfma_f32_16x16x32_bf16 v[12:15], a[176:179], v[32:35], v[12:15]
  s_cmp_eq_u64 vcc, 0
  s_cselect_b32 s52, s53, 0
  s_mov_b32 s53, s54
  v_mfma_f32_16x16x32_bf16 v[16:19], a[180:183], v[32:35], v[16:19]
  buffer_store_dwordx4 v[168:171], v0, s[4:7], s45 offen sc1
  v_mfma_f32_16x16x32_bf16 v[20:23], a[184:187], v[32:35], v[20:23]
  ds_write_b128 v3, v[120:123] offset:1024
  v_cvt_pk_bf16_f32 v100, v100, v100
  v_mfma_f32_16x16x32_bf16 v[24:27], a[188:191], v[32:35], v[24:27]
  v_and_b32 v100, 0xffff0000, v100
  s_waitcnt lgkmcnt(4)
  v_mfma_f32_16x16x32_bf16 v[12:15], a[192:195], v[36:39], v[12:15]
  v_mul_f32 v102, 0x3ae38e39, v102
  v_mfma_f32_16x16x32_bf16 v[16:19], a[196:199], v[36:39], v[16:19]
  buffer_store_dwordx4 v[172:175], v0, s[4:7], s59 offen sc1
  v_mfma_f32_16x16x32_bf16 v[20:23], a[200:203], v[36:39], v[20:23]
  ds_write_b128 v3, v[124:127] offset:2048
  v_mfma_f32_16x16x32_bf16 v[24:27], a[204:207], v[36:39], v[24:27]
  v_cvt_pk_bf16_f32 v102, v102, v102
  s_mul_i32 s45, s36, 144
  s_add_u32 s45, s45, s50
  v_mfma_f32_16x16x32_bf16 v[12:15], a[208:211], v[40:43], v[12:15]
  v_and_b32 v102, 0xffff0000, v102
  s_lshl_b32 s45, s45, 10
  s_add_u32 s45, s45, 0x5000000
  v_mfma_f32_16x16x32_bf16 v[16:19], a[212:215], v[40:43], v[16:19]
  v_add_f32 v102, 0x3727c5ac, v102
  s_add_u32 s59, s45, 0x1b0000
  v_mfma_f32_16x16x32_bf16 v[20:23], a[216:219], v[40:43], v[20:23]
  ds_write_b128 v3, v[128:131] offset:3072
  v_mfma_f32_16x16x32_bf16 v[24:27], a[220:223], v[40:43], v[24:27]
  v_cvt_pk_bf16_f32 v102, v102, v102
  s_cmp_lt_u32 s36, 116
  s_cselect_b32 s59, s59, 0x40000000
  s_waitcnt lgkmcnt(4)
  v_mfma_f32_16x16x32_bf16 v[12:15], a[224:227], v[176:179], v[12:15]
  v_and_b32 v102, 0xffff0000, v102
  v_mfma_f32_16x16x32_bf16 v[16:19], a[228:231], v[176:179], v[16:19]
  v_sqrt_f32 v102, v102
  v_mfma_f32_16x16x32_bf16 v[20:23], a[232:235], v[176:179], v[20:23]
  ds_write_b128 v3, v[132:135] offset:4096
  v_mfma_f32_16x16x32_bf16 v[24:27], a[236:239], v[176:179], v[24:27]
  v_cvt_pk_bf16_f32 v102, v102, v102
  v_mfma_f32_16x16x32_bf16 v[12:15], a[240:243], v[180:183], v[12:15]
  v_and_b32 v102, 0xffff0000, v102
  v_mfma_f32_16x16x32_bf16 v[16:19], a[244:247], v[180:183], v[16:19]
  v_rcp_f32 v102, v102
  buffer_load_dword v113, v112, s[4:7], s56 offen sc1
  v_mfma_f32_16x16x32_bf16 v[20:23], a[248:251], v[180:183], v[20:23]
  v_mul_f32 v102, v102, v102
  v_mfma_f32_16x16x32_bf16 v[24:27], a[252:255], v[180:183], v[24:27]
  s_mov_b32 s36, s37
  s_cmp_eq_u32 s52, 1
  s_cbranch_scc1 L_dd_deep1
  s_mov_b32 s57, 0
  s_branch L_dd_fin0
.p2align 6
L_dd_deep1:
  s_waitcnt lgkmcnt(0)
  s_barrier
  v_xor_b32 v2, 0x10000, v2
  v_xor_b32 v3, 0x10000, v3
  ds_read_b128 v[28:31], v2 offset:0
  ds_read_b128 v[32:35], v2 offset:1024
  ds_read_b128 v[40:43], v2 offset:3072
  ds_read_b128 v[36:39], v2 offset:2048
  s_waitcnt lgkmcnt(3)
  v_mfma_f32_16x16x32_bf16 v[148:151], v[224:227], v[28:31], 0
  ds_read_b128 v[180:183], v2 offset:5120
  v_mfma_f32_16x16x32_bf16 v[152:155], v[228:231], v[28:31], 0
  ds_read_b128 v[176:179], v2 offset:4096
  s_add_u32 s37, s36, 2
  v_add_f32 v164, v136, v138
  v_mfma_f32_16x16x32_bf16 v[156:159], v[232:235], v[28:31], 0
  s_add_u32 s55, s36, 4
  v_add_f32 v165, v140, v142
  v_fmac_f32 v12, v64, v100
  v_mfma_f32_16x16x32_bf16 v[160:163], v[236:239], v[28:31], 0
  s_mul_i32 s38, s55, 18432
  v_add_f32 v166, v137, v139
  v_fmac_f32 v13, v65, v100
  s_waitcnt lgkmcnt(4)
  v_mfma_f32_16x16x32_bf16 v[148:151], v[240:243], v[32:35], v[148:151]
  s_add_u32 s38, s38, 0x480000
  v_add_f32 v167, v141, v143
  v_fmac_f32 v14, v66, v100
  v_fmac_f32 v15, v67, v100
  v_mfma_f32_16x16x32_bf16 v[152:155], v[244:247], v[32:35], v[152:155]
  s_lshl_b32 s51, s55, 12
  v_add_f32 v164, v164, v144
  v_fmac_f32 v16, v68, v100
  v_mfma_f32_16x16x32_bf16 v[156:159], v[248:251], v[32:35], v[156:159]
  s_add_u32 s51, s51, 0x700000
  v_add_f32 v166, v166, v145
  v_fmac_f32 v17, v69, v100
  v_mfma_f32_16x16x32_bf16 v[160:163], v[252:255], v[32:35], v[160:163]
  s_sub_u32 s56, s38, 0x9000
  v_add_f32 v164, v164, v165
  s_waitcnt lgkmcnt(2)
  v_mfma_f32_16x16x32_bf16 v[148:151], a[0:3], v[36:39], v[148:151]
  ds_read_b128 v[32:35], v2 offset:7168
  s_cmp_lt_u32 s55, 100
  v_add_f32 v166, v166, v167
  v_mfma_f32_16x16x32_bf16 v[152:155], a[4:7], v[36:39], v[152:155]
  ds_read_b128 v[28:31], v2 offset:6144
  s_cselect_b32 s54, 1, 0
  v_mov_b32 v165, v164
  v_fmac_f32 v18, v70, v100
  v_mfma_f32_16x16x32_bf16 v[156:159], a[8:11], v[36:39], v[156:159]
  s_cselect_b32 s38, s38, 0x40000000
  v_permlane32_swap_b32 v164, v165
  v_mfma_f32_16x16x32_bf16 v[160:163], a[12:15], v[36:39], v[160:163]
  s_cselect_b32 s51, s51, 0x40000000
  v_add_f32 v164, v164, v165
  v_fmac_f32 v19, v71, v100
  v_mfma_f32_16x16x32_bf16 v[148:151], a[16:19], v[40:43], v[148:151]
  s_add_u32 s39, s38, 4096
  v_mov_b32 v165, v164
  v_fmac_f32 v20, v72, v100
  v_mfma_f32_16x16x32_bf16 v[152:155], a[20:23], v[40:43], v[152:155]
  v_permlane16_swap_b32 v164, v165
  v_fmac_f32 v21, v73, v100
  v_mfma_f32_16x16x32_bf16 v[156:159], a[24:27], v[40:43], v[156:159]
  v_add_f32 v164, v164, v165
  buffer_load_dwordx4 v[116:119], v4, s[4:7], s38 offen offset:0 sc1
  v_mfma_f32_16x16x32_bf16 v[160:163], a[28:31], v[40:43], v[160:163]
  v_mul_f32 v165, 0xbd638e39, v164
  v_fmac_f32 v22, v74, v100
  s_waitcnt lgkmcnt(2)
  v_mfma_f32_16x16x32_bf16 v[148:151], a[32:35], v[176:179], v[148:151]
  ds_read_b128 v[40:43], v2 offset:9216
  v_add_f32 v136, v136, v165
  v_fmac_f32 v23, v75, v100
  v_mfma_f32_16x16x32_bf16 v[152:155], a[36:39], v[176:179], v[152:155]
  ds_read_b128 v[36:39], v2 offset:8192
  v_add_f32 v138, v138, v165
  v_fmac_f32 v24, v76, v100
  v_mfma_f32_16x16x32_bf16 v[156:159], a[40:43], v[176:179], v[156:159]
  v_add_f32 v140, v140, v165
  v_fmac_f32 v25, v77, v100
  v_fmac_f32 v26, v78, v100
  v_mfma_f32_16x16x32_bf16 v[160:163], a[44:47], v[176:179], v[160:163]
  v_add_f32 v142, v142, v165
  buffer_load_dwordx4 v[120:123], v4, s[4:7], s38 offen offset:1024 sc1
  v_mfma_f32_16x16x32_bf16 v[148:151], a[48:51], v[180:183], v[148:151]
  v_add_f32 v144, v144, v165
  v_fmac_f32 v27, v79, v100
  v_max_f32 v12, 0, v12
  v_mfma_f32_16x16x32_bf16 v[152:155], a[52:55], v[180:183], v[152:155]
  v_mul_f32 v144, v144, v11
  v_max_f32 v13, 0, v13
  v_max_f32 v14, 0, v14
  v_mfma_f32_16x16x32_bf16 v[156:159], a[56:59], v[180:183], v[156:159]
  v_mul_f32 v167, v136, v136
  v_max_f32 v15, 0, v15
  v_max_f32 v16, 0, v16
  v_mfma_f32_16x16x32_bf16 v[160:163], a[60:63], v[180:183], v[160:163]
  v_fmac_f32 v167, v138, v138
  v_max_f32 v17, 0, v17
  s_waitcnt lgkmcnt(2)
  v_mfma_f32_16x16x32_bf16 v[148:151], a[64:67], v[28:31], v[148:151]
  ds_read_b128 v[180:183], v2 offset:11264
  v_fmac_f32 v167, v140, v140
  v_max_f32 v18, 0, v18
  v_max_f32 v19, 0, v19
  v_mfma_f32_16x16x32_bf16 v[152:155], a[68:71], v[28:31], v[152:155]
  ds_read_b128 v[176:179], v2 offset:10240
  v_fmac_f32 v167, v142, v142
  v_mul_f32 v20, v20, v102
  v_mfma_f32_16x16x32_bf16 v[156:159], a[72:75], v[28:31], v[156:159]
  v_fmac_f32 v167, v144, v144
  v_mul_f32 v21, v21, v102
  v_mul_f32 v22, v22, v102
  v_mfma_f32_16x16x32_bf16 v[160:163], a[76:79], v[28:31], v[160:163]
  buffer_load_dwordx4 v[124:127], v4, s[4:7], s38 offen offset:2048 sc1
  v_mfma_f32_16x16x32_bf16 v[148:151], a[80:83], v[32:35], v[148:151]
  v_mul_f32 v23, v23, v102
  v_mul_f32 v24, v24, v102
  v_fmac_f32 v166, 0x3d000000, v167
  v_mfma_f32_16x16x32_bf16 v[152:155], a[84:87], v[32:35], v[152:155]
  v_mul_f32 v25, v25, v102
  v_mul_f32 v26, v26, v102
  v_mov_b32 v165, v166
  v_mfma_f32_16x16x32_bf16 v[156:159], a[88:91], v[32:35], v[156:159]
  v_mul_f32 v27, v27, v102
  v_mul_f32 v12, v12, v20
  v_mfma_f32_16x16x32_bf16 v[160:163], a[92:95], v[32:35], v[160:163]
  v_mul_f32 v13, v13, v21
  v_mul_f32 v14, v14, v22
  s_waitcnt lgkmcnt(2)
  v_mfma_f32_16x16x32_bf16 v[148:151], a[96:99], v[36:39], v[148:151]
  ds_read_b128 v[32:35], v2 offset:13312
  v_mul_f32 v15, v15, v23
  v_mul_f32 v16, v16, v24
  v_mfma_f32_16x16x32_bf16 v[152:155], a[100:103], v[36:39], v[152:155]
  ds_read_b128 v[28:31], v2 offset:12288
  v_mul_f32 v17, v17, v25
  v_mul_f32 v18, v18, v26
  v_mfma_f32_16x16x32_bf16 v[156:159], a[104:107], v[36:39], v[156:159]
  buffer_load_dwordx4 v[128:131], v4, s[4:7], s38 offen offset:3072 sc1
  v_mul_f32 v19, v19, v27
  v_mfma_f32_16x16x32_bf16 v[160:163], a[108:111], v[36:39], v[160:163]
  v_cvt_pk_bf16_f32 v104, v12, v13
  v_cvt_pk_bf16_f32 v105, v14, v15
  v_mfma_f32_16x16x32_bf16 v[148:151], a[112:115], v[40:43], v[148:151]
  v_cvt_pk_bf16_f32 v106, v16, v17
  v_cvt_pk_bf16_f32 v107, v18, v19
  v_mfma_f32_16x16x32_bf16 v[152:155], a[116:119], v[40:43], v[152:155]
  v_min_u32 v104, -2, v104
  v_permlane32_swap_b32 v166, v165
  v_mfma_f32_16x16x32_bf16 v[156:159], a[120:123], v[40:43], v[156:159]
  buffer_load_dwordx4 v[132:135], v4, s[4:7], s39 offen offset:0 sc1
  v_mfma_f32_16x16x32_bf16 v[160:163], a[124:127], v[40:43], v[160:163]
  v_add_f32 v166, v166, v165
  s_waitcnt lgkmcnt(2)
  v_mfma_f32_16x16x32_bf16 v[148:151], a[128:131], v[176:179], v[148:151]
  ds_read_b128 v[40:43], v2 offset:15360
  v_mov_b32 v165, v166
  v_mfma_f32_16x16x32_bf16 v[152:155], a[132:135], v[176:179], v[152:155]
  ds_read_b128 v[36:39], v2 offset:14336
  v_permlane16_swap_b32 v166, v165
  v_mfma_f32_16x16x32_bf16 v[156:159], a[136:139], v[176:179], v[156:159]
  buffer_load_dwordx2 v[136:137], v9, s[4:7], s51 offen offset:0 sc1
  v_mfma_f32_16x16x32_bf16 v[160:163], a[140:143], v[176:179], v[160:163]
  v_add_f32 v166, v166, v165
  v_mfma_f32_16x16x32_bf16 v[148:151], a[144:147], v[180:183], v[148:151]
  s_waitcnt vmcnt(6)
  buffer_load_dwordx2 v[138:139], v9, s[4:7], s51 offen offset:512 sc1
  v_mfma_f32_16x16x32_bf16 v[152:155], a[148:151], v[180:183], v[152:155]
  v_max_u32 v8, v80, v82
  v_max3_u32 v8, v8, v84, v86
  v_mul_f32 v164, 0xbae38e39, v164
  v_mfma_f32_16x16x32_bf16 v[156:159], a[152:155], v[180:183], v[156:159]
  buffer_load_dwordx2 v[140:141], v9, s[4:7], s51 offen offset:1024 sc1
  v_mfma_f32_16x16x32_bf16 v[160:163], a[156:159], v[180:183], v[160:163]
  v_max3_u32 v8, v8, v88, v44
  v_max3_u32 v8, v8, v48, v52
  s_waitcnt lgkmcnt(2)
  v_mfma_f32_16x16x32_bf16 v[148:151], a[160:163], v[28:31], v[148:151]
  ds_read_b128 v[180:183], v2 offset:17408
  v_max3_u32 v8, v8, v56, v60
  v_cmp_eq_u32 vcc, -1, v8
  v_mfma_f32_16x16x32_bf16 v[152:155], a[164:167], v[28:31], v[152:155]
  ds_read_b128 v[176:179], v2 offset:16384
  buffer_load_dwordx2 v[142:143], v9, s[4:7], s51 offen offset:1536 sc1
  v_mfma_f32_16x16x32_bf16 v[156:159], a[168:171], v[28:31], v[156:159]
  ds_write_b128 v3, v[44:47] offset:0
  v_mfma_f32_16x16x32_bf16 v[160:163], a[172:175], v[28:31], v[160:163]
  buffer_load_dwordx2 v[144:145], v10, s[4:7], s51 offen offset:2048 sc1
  v_mfma_f32_16x16x32_bf16 v[148:151], a[176:179], v[32:35], v[148:151]
  s_cmp_eq_u64 vcc, 0
  s_cselect_b32 s52, s53, 0
  s_mov_b32 s53, s54
  v_mfma_f32_16x16x32_bf16 v[152:155], a[180:183], v[32:35], v[152:155]
  buffer_store_dwordx4 v[104:107], v0, s[4:7], s45 offen sc1
  v_mfma_f32_16x16x32_bf16 v[156:159], a[184:187], v[32:35], v[156:159]
  ds_write_b128 v3, v[48:51] offset:1024
  v_cvt_pk_bf16_f32 v164, v164, v164
  v_mfma_f32_16x16x32_bf16 v[160:163], a[188:191], v[32:35], v[160:163]
  v_and_b32 v164, 0xffff0000, v164
  s_waitcnt lgkmcnt(4)
  v_mfma_f32_16x16x32_bf16 v[148:151], a[192:195], v[36:39], v[148:151]
  v_mul_f32 v166, 0x3ae38e39, v166
  v_mfma_f32_16x16x32_bf16 v[152:155], a[196:199], v[36:39], v[152:155]
  buffer_store_dwordx4 v[172:175], v0, s[4:7], s59 offen sc1
  v_mfma_f32_16x16x32_bf16 v[156:159], a[200:203], v[36:39], v[156:159]
  ds_write_b128 v3, v[52:55] offset:2048
  v_mfma_f32_16x16x32_bf16 v[160:163], a[204:207], v[36:39], v[160:163]
  v_cvt_pk_bf16_f32 v166, v166, v166
  s_mul_i32 s45, s36, 144
  s_add_u32 s45, s45, s50
  v_mfma_f32_16x16x32_bf16 v[148:151], a[208:211], v[40:43], v[148:151]
  v_and_b32 v166, 0xffff0000, v166
  s_lshl_b32 s45, s45, 10
  s_add_u32 s45, s45, 0x5000000
  v_mfma_f32_16x16x32_bf16 v[152:155], a[212:215], v[40:43], v[152:155]
  v_add_f32 v166, 0x3727c5ac, v166
  s_add_u32 s59, s45, 0x1b0000
  v_mfma_f32_16x16x32_bf16 v[156:159], a[216:219], v[40:43], v[156:159]
  ds_write_b128 v3, v[56:59] offset:3072
  v_mfma_f32_16x16x32_bf16 v[160:163], a[220:223], v[40:43], v[160:163]
  v_cvt_pk_bf16_f32 v166, v166, v166
  s_cmp_lt_u32 s36, 116
  s_cselect_b32 s59, s59, 0x40000000
  s_waitcnt lgkmcnt(4)
  v_mfma_f32_16x16x32_bf16 v[148:151], a[224:227], v[176:179], v[148:151]
  v_and_b32 v166, 0xffff0000, v166
  v_mfma_f32_16x16x32_bf16 v[152:155], a[228:231], v[176:179], v[152:155]
  v_sqrt_f32 v166, v166
  v_mfma_f32_16x16x32_bf16 v[156:159], a[232:235], v[176:179], v[156:159]
  ds_write_b128 v3, v[60:63] offset:4096
  v_mfma_f32_16x16x32_bf16 v[160:163], a[236:239], v[176:179], v[160:163]
  v_cvt_pk_bf16_f32 v166, v166, v166
  v_mfma_f32_16x16x32_bf16 v[148:151], a[240:243], v[180:183], v[148:151]
  v_and_b32 v166, 0xffff0000, v166
  v_mfma_f32_16x16x32_bf16 v[152:155], a[244:247], v[180:183], v[152:155]
  v_rcp_f32 v166, v166
  buffer_load_dword v113, v112, s[4:7], s56 offen sc1
  v_mfma_f32_16x16x32_bf16 v[156:159], a[248:251], v[180:183], v[156:159]
  v_mul_f32 v166, v166, v166
  v_mfma_f32_16x16x32_bf16 v[160:163], a[252:255], v[180:183], v[160:163]
  s_mov_b32 s36, s37
  s_cmp_eq_u32 s52, 1
  s_cbranch_scc1 L_dd_deep0
  s_mov_b32 s57, 0
  s_branch L_dd_fin1
.p2align 6
L_dd_go0:
  s_waitcnt lgkmcnt(0)
  s_barrier
  v_xor_b32 v2, 0x10000, v2
  v_xor_b32 v3, 0x10000, v3
  ds_read_b128 v[28:31], v2 offset:0
  ds_read_b128 v[32:35], v2 offset:1024
  ds_read_b128 v[40:43], v2 offset:3072
  ds_read_b128 v[36:39], v2 offset:2048
  s_waitcnt lgkmcnt(3)
  v_mfma_f32_16x16x32_bf16 v[12:15], v[224:227], v[28:31], 0
  ds_read_b128 v[180:183], v2 offset:5120
  v_mfma_f32_16x16x32_bf16 v[16:19], v[228:231], v[28:31], 0
  ds_read_b128 v[176:179], v2 offset:4096
  s_add_u32 s37, s36, 2
  v_mfma_f32_16x16x32_bf16 v[20:23], v[232:235], v[28:31], 0
  s_mul_i32 s38, s37, 18432
  v_add_f32 v100, v80, v82
  v_mfma_f32_16x16x32_bf16 v[24:27], v[236:239], v[28:31], 0
  s_add_u32 s38, s38, 0x480000
  v_add_f32 v101, v84, v86
  s_waitcnt lgkmcnt(4)
  v_mfma_f32_16x16x32_bf16 v[12:15], v[240:243], v[32:35], v[12:15]
  s_lshl_b32 s51, s37, 12
  v_add_f32 v102, v81, v83
  v_mfma_f32_16x16x32_bf16 v[16:19], v[244:247], v[32:35], v[16:19]
  s_add_u32 s51, s51, 0x700000
  v_add_f32 v103, v85, v87
  v_mfma_f32_16x16x32_bf16 v[20:23], v[248:251], v[32:35], v[20:23]
  s_sub_u32 s56, s38, 0x0
  v_add_f32 v100, v100, v88
  v_mfma_f32_16x16x32_bf16 v[24:27], v[252:255], v[32:35], v[24:27]
  s_cmp_lt_u32 s37, 128
  s_waitcnt lgkmcnt(2)
  v_mfma_f32_16x16x32_bf16 v[12:15], a[0:3], v[36:39], v[12:15]
  ds_read_b128 v[32:35], v2 offset:7168
  s_cselect_b32 s38, s38, 0x40000000
  v_mfma_f32_16x16x32_bf16 v[16:19], a[4:7], v[36:39], v[16:19]
  ds_read_b128 v[28:31], v2 offset:6144
  s_cselect_b32 s51, s51, 0x40000000
  v_mfma_f32_16x16x32_bf16 v[20:23], a[8:11], v[36:39], v[20:23]
  s_add_u32 s39, s38, 4096
  v_add_f32 v102, v102, v89
  v_mfma_f32_16x16x32_bf16 v[24:27], a[12:15], v[36:39], v[24:27]
  v_add_f32 v100, v100, v101
  s_mul_i32 s45, s36, 144
  v_mfma_f32_16x16x32_bf16 v[12:15], a[16:19], v[40:43], v[12:15]
  v_add_f32 v102, v102, v103
  s_add_u32 s45, s45, s50
  v_mfma_f32_16x16x32_bf16 v[16:19], a[20:23], v[40:43], v[16:19]
  v_mov_b32 v101, v100
  s_lshl_b32 s45, s45, 10
  v_mfma_f32_16x16x32_bf16 v[20:23], a[24:27], v[40:43], v[20:23]
  v_permlane32_swap_b32 v100, v101
  v_mfma_f32_16x16x32_bf16 v[24:27], a[28:31], v[40:43], v[24:27]
  v_add_f32 v100, v100, v101
  s_waitcnt lgkmcnt(2)
  v_mfma_f32_16x16x32_bf16 v[12:15], a[32:35], v[176:179], v[12:15]
  ds_read_b128 v[40:43], v2 offset:9216
  v_mov_b32 v101, v100
  v_mfma_f32_16x16x32_bf16 v[16:19], a[36:39], v[176:179], v[16:19]
  ds_read_b128 v[36:39], v2 offset:8192
  s_add_u32 s45, s45, 0x5000000
  v_mfma_f32_16x16x32_bf16 v[20:23], a[40:43], v[176:179], v[20:23]
  v_permlane16_swap_b32 v100, v101
  v_mfma_f32_16x16x32_bf16 v[24:27], a[44:47], v[176:179], v[24:27]
  v_add_f32 v100, v100, v101
  s_add_u32 s59, s45, 0x1b0000
  v_mfma_f32_16x16x32_bf16 v[12:15], a[48:51], v[180:183], v[12:15]
  v_mul_f32 v101, 0xbd638e39, v100
  v_mfma_f32_16x16x32_bf16 v[16:19], a[52:55], v[180:183], v[16:19]
  v_add_f32 v80, v80, v101
  v_mfma_f32_16x16x32_bf16 v[20:23], a[56:59], v[180:183], v[20:23]
  v_add_f32 v82, v82, v101
  v_mfma_f32_16x16x32_bf16 v[24:27], a[60:63], v[180:183], v[24:27]
  v_add_f32 v84, v84, v101
  s_waitcnt lgkmcnt(2)
  v_mfma_f32_16x16x32_bf16 v[12:15], a[64:67], v[28:31], v[12:15]
  ds_read_b128 v[180:183], v2 offset:11264
  v_add_f32 v86, v86, v101
  v_mfma_f32_16x16x32_bf16 v[16:19], a[68:71], v[28:31], v[16:19]
  ds_read_b128 v[176:179], v2 offset:10240
  v_add_f32 v88, v88, v101
  v_mfma_f32_16x16x32_bf16 v[20:23], a[72:75], v[28:31], v[20:23]
  v_mul_f32 v88, v88, v11
  v_mfma_f32_16x16x32_bf16 v[24:27], a[76:79], v[28:31], v[24:27]
  v_mul_f32 v103, v80, v80
  v_mfma_f32_16x16x32_bf16 v[12:15], a[80:83], v[32:35], v[12:15]
  v_fmac_f32 v103, v82, v82
  v_mfma_f32_16x16x32_bf16 v[16:19], a[84:87], v[32:35], v[16:19]
  v_fmac_f32 v103, v84, v84
  v_mfma_f32_16x16x32_bf16 v[20:23], a[88:91], v[32:35], v[20:23]
  v_fmac_f32 v103, v86, v86
  v_mfma_f32_16x16x32_bf16 v[24:27], a[92:95], v[32:35], v[24:27]
  v_fmac_f32 v103, v88, v88
  s_waitcnt lgkmcnt(2)
  v_mfma_f32_16x16x32_bf16 v[12:15], a[96:99], v[36:39], v[12:15]
  ds_read_b128 v[32:35], v2 offset:13312
  v_fmac_f32 v102, 0x3d000000, v103
  v_mfma_f32_16x16x32_bf16 v[16:19], a[100:103], v[36:39], v[16:19]
  ds_read_b128 v[28:31], v2 offset:12288
  v_mov_b32 v101, v102
  v_mfma_f32_16x16x32_bf16 v[20:23], a[104:107], v[36:39], v[20:23]
  buffer_load_dwordx4 v[44:47], v4, s[4:7], s38 offen offset:0 sc1
  v_mfma_f32_16x16x32_bf16 v[24:27], a[108:111], v[36:39], v[24:27]
  v_permlane32_swap_b32 v102, v101
  v_mfma_f32_16x16x32_bf16 v[12:15], a[112:115], v[40:43], v[12:15]
  v_add_f32 v102, v102, v101
  v_mfma_f32_16x16x32_bf16 v[16:19], a[116:119], v[40:43], v[16:19]
  v_mov_b32 v101, v102
  v_mfma_f32_16x16x32_bf16 v[20:23], a[120:123], v[40:43], v[20:23]
  buffer_load_dwordx4 v[48:51], v4, s[4:7], s38 offen offset:1024 sc1
  v_mfma_f32_16x16x32_bf16 v[24:27], a[124:127], v[40:43], v[24:27]
  s_waitcnt lgkmcnt(2)
  v_mfma_f32_16x16x32_bf16 v[12:15], a[128:131], v[176:179], v[12:15]
  ds_read_b128 v[40:43], v2 offset:15360
  v_mfma_f32_16x16x32_bf16 v[16:19], a[132:135], v[176:179], v[16:19]
  ds_read_b128 v[36:39], v2 offset:14336
  v_mfma_f32_16x16x32_bf16 v[20:23], a[136:139], v[176:179], v[20:23]
  buffer_load_dwordx4 v[52:55], v4, s[4:7], s38 offen offset:2048 sc1
  v_mfma_f32_16x16x32_bf16 v[24:27], a[140:143], v[176:179], v[24:27]
  v_permlane16_swap_b32 v102, v101
  v_mfma_f32_16x16x32_bf16 v[12:15], a[144:147], v[180:183], v[12:15]
  v_add_f32 v102, v102, v101
  v_mfma_f32_16x16x32_bf16 v[16:19], a[148:151], v[180:183], v[16:19]
  v_mul_f32 v100, 0xbae38e39, v100
  v_mfma_f32_16x16x32_bf16 v[20:23], a[152:155], v[180:183], v[20:23]
  buffer_load_dwordx4 v[56:59], v4, s[4:7], s38 offen offset:3072 sc1
  v_mfma_f32_16x16x32_bf16 v[24:27], a[156:159], v[180:183], v[24:27]
  v_cvt_pk_bf16_f32 v100, v100, v100
  s_waitcnt lgkmcnt(2)
  v_mfma_f32_16x16x32_bf16 v[12:15], a[160:163], v[28:31], v[12:15]
  ds_read_b128 v[180:183], v2 offset:17408
  v_and_b32 v100, 0xffff0000, v100
  v_mfma_f32_16x16x32_bf16 v[16:19], a[164:167], v[28:31], v[16:19]
  ds_read_b128 v[176:179], v2 offset:16384
  v_mul_f32 v102, 0x3ae38e39, v102
  v_mfma_f32_16x16x32_bf16 v[20:23], a[168:171], v[28:31], v[20:23]
  buffer_load_dwordx4 v[60:63], v4, s[4:7], s39 offen offset:0 sc1
  v_mfma_f32_16x16x32_bf16 v[24:27], a[172:175], v[28:31], v[24:27]
  v_cvt_pk_bf16_f32 v102, v102, v102
  v_mfma_f32_16x16x32_bf16 v[12:15], a[176:179], v[32:35], v[12:15]
  v_and_b32 v102, 0xffff0000, v102
  v_mfma_f32_16x16x32_bf16 v[16:19], a[180:183], v[32:35], v[16:19]
  v_add_f32 v102, 0x3727c5ac, v102
  v_mfma_f32_16x16x32_bf16 v[20:23], a[184:187], v[32:35], v[20:23]
  buffer_load_dwordx2 v[80:81], v9, s[4:7], s51 offen offset:0 sc1
  v_mfma_f32_16x16x32_bf16 v[24:27], a[188:191], v[32:35], v[24:27]
  v_cvt_pk_bf16_f32 v102, v102, v102
  s_waitcnt lgkmcnt(2)
  v_mfma_f32_16x16x32_bf16 v[12:15], a[192:195], v[36:39], v[12:15]
  buffer_load_dwordx2 v[82:83], v9, s[4:7], s51 offen offset:512 sc1
  v_mfma_f32_16x16x32_bf16 v[16:19], a[196:199], v[36:39], v[16:19]
  v_and_b32 v102, 0xffff0000, v102
  v_mfma_f32_16x16x32_bf16 v[20:23], a[200:203], v[36:39], v[20:23]
  buffer_load_dwordx2 v[84:85], v9, s[4:7], s51 offen offset:1024 sc1
  v_mfma_f32_16x16x32_bf16 v[24:27], a[204:207], v[36:39], v[24:27]
  v_sqrt_f32 v102, v102
  v_mfma_f32_16x16x32_bf16 v[12:15], a[208:211], v[40:43], v[12:15]
  buffer_load_dwordx2 v[86:87], v9, s[4:7], s51 offen offset:1536 sc1
  v_mfma_f32_16x16x32_bf16 v[16:19], a[212:215], v[40:43], v[16:19]
  v_cvt_pk_bf16_f32 v102, v102, v102
  v_mfma_f32_16x16x32_bf16 v[20:23], a[216:219], v[40:43], v[20:23]
  buffer_load_dwordx2 v[88:89], v10, s[4:7], s51 offen offset:2048 sc1
  v_mfma_f32_16x16x32_bf16 v[24:27], a[220:223], v[40:43], v[24:27]
  v_and_b32 v102, 0xffff0000, v102
  s_waitcnt lgkmcnt(0)
  v_mfma_f32_16x16x32_bf16 v[12:15], a[224:227], v[176:179], v[12:15]
  v_rcp_f32 v102, v102
  v_mfma_f32_16x16x32_bf16 v[16:19], a[228:231], v[176:179], v[16:19]
  v_mul_f32 v102, v102, v102
  v_mfma_f32_16x16x32_bf16 v[20:23], a[232:235], v[176:179], v[20:23]
  s_cmp_lt_u32 s36, 116
  s_cselect_b32 s59, s59, 0x40000000
  v_mfma_f32_16x16x32_bf16 v[24:27], a[236:239], v[176:179], v[24:27]
  buffer_load_dword v113, v112, s[4:7], s56 offen sc1
  v_mfma_f32_16x16x32_bf16 v[12:15], a[240:243], v[180:183], v[12:15]
  v_mfma_f32_16x16x32_bf16 v[16:19], a[244:247], v[180:183], v[16:19]
  v_mfma_f32_16x16x32_bf16 v[20:23], a[248:251], v[180:183], v[20:23]
  v_mfma_f32_16x16x32_bf16 v[24:27], a[252:255], v[180:183], v[24:27]
  s_mov_b32 s36, s37
  s_mov_b32 s57, 1
L_dd_fin0:
  v_pk_fma_f32 v[12:13], v[64:65], v[100:101], v[12:13] op_sel_hi:[1,0,1]
  v_pk_fma_f32 v[14:15], v[66:67], v[100:101], v[14:15] op_sel_hi:[1,0,1]
  v_pk_fma_f32 v[16:17], v[68:69], v[100:101], v[16:17] op_sel_hi:[1,0,1]
  v_pk_fma_f32 v[18:19], v[70:71], v[100:101], v[18:19] op_sel_hi:[1,0,1]
  v_pk_fma_f32 v[20:21], v[72:73], v[100:101], v[20:21] op_sel_hi:[1,0,1]
  v_pk_fma_f32 v[22:23], v[74:75], v[100:101], v[22:23] op_sel_hi:[1,0,1]
  v_pk_fma_f32 v[24:25], v[76:77], v[100:101], v[24:25] op_sel_hi:[1,0,1]
  v_pk_fma_f32 v[26:27], v[78:79], v[100:101], v[26:27] op_sel_hi:[1,0,1]
  v_max_f32 v12, 0, v12
  v_max_f32 v13, 0, v13
  v_max_f32 v14, 0, v14
  v_max_f32 v15, 0, v15
  v_max_f32 v16, 0, v16
  v_max_f32 v17, 0, v17
  v_max_f32 v18, 0, v18
  v_max_f32 v19, 0, v19
  v_pk_mul_f32 v[20:21], v[20:21], v[102:103] op_sel_hi:[1,0]
  v_pk_mul_f32 v[22:23], v[22:23], v[102:103] op_sel_hi:[1,0]
  v_pk_mul_f32 v[24:25], v[24:25], v[102:103] op_sel_hi:[1,0]
  v_pk_mul_f32 v[26:27], v[26:27], v[102:103] op_sel_hi:[1,0]
  v_pk_mul_f32 v[12:13], v[12:13], v[20:21]
  v_pk_mul_f32 v[14:15], v[14:15], v[22:23]
  v_pk_mul_f32 v[16:17], v[16:17], v[24:25]
  v_pk_mul_f32 v[18:19], v[18:19], v[26:27]
  v_cvt_pk_bf16_f32 v104, v12, v13
  v_cvt_pk_bf16_f32 v105, v14, v15
  v_cvt_pk_bf16_f32 v106, v16, v17
  v_cvt_pk_bf16_f32 v107, v18, v19
  v_min_u32 v104, -2, v104
  buffer_store_dwordx4 v[104:107], v0, s[4:7], s45 offen sc1
  buffer_store_dwordx4 v[172:175], v0, s[4:7], s59 offen sc1
  s_cmp_ge_u32 s36, 128
  s_cbranch_scc1 L_dd_done
L_dd_spin1:
  s_mul_i32 s38, s36, 18432
  s_add_u32 s38, s38, 0x480000
  s_lshl_b32 s51, s36, 12
  s_add_u32 s51, s51, 0x700000
  s_add_u32 s39, s38, 4096
  s_add_u32 s37, s36, 2
  s_cmp_lt_u32 s37, 100
  s_cselect_b32 s53, 0, s57
  s_cmp_eq_u32 s53, 1
  s_cbranch_scc1 L_dd_quick1
  s_waitcnt vmcnt(2)
  v_cmp_eq_u32 vcc, -1, v113
  s_cmp_lt_u32 s37, 100
  s_cselect_b32 s53, 1, 0
  s_bitcmp1_b32 vcc_lo, 1
  s_cselect_b32 s53, 0, s53
  s_bitcmp0_b32 vcc_lo, 0
  s_cselect_b32 s58, 1, 0
  s_cmp_eq_u32 s57, 0
  s_cbranch_scc1 L_dd_fetch1
  s_mov_b32 s58, 0
  v_max_u32 v8, v80, v82
  v_max3_u32 v8, v8, v84, v86
  v_max3_u32 v8, v8, v88, v44
  v_max3_u32 v8, v8, v48, v52
  v_max3_u32 v8, v8, v56, v60
  v_cmp_eq_u32 vcc, -1, v8
  s_cbranch_vccnz L_dd_fetch1
L_dd_have1:
  ds_write_b128 v3, v[44:47] offset:0
  ds_write_b128 v3, v[48:51] offset:1024
  ds_write_b128 v3, v[52:55] offset:2048
  ds_write_b128 v3, v[56:59] offset:3072
  ds_write_b128 v3, v[60:63] offset:4096
  v_mov_b64 v[136:137], v[80:81]
  v_mov_b64 v[138:139], v[82:83]
  v_mov_b64 v[140:141], v[84:85]
  v_mov_b64 v[142:143], v[86:87]
  v_mov_b64 v[144:145], v[88:89]
  s_branch L_dd_staged1
L_dd_quick1:
  s_mov_b32 s53, 0
  s_waitcnt vmcnt(3)
  v_max_u32 v8, v80, v82
  v_max3_u32 v8, v8, v84, v86
  v_max3_u32 v8, v8, v88, v44
  v_max3_u32 v8, v8, v48, v52
  v_max3_u32 v8, v8, v56, v60
  v_cmp_eq_u32 vcc, -1, v8
  s_cbranch_vccz L_dd_have1
  s_waitcnt vmcnt(2)
  v_cmp_eq_u32 vcc, -1, v113
  s_bitcmp0_b32 vcc_lo, 0
  s_cselect_b32 s58, 1, 0
L_dd_fetch1:
  s_cmp_eq_u32 s58, 1
  s_mov_b32 s49, 0
  s_cbranch_scc1 L_spind_43_s
L_spin_41:
  s_cmp_ge_u32 s36, 120
  s_cbranch_scc1 L_spind_43_s
  s_mov_b64 exec, 0x1
L_spind_43:
  buffer_load_dword v8, v4, s[4:7], s38 offen offset:0 sc1
  s_add_u32 s49, s49, 1
  s_cmp_ge_u32 s49, 1048576
  s_cbranch_scc1 L_fail
  s_waitcnt vmcnt(0)
  v_cmp_eq_u32 vcc, -1, v8
  s_cbranch_vccnz L_spind_43
  s_mov_b64 exec, -1
L_spind_43_s:
  buffer_load_dwordx2 v[136:137], v9, s[4:7], s51 offen offset:0 sc1
  buffer_load_dwordx2 v[138:139], v9, s[4:7], s51 offen offset:512 sc1
  buffer_load_dwordx2 v[140:141], v9, s[4:7], s51 offen offset:1024 sc1
  buffer_load_dwordx2 v[142:143], v9, s[4:7], s51 offen offset:1536 sc1
  buffer_load_dwordx2 v[144:145], v10, s[4:7], s51 offen offset:2048 sc1
  buffer_load_dwordx4 v[116:119], v4, s[4:7], s38 offen offset:0 sc1
  buffer_load_dwordx4 v[120:123], v4, s[4:7], s38 offen offset:1024 sc1
  buffer_load_dwordx4 v[124:127], v4, s[4:7], s38 offen offset:2048 sc1
  buffer_load_dwordx4 v[128:131], v4, s[4:7], s38 offen offset:3072 sc1
  buffer_load_dwordx4 v[132:135], v4, s[4:7], s39 offen offset:0 sc1
  s_add_u32 s49, s49, 1
  s_cmp_ge_u32 s49, 1048576
  s_cbranch_scc1 L_fail
  s_waitcnt vmcnt(8)
  v_max_u32 v8, v136, v138
  s_waitcnt vmcnt(6)
  v_max3_u32 v8, v8, v140, v142
  s_waitcnt vmcnt(4)
  v_max3_u32 v8, v8, v144, v116
  s_waitcnt vmcnt(2)
  v_max3_u32 v8, v8, v120, v124
  s_waitcnt vmcnt(0)
  v_max3_u32 v8, v8, v128, v132
  v_cmp_eq_u32 vcc, -1, v8
  s_cbranch_vccnz L_spin_41
L_spinc_42:
  ds_write_b128 v3, v[116:119] offset:0
  ds_write_b128 v3, v[120:123] offset:1024
  ds_write_b128 v3, v[124:127] offset:2048
  ds_write_b128 v3, v[128:131] offset:3072
  ds_write_b128 v3, v[132:135] offset:4096
L_dd_staged1:
  s_cmp_eq_u32 s53, 0
  s_cbranch_scc1 L_dd_go1
  s_waitcnt lgkmcnt(0)
  s_mul_i32 s38, s37, 18432
  s_add_u32 s38, s38, 0x480000
  s_lshl_b32 s51, s37, 12
  s_add_u32 s51, s51, 0x700000
  s_add_u32 s39, s38, 4096
  buffer_load_dwordx2 v[80:81], v9, s[4:7], s51 offen offset:0 sc1
  buffer_load_dwordx2 v[82:83], v9, s[4:7], s51 offen offset:512 sc1
  buffer_load_dwordx2 v[84:85], v9, s[4:7], s51 offen offset:1024 sc1
  buffer_load_dwordx2 v[86:87], v9, s[4:7], s51 offen offset:1536 sc1
  buffer_load_dwordx2 v[88:89], v10, s[4:7], s51 offen offset:2048 sc1
  buffer_load_dwordx4 v[44:47], v4, s[4:7], s38 offen offset:0 sc1
  buffer_load_dwordx4 v[48:51], v4, s[4:7], s38 offen offset:1024 sc1
  buffer_load_dwordx4 v[52:55], v4, s[4:7], s38 offen offset:2048 sc1
  buffer_load_dwordx4 v[56:59], v4, s[4:7], s38 offen offset:3072 sc1
  buffer_load_dwordx4 v[60:63], v4, s[4:7], s39 offen offset:0 sc1
  s_mov_b32 s45, 0x40000000
  s_mov_b32 s59, 0x40000000
  s_branch L_dd_deep1
.p2align 6
L_dd_go1:
  s_waitcnt lgkmcnt(0)
  s_barrier
  v_xor_b32 v2, 0x10000, v2
  v_xor_b32 v3, 0x10000, v3
  ds_read_b128 v[28:31], v2 offset:0
  ds_read_b128 v[32:35], v2 offset:1024
  ds_read_b128 v[40:43], v2 offset:3072
  ds_read_b128 v[36:39], v2 offset:2048
  s_waitcnt lgkmcnt(3)
  v_mfma_f32_16x16x32_bf16 v[148:151], v[224:227], v[28:31], 0
  ds_read_b128 v[180:183], v2 offset:5120
  v_mfma_f32_16x16x32_bf16 v[152:155], v[228:231], v[28:31], 0
  ds_read_b128 v[176:179], v2 offset:4096
  s_add_u32 s37, s36, 2
  v_mfma_f32_16x16x32_bf16 v[156:159], v[232:235], v[28:31], 0
  s_mul_i32 s38, s37, 18432
  v_add_f32 v164, v136, v138
  v_mfma_f32_16x16x32_bf16 v[160:163], v[236:239], v[28:31], 0
  s_add_u32 s38, s38, 0x480000
  v_add_f32 v165, v140, v142
  s_waitcnt lgkmcnt(4)
  v_mfma_f32_16x16x32_bf16 v[148:151], v[240:243], v[32:35], v[148:151]
  s_lshl_b32 s51, s37, 12
  v_add_f32 v166, v137, v139
  v_mfma_f32_16x16x32_bf16 v[152:155], v[244:247], v[32:35], v[152:155]
  s_add_u32 s51, s51, 0x700000
  v_add_f32 v167, v141, v143
  v_mfma_f32_16x16x32_bf16 v[156:159], v[248:251], v[32:35], v[156:159]
  s_sub_u32 s56, s38, 0x0
  v_add_f32 v164, v164, v144
  v_mfma_f32_16x16x32_bf16 v[160:163], v[252:255], v[32:35], v[160:163]
  s_cmp_lt_u32 s37, 128
  s_waitcnt lgkmcnt(2)
  v_mfma_f32_16x16x32_bf16 v[148:151], a[0:3], v[36:39], v[148:151]
  ds_read_b128 v[32:35], v2 offset:7168
  s_cselect_b32 s38, s38, 0x40000000
  v_mfma_f32_16x16x32_bf16 v[152:155], a[4:7], v[36:39], v[152:155]
  ds_read_b128 v[28:31], v2 offset:6144
  s_cselect_b32 s51, s51, 0x40000000
  v_mfma_f32_16x16x32_bf16 v[156:159], a[8:11], v[36:39], v[156:159]
  s_add_u32 s39, s38, 4096
  v_add_f32 v166, v166, v145
  v_mfma_f32_16x16x32_bf16 v[160:163], a[12:15], v[36:39], v[160:163]
  v_add_f32 v164, v164, v165
  s_mul_i32 s45, s36, 144
  v_mfma_f32_16x16x32_bf16 v[148:151], a[16:19], v[40:43], v[148:151]
  v_add_f32 v166, v166, v167
  s_add_u32 s45, s45, s50
  v_mfma_f32_16x16x32_bf16 v[152:155], a[20:23], v[40:43], v[152:155]
  v_mov_b32 v165, v164
  s_lshl_b32 s45, s45, 10
  v_mfma_f32_16x16x32_bf16 v[156:159], a[24:27], v[40:43], v[156:159]
  v_permlane32_swap_b32 v164, v165
  v_mfma_f32_16x16x32_bf16 v[160:163], a[28:31], v[40:43], v[160:163]
  v_add_f32 v164, v164, v165
  s_waitcnt lgkmcnt(2)
  v_mfma_f32_16x16x32_bf16 v[148:151], a[32:35], v[176:179], v[148:151]
  ds_read_b128 v[40:43], v2 offset:9216
  v_mov_b32 v165, v164
  v_mfma_f32_16x16x32_bf16 v[152:155], a[36:39], v[176:179], v[152:155]
  ds_read_b128 v[36:39], v2 offset:8192
  s_add_u32 s45, s45, 0x5000000
  v_mfma_f32_16x16x32_bf16 v[156:159], a[40:43], v[176:179], v[156:159]
  v_permlane16_swap_b32 v164, v165
  v_mfma_f32_16x16x32_bf16 v[160:163], a[44:47], v[176:179], v[160:163]
  v_add_f32 v164, v164, v165
  s_add_u32 s59, s45, 0x1b0000
  v_mfma_f32_16x16x32_bf16 v[148:151], a[48:51], v[180:183], v[148:151]
  v_mul_f32 v165, 0xbd638e39, v164
  v_mfma_f32_16x16x32_bf16 v[152:155], a[52:55], v[180:183], v[152:155]
  v_add_f32 v136, v136, v165
  v_mfma_f32_16x16x32_bf16 v[156:159], a[56:59], v[180:183], v[156:159]
  v_add_f32 v138, v138, v165
  v_mfma_f32_16x16x32_bf16 v[160:163], a[60:63], v[180:183], v[160:163]
  v_add_f32 v140, v140, v165
  s_waitcnt lgkmcnt(2)
  v_mfma_f32_16x16x32_bf16 v[148:151], a[64:67], v[28:31], v[148:151]
  ds_read_b128 v[180:183], v2 offset:11264
  v_add_f32 v142, v142, v165
  v_mfma_f32_16x16x32_bf16 v[152:155], a[68:71], v[28:31], v[152:155]
  ds_read_b128 v[176:179], v2 offset:10240
  v_add_f32 v144, v144, v165
  v_mfma_f32_16x16x32_bf16 v[156:159], a[72:75], v[28:31], v[156:159]
  v_mul_f32 v144, v144, v11
  v_mfma_f32_16x16x32_bf16 v[160:163], a[76:79], v[28:31], v[160:163]
  v_mul_f32 v167, v136, v136
  v_mfma_f32_16x16x32_bf16 v[148:151], a[80:83], v[32:35], v[148:151]
  v_fmac_f32 v167, v138, v138
  v_mfma_f32_16x16x32_bf16 v[152:155], a[84:87], v[32:35], v[152:155]
  v_fmac_f32 v167, v140, v140
  v_mfma_f32_16x16x32_bf16 v[156:159], a[88:91], v[32:35], v[156:159]
  v_fmac_f32 v167, v142, v142
  v_mfma_f32_16x16x32_bf16 v[160:163], a[92:95], v[32:35], v[160:163]
  v_fmac_f32 v167, v144, v144
  s_waitcnt lgkmcnt(2)
  v_mfma_f32_16x16x32_bf16 v[148:151], a[96:99], v[36:39], v[148:151]
  ds_read_b128 v[32:35], v2 offset:13312
  v_fmac_f32 v166, 0x3d000000, v167
  v_mfma_f32_16x16x32_bf16 v[152:155], a[100:103], v[36:39], v[152:155]
  ds_read_b128 v[28:31], v2 offset:12288
  v_mov_b32 v165, v166
  v_mfma_f32_16x16x32_bf16 v[156:159], a[104:107], v[36:39], v[156:159]
  buffer_load_dwordx4 v[116:119], v4, s[4:7], s38 offen offset:0 sc1
  v_mfma_f32_16x16x32_bf16 v[160:163], a[108:111], v[36:39], v[160:163]
  v_permlane32_swap_b32 v166, v165
  v_mfma_f32_16x16x32_bf16 v[148:151], a[112:115], v[40:43], v[148:151]
  v_add_f32 v166, v166, v165
  v_mfma_f32_16x16x32_bf16 v[152:155], a[116:119], v[40:43], v[152:155]
  v_mov_b32 v165, v166
  v_mfma_f32_16x16x32_bf16 v[156:159], a[120:123], v[40:43], v[156:159]
  buffer_load_dwordx4 v[120:123], v4, s[4:7], s38 offen offset:1024 sc1
  v_mfma_f32_16x16x32_bf16 v[160:163], a[124:127], v[40:43], v[160:163]
  s_waitcnt lgkmcnt(2)
  v_mfma_f32_16x16x32_bf16 v[148:151], a[128:131], v[176:179], v[148:151]
  ds_read_b128 v[40:43], v2 offset:15360
  v_mfma_f32_16x16x32_bf16 v[152:155], a[132:135], v[176:179], v[152:155]
  ds_read_b128 v[36:39], v2 offset:14336
  v_mfma_f32_16x16x32_bf16 v[156:159], a[136:139], v[176:179], v[156:159]
  buffer_load_dwordx4 v[124:127], v4, s[4:7], s38 offen offset:2048 sc1
  v_mfma_f32_16x16x32_bf16 v[160:163], a[140:143], v[176:179], v[160:163]
  v_permlane16_swap_b32 v166, v165
  v_mfma_f32_16x16x32_bf16 v[148:151], a[144:147], v[180:183], v[148:151]
  v_add_f32 v166, v166, v165
  v_mfma_f32_16x16x32_bf16 v[152:155], a[148:151], v[180:183], v[152:155]
  v_mul_f32 v164, 0xbae38e39, v164
  v_mfma_f32_16x16x32_bf16 v[156:159], a[152:155], v[180:183], v[156:159]
  buffer_load_dwordx4 v[128:131], v4, s[4:7], s38 offen offset:3072 sc1
  v_mfma_f32_16x16x32_bf16 v[160:163], a[156:159], v[180:183], v[160:163]
  v_cvt_pk_bf16_f32 v164, v164, v164
  s_waitcnt lgkmcnt(2)
  v_mfma_f32_16x16x32_bf16 v[148:151], a[160:163], v[28:31], v[148:151]
  ds_read_b128 v[180:183], v2 offset:17408
  v_and_b32 v164, 0xffff0000, v164
  v_mfma_f32_16x16x32_bf16 v[152:155], a[164:167], v[28:31], v[152:155]
  ds_read_b128 v[176:179], v2 offset:16384
  v_mul_f32 v166, 0x3ae38e39, v166
  v_mfma_f32_16x16x32_bf16 v[156:159], a[168:171], v[28:31], v[156:159]
  buffer_load_dwordx4 v[132:135], v4, s[4:7], s39 offen offset:0 sc1
  v_mfma_f32_16x16x32_bf16 v[160:163], a[172:175], v[28:31], v[160:163]
  v_cvt_pk_bf16_f32 v166, v166, v166
  v_mfma_f32_16x16x32_bf16 v[148:151], a[176:179], v[32:35], v[148:151]
  v_and_b32 v166, 0xffff0000, v166
  v_mfma_f32_16x16x32_bf16 v[152:155], a[180:183], v[32:35], v[152:155]
  v_add_f32 v166, 0x3727c5ac, v166
  v_mfma_f32_16x16x32_bf16 v[156:159], a[184:187], v[32:35], v[156:159]
  buffer_load_dwordx2 v[136:137], v9, s[4:7], s51 offen offset:0 sc1
  v_mfma_f32_16x16x32_bf16 v[160:163], a[188:191], v[32:35], v[160:163]
  v_cvt_pk_bf16_f32 v166, v166, v166
  s_waitcnt lgkmcnt(2)
  v_mfma_f32_16x16x32_bf16 v[148:151], a[192:195], v[36:39], v[148:151]
  buffer_load_dwordx2 v[138:139], v9, s[4:7], s51 offen offset:512 sc1
  v_mfma_f32_16x16x32_bf16 v[152:155], a[196:199], v[36:39], v[152:155]
  v_and_b32 v166, 0xffff0000, v166
  v_mfma_f32_16x16x32_bf16 v[156:159], a[200:203], v[36:39], v[156:159]
  buffer_load_dwordx2 v[140:141], v9, s[4:7], s51 offen offset:1024 sc1
  v_mfma_f32_16x16x32_bf16 v[160:163], a[204:207], v[36:39], v[160:163]
  v_sqrt_f32 v166, v166
  v_mfma_f32_16x16x32_bf16 v[148:151], a[208:211], v[40:43], v[148:151]
  buffer_load_dwordx2 v[142:143], v9, s[4:7], s51 offen offset:1536 sc1
  v_mfma_f32_16x16x32_bf16 v[152:155], a[212:215], v[40:43], v[152:155]
  v_cvt_pk_bf16_f32 v166, v166, v166
  v_mfma_f32_16x16x32_bf16 v[156:159], a[216:219], v[40:43], v[156:159]
  buffer_load_dwordx2 v[144:145], v10, s[4:7], s51 offen offset:2048 sc1
  v_mfma_f32_16x16x32_bf16 v[160:163], a[220:223], v[40:43], v[160:163]
  v_and_b32 v166, 0xffff0000, v166
  s_waitcnt lgkmcnt(0)
  v_mfma_f32_16x16x32_bf16 v[148:151], a[224:227], v[176:179], v[148:151]
  v_rcp_f32 v166, v166
  v_mfma_f32_16x16x32_bf16 v[152:155], a[228:231], v[176:179], v[152:155]
  v_mul_f32 v166, v166, v166
  v_mfma_f32_16x16x32_bf16 v[156:159], a[232:235], v[176:179], v[156:159]
  s_cmp_lt_u32 s36, 116
  s_cselect_b32 s59, s59, 0x40000000
  v_mfma_f32_16x16x32_bf16 v[160:163], a[236:239], v[176:179], v[160:163]
  buffer_load_dword v113, v112, s[4:7], s56 offen sc1
  v_mfma_f32_16x16x32_bf16 v[148:151], a[240:243], v[180:183], v[148:151]
  v_mfma_f32_16x16x32_bf16 v[152:155], a[244:247], v[180:183], v[152:155]
  v_mfma_f32_16x16x32_bf16 v[156:159], a[248:251], v[180:183], v[156:159]
  v_mfma_f32_16x16x32_bf16 v[160:163], a[252:255], v[180:183], v[160:163]
  s_mov_b32 s36, s37
  s_mov_b32 s57, 1
L_dd_fin1:
  v_pk_fma_f32 v[148:149], v[64:65], v[164:165], v[148:149] op_sel_hi:[1,0,1]
  v_pk_fma_f32 v[150:151], v[66:67], v[164:165], v[150:151] op_sel_hi:[1,0,1]
  v_pk_fma_f32 v[152:153], v[68:69], v[164:165], v[152:153] op_sel_hi:[1,0,1]
  v_pk_fma_f32 v[154:155], v[70:71], v[164:165], v[154:155] op_sel_hi:[1,0,1]
  v_pk_fma_f32 v[156:157], v[72:73], v[164:165], v[156:157] op_sel_hi:[1,0,1]
  v_pk_fma_f32 v[158:159], v[74:75], v[164:165], v[158:159] op_sel_hi:[1,0,1]
  v_pk_fma_f32 v[160:161], v[76:77], v[164:165], v[160:161] op_sel_hi:[1,0,1]
  v_pk_fma_f32 v[162:163], v[78:79], v[164:165], v[162:163] op_sel_hi:[1,0,1]
  v_max_f32 v148, 0, v148
  v_max_f32 v149, 0, v149
  v_max_f32 v150, 0, v150
  v_max_f32 v151, 0, v151
  v_max_f32 v152, 0, v152
  v_max_f32 v153, 0, v153
  v_max_f32 v154, 0, v154
  v_max_f32 v155, 0, v155
  v_pk_mul_f32 v[156:157], v[156:157], v[166:167] op_sel_hi:[1,0]
  v_pk_mul_f32 v[158:159], v[158:159], v[166:167] op_sel_hi:[1,0]
  v_pk_mul_f32 v[160:161], v[160:161], v[166:167] op_sel_hi:[1,0]
  v_pk_mul_f32 v[162:163], v[162:163], v[166:167] op_sel_hi:[1,0]
  v_pk_mul_f32 v[148:149], v[148:149], v[156:157]
  v_pk_mul_f32 v[150:151], v[150:151], v[158:159]
  v_pk_mul_f32 v[152:153], v[152:153], v[160:161]
  v_pk_mul_f32 v[154:155], v[154:155], v[162:163]
  v_cvt_pk_bf16_f32 v168, v148, v149
  v_cvt_pk_bf16_f32 v169, v150, v151
  v_cvt_pk_bf16_f32 v170, v152, v153
  v_cvt_pk_bf16_f32 v171, v154, v155
  v_min_u32 v168, -2, v168
  buffer_store_dwordx4 v[168:171], v0, s[4:7], s45 offen sc1
  buffer_store_dwordx4 v[172:175], v0, s[4:7], s59 offen sc1
  s_cmp_ge_u32 s36, 128
  s_cbranch_scc1 L_dd_done
L_dd_spin0:
  s_mul_i32 s38, s36, 18432
  s_add_u32 s38, s38, 0x480000
  s_lshl_b32 s51, s36, 12
  s_add_u32 s51, s51, 0x700000
  s_add_u32 s39, s38, 4096
  s_add_u32 s37, s36, 2
  s_cmp_lt_u32 s37, 100
  s_cselect_b32 s53, 0, s57
  s_cmp_eq_u32 s53, 1
  s_cbranch_scc1 L_dd_quick0
  s_waitcnt vmcnt(2)
  v_cmp_eq_u32 vcc, -1, v113
  s_cmp_lt_u32 s37, 100
  s_cselect_b32 s53, 1, 0
  s_bitcmp1_b32 vcc_lo, 1
  s_cselect_b32 s53, 0, s53
  s_bitcmp0_b32 vcc_lo, 0
  s_cselect_b32 s58, 1, 0
  s_cmp_eq_u32 s57, 0
  s_cbranch_scc1 L_dd_fetch0
  s_mov_b32 s58, 0
  v_max_u32 v8, v136, v138
  v_max3_u32 v8, v8, v140, v142
  v_max3_u32 v8, v8, v144, v116
  v_max3_u32 v8, v8, v120, v124
  v_max3_u32 v8, v8, v128, v132
  v_cmp_eq_u32 vcc, -1, v8
  s_cbranch_vccnz L_dd_fetch0
L_dd_have0:
  ds_write_b128 v3, v[116:119] offset:0
  ds_write_b128 v3, v[120:123] offset:1024
  ds_write_b128 v3, v[124:127] offset:2048
  ds_write_b128 v3, v[128:131] offset:3072
  ds_write_b128 v3, v[132:135] offset:4096
  v_mov_b64 v[80:81], v[136:137]
  v_mov_b64 v[82:83], v[138:139]
  v_mov_b64 v[84:85], v[140:141]
  v_mov_b64 v[86:87], v[142:143]
  v_mov_b64 v[88:89], v[144:145]
  s_branch L_dd_staged0
L_dd_quick0:
  s_mov_b32 s53, 0
  s_waitcnt vmcnt(3)
  v_max_u32 v8, v136, v138
  v_max3_u32 v8, v8, v140, v142
  v_max3_u32 v8, v8, v144, v116
  v_max3_u32 v8, v8, v120, v124
  v_max3_u32 v8, v8, v128, v132
  v_cmp_eq_u32 vcc, -1, v8
  s_cbranch_vccz L_dd_have0
  s_waitcnt vmcnt(2)
  v_cmp_eq_u32 vcc, -1, v113
  s_bitcmp0_b32 vcc_lo, 0
  s_cselect_b32 s58, 1, 0
L_dd_fetch0:
  s_cmp_eq_u32 s58, 1
  s_mov_b32 s49, 0
  s_cbranch_scc1 L_spind_46_s
L_spin_44:
  s_cmp_ge_u32 s36, 120
  s_cbranch_scc1 L_spind_46_s
  s_mov_b64 exec, 0x1
L_spind_46:
  buffer_load_dword v8, v4, s[4:7], s38 offen offset:0 sc1
  s_add_u32 s49, s49, 1
  s_cmp_ge_u32 s49, 1048576
  s_cbranch_scc1 L_fail
  s_waitcnt vmcnt(0)
  v_cmp_eq_u32 vcc, -1, v8
  s_cbranch_vccnz L_spind_46
  s_mov_b64 exec, -1
L_spind_46_s:
  buffer_load_dwordx2 v[80:81], v9, s[4:7], s51 offen offset:0 sc1
  buffer_load_dwordx2 v[82:83], v9, s[4:7], s51 offen offset:512 sc1
  buffer_load_dwordx2 v[84:85], v9, s[4:7], s51 offen offset:1024 sc1
  buffer_load_dwordx2 v[86:87], v9, s[4:7], s51 offen offset:1536 sc1
  buffer_load_dwordx2 v[88:89], v10, s[4:7], s51 offen offset:2048 sc1
  buffer_load_dwordx4 v[44:47], v4, s[4:7], s38 offen offset:0 sc1
  buffer_load_dwordx4 v[48:51], v4, s[4:7], s38 offen offset:1024 sc1
  buffer_load_dwordx4 v[52:55], v4, s[4:7], s38 offen offset:2048 sc1
  buffer_load_dwordx4 v[56:59], v4, s[4:7], s38 offen offset:3072 sc1
  buffer_load_dwordx4 v[60:63], v4, s[4:7], s39 offen offset:0 sc1
  s_add_u32 s49, s49, 1
  s_cmp_ge_u32 s49, 1048576
  s_cbranch_scc1 L_fail
  s_waitcnt vmcnt(8)
  v_max_u32 v8, v80, v82
  s_waitcnt vmcnt(6)
  v_max3_u32 v8, v8, v84, v86
  s_waitcnt vmcnt(4)
  v_max3_u32 v8, v8, v88, v44
  s_waitcnt vmcnt(2)
  v_max3_u32 v8, v8, v48, v52
  s_waitcnt vmcnt(0)
  v_max3_u32 v8, v8, v56, v60
  v_cmp_eq_u32 vcc, -1, v8
  s_cbranch_vccnz L_spin_44
L_spinc_45:
  ds_write_b128 v3, v[44:47] offset:0
  ds_write_b128 v3, v[48:51] offset:1024
  ds_write_b128 v3, v[52:55] offset:2048
  ds_write_b128 v3, v[56:59] offset:3072
  ds_write_b128 v3, v[60:63] offset:4096
L_dd_staged0:
  s_cmp_eq_u32 s53, 0
  s_cbranch_scc1 L_dd_go0
  s_waitcnt lgkmcnt(0)
  s_mul_i32 s38, s37, 18432
  s_add_u32 s38, s38, 0x480000
  s_lshl_b32 s51, s37, 12
  s_add_u32 s51, s51, 0x700000
  s_add_u32 s39, s38, 4096
  buffer_load_dwordx2 v[136:137], v9, s[4:7], s51 offen offset:0 sc1
  buffer_load_dwordx2 v[138:139], v9, s[4:7], s51 offen offset:512 sc1
  buffer_load_dwordx2 v[140:141], v9, s[4:7], s51 offen offset:1024 sc1
  buffer_load_dwordx2 v[142:143], v9, s[4:7], s51 offen offset:1536 sc1
  buffer_load_dwordx2 v[144:145], v10, s[4:7], s51 offen offset:2048 sc1
  buffer_load_dwordx4 v[116:119], v4, s[4:7], s38 offen offset:0 sc1
  buffer_load_dwordx4 v[120:123], v4, s[4:7], s38 offen offset:1024 sc1
  buffer_load_dwordx4 v[124:127], v4, s[4:7], s38 offen offset:2048 sc1
  buffer_load_dwordx4 v[128:131], v4, s[4:7], s38 offen offset:3072 sc1
  buffer_load_dwordx4 v[132:135], v4, s[4:7], s39 offen offset:0 sc1
  s_mov_b32 s45, 0x40000000
  s_mov_b32 s59, 0x40000000
  s_branch L_dd_deep0
L_dd_done:
  s_branch L_exit
L_role_ee:
  s_and_b32 s36, s24, 1
  s_lshr_b32 s50, s24, 1
  s_mul_i32 s51, s50, 43
  s_lshr_b32 s51, s51, 8
  s_mul_i32 s26, s51, 6
  s_sub_u32 s50, s50, s26
  s_load_dwordx2 s[8:9], s[0:1], 80
  s_mov_b32 s10, 0x510000
  s_mov_b32 s11, 0x20000
  s_waitcnt lgkmcnt(0)
  s_mul_i32 s27, s51, 6
  s_mul_i32 s29, s25, 3
  s_add_u32 s29, s29, 1
  s_lshr_b32 s29, s29, 1
  s_add_u32 s29, s29, s27
  s_lshr_b32 s30, s25, 1
  s_mul_i32 s30, s30, 3
  s_add_u32 s30, s30, 1
  s_add_u32 s30, s30, s27
  s_mul_i32 s27, s50, 884736
  v_lshrrev_b32 v20, 2, v1
  v_mul_u32_u24 v20, 1152, v20
  v_and_b32 v21, 3, v1
  v_lshlrev_b32 v21, 4, v21
  v_add3_u32 v20, v20, v21, s27
  s_lshl_b32 s27, s30, 6
  v_add_u32 v21, s27, v20
  s_lshl_b32 s27, s29, 6
  v_add_u32 v20, s27, v20
  s_mul_i32 s26, s25, 36864
  v_lshrrev_b32 v24, 4, v1
  v_mul_u32_u24 v24, 512, v24
  v_bfe_u32 v25, v1, 2, 2
  v_mul_u32_u24 v25, 64, v25
  v_add_u32 v24, v24, v25
  v_and_b32 v25, 3, v1
  v_mul_u32_u24 v25, 16, v25
  v_add3_u32 v22, v24, v25, s26
  s_and_b32 s27, s25, 1
  s_lshl_b32 s27, s27, 3
  v_add_u32 v23, s27, v22
  s_lshl_b32 s29, s29, 10
  v_add_u32 v9, s29, v0
  s_lshl_b32 s30, s30, 10
  s_lshl_b32 s27, s27, 6
  s_add_u32 s30, s30, s27
  v_lshrrev_b32 v10, 1, v0
  v_add_u32 v10, s30, v10
  s_add_u32 m0, s26, 0x0
  s_mov_b32 s27, 0x0
  buffer_load_dwordx4 v20, s[8:11], s27 offen  lds
  s_add_u32 m0, s26, 0x400
  s_mov_b32 s27, 0x4800
  buffer_load_dwordx4 v20, s[8:11], s27 offen  lds
  s_add_u32 m0, s26, 0x800
  s_mov_b32 s27, 0x0
  buffer_load_dwordx4 v21, s[8:11], s27 offen  lds
  s_add_u32 m0, s26, 0xc00
  s_mov_b32 s27, 0x4800
  buffer_load_dwordx4 v21, s[8:11], s27 offen  lds
  s_add_u32 m0, s26, 0x1000
  s_mov_b32 s27, 0x9000
  buffer_load_dwordx4 v20, s[8:11], s27 offen  lds
  s_add_u32 m0, s26, 0x1400
  s_mov_b32 s27, 0xd800
  buffer_load_dwordx4 v20, s[8:11], s27 offen  lds
  s_add_u32 m0, s26, 0x1800
  s_mov_b32 s27, 0x9000
  buffer_load_dwordx4 v21, s[8:11], s27 offen  lds
  s_add_u32 m0, s26, 0x1c00
  s_mov_b32 s27, 0xd800
  buffer_load_dwordx4 v21, s[8:11], s27 offen  lds
  s_add_u32 m0, s26, 0x2000
  s_mov_b32 s27, 0x12000
  buffer_load_dwordx4 v20, s[8:11], s27 offen  lds
  s_add_u32 m0, s26, 0x2400
  s_mov_b32 s27, 0x16800
  buffer_load_dwordx4 v20, s[8:11], s27 offen  lds
  s_add_u32 m0, s26, 0x2800
  s_mov_b32 s27, 0x12000
  buffer_load_dwordx4 v21, s[8:11], s27 offen  lds
  s_add_u32 m0, s26, 0x2c00
  s_mov_b32 s27, 0x16800
  buffer_load_dwordx4 v21, s[8:11], s27 offen  lds
  s_add_u32 m0, s26, 0x3000
  s_mov_b32 s27, 0x1b000
  buffer_load_dwordx4 v20, s[8:11], s27 offen  lds
  s_add_u32 m0, s26, 0x3400
  s_mov_b32 s27, 0x1f800
  buffer_load_dwordx4 v20, s[8:11], s27 offen  lds
  s_add_u32 m0, s26, 0x3800
  s_mov_b32 s27, 0x1b000
  buffer_load_dwordx4 v21, s[8:11], s27 offen  lds
  s_add_u32 m0, s26, 0x3c00
  s_mov_b32 s27, 0x1f800
  buffer_load_dwordx4 v21, s[8:11], s27 offen  lds
  s_add_u32 m0, s26, 0x4000
  s_mov_b32 s27, 0x24000
  buffer_load_dwordx4 v20, s[8:11], s27 offen  lds
  s_add_u32 m0, s26, 0x4400
  s_mov_b32 s27, 0x28800
  buffer_load_dwordx4 v20, s[8:11], s27 offen  lds
  s_add_u32 m0, s26, 0x4800
  s_mov_b32 s27, 0x24000
  buffer_load_dwordx4 v21, s[8:11], s27 offen  lds
  s_add_u32 m0, s26, 0x4c00
  s_mov_b32 s27, 0x28800
  buffer_load_dwordx4 v21, s[8:11], s27 offen  lds
  s_add_u32 m0, s26, 0x5000
  s_mov_b32 s27, 0x2d000
  buffer_load_dwordx4 v20, s[8:11], s27 offen  lds
  s_add_u32 m0, s26, 0x5400
  s_mov_b32 s27, 0x31800
  buffer_load_dwordx4 v20, s[8:11], s27 offen  lds
  s_add_u32 m0, s26, 0x5800
  s_mov_b32 s27, 0x2d000
  buffer_load_dwordx4 v21, s[8:11], s27 offen  lds
  s_add_u32 m0, s26, 0x5c00
  s_mov_b32 s27, 0x31800
  buffer_load_dwordx4 v21, s[8:11], s27 offen  lds
  s_add_u32 m0, s26, 0x6000
  s_mov_b32 s27, 0x36000
  buffer_load_dwordx4 v20, s[8:11], s27 offen  lds
  s_add_u32 m0, s26, 0x6400
  s_mov_b32 s27, 0x3a800
  buffer_load_dwordx4 v20, s[8:11], s27 offen  lds
  s_add_u32 m0, s26, 0x6800
  s_mov_b32 s27, 0x36000
  buffer_load_dwordx4 v21, s[8:11], s27 offen  lds
  s_add_u32 m0, s26, 0x6c00
  s_mov_b32 s27, 0x3a800
  buffer_load_dwordx4 v21, s[8:11], s27 offen  lds
  s_add_u32 m0, s26, 0x7000
  s_mov_b32 s27, 0x3f000
  buffer_load_dwordx4 v20, s[8:11], s27 offen  lds
  s_add_u32 m0, s26, 0x7400
  s_mov_b32 s27, 0x43800
  buffer_load_dwordx4 v20, s[8:11], s27 offen  lds
  s_add_u32 m0, s26, 0x7800
  s_mov_b32 s27, 0x3f000
  buffer_load_dwordx4 v21, s[8:11], s27 offen  lds
  s_add_u32 m0, s26, 0x7c00
  s_mov_b32 s27, 0x43800
  buffer_load_dwordx4 v21, s[8:11], s27 offen  lds
  s_add_u32 m0, s26, 0x8000
  s_mov_b32 s27, 0x48000
  buffer_load_dwordx4 v20, s[8:11], s27 offen  lds
  s_add_u32 m0, s26, 0x8400
  s_mov_b32 s27, 0x4c800
  buffer_load_dwordx4 v20, s[8:11], s27 offen  lds
  s_add_u32 m0, s26, 0x8800
  s_mov_b32 s27, 0x48000
  buffer_load_dwordx4 v21, s[8:11], s27 offen  lds
  s_add_u32 m0, s26, 0x8c00
  s_mov_b32 s27, 0x4c800
  buffer_load_dwordx4 v21, s[8:11], s27 offen  lds
  s_waitcnt vmcnt(32)
  ds_read_b64_tr_b16 v[224:225], v22 offset:0
  ds_read_b64_tr_b16 v[226:227], v22 offset:256
  ds_read_b64_tr_b16 v[228:229], v22 offset:8
  ds_read_b64_tr_b16 v[230:231], v22 offset:264
  ds_read_b64_tr_b16 v[232:233], v23 offset:2048
  ds_read_b64_tr_b16 v[234:235], v23 offset:2304
  s_waitcnt lgkmcnt(0)
  s_add_u32 m0, s26, 0x0
  s_mov_b32 s27, 0x51000
  buffer_load_dwordx4 v20, s[8:11], s27 offen  lds
  s_add_u32 m0, s26, 0x400
  s_mov_b32 s27, 0x55800
  buffer_load_dwordx4 v20, s[8:11], s27 offen  lds
  s_add_u32 m0, s26, 0x800
  s_mov_b32 s27, 0x51000
  buffer_load_dwordx4 v21, s[8:11], s27 offen  lds
  s_add_u32 m0, s26, 0xc00
  s_mov_b32 s27, 0x55800
  buffer_load_dwordx4 v21, s[8:11], s27 offen  lds
  s_waitcnt vmcnt(32)
  ds_read_b64_tr_b16 v[236:237], v22 offset:4096
  ds_read_b64_tr_b16 v[238:239], v22 offset:4352
  ds_read_b64_tr_b16 v[240:241], v22 offset:4104
  ds_read_b64_tr_b16 v[242:243], v22 offset:4360
  ds_read_b64_tr_b16 v[244:245], v23 offset:6144
  ds_read_b64_tr_b16 v[246:247], v23 offset:6400
  s_waitcnt lgkmcnt(0)
  s_add_u32 m0, s26, 0x1000
  s_mov_b32 s27, 0x5a000
  buffer_load_dwordx4 v20, s[8:11], s27 offen  lds
  s_add_u32 m0, s26, 0x1400
  s_mov_b32 s27, 0x5e800
  buffer_load_dwordx4 v20, s[8:11], s27 offen  lds
  s_add_u32 m0, s26, 0x1800
  s_mov_b32 s27, 0x5a000
  buffer_load_dwordx4 v21, s[8:11], s27 offen  lds
  s_add_u32 m0, s26, 0x1c00
  s_mov_b32 s27, 0x5e800
  buffer_load_dwordx4 v21, s[8:11], s27 offen  lds
  s_waitcnt vmcnt(32)
  ds_read_b64_tr_b16 v[248:249], v22 offset:8192
  ds_read_b64_tr_b16 v[250:251], v22 offset:8448
  ds_read_b64_tr_b16 v[252:253], v22 offset:8200
  ds_read_b64_tr_b16 v[254:255], v22 offset:8456
  ds_read_b64_tr_b16 a[0:1], v23 offset:10240
  ds_read_b64_tr_b16 a[2:3], v23 offset:10496
  s_waitcnt lgkmcnt(0)
  s_add_u32 m0, s26, 0x2000
  s_mov_b32 s27, 0x63000
  buffer_load_dwordx4 v20, s[8:11], s27 offen  lds
  s_add_u32 m0, s26, 0x2400
  s_mov_b32 s27, 0x67800
  buffer_load_dwordx4 v20, s[8:11], s27 offen  lds
  s_add_u32 m0, s26, 0x2800
  s_mov_b32 s27, 0x63000
  buffer_load_dwordx4 v21, s[8:11], s27 offen  lds
  s_add_u32 m0, s26, 0x2c00
  s_mov_b32 s27, 0x67800
  buffer_load_dwordx4 v21, s[8:11], s27 offen  lds
  s_waitcnt vmcnt(32)
  ds_read_b64_tr_b16 a[4:5], v22 offset:12288
  ds_read_b64_tr_b16 a[6:7], v22 offset:12544
  ds_read_b64_tr_b16 a[8:9], v22 offset:12296
  ds_read_b64_tr_b16 a[10:11], v22 offset:12552
  ds_read_b64_tr_b16 a[12:13], v23 offset:14336
  ds_read_b64_tr_b16 a[14:15], v23 offset:14592
  s_waitcnt lgkmcnt(0)
  s_add_u32 m0, s26, 0x3000
  s_mov_b32 s27, 0x6c000
  buffer_load_dwordx4 v20, s[8:11], s27 offen  lds
  s_add_u32 m0, s26, 0x3400
  s_mov_b32 s27, 0x70800
  buffer_load_dwordx4 v20, s[8:11], s27 offen  lds
  s_add_u32 m0, s26, 0x3800
  s_mov_b32 s27, 0x6c000
  buffer_load_dwordx4 v21, s[8:11], s27 offen  lds
  s_add_u32 m0, s26, 0x3c00
  s_mov_b32 s27, 0x70800
  buffer_load_dwordx4 v21, s[8:11], s27 offen  lds
  s_waitcnt vmcnt(32)
  ds_read_b64_tr_b16 a[16:17], v22 offset:16384
  ds_read_b64_tr_b16 a[18:19], v22 offset:16640
  ds_read_b64_tr_b16 a[20:21], v22 offset:16392
  ds_read_b64_tr_b16 a[22:23], v22 offset:16648
  ds_read_b64_tr_b16 a[24:25], v23 offset:18432
  ds_read_b64_tr_b16 a[26:27], v23 offset:18688
  s_waitcnt lgkmcnt(0)
  s_add_u32 m0, s26, 0x4000
  s_mov_b32 s27, 0x75000
  buffer_load_dwordx4 v20, s[8:11], s27 offen  lds
  s_add_u32 m0, s26, 0x4400
  s_mov_b32 s27, 0x79800
  buffer_load_dwordx4 v20, s[8:11], s27 offen  lds
  s_add_u32 m0, s26, 0x4800
  s_mov_b32 s27, 0x75000
  buffer_load_dwordx4 v21, s[8:11], s27 offen  lds
  s_add_u32 m0, s26, 0x4c00
  s_mov_b32 s27, 0x79800
  buffer_load_dwordx4 v21, s[8:11], s27 offen  lds
  s_waitcnt vmcnt(32)
  ds_read_b64_tr_b16 a[28:29], v22 offset:20480
  ds_read_b64_tr_b16 a[30:31], v22 offset:20736
  ds_read_b64_tr_b16 a[32:33], v22 offset:20488
  ds_read_b64_tr_b16 a[34:35], v22 offset:20744
  ds_read_b64_tr_b16 a[36:37], v23 offset:22528
  ds_read_b64_tr_b16 a[38:39], v23 offset:22784
  s_waitcnt lgkmcnt(0)
  s_add_u32 m0, s26, 0x5000
  s_mov_b32 s27, 0x7e000
  buffer_load_dwordx4 v20, s[8:11], s27 offen  lds
  s_add_u32 m0, s26, 0x5400
  s_mov_b32 s27, 0x82800
  buffer_load_dwordx4 v20, s[8:11], s27 offen  lds
  s_add_u32 m0, s26, 0x5800
  s_mov_b32 s27, 0x7e000
  buffer_load_dwordx4 v21, s[8:11], s27 offen  lds
  s_add_u32 m0, s26, 0x5c00
  s_mov_b32 s27, 0x82800
  buffer_load_dwordx4 v21, s[8:11], s27 offen  lds
  s_waitcnt vmcnt(32)
  ds_read_b64_tr_b16 a[40:41], v22 offset:24576
  ds_read_b64_tr_b16 a[42:43], v22 offset:24832
  ds_read_b64_tr_b16 a[44:45], v22 offset:24584
  ds_read_b64_tr_b16 a[46:47], v22 offset:24840
  ds_read_b64_tr_b16 a[48:49], v23 offset:26624
  ds_read_b64_tr_b16 a[50:51], v23 offset:26880
  s_waitcnt lgkmcnt(0)
  s_add_u32 m0, s26, 0x6000
  s_mov_b32 s27, 0x87000
  buffer_load_dwordx4 v20, s[8:11], s27 offen  lds
  s_add_u32 m0, s26, 0x6400
  s_mov_b32 s27, 0x8b800
  buffer_load_dwordx4 v20, s[8:11], s27 offen  lds
  s_add_u32 m0, s26, 0x6800
  s_mov_b32 s27, 0x87000
  buffer_load_dwordx4 v21, s[8:11], s27 offen  lds
  s_add_u32 m0, s26, 0x6c00
  s_mov_b32 s27, 0x8b800
  buffer_load_dwordx4 v21, s[8:11], s27 offen  lds
  s_waitcnt vmcnt(32)
  ds_read_b64_tr_b16 a[52:53], v22 offset:28672
  ds_read_b64_tr_b16 a[54:55], v22 offset:28928
  ds_read_b64_tr_b16 a[56:57], v22 offset:28680
  ds_read_b64_tr_b16 a[58:59], v22 offset:28936
  ds_read_b64_tr_b16 a[60:61], v23 offset:30720
  ds_read_b64_tr_b16 a[62:63], v23 offset:30976
  s_waitcnt lgkmcnt(0)
  s_add_u32 m0, s26, 0x7000
  s_mov_b32 s27, 0x90000
  buffer_load_dwordx4 v20, s[8:11], s27 offen  lds
  s_add_u32 m0, s26, 0x7400
  s_mov_b32 s27, 0x94800
  buffer_load_dwordx4 v20, s[8:11], s27 offen  lds
  s_add_u32 m0, s26, 0x7800
  s_mov_b32 s27, 0x90000
  buffer_load_dwordx4 v21, s[8:11], s27 offen  lds
  s_add_u32 m0, s26, 0x7c00
  s_mov_b32 s27, 0x94800
  buffer_load_dwordx4 v21, s[8:11], s27 offen  lds
  s_waitcnt vmcnt(32)
  ds_read_b64_tr_b16 a[64:65], v22 offset:32768
  ds_read_b64_tr_b16 a[66:67], v22 offset:33024
  ds_read_b64_tr_b16 a[68:69], v22 offset:32776
  ds_read_b64_tr_b16 a[70:71], v22 offset:33032
  ds_read_b64_tr_b16 a[72:73], v23 offset:34816
  ds_read_b64_tr_b16 a[74:75], v23 offset:35072
  s_waitcnt lgkmcnt(0)
  s_add_u32 m0, s26, 0x8000
  s_mov_b32 s27, 0x99000
  buffer_load_dwordx4 v20, s[8:11], s27 offen  lds
  s_add_u32 m0, s26, 0x8400
  s_mov_b32 s27, 0x9d800
  buffer_load_dwordx4 v20, s[8:11], s27 offen  lds
  s_add_u32 m0, s26, 0x8800
  s_mov_b32 s27, 0x99000
  buffer_load_dwordx4 v21, s[8:11], s27 offen  lds
  s_add_u32 m0, s26, 0x8c00
  s_mov_b32 s27, 0x9d800
  buffer_load_dwordx4 v21, s[8:11], s27 offen  lds
  s_waitcnt vmcnt(32)
  ds_read_b64_tr_b16 a[76:77], v22 offset:0
  ds_read_b64_tr_b16 a[78:79], v22 offset:256
  ds_read_b64_tr_b16 a[80:81], v22 offset:8
  ds_read_b64_tr_b16 a[82:83], v22 offset:264
  ds_read_b64_tr_b16 a[84:85], v23 offset:2048
  ds_read_b64_tr_b16 a[86:87], v23 offset:2304
  s_waitcnt lgkmcnt(0)
  s_add_u32 m0, s26, 0x0
  s_mov_b32 s27, 0xa2000
  buffer_load_dwordx4 v20, s[8:11], s27 offen  lds
  s_add_u32 m0, s26, 0x400
  s_mov_b32 s27, 0xa6800
  buffer_load_dwordx4 v20, s[8:11], s27 offen  lds
  s_add_u32 m0, s26, 0x800
  s_mov_b32 s27, 0xa2000
  buffer_load_dwordx4 v21, s[8:11], s27 offen  lds
  s_add_u32 m0, s26, 0xc00
  s_mov_b32 s27, 0xa6800
  buffer_load_dwordx4 v21, s[8:11], s27 offen  lds
  s_waitcnt vmcnt(32)
  ds_read_b64_tr_b16 a[88:89], v22 offset:4096
  ds_read_b64_tr_b16 a[90:91], v22 offset:4352
  ds_read_b64_tr_b16 a[92:93], v22 offset:4104
  ds_read_b64_tr_b16 a[94:95], v22 offset:4360
  ds_read_b64_tr_b16 a[96:97], v23 offset:6144
  ds_read_b64_tr_b16 a[98:99], v23 offset:6400
  s_waitcnt lgkmcnt(0)
  s_add_u32 m0, s26, 0x1000
  s_mov_b32 s27, 0xab000
  buffer_load_dwordx4 v20, s[8:11], s27 offen  lds
  s_add_u32 m0, s26, 0x1400
  s_mov_b32 s27, 0xaf800
  buffer_load_dwordx4 v20, s[8:11], s27 offen  lds
  s_add_u32 m0, s26, 0x1800
  s_mov_b32 s27, 0xab000
  buffer_load_dwordx4 v21, s[8:11], s27 offen  lds
  s_add_u32 m0, s26, 0x1c00
  s_mov_b32 s27, 0xaf800
  buffer_load_dwordx4 v21, s[8:11], s27 offen  lds
  s_waitcnt vmcnt(32)
  ds_read_b64_tr_b16 a[100:101], v22 offset:8192
  ds_read_b64_tr_b16 a[102:103], v22 offset:8448
  ds_read_b64_tr_b16 a[104:105], v22 offset:8200
  ds_read_b64_tr_b16 a[106:107], v22 offset:8456
  ds_read_b64_tr_b16 a[108:109], v23 offset:10240
  ds_read_b64_tr_b16 a[110:111], v23 offset:10496
  s_waitcnt lgkmcnt(0)
  s_add_u32 m0, s26, 0x2000
  s_mov_b32 s27, 0xb4000
  buffer_load_dwordx4 v20, s[8:11], s27 offen  lds
  s_add_u32 m0, s26, 0x2400
  s_mov_b32 s27, 0xb8800
  buffer_load_dwordx4 v20, s[8:11], s27 offen  lds
  s_add_u32 m0, s26, 0x2800
  s_mov_b32 s27, 0xb4000
  buffer_load_dwordx4 v21, s[8:11], s27 offen  lds
  s_add_u32 m0, s26, 0x2c00
  s_mov_b32 s27, 0xb8800
  buffer_load_dwordx4 v21, s[8:11], s27 offen  lds
  s_waitcnt vmcnt(32)
  ds_read_b64_tr_b16 a[112:113], v22 offset:12288
  ds_read_b64_tr_b16 a[114:115], v22 offset:12544
  ds_read_b64_tr_b16 a[116:117], v22 offset:12296
  ds_read_b64_tr_b16 a[118:119], v22 offset:12552
  ds_read_b64_tr_b16 a[120:121], v23 offset:14336
  ds_read_b64_tr_b16 a[122:123], v23 offset:14592
  s_waitcnt lgkmcnt(0)
  s_add_u32 m0, s26, 0x3000
  s_mov_b32 s27, 0xbd000
  buffer_load_dwordx4 v20, s[8:11], s27 offen  lds
  s_add_u32 m0, s26, 0x3400
  s_mov_b32 s27, 0xc1800
  buffer_load_dwordx4 v20, s[8:11], s27 offen  lds
  s_add_u32 m0, s26, 0x3800
  s_mov_b32 s27, 0xbd000
  buffer_load_dwordx4 v21, s[8:11], s27 offen  lds
  s_add_u32 m0, s26, 0x3c00
  s_mov_b32 s27, 0xc1800
  buffer_load_dwordx4 v21, s[8:11], s27 offen  lds
  s_waitcnt vmcnt(32)
  ds_read_b64_tr_b16 a[124:125], v22 offset:16384
  ds_read_b64_tr_b16 a[126:127], v22 offset:16640
  ds_read_b64_tr_b16 a[128:129], v22 offset:16392
  ds_read_b64_tr_b16 a[130:131], v22 offset:16648
  ds_read_b64_tr_b16 a[132:133], v23 offset:18432
  ds_read_b64_tr_b16 a[134:135], v23 offset:18688
  s_waitcnt lgkmcnt(0)
  s_add_u32 m0, s26, 0x4000
  s_mov_b32 s27, 0xc6000
  buffer_load_dwordx4 v20, s[8:11], s27 offen  lds
  s_add_u32 m0, s26, 0x4400
  s_mov_b32 s27, 0xca800
  buffer_load_dwordx4 v20, s[8:11], s27 offen  lds
  s_add_u32 m0, s26, 0x4800
  s_mov_b32 s27, 0xc6000
  buffer_load_dwordx4 v21, s[8:11], s27 offen  lds
  s_add_u32 m0, s26, 0x4c00
  s_mov_b32 s27, 0xca800
  buffer_load_dwordx4 v21, s[8:11], s27 offen  lds
  s_waitcnt vmcnt(32)
  ds_read_b64_tr_b16 a[136:137], v22 offset:20480
  ds_read_b64_tr_b16 a[138:139], v22 offset:20736
  ds_read_b64_tr_b16 a[140:141], v22 offset:20488
  ds_read_b64_tr_b16 a[142:143], v22 offset:20744
  ds_read_b64_tr_b16 a[144:145], v23 offset:22528
  ds_read_b64_tr_b16 a[146:147], v23 offset:22784
  s_waitcnt lgkmcnt(0)
  s_add_u32 m0, s26, 0x5000
  s_mov_b32 s27, 0xcf000
  buffer_load_dwordx4 v20, s[8:11], s27 offen  lds
  s_add_u32 m0, s26, 0x5400
  s_mov_b32 s27, 0xd3800
  buffer_load_dwordx4 v20, s[8:11], s27 offen  lds
  s_add_u32 m0, s26, 0x5800
  s_mov_b32 s27, 0xcf000
  buffer_load_dwordx4 v21, s[8:11], s27 offen  lds
  s_add_u32 m0, s26, 0x5c00
  s_mov_b32 s27, 0xd3800
  buffer_load_dwordx4 v21, s[8:11], s27 offen  lds
  s_waitcnt vmcnt(32)
  ds_read_b64_tr_b16 a[148:149], v22 offset:24576
  ds_read_b64_tr_b16 a[150:151], v22 offset:24832
  ds_read_b64_tr_b16 a[152:153], v22 offset:24584
  ds_read_b64_tr_b16 a[154:155], v22 offset:24840
  ds_read_b64_tr_b16 a[156:157], v23 offset:26624
  ds_read_b64_tr_b16 a[158:159], v23 offset:26880
  s_waitcnt vmcnt(28)
  ds_read_b64_tr_b16 a[160:161], v22 offset:28672
  ds_read_b64_tr_b16 a[162:163], v22 offset:28928
  ds_read_b64_tr_b16 a[164:165], v22 offset:28680
  ds_read_b64_tr_b16 a[166:167], v22 offset:28936
  ds_read_b64_tr_b16 a[168:169], v23 offset:30720
  ds_read_b64_tr_b16 a[170:171], v23 offset:30976
  s_waitcnt vmcnt(24)
  ds_read_b64_tr_b16 a[172:173], v22 offset:32768
  ds_read_b64_tr_b16 a[174:175], v22 offset:33024
  ds_read_b64_tr_b16 a[176:177], v22 offset:32776
  ds_read_b64_tr_b16 a[178:179], v22 offset:33032
  ds_read_b64_tr_b16 a[180:181], v23 offset:34816
  ds_read_b64_tr_b16 a[182:183], v23 offset:35072
  s_waitcnt vmcnt(20)
  ds_read_b64_tr_b16 a[184:185], v22 offset:0
  ds_read_b64_tr_b16 a[186:187], v22 offset:256
  ds_read_b64_tr_b16 a[188:189], v22 offset:8
  ds_read_b64_tr_b16 a[190:191], v22 offset:264
  ds_read_b64_tr_b16 a[192:193], v23 offset:2048
  ds_read_b64_tr_b16 a[194:195], v23 offset:2304
  s_waitcnt vmcnt(16)
  ds_read_b64_tr_b16 a[196:197], v22 offset:4096
  ds_read_b64_tr_b16 a[198:199], v22 offset:4352
  ds_read_b64_tr_b16 a[200:201], v22 offset:4104
  ds_read_b64_tr_b16 a[202:203], v22 offset:4360
  ds_read_b64_tr_b16 a[204:205], v23 offset:6144
  ds_read_b64_tr_b16 a[206:207], v23 offset:6400
  s_waitcnt vmcnt(12)
  ds_read_b64_tr_b16 a[208:209], v22 offset:8192
  ds_read_b64_tr_b16 a[210:211], v22 offset:8448
  ds_read_b64_tr_b16 a[212:213], v22 offset:8200
  ds_read_b64_tr_b16 a[214:215], v22 offset:8456
  ds_read_b64_tr_b16 a[216:217], v23 offset:10240
  ds_read_b64_tr_b16 a[218:219], v23 offset:10496
  s_waitcnt vmcnt(8)
  ds_read_b64_tr_b16 a[220:221], v22 offset:12288
  ds_read_b64_tr_b16 a[222:223], v22 offset:12544
  ds_read_b64_tr_b16 a[224:225], v22 offset:12296
  ds_read_b64_tr_b16 a[226:227], v22 offset:12552
  ds_read_b64_tr_b16 a[228:229], v23 offset:14336
  ds_read_b64_tr_b16 a[230:231], v23 offset:14592
  s_waitcnt vmcnt(4)
  ds_read_b64_tr_b16 a[232:233], v22 offset:16384
  ds_read_b64_tr_b16 a[234:235], v22 offset:16640
  ds_read_b64_tr_b16 a[236:237], v22 offset:16392
  ds_read_b64_tr_b16 a[238:239], v22 offset:16648
  ds_read_b64_tr_b16 a[240:241], v23 offset:18432
  ds_read_b64_tr_b16 a[242:243], v23 offset:18688
  s_waitcnt vmcnt(0)
  ds_read_b64_tr_b16 a[244:245], v22 offset:20480
  ds_read_b64_tr_b16 a[246:247], v22 offset:20736
  ds_read_b64_tr_b16 a[248:249], v22 offset:20488
  ds_read_b64_tr_b16 a[250:251], v22 offset:20744
  ds_read_b64_tr_b16 a[252:253], v23 offset:22528
  ds_read_b64_tr_b16 a[254:255], v23 offset:22784
  s_waitcnt lgkmcnt(0)
  s_mov_b32 s28, 0
L_reg_47:
  v_mov_b32 v26, 0
  buffer_load_dword v27, v26, s[20:23], 0 offen offset:64 sc1
  s_add_u32 s28, s28, 1
  s_cmp_gt_u32 s28, 1048576
  s_cbranch_scc1 L_fail
  s_waitcnt vmcnt(0)
  v_readfirstlane_b32 s67, v27
L_regc_48:
  s_and_b32 s26, s67, 0xffff
  s_cmp_lt_u32 s26, 256
  s_cbranch_scc1 L_reg_47
  s_lshr_b32 s67, s67, 16
  s_barrier
  v_or_b32 v2, 0x10000, v0
  s_mul_i32 s27, s25, 6144
  v_add_u32 v3, s27, v0
  v_mov_b32 v4, v3
  s_mul_i32 s27, s50, 96
  v_min_u32 v7, 23, v1
  v_lshlrev_b32 v7, 2, v7
  v_add_u32 v7, s27, v7
  s_lshl_b32 s51, s51, 5
  s_lshl_b32 s27, s50, 2
  s_add_u32 s51, s51, s27
  s_add_u32 s51, s51, s25
  s_lshl_b32 s51, s51, 2
  s_add_u32 s51, s51, 0x38000
  v_mov_b32 v172, -1
  v_mov_b32 v173, -1
  v_mov_b32 v174, -1
  v_mov_b32 v175, -1
  v_mov_b32 v113, 0x47ff0
  v_cmp_eq_u32 vcc, 16, v0
  s_nop 1
  v_cndmask_b32 v113, 0, v113, vcc
  v_add_u32 v112, v113, v4
  v_mov_b32 v113, 0x40000000
  v_cmp_gt_u32 vcc, 32, v0
  s_nop 1
  v_cndmask_b32 v112, v113, v112, vcc
  v_mov_b32 v113, -1
  s_mov_b32 s57, 0
  v_mul_u32_u24 v114, 63, v0
  v_add_u32 v114, v114, v4
  s_branch L_ee_spin0
.p2align 6
L_ee_deep0:
  s_waitcnt lgkmcnt(0)
  s_barrier
  v_xor_b32 v2, 0x10000, v2
  v_xor_b32 v3, 0x10000, v3
  ds_read_b128 v[28:31], v2 offset:0
  ds_read_b128 v[32:35], v2 offset:1024
  ds_read_b128 v[40:43], v2 offset:3072
  ds_read_b128 v[36:39], v2 offset:2048
  s_waitcnt lgkmcnt(3)
  v_mfma_f32_16x16x32_bf16 v[12:15], v[224:227], v[28:31], 0
  ds_read_b128 v[180:183], v2 offset:5120
  v_mfma_f32_16x16x32_bf16 v[16:19], v[228:231], v[28:31], 0
  ds_read_b128 v[176:179], v2 offset:4096
  s_add_u32 s37, s36, 2
  v_mfma_f32_16x16x32_bf16 v[20:23], v[232:235], v[28:31], 0
  s_add_u32 s55, s36, 4
  v_cvt_pk_bf16_f32 v148, v148, v149
  s_waitcnt lgkmcnt(4)
  v_mfma_f32_16x16x32_bf16 v[12:15], v[236:239], v[32:35], v[12:15]
  s_mul_i32 s38, s55, 6
  v_cvt_pk_bf16_f32 v149, v150, v151
  v_mfma_f32_16x16x32_bf16 v[16:19], v[240:243], v[32:35], v[16:19]
  s_add_u32 s38, s38, s50
  v_cvt_pk_bf16_f32 v150, v152, v153
  v_mfma_f32_16x16x32_bf16 v[20:23], v[244:247], v[32:35], v[20:23]
  s_mul_i32 s38, s38, 24576
  s_waitcnt lgkmcnt(2)
  v_mfma_f32_16x16x32_bf16 v[12:15], v[248:251], v[36:39], v[12:15]
  ds_read_b128 v[32:35], v2 offset:7168
  s_add_u32 s38, s38, 0x5000000
  v_mfma_f32_16x16x32_bf16 v[16:19], v[252:255], v[36:39], v[16:19]
  ds_read_b128 v[28:31], v2 offset:6144
  s_sub_u32 s56, s38, 0x48000
  v_mfma_f32_16x16x32_bf16 v[20:23], a[0:3], v[36:39], v[20:23]
  s_cmp_lt_u32 s55, 110
  v_cvt_pk_bf16_f32 v151, v154, v155
  v_mfma_f32_16x16x32_bf16 v[12:15], a[4:7], v[40:43], v[12:15]
  s_cselect_b32 s54, 1, 0
  v_min_u32 v148, -2, v148
  v_mfma_f32_16x16x32_bf16 v[16:19], a[8:11], v[40:43], v[16:19]
  s_cselect_b32 s38, s38, 0x40000000
  v_mfma_f32_16x16x32_bf16 v[20:23], a[12:15], v[40:43], v[20:23]
  s_add_u32 s39, s38, 4096
  s_waitcnt lgkmcnt(2)
  v_mfma_f32_16x16x32_bf16 v[12:15], a[16:19], v[176:179], v[12:15]
  ds_read_b128 v[40:43], v2 offset:9216
  v_mfma_f32_16x16x32_bf16 v[16:19], a[20:23], v[176:179], v[16:19]
  ds_read_b128 v[36:39], v2 offset:8192
  v_mfma_f32_16x16x32_bf16 v[20:23], a[24:27], v[176:179], v[20:23]
  buffer_load_dwordx4 v[44:47], v4, s[4:7], s38 offen offset:0 sc1
  v_mfma_f32_16x16x32_bf16 v[12:15], a[28:31], v[180:183], v[12:15]
  v_mfma_f32_16x16x32_bf16 v[16:19], a[32:35], v[180:183], v[16:19]
  v_mfma_f32_16x16x32_bf16 v[20:23], a[36:39], v[180:183], v[20:23]
  s_waitcnt lgkmcnt(2)
  v_mfma_f32_16x16x32_bf16 v[12:15], a[40:43], v[28:31], v[12:15]
  ds_read_b128 v[180:183], v2 offset:11264
  v_mfma_f32_16x16x32_bf16 v[16:19], a[44:47], v[28:31], v[16:19]
  ds_read_b128 v[176:179], v2 offset:10240
  v_mfma_f32_16x16x32_bf16 v[20:23], a[48:51], v[28:31], v[20:23]
  buffer_load_dwordx4 v[48:51], v4, s[4:7], s38 offen offset:1024 sc1
  v_mfma_f32_16x16x32_bf16 v[12:15], a[52:55], v[32:35], v[12:15]
  v_mfma_f32_16x16x32_bf16 v[16:19], a[56:59], v[32:35], v[16:19]
  v_mfma_f32_16x16x32_bf16 v[20:23], a[60:63], v[32:35], v[20:23]
  s_waitcnt lgkmcnt(2)
  v_mfma_f32_16x16x32_bf16 v[12:15], a[64:67], v[36:39], v[12:15]
  ds_read_b128 v[32:35], v2 offset:13312
  v_mfma_f32_16x16x32_bf16 v[16:19], a[68:71], v[36:39], v[16:19]
  ds_read_b128 v[28:31], v2 offset:12288
  v_mfma_f32_16x16x32_bf16 v[20:23], a[72:75], v[36:39], v[20:23]
  buffer_load_dwordx4 v[52:55], v4, s[4:7], s38 offen offset:2048 sc1
  v_mfma_f32_16x16x32_bf16 v[12:15], a[76:79], v[40:43], v[12:15]
  v_mfma_f32_16x16x32_bf16 v[16:19], a[80:83], v[40:43], v[16:19]
  v_mfma_f32_16x16x32_bf16 v[20:23], a[84:87], v[40:43], v[20:23]
  s_waitcnt lgkmcnt(2)
  v_mfma_f32_16x16x32_bf16 v[12:15], a[88:91], v[176:179], v[12:15]
  ds_read_b128 v[40:43], v2 offset:15360
  v_mfma_f32_16x16x32_bf16 v[16:19], a[92:95], v[176:179], v[16:19]
  ds_read_b128 v[36:39], v2 offset:14336
  v_mfma_f32_16x16x32_bf16 v[20:23], a[96:99], v[176:179], v[20:23]
  buffer_load_dwordx4 v[56:59], v4, s[4:7], s38 offen offset:3072 sc1
  v_mfma_f32_16x16x32_bf16 v[12:15], a[100:103], v[180:183], v[12:15]
  v_mfma_f32_16x16x32_bf16 v[16:19], a[104:107], v[180:183], v[16:19]
  v_mfma_f32_16x16x32_bf16 v[20:23], a[108:111], v[180:183], v[20:23]
  s_waitcnt lgkmcnt(2)
  v_mfma_f32_16x16x32_bf16 v[12:15], a[112:115], v[28:31], v[12:15]
  ds_read_b128 v[180:183], v2 offset:17408
  v_mfma_f32_16x16x32_bf16 v[16:19], a[116:119], v[28:31], v[16:19]
  ds_read_b128 v[176:179], v2 offset:16384
  v_mfma_f32_16x16x32_bf16 v[20:23], a[120:123], v[28:31], v[20:23]
  buffer_load_dwordx4 v[60:63], v4, s[4:7], s39 offen offset:0 sc1
  v_mfma_f32_16x16x32_bf16 v[12:15], a[124:127], v[32:35], v[12:15]
  v_mfma_f32_16x16x32_bf16 v[16:19], a[128:131], v[32:35], v[16:19]
  s_waitcnt vmcnt(5)
  v_max_u32 v8, v116, v120
  v_mfma_f32_16x16x32_bf16 v[20:23], a[132:135], v[32:35], v[20:23]
  v_max3_u32 v8, v8, v124, v128
  s_waitcnt lgkmcnt(2)
  v_mfma_f32_16x16x32_bf16 v[12:15], a[136:139], v[36:39], v[12:15]
  ds_read_b128 v[32:35], v2 offset:19456
  v_max3_u32 v8, v8, v132, v136
  v_mfma_f32_16x16x32_bf16 v[16:19], a[140:143], v[36:39], v[16:19]
  ds_read_b128 v[28:31], v2 offset:18432
  v_cmp_eq_u32 vcc, -1, v8
  v_mfma_f32_16x16x32_bf16 v[20:23], a[144:147], v[36:39], v[20:23]
  buffer_load_dwordx4 v[64:67], v4, s[4:7], s39 offen offset:1024 sc1
  v_mfma_f32_16x16x32_bf16 v[12:15], a[148:151], v[40:43], v[12:15]
  ds_write_b128 v3, v[116:119] offset:0
  v_mfma_f32_16x16x32_bf16 v[16:19], a[152:155], v[40:43], v[16:19]
  s_cmp_eq_u64 vcc, 0
  s_cselect_b32 s52, s53, 0
  v_mfma_f32_16x16x32_bf16 v[20:23], a[156:159], v[40:43], v[20:23]
  s_mov_b32 s53, s54
  s_waitcnt lgkmcnt(3)
  v_mfma_f32_16x16x32_bf16 v[12:15], a[160:163], v[176:179], v[12:15]
  ds_read_b128 v[40:43], v2 offset:21504
  v_mfma_f32_16x16x32_bf16 v[16:19], a[164:167], v[176:179], v[16:19]
  ds_read_b128 v[36:39], v2 offset:20480
  v_mfma_f32_16x16x32_bf16 v[20:23], a[168:171], v[176:179], v[20:23]
  ds_write_b128 v3, v[120:123] offset:1024
  v_mfma_f32_16x16x32_bf16 v[12:15], a[172:175], v[180:183], v[12:15]
  buffer_store_dwordx4 v[148:151], v9, s[4:7], s45 offen sc1
  v_mfma_f32_16x16x32_bf16 v[16:19], a[176:179], v[180:183], v[16:19]
  v_cvt_pk_bf16_f32 v156, v156, v157
  v_cvt_pk_bf16_f32 v157, v158, v159
  v_mfma_f32_16x16x32_bf16 v[20:23], a[180:183], v[180:183], v[20:23]
  v_min_u32 v156, -2, v156
  s_waitcnt lgkmcnt(4)
  v_mfma_f32_16x16x32_bf16 v[12:15], a[184:187], v[28:31], v[12:15]
  ds_read_b128 v[180:183], v2 offset:23552
  v_mfma_f32_16x16x32_bf16 v[16:19], a[188:191], v[28:31], v[16:19]
  ds_read_b128 v[176:179], v2 offset:22528
  v_mfma_f32_16x16x32_bf16 v[20:23], a[192:195], v[28:31], v[20:23]
  ds_write_b128 v3, v[124:127] offset:2048
  v_mfma_f32_16x16x32_bf16 v[12:15], a[196:199], v[32:35], v[12:15]
  buffer_store_dwordx2 v[156:157], v10, s[4:7], s45 offen sc1
  v_mfma_f32_16x16x32_bf16 v[16:19], a[200:203], v[32:35], v[16:19]
  v_mfma_f32_16x16x32_bf16 v[20:23], a[204:207], v[32:35], v[20:23]
  buffer_store_dwordx4 v[172:175], v9, s[4:7], s59 offen sc1
  s_waitcnt lgkmcnt(4)
  v_mfma_f32_16x16x32_bf16 v[12:15], a[208:211], v[36:39], v[12:15]
  ds_write_b128 v3, v[128:131] offset:3072
  v_mfma_f32_16x16x32_bf16 v[16:19], a[212:215], v[36:39], v[16:19]
  v_mfma_f32_16x16x32_bf16 v[20:23], a[216:219], v[36:39], v[20:23]
  v_mfma_f32_16x16x32_bf16 v[12:15], a[220:223], v[40:43], v[12:15]
  buffer_store_dwordx2 v[172:173], v10, s[4:7], s59 offen sc1
  v_mfma_f32_16x16x32_bf16 v[16:19], a[224:227], v[40:43], v[16:19]
  ds_write_b128 v3, v[132:135] offset:4096
  v_mfma_f32_16x16x32_bf16 v[20:23], a[228:231], v[40:43], v[20:23]
  s_mul_i32 s45, s36, 6
  s_add_u32 s45, s45, s50
  s_waitcnt lgkmcnt(3)
  v_mfma_f32_16x16x32_bf16 v[12:15], a[232:235], v[176:179], v[12:15]
  s_mul_i32 s45, s45, 18432
  s_add_u32 s45, s45, 0x9000000
  v_mfma_f32_16x16x32_bf16 v[16:19], a[236:239], v[176:179], v[16:19]
  s_add_u32 s59, s45, 0x144000
  v_mfma_f32_16x16x32_bf16 v[20:23], a[240:243], v[176:179], v[20:23]
  ds_write_b128 v3, v[136:139] offset:5120
  v_mfma_f32_16x16x32_bf16 v[12:15], a[244:247], v[180:183], v[12:15]
  s_cmp_lt_u32 s36, 116
  s_cselect_b32 s59, s59, 0x40000000
  v_mfma_f32_16x16x32_bf16 v[16:19], a[248:251], v[180:183], v[16:19]
  buffer_load_dword v113, v112, s[4:7], s56 offen sc1
  v_mfma_f32_16x16x32_bf16 v[20:23], a[252:255], v[180:183], v[20:23]
  s_mov_b32 s36, s37
  s_cmp_eq_u32 s52, 1
  s_cbranch_scc1 L_ee_deep1
  s_mov_b32 s57, 0
  s_branch L_ee_fin0
.p2align 6
L_ee_deep1:
  s_waitcnt lgkmcnt(0)
  s_barrier
  v_xor_b32 v2, 0x10000, v2
  v_xor_b32 v3, 0x10000, v3
  ds_read_b128 v[28:31], v2 offset:0
  ds_read_b128 v[32:35], v2 offset:1024
  ds_read_b128 v[40:43], v2 offset:3072
  ds_read_b128 v[36:39], v2 offset:2048
  s_waitcnt lgkmcnt(3)
  v_mfma_f32_16x16x32_bf16 v[148:151], v[224:227], v[28:31], 0
  ds_read_b128 v[180:183], v2 offset:5120
  v_mfma_f32_16x16x32_bf16 v[152:155], v[228:231], v[28:31], 0
  ds_read_b128 v[176:179], v2 offset:4096
  s_add_u32 s37, s36, 2
  v_mfma_f32_16x16x32_bf16 v[156:159], v[232:235], v[28:31], 0
  s_add_u32 s55, s36, 4
  v_cvt_pk_bf16_f32 v12, v12, v13
  s_waitcnt lgkmcnt(4)
  v_mfma_f32_16x16x32_bf16 v[148:151], v[236:239], v[32:35], v[148:151]
  s_mul_i32 s38, s55, 6
  v_cvt_pk_bf16_f32 v13, v14, v15
  v_mfma_f32_16x16x32_bf16 v[152:155], v[240:243], v[32:35], v[152:155]
  s_add_u32 s38, s38, s50
  v_cvt_pk_bf16_f32 v14, v16, v17
  v_mfma_f32_16x16x32_bf16 v[156:159], v[244:247], v[32:35], v[156:159]
  s_mul_i32 s38, s38, 24576
  s_waitcnt lgkmcnt(2)
  v_mfma_f32_16x16x32_bf16 v[148:151], v[248:251], v[36:39], v[148:151]
  ds_read_b128 v[32:35], v2 offset:7168
  s_add_u32 s38, s38, 0x5000000
  v_mfma_f32_16x16x32_bf16 v[152:155], v[252:255], v[36:39], v[152:155]
  ds_read_b128 v[28:31], v2 offset:6144
  s_sub_u32 s56, s38, 0x48000
  v_mfma_f32_16x16x32_bf16 v[156:159], a[0:3], v[36:39], v[156:159]
  s_cmp_lt_u32 s55, 110
  v_cvt_pk_bf16_f32 v15, v18, v19
  v_mfma_f32_16x16x32_bf16 v[148:151], a[4:7], v[40:43], v[148:151]
  s_cselect_b32 s54, 1, 0
  v_min_u32 v12, -2, v12
  v_mfma_f32_16x16x32_bf16 v[152:155], a[8:11], v[40:43], v[152:155]
  s_cselect_b32 s38, s38, 0x40000000
  v_mfma_f32_16x16x32_bf16 v[156:159], a[12:15], v[40:43], v[156:159]
  s_add_u32 s39, s38, 4096
  s_waitcnt lgkmcnt(2)
  v_mfma_f32_16x16x32_bf16 v[148:151], a[16:19], v[176:179], v[148:151]
  ds_read_b128 v[40:43], v2 offset:9216
  v_mfma_f32_16x16x32_bf16 v[152:155], a[20:23], v[176:179], v[152:155]
  ds_read_b128 v[36:39], v2 offset:8192
  v_mfma_f32_16x16x32_bf16 v[156:159], a[24:27], v[176:179], v[156:159]
  buffer_load_dwordx4 v[116:119], v4, s[4:7], s38 offen offset:0 sc1
  v_mfma_f32_16x16x32_bf16 v[148:151], a[28:31], v[180:183], v[148:151]
  v_mfma_f32_16x16x32_bf16 v[152:155], a[32:35], v[180:183], v[152:155]
  v_mfma_f32_16x16x32_bf16 v[156:159], a[36:39], v[180:183], v[156:159]
  s_waitcnt lgkmcnt(2)
  v_mfma_f32_16x16x32_bf16 v[148:151], a[40:43], v[28:31], v[148:151]
  ds_read_b128 v[180:183], v2 offset:11264
  v_mfma_f32_16x16x32_bf16 v[152:155], a[44:47], v[28:31], v[152:155]
  ds_read_b128 v[176:179], v2 offset:10240
  v_mfma_f32_16x16x32_bf16 v[156:159], a[48:51], v[28:31], v[156:159]
  buffer_load_dwordx4 v[120:123], v4, s[4:7], s38 offen offset:1024 sc1
  v_mfma_f32_16x16x32_bf16 v[148:151], a[52:55], v[32:35], v[148:151]
  v_mfma_f32_16x16x32_bf16 v[152:155], a[56:59], v[32:35], v[152:155]
  v_mfma_f32_16x16x32_bf16 v[156:159], a[60:63], v[32:35], v[156:159]
  s_waitcnt lgkmcnt(2)
  v_mfma_f32_16x16x32_bf16 v[148:151], a[64:67], v[36:39], v[148:151]
  ds_read_b128 v[32:35], v2 offset:13312
  v_mfma_f32_16x16x32_bf16 v[152:155], a[68:71], v[36:39], v[152:155]
  ds_read_b128 v[28:31], v2 offset:12288
  v_mfma_f32_16x16x32_bf16 v[156:159], a[72:75], v[36:39], v[156:159]
  buffer_load_dwordx4 v[124:127], v4, s[4:7], s38 offen offset:2048 sc1
  v_mfma_f32_16x16x32_bf16 v[148:151], a[76:79], v[40:43], v[148:151]
  v_mfma_f32_16x16x32_bf16 v[152:155], a[80:83], v[40:43], v[152:155]
  v_mfma_f32_16x16x32_bf16 v[156:159], a[84:87], v[40:43], v[156:159]
  s_waitcnt lgkmcnt(2)
  v_mfma_f32_16x16x32_bf16 v[148:151], a[88:91], v[176:179], v[148:151]
  ds_read_b128 v[40:43], v2 offset:15360
  v_mfma_f32_16x16x32_bf16 v[152:155], a[92:95], v[176:179], v[152:155]
  ds_read_b128 v[36:39], v2 offset:14336
  v_mfma_f32_16x16x32_bf16 v[156:159], a[96:99], v[176:179], v[156:159]
  buffer_load_dwordx4 v[128:131], v4, s[4:7], s38 offen offset:3072 sc1
  v_mfma_f32_16x16x32_bf16 v[148:151], a[100:103], v[180:183], v[148:151]
  v_mfma_f32_16x16x32_bf16 v[152:155], a[104:107], v[180:183], v[152:155]
  v_mfma_f32_16x16x32_bf16 v[156:159], a[108:111], v[180:183], v[156:159]
  s_waitcnt lgkmcnt(2)
  v_mfma_f32_16x16x32_bf16 v[148:151], a[112:115], v[28:31], v[148:151]
  ds_read_b128 v[180:183], v2 offset:17408
  v_mfma_f32_16x16x32_bf16 v[152:155], a[116:119], v[28:31], v[152:155]
  ds_read_b128 v[176:179], v2 offset:16384
  v_mfma_f32_16x16x32_bf16 v[156:159], a[120:123], v[28:31], v[156:159]
  buffer_load_dwordx4 v[132:135], v4, s[4:7], s39 offen offset:0 sc1
  v_mfma_f32_16x16x32_bf16 v[148:151], a[124:127], v[32:35], v[148:151]
  v_mfma_f32_16x16x32_bf16 v[152:155], a[128:131], v[32:35], v[152:155]
  s_waitcnt vmcnt(5)
  v_max_u32 v8, v44, v48
  v_mfma_f32_16x16x32_bf16 v[156:159], a[132:135], v[32:35], v[156:159]
  v_max3_u32 v8, v8, v52, v56
  s_waitcnt lgkmcnt(2)
  v_mfma_f32_16x16x32_bf16 v[148:151], a[136:139], v[36:39], v[148:151]
  ds_read_b128 v[32:35], v2 offset:19456
  v_max3_u32 v8, v8, v60, v64
  v_mfma_f32_16x16x32_bf16 v[152:155], a[140:143], v[36:39], v[152:155]
  ds_read_b128 v[28:31], v2 offset:18432
  v_cmp_eq_u32 vcc, -1, v8
  v_mfma_f32_16x16x32_bf16 v[156:159], a[144:147], v[36:39], v[156:159]
  buffer_load_dwordx4 v[136:139], v4, s[4:7], s39 offen offset:1024 sc1
  v_mfma_f32_16x16x32_bf16 v[148:151], a[148:151], v[40:43], v[148:151]
  ds_write_b128 v3, v[44:47] offset:0
  v_mfma_f32_16x16x32_bf16 v[152:155], a[152:155], v[40:43], v[152:155]
  s_cmp_eq_u64 vcc, 0
  s_cselect_b32 s52, s53, 0
  v_mfma_f32_16x16x32_bf16 v[156:159], a[156:159], v[40:43], v[156:159]
  s_mov_b32 s53, s54
  s_waitcnt lgkmcnt(3)
  v_mfma_f32_16x16x32_bf16 v[148:151], a[160:163], v[176:179], v[148:151]
  ds_read_b128 v[40:43], v2 offset:21504
  v_mfma_f32_16x16x32_bf16 v[152:155], a[164:167], v[176:179], v[152:155]
  ds_read_b128 v[36:39], v2 offset:20480
  v_mfma_f32_16x16x32_bf16 v[156:159], a[168:171], v[176:179], v[156:159]
  ds_write_b128 v3, v[48:51] offset:1024
  v_mfma_f32_16x16x32_bf16 v[148:151], a[172:175], v[180:183], v[148:151]
  buffer_store_dwordx4 v[12:15], v9, s[4:7], s45 offen sc1
  v_mfma_f32_16x16x32_bf16 v[152:155], a[176:179], v[180:183], v[152:155]
  v_cvt_pk_bf16_f32 v20, v20, v21
  v_cvt_pk_bf16_f32 v21, v22, v23
  v_mfma_f32_16x16x32_bf16 v[156:159], a[180:183], v[180:183], v[156:159]
  v_min_u32 v20, -2, v20
  s_waitcnt lgkmcnt(4)
  v_mfma_f32_16x16x32_bf16 v[148:151], a[184:187], v[28:31], v[148:151]
  ds_read_b128 v[180:183], v2 offset:23552
  v_mfma_f32_16x16x32_bf16 v[152:155], a[188:191], v[28:31], v[152:155]
  ds_read_b128 v[176:179], v2 offset:22528
  v_mfma_f32_16x16x32_bf16 v[156:159], a[192:195], v[28:31], v[156:159]
  ds_write_b128 v3, v[52:55] offset:2048
  v_mfma_f32_16x16x32_bf16 v[148:151], a[196:199], v[32:35], v[148:151]
  buffer_store_dwordx2 v[20:21], v10, s[4:7], s45 offen sc1
  v_mfma_f32_16x16x32_bf16 v[152:155], a[200:203], v[32:35], v[152:155]
  v_mfma_f32_16x16x32_bf16 v[156:159], a[204:207], v[32:35], v[156:159]
  buffer_store_dwordx4 v[172:175], v9, s[4:7], s59 offen sc1
  s_waitcnt lgkmcnt(4)
  v_mfma_f32_16x16x32_bf16 v[148:151], a[208:211], v[36:39], v[148:151]
  ds_write_b128 v3, v[56:59] offset:3072
  v_mfma_f32_16x16x32_bf16 v[152:155], a[212:215], v[36:39], v[152:155]
  v_mfma_f32_16x16x32_bf16 v[156:159], a[216:219], v[36:39], v[156:159]
  v_mfma_f32_16x16x32_bf16 v[148:151], a[220:223], v[40:43], v[148:151]
  buffer_store_dwordx2 v[172:173], v10, s[4:7], s59 offen sc1
  v_mfma_f32_16x16x32_bf16 v[152:155], a[224:227], v[40:43], v[152:155]
  ds_write_b128 v3, v[60:63] offset:4096
  v_mfma_f32_16x16x32_bf16 v[156:159], a[228:231], v[40:43], v[156:159]
  s_mul_i32 s45, s36, 6
  s_add_u32 s45, s45, s50
  s_waitcnt lgkmcnt(3)
  v_mfma_f32_16x16x32_bf16 v[148:151], a[232:235], v[176:179], v[148:151]
  s_mul_i32 s45, s45, 18432
  s_add_u32 s45, s45, 0x9000000
  v_mfma_f32_16x16x32_bf16 v[152:155], a[236:239], v[176:179], v[152:155]
  s_add_u32 s59, s45, 0x144000
  v_mfma_f32_16x16x32_bf16 v[156:159], a[240:243], v[176:179], v[156:159]
  ds_write_b128 v3, v[64:67] offset:5120
  v_mfma_f32_16x16x32_bf16 v[148:151], a[244:247], v[180:183], v[148:151]
  s_cmp_lt_u32 s36, 116
  s_cselect_b32 s59, s59, 0x40000000
  v_mfma_f32_16x16x32_bf16 v[152:155], a[248:251], v[180:183], v[152:155]
  buffer_load_dword v113, v112, s[4:7], s56 offen sc1
  v_mfma_f32_16x16x32_bf16 v[156:159], a[252:255], v[180:183], v[156:159]
  s_mov_b32 s36, s37
  s_cmp_eq_u32 s52, 1
  s_cbranch_scc1 L_ee_deep0
  s_mov_b32 s57, 0
  s_branch L_ee_fin1
.p2align 6
L_ee_go0:
  s_waitcnt lgkmcnt(0)
  s_barrier
  v_xor_b32 v2, 0x10000, v2
  v_xor_b32 v3, 0x10000, v3
  ds_read_b128 v[28:31], v2 offset:0
  ds_read_b128 v[32:35], v2 offset:1024
  ds_read_b128 v[40:43], v2 offset:3072
  ds_read_b128 v[36:39], v2 offset:2048
  s_waitcnt lgkmcnt(3)
  v_mfma_f32_16x16x32_bf16 v[12:15], v[224:227], v[28:31], 0
  ds_read_b128 v[180:183], v2 offset:5120
  v_mfma_f32_16x16x32_bf16 v[16:19], v[228:231], v[28:31], 0
  ds_read_b128 v[176:179], v2 offset:4096
  s_add_u32 s37, s36, 2
  v_mfma_f32_16x16x32_bf16 v[20:23], v[232:235], v[28:31], 0
  s_mul_i32 s38, s37, 6
  s_waitcnt lgkmcnt(4)
  v_mfma_f32_16x16x32_bf16 v[12:15], v[236:239], v[32:35], v[12:15]
  s_add_u32 s38, s38, s50
  v_mfma_f32_16x16x32_bf16 v[16:19], v[240:243], v[32:35], v[16:19]
  s_mul_i32 s38, s38, 24576
  v_mfma_f32_16x16x32_bf16 v[20:23], v[244:247], v[32:35], v[20:23]
  s_add_u32 s38, s38, 0x5000000
  s_waitcnt lgkmcnt(2)
  v_mfma_f32_16x16x32_bf16 v[12:15], v[248:251], v[36:39], v[12:15]
  ds_read_b128 v[32:35], v2 offset:7168
  s_sub_u32 s56, s38, 0x0
  v_mfma_f32_16x16x32_bf16 v[16:19], v[252:255], v[36:39], v[16:19]
  ds_read_b128 v[28:31], v2 offset:6144
  s_cmp_lt_u32 s37, 128
  v_mfma_f32_16x16x32_bf16 v[20:23], a[0:3], v[36:39], v[20:23]
  s_cselect_b32 s38, s38, 0x40000000
  v_mfma_f32_16x16x32_bf16 v[12:15], a[4:7], v[40:43], v[12:15]
  s_add_u32 s39, s38, 4096
  v_mfma_f32_16x16x32_bf16 v[16:19], a[8:11], v[40:43], v[16:19]
  s_mul_i32 s45, s36, 6
  s_add_u32 s45, s45, s50
  v_mfma_f32_16x16x32_bf16 v[20:23], a[12:15], v[40:43], v[20:23]
  s_mul_i32 s45, s45, 18432
  s_waitcnt lgkmcnt(2)
  v_mfma_f32_16x16x32_bf16 v[12:15], a[16:19], v[176:179], v[12:15]
  ds_read_b128 v[40:43], v2 offset:9216
  s_add_u32 s45, s45, 0x9000000
  v_mfma_f32_16x16x32_bf16 v[16:19], a[20:23], v[176:179], v[16:19]
  ds_read_b128 v[36:39], v2 offset:8192
  s_add_u32 s59, s45, 0x144000
  v_mfma_f32_16x16x32_bf16 v[20:23], a[24:27], v[176:179], v[20:23]
  s_cmp_lt_u32 s36, 116
  s_cselect_b32 s59, s59, 0x40000000
  v_mfma_f32_16x16x32_bf16 v[12:15], a[28:31], v[180:183], v[12:15]
  v_mfma_f32_16x16x32_bf16 v[16:19], a[32:35], v[180:183], v[16:19]
  v_mfma_f32_16x16x32_bf16 v[20:23], a[36:39], v[180:183], v[20:23]
  s_waitcnt lgkmcnt(2)
  v_mfma_f32_16x16x32_bf16 v[12:15], a[40:43], v[28:31], v[12:15]
  ds_read_b128 v[180:183], v2 offset:11264
  v_mfma_f32_16x16x32_bf16 v[16:19], a[44:47], v[28:31], v[16:19]
  ds_read_b128 v[176:179], v2 offset:10240
  v_mfma_f32_16x16x32_bf16 v[20:23], a[48:51], v[28:31], v[20:23]
  v_mfma_f32_16x16x32_bf16 v[12:15], a[52:55], v[32:35], v[12:15]
  v_mfma_f32_16x16x32_bf16 v[16:19], a[56:59], v[32:35], v[16:19]
  v_mfma_f32_16x16x32_bf16 v[20:23], a[60:63], v[32:35], v[20:23]
  s_waitcnt lgkmcnt(2)
  v_mfma_f32_16x16x32_bf16 v[12:15], a[64:67], v[36:39], v[12:15]
  ds_read_b128 v[32:35], v2 offset:13312
  v_mfma_f32_16x16x32_bf16 v[16:19], a[68:71], v[36:39], v[16:19]
  ds_read_b128 v[28:31], v2 offset:12288
  v_mfma_f32_16x16x32_bf16 v[20:23], a[72:75], v[36:39], v[20:23]
  buffer_load_dwordx4 v[44:47], v4, s[4:7], s38 offen offset:0 sc1
  v_mfma_f32_16x16x32_bf16 v[12:15], a[76:79], v[40:43], v[12:15]
  v_mfma_f32_16x16x32_bf16 v[16:19], a[80:83], v[40:43], v[16:19]
  v_mfma_f32_16x16x32_bf16 v[20:23], a[84:87], v[40:43], v[20:23]
  s_waitcnt lgkmcnt(2)
  v_mfma_f32_16x16x32_bf16 v[12:15], a[88:91], v[176:179], v[12:15]
  ds_read_b128 v[40:43], v2 offset:15360
  v_mfma_f32_16x16x32_bf16 v[16:19], a[92:95], v[176:179], v[16:19]
  ds_read_b128 v[36:39], v2 offset:14336
  v_mfma_f32_16x16x32_bf16 v[20:23], a[96:99], v[176:179], v[20:23]
  buffer_load_dwordx4 v[48:51], v4, s[4:7], s38 offen offset:1024 sc1
  v_mfma_f32_16x16x32_bf16 v[12:15], a[100:103], v[180:183], v[12:15]
  v_mfma_f32_16x16x32_bf16 v[16:19], a[104:107], v[180:183], v[16:19]
  v_mfma_f32_16x16x32_bf16 v[20:23], a[108:111], v[180:183], v[20:23]
  s_waitcnt lgkmcnt(2)
  v_mfma_f32_16x16x32_bf16 v[12:15], a[112:115], v[28:31], v[12:15]
  ds_read_b128 v[180:183], v2 offset:17408
  v_mfma_f32_16x16x32_bf16 v[16:19], a[116:119], v[28:31], v[16:19]
  ds_read_b128 v[176:179], v2 offset:16384
  v_mfma_f32_16x16x32_bf16 v[20:23], a[120:123], v[28:31], v[20:23]
  buffer_load_dwordx4 v[52:55], v4, s[4:7], s38 offen offset:2048 sc1
  v_mfma_f32_16x16x32_bf16 v[12:15], a[124:127], v[32:35], v[12:15]
  v_mfma_f32_16x16x32_bf16 v[16:19], a[128:131], v[32:35], v[16:19]
  v_mfma_f32_16x16x32_bf16 v[20:23], a[132:135], v[32:35], v[20:23]
  s_waitcnt lgkmcnt(2)
  v_mfma_f32_16x16x32_bf16 v[12:15], a[136:139], v[36:39], v[12:15]
  ds_read_b128 v[32:35], v2 offset:19456
  v_mfma_f32_16x16x32_bf16 v[16:19], a[140:143], v[36:39], v[16:19]
  ds_read_b128 v[28:31], v2 offset:18432
  v_mfma_f32_16x16x32_bf16 v[20:23], a[144:147], v[36:39], v[20:23]
  buffer_load_dwordx4 v[56:59], v4, s[4:7], s38 offen offset:3072 sc1
  v_mfma_f32_16x16x32_bf16 v[12:15], a[148:151], v[40:43], v[12:15]
  v_mfma_f32_16x16x32_bf16 v[16:19], a[152:155], v[40:43], v[16:19]
  v_mfma_f32_16x16x32_bf16 v[20:23], a[156:159], v[40:43], v[20:23]
  s_waitcnt lgkmcnt(2)
  v_mfma_f32_16x16x32_bf16 v[12:15], a[160:163], v[176:179], v[12:15]
  ds_read_b128 v[40:43], v2 offset:21504
  v_mfma_f32_16x16x32_bf16 v[16:19], a[164:167], v[176:179], v[16:19]
  ds_read_b128 v[36:39], v2 offset:20480
  v_mfma_f32_16x16x32_bf16 v[20:23], a[168:171], v[176:179], v[20:23]
  buffer_load_dwordx4 v[60:63], v4, s[4:7], s39 offen offset:0 sc1
  v_mfma_f32_16x16x32_bf16 v[12:15], a[172:175], v[180:183], v[12:15]
  v_mfma_f32_16x16x32_bf16 v[16:19], a[176:179], v[180:183], v[16:19]
  v_mfma_f32_16x16x32_bf16 v[20:23], a[180:183], v[180:183], v[20:23]
  s_waitcnt lgkmcnt(2)
  v_mfma_f32_16x16x32_bf16 v[12:15], a[184:187], v[28:31], v[12:15]
  ds_read_b128 v[180:183], v2 offset:23552
  v_mfma_f32_16x16x32_bf16 v[16:19], a[188:191], v[28:31], v[16:19]
  ds_read_b128 v[176:179], v2 offset:22528
  v_mfma_f32_16x16x32_bf16 v[20:23], a[192:195], v[28:31], v[20:23]
  buffer_load_dwordx4 v[64:67], v4, s[4:7], s39 offen offset:1024 sc1
  v_mfma_f32_16x16x32_bf16 v[12:15], a[196:199], v[32:35], v[12:15]
  v_mfma_f32_16x16x32_bf16 v[16:19], a[200:203], v[32:35], v[16:19]
  v_mfma_f32_16x16x32_bf16 v[20:23], a[204:207], v[32:35], v[20:23]
  s_waitcnt lgkmcnt(2)
  v_mfma_f32_16x16x32_bf16 v[12:15], a[208:211], v[36:39], v[12:15]
  v_mfma_f32_16x16x32_bf16 v[16:19], a[212:215], v[36:39], v[16:19]
  v_mfma_f32_16x16x32_bf16 v[20:23], a[216:219], v[36:39], v[20:23]
  v_mfma_f32_16x16x32_bf16 v[12:15], a[220:223], v[40:43], v[12:15]
  v_mfma_f32_16x16x32_bf16 v[16:19], a[224:227], v[40:43], v[16:19]
  v_mfma_f32_16x16x32_bf16 v[20:23], a[228:231], v[40:43], v[20:23]
  s_waitcnt lgkmcnt(0)
  v_mfma_f32_16x16x32_bf16 v[12:15], a[232:235], v[176:179], v[12:15]
  buffer_load_dword v113, v112, s[4:7], s56 offen sc1
  v_mfma_f32_16x16x32_bf16 v[16:19], a[236:239], v[176:179], v[16:19]
  v_mfma_f32_16x16x32_bf16 v[20:23], a[240:243], v[176:179], v[20:23]
  v_mfma_f32_16x16x32_bf16 v[12:15], a[244:247], v[180:183], v[12:15]
  v_mfma_f32_16x16x32_bf16 v[16:19], a[248:251], v[180:183], v[16:19]
  v_mfma_f32_16x16x32_bf16 v[20:23], a[252:255], v[180:183], v[20:23]
  s_mov_b32 s36, s37
  s_mov_b32 s57, 1
L_ee_fin0:
  v_cvt_pk_bf16_f32 v12, v12, v13
  v_cvt_pk_bf16_f32 v13, v14, v15
  v_cvt_pk_bf16_f32 v14, v16, v17
  v_cvt_pk_bf16_f32 v15, v18, v19
  v_min_u32 v12, -2, v12
  buffer_store_dwordx4 v[12:15], v9, s[4:7], s45 offen sc1
  v_cvt_pk_bf16_f32 v20, v20, v21
  v_cvt_pk_bf16_f32 v21, v22, v23
  v_min_u32 v20, -2, v20
  buffer_store_dwordx2 v[20:21], v10, s[4:7], s45 offen sc1
  buffer_store_dwordx4 v[172:175], v9, s[4:7], s59 offen sc1
  buffer_store_dwordx2 v[172:173], v10, s[4:7], s59 offen sc1
  s_cmp_ge_u32 s36, 128
  s_cbranch_scc1 L_ee_done
L_ee_spin1:
  s_mul_i32 s38, s36, 6
  s_add_u32 s38, s38, s50
  s_mul_i32 s38, s38, 24576
  s_add_u32 s38, s38, 0x5000000
  s_add_u32 s39, s38, 4096
  s_add_u32 s37, s36, 2
  s_cmp_lt_u32 s37, 110
  s_cselect_b32 s53, 0, s57
  s_cmp_eq_u32 s53, 1
  s_cbranch_scc1 L_ee_quick1
  s_waitcnt vmcnt(4)
  v_cmp_eq_u32 vcc, -1, v113
  s_cmp_lt_u32 s37, 110
  s_cselect_b32 s53, 1, 0
  s_bitcmp1_b32 vcc_lo, 1
  s_cselect_b32 s53, 0, s53
  s_bitcmp0_b32 vcc_lo, 0
  s_cselect_b32 s58, 1, 0
  s_cmp_eq_u32 s57, 0
  s_cbranch_scc1 L_ee_fetch1
  s_mov_b32 s58, 0
  v_max_u32 v8, v44, v48
  v_max3_u32 v8, v8, v52, v56
  v_max3_u32 v8, v8, v60, v64
  v_cmp_eq_u32 vcc, -1, v8
  s_cbranch_vccnz L_ee_fetch1
L_ee_have1:
  ds_write_b128 v3, v[44:47] offset:0
  ds_write_b128 v3, v[48:51] offset:1024
  ds_write_b128 v3, v[52:55] offset:2048
  ds_write_b128 v3, v[56:59] offset:3072
  ds_write_b128 v3, v[60:63] offset:4096
  ds_write_b128 v3, v[64:67] offset:5120
  s_branch L_ee_staged1
L_ee_quick1:
  s_mov_b32 s53, 0
  s_waitcnt vmcnt(5)
  v_max_u32 v8, v44, v48
  v_max3_u32 v8, v8, v52, v56
  v_max3_u32 v8, v8, v60, v64
  v_cmp_eq_u32 vcc, -1, v8
  s_cbranch_vccz L_ee_have1
  s_waitcnt vmcnt(4)
  v_cmp_eq_u32 vcc, -1, v113
  s_bitcmp0_b32 vcc_lo, 0
  s_cselect_b32 s58, 1, 0
L_ee_fetch1:
  s_cmp_eq_u32 s58, 1
  s_mov_b32 s49, 0
  s_cbranch_scc1 L_spind_51_s
L_spin_49:
  s_cmp_ge_u32 s36, 120
  s_cbranch_scc1 L_spind_51_s
  s_mov_b64 exec, 0x1
L_spind_51:
  buffer_load_dword v8, v4, s[4:7], s38 offen offset:0 sc1
  s_add_u32 s49, s49, 1
  s_cmp_ge_u32 s49, 1048576
  s_cbranch_scc1 L_fail
  s_waitcnt vmcnt(0)
  v_cmp_eq_u32 vcc, -1, v8
  s_cbranch_vccnz L_spind_51
  s_mov_b64 exec, -1
L_spind_51_s:
  buffer_load_dwordx4 v[116:119], v4, s[4:7], s38 offen offset:0 sc1
  buffer_load_dwordx4 v[120:123], v4, s[4:7], s38 offen offset:1024 sc1
  buffer_load_dwordx4 v[124:127], v4, s[4:7], s38 offen offset:2048 sc1
  buffer_load_dwordx4 v[128:131], v4, s[4:7], s38 offen offset:3072 sc1
  buffer_load_dwordx4 v[132:135], v4, s[4:7], s39 offen offset:0 sc1
  buffer_load_dwordx4 v[136:139], v4, s[4:7], s39 offen offset:1024 sc1
  s_add_u32 s49, s49, 1
  s_cmp_ge_u32 s49, 1048576
  s_cbranch_scc1 L_fail
  s_waitcnt vmcnt(4)
  v_max_u32 v8, v116, v120
  s_waitcnt vmcnt(2)
  v_max3_u32 v8, v8, v124, v128
  s_waitcnt vmcnt(0)
  v_max3_u32 v8, v8, v132, v136
  v_cmp_eq_u32 vcc, -1, v8
  s_cbranch_vccnz L_spin_49
L_spinc_50:
  ds_write_b128 v3, v[116:119] offset:0
  ds_write_b128 v3, v[120:123] offset:1024
  ds_write_b128 v3, v[124:127] offset:2048
  ds_write_b128 v3, v[128:131] offset:3072
  ds_write_b128 v3, v[132:135] offset:4096
  ds_write_b128 v3, v[136:139] offset:5120
L_ee_staged1:
  s_cmp_eq_u32 s53, 0
  s_cbranch_scc1 L_ee_go1
  s_waitcnt lgkmcnt(0)
  s_mul_i32 s38, s37, 6
  s_add_u32 s38, s38, s50
  s_mul_i32 s38, s38, 24576
  s_add_u32 s38, s38, 0x5000000
  s_add_u32 s39, s38, 4096
  buffer_load_dwordx4 v[44:47], v4, s[4:7], s38 offen offset:0 sc1
  buffer_load_dwordx4 v[48:51], v4, s[4:7], s38 offen offset:1024 sc1
  buffer_load_dwordx4 v[52:55], v4, s[4:7], s38 offen offset:2048 sc1
  buffer_load_dwordx4 v[56:59], v4, s[4:7], s38 offen offset:3072 sc1
  buffer_load_dwordx4 v[60:63], v4, s[4:7], s39 offen offset:0 sc1
  buffer_load_dwordx4 v[64:67], v4, s[4:7], s39 offen offset:1024 sc1
  s_mov_b32 s45, 0x40000000
  s_mov_b32 s59, 0x40000000
  s_branch L_ee_deep1
.p2align 6
L_ee_go1:
  s_waitcnt lgkmcnt(0)
  s_barrier
  v_xor_b32 v2, 0x10000, v2
  v_xor_b32 v3, 0x10000, v3
  ds_read_b128 v[28:31], v2 offset:0
  ds_read_b128 v[32:35], v2 offset:1024
  ds_read_b128 v[40:43], v2 offset:3072
  ds_read_b128 v[36:39], v2 offset:2048
  s_waitcnt lgkmcnt(3)
  v_mfma_f32_16x16x32_bf16 v[148:151], v[224:227], v[28:31], 0
  ds_read_b128 v[180:183], v2 offset:5120
  v_mfma_f32_16x16x32_bf16 v[152:155], v[228:231], v[28:31], 0
  ds_read_b128 v[176:179], v2 offset:4096
  s_add_u32 s37, s36, 2
  v_mfma_f32_16x16x32_bf16 v[156:159], v[232:235], v[28:31], 0
  s_mul_i32 s38, s37, 6
  s_waitcnt lgkmcnt(4)
  v_mfma_f32_16x16x32_bf16 v[148:151], v[236:239], v[32:35], v[148:151]
  s_add_u32 s38, s38, s50
  v_mfma_f32_16x16x32_bf16 v[152:155], v[240:243], v[32:35], v[152:155]
  s_mul_i32 s38, s38, 24576
  v_mfma_f32_16x16x32_bf16 v[156:159], v[244:247], v[32:35], v[156:159]
  s_add_u32 s38, s38, 0x5000000
  s_waitcnt lgkmcnt(2)
  v_mfma_f32_16x16x32_bf16 v[148:151], v[248:251], v[36:39], v[148:151]
  ds_read_b128 v[32:35], v2 offset:7168
  s_sub_u32 s56, s38, 0x0
  v_mfma_f32_16x16x32_bf16 v[152:155], v[252:255], v[36:39], v[152:155]
  ds_read_b128 v[28:31], v2 offset:6144
  s_cmp_lt_u32 s37, 128
  v_mfma_f32_16x16x32_bf16 v[156:159], a[0:3], v[36:39], v[156:159]
  s_cselect_b32 s38, s38, 0x40000000
  v_mfma_f32_16x16x32_bf16 v[148:151], a[4:7], v[40:43], v[148:151]
  s_add_u32 s39, s38, 4096
  v_mfma_f32_16x16x32_bf16 v[152:155], a[8:11], v[40:43], v[152:155]
  s_mul_i32 s45, s36, 6
  s_add_u32 s45, s45, s50
  v_mfma_f32_16x16x32_bf16 v[156:159], a[12:15], v[40:43], v[156:159]
  s_mul_i32 s45, s45, 18432
  s_waitcnt lgkmcnt(2)
  v_mfma_f32_16x16x32_bf16 v[148:151], a[16:19], v[176:179], v[148:151]
  ds_read_b128 v[40:43], v2 offset:9216
  s_add_u32 s45, s45, 0x9000000
  v_mfma_f32_16x16x32_bf16 v[152:155], a[20:23], v[176:179], v[152:155]
  ds_read_b128 v[36:39], v2 offset:8192
  s_add_u32 s59, s45, 0x144000
  v_mfma_f32_16x16x32_bf16 v[156:159], a[24:27], v[176:179], v[156:159]
  s_cmp_lt_u32 s36, 116
  s_cselect_b32 s59, s59, 0x40000000
  v_mfma_f32_16x16x32_bf16 v[148:151], a[28:31], v[180:183], v[148:151]
  v_mfma_f32_16x16x32_bf16 v[152:155], a[32:35], v[180:183], v[152:155]
  v_mfma_f32_16x16x32_bf16 v[156:159], a[36:39], v[180:183], v[156:159]
  s_waitcnt lgkmcnt(2)
  v_mfma_f32_16x16x32_bf16 v[148:151], a[40:43], v[28:31], v[148:151]
  ds_read_b128 v[180:183], v2 offset:11264
  v_mfma_f32_16x16x32_bf16 v[152:155], a[44:47], v[28:31], v[152:155]
  ds_read_b128 v[176:179], v2 offset:10240
  v_mfma_f32_16x16x32_bf16 v[156:159], a[48:51], v[28:31], v[156:159]
  v_mfma_f32_16x16x32_bf16 v[148:151], a[52:55], v[32:35], v[148:151]
  v_mfma_f32_16x16x32_bf16 v[152:155], a[56:59], v[32:35], v[152:155]
  v_mfma_f32_16x16x32_bf16 v[156:159], a[60:63], v[32:35], v[156:159]
  s_waitcnt lgkmcnt(2)
  v_mfma_f32_16x16x32_bf16 v[148:151], a[64:67], v[36:39], v[148:151]
  ds_read_b128 v[32:35], v2 offset:13312
  v_mfma_f32_16x16x32_bf16 v[152:155], a[68:71], v[36:39], v[152:155]
  ds_read_b128 v[28:31], v2 offset:12288
  v_mfma_f32_16x16x32_bf16 v[156:159], a[72:75], v[36:39], v[156:159]
  buffer_load_dwordx4 v[116:119], v4, s[4:7], s38 offen offset:0 sc1
  v_mfma_f32_16x16x32_bf16 v[148:151], a[76:79], v[40:43], v[148:151]
  v_mfma_f32_16x16x32_bf16 v[152:155], a[80:83], v[40:43], v[152:155]
  v_mfma_f32_16x16x32_bf16 v[156:159], a[84:87], v[40:43], v[156:159]
  s_waitcnt lgkmcnt(2)
  v_mfma_f32_16x16x32_bf16 v[148:151], a[88:91], v[176:179], v[148:151]
  ds_read_b128 v[40:43], v2 offset:15360
  v_mfma_f32_16x16x32_bf16 v[152:155], a[92:95], v[176:179], v[152:155]
  ds_read_b128 v[36:39], v2 offset:14336
  v_mfma_f32_16x16x32_bf16 v[156:159], a[96:99], v[176:179], v[156:159]
  buffer_load_dwordx4 v[120:123], v4, s[4:7], s38 offen offset:1024 sc1
  v_mfma_f32_16x16x32_bf16 v[148:151], a[100:103], v[180:183], v[148:151]
  v_mfma_f32_16x16x32_bf16 v[152:155], a[104:107], v[180:183], v[152:155]
  v_mfma_f32_16x16x32_bf16 v[156:159], a[108:111], v[180:183], v[156:159]
  s_waitcnt lgkmcnt(2)
  v_mfma_f32_16x16x32_bf16 v[148:151], a[112:115], v[28:31], v[148:151]
  ds_read_b128 v[180:183], v2 offset:17408
  v_mfma_f32_16x16x32_bf16 v[152:155], a[116:119], v[28:31], v[152:155]
  ds_read_b128 v[176:179], v2 offset:16384
  v_mfma_f32_16x16x32_bf16 v[156:159], a[120:123], v[28:31], v[156:159]
  buffer_load_dwordx4 v[124:127], v4, s[4:7], s38 offen offset:2048 sc1
  v_mfma_f32_16x16x32_bf16 v[148:151], a[124:127], v[32:35], v[148:151]
  v_mfma_f32_16x16x32_bf16 v[152:155], a[128:131], v[32:35], v[152:155]
  v_mfma_f32_16x16x32_bf16 v[156:159], a[132:135], v[32:35], v[156:159]
  s_waitcnt lgkmcnt(2)
  v_mfma_f32_16x16x32_bf16 v[148:151], a[136:139], v[36:39], v[148:151]
  ds_read_b128 v[32:35], v2 offset:19456
  v_mfma_f32_16x16x32_bf16 v[152:155], a[140:143], v[36:39], v[152:155]
  ds_read_b128 v[28:31], v2 offset:18432
  v_mfma_f32_16x16x32_bf16 v[156:159], a[144:147], v[36:39], v[156:159]
  buffer_load_dwordx4 v[128:131], v4, s[4:7], s38 offen offset:3072 sc1
  v_mfma_f32_16x16x32_bf16 v[148:151], a[148:151], v[40:43], v[148:151]
  v_mfma_f32_16x16x32_bf16 v[152:155], a[152:155], v[40:43], v[152:155]
  v_mfma_f32_16x16x32_bf16 v[156:159], a[156:159], v[40:43], v[156:159]
  s_waitcnt lgkmcnt(2)
  v_mfma_f32_16x16x32_bf16 v[148:151], a[160:163], v[176:179], v[148:151]
  ds_read_b128 v[40:43], v2 offset:21504
  v_mfma_f32_16x16x32_bf16 v[152:155], a[164:167], v[176:179], v[152:155]
  ds_read_b128 v[36:39], v2 offset:20480
  v_mfma_f32_16x16x32_bf16 v[156:159], a[168:171], v[176:179], v[156:159]
  buffer_load_dwordx4 v[132:135], v4, s[4:7], s39 offen offset:0 sc1
  v_mfma_f32_16x16x32_bf16 v[148:151], a[172:175], v[180:183], v[148:151]
  v_mfma_f32_16x16x32_bf16 v[152:155], a[176:179], v[180:183], v[152:155]
  v_mfma_f32_16x16x32_bf16 v[156:159], a[180:183], v[180:183], v[156:159]
  s_waitcnt lgkmcnt(2)
  v_mfma_f32_16x16x32_bf16 v[148:151], a[184:187], v[28:31], v[148:151]
  ds_read_b128 v[180:183], v2 offset:23552
  v_mfma_f32_16x16x32_bf16 v[152:155], a[188:191], v[28:31], v[152:155]
  ds_read_b128 v[176:179], v2 offset:22528
  v_mfma_f32_16x16x32_bf16 v[156:159], a[192:195], v[28:31], v[156:159]
  buffer_load_dwordx4 v[136:139], v4, s[4:7], s39 offen offset:1024 sc1
  v_mfma_f32_16x16x32_bf16 v[148:151], a[196:199], v[32:35], v[148:151]
  v_mfma_f32_16x16x32_bf16 v[152:155], a[200:203], v[32:35], v[152:155]
  v_mfma_f32_16x16x32_bf16 v[156:159], a[204:207], v[32:35], v[156:159]
  s_waitcnt lgkmcnt(2)
  v_mfma_f32_16x16x32_bf16 v[148:151], a[208:211], v[36:39], v[148:151]
  v_mfma_f32_16x16x32_bf16 v[152:155], a[212:215], v[36:39], v[152:155]
  v_mfma_f32_16x16x32_bf16 v[156:159], a[216:219], v[36:39], v[156:159]
  v_mfma_f32_16x16x32_bf16 v[148:151], a[220:223], v[40:43], v[148:151]
  v_mfma_f32_16x16x32_bf16 v[152:155], a[224:227], v[40:43], v[152:155]
  v_mfma_f32_16x16x32_bf16 v[156:159], a[228:231], v[40:43], v[156:159]
  s_waitcnt lgkmcnt(0)
  v_mfma_f32_16x16x32_bf16 v[148:151], a[232:235], v[176:179], v[148:151]
  buffer_load_dword v113, v112, s[4:7], s56 offen sc1
  v_mfma_f32_16x16x32_bf16 v[152:155], a[236:239], v[176:179], v[152:155]
  v_mfma_f32_16x16x32_bf16 v[156:159], a[240:243], v[176:179], v[156:159]
  v_mfma_f32_16x16x32_bf16 v[148:151], a[244:247], v[180:183], v[148:151]
  v_mfma_f32_16x16x32_bf16 v[152:155], a[248:251], v[180:183], v[152:155]
  v_mfma_f32_16x16x32_bf16 v[156:159], a[252:255], v[180:183], v[156:159]
  s_mov_b32 s36, s37
  s_mov_b32 s57, 1
L_ee_fin1:
  v_cvt_pk_bf16_f32 v148, v148, v149
  v_cvt_pk_bf16_f32 v149, v150, v151
  v_cvt_pk_bf16_f32 v150, v152, v153
  v_cvt_pk_bf16_f32 v151, v154, v155
  v_min_u32 v148, -2, v148
  buffer_store_dwordx4 v[148:151], v9, s[4:7], s45 offen sc1
  v_cvt_pk_bf16_f32 v156, v156, v157
  v_cvt_pk_bf16_f32 v157, v158, v159
  v_min_u32 v156, -2, v156
  buffer_store_dwordx2 v[156:157], v10, s[4:7], s45 offen sc1
  buffer_store_dwordx4 v[172:175], v9, s[4:7], s59 offen sc1
  buffer_store_dwordx2 v[172:173], v10, s[4:7], s59 offen sc1
  s_cmp_ge_u32 s36, 128
  s_cbranch_scc1 L_ee_done
L_ee_spin0:
  s_mul_i32 s38, s36, 6
  s_add_u32 s38, s38, s50
  s_mul_i32 s38, s38, 24576
  s_add_u32 s38, s38, 0x5000000
  s_add_u32 s39, s38, 4096
  s_add_u32 s37, s36, 2
  s_cmp_lt_u32 s37, 110
  s_cselect_b32 s53, 0, s57
  s_cmp_eq_u32 s53, 1
  s_cbranch_scc1 L_ee_quick0
  s_waitcnt vmcnt(4)
  v_cmp_eq_u32 vcc, -1, v113
  s_cmp_lt_u32 s37, 110
  s_cselect_b32 s53, 1, 0
  s_bitcmp1_b32 vcc_lo, 1
  s_cselect_b32 s53, 0, s53
  s_bitcmp0_b32 vcc_lo, 0
  s_cselect_b32 s58, 1, 0
  s_cmp_eq_u32 s57, 0
  s_cbranch_scc1 L_ee_fetch0
  s_mov_b32 s58, 0
  v_max_u32 v8, v116, v120
  v_max3_u32 v8, v8, v124, v128
  v_max3_u32 v8, v8, v132, v136
  v_cmp_eq_u32 vcc, -1, v8
  s_cbranch_vccnz L_ee_fetch0
L_ee_have0:
  ds_write_b128 v3, v[116:119] offset:0
  ds_write_b128 v3, v[120:123] offset:1024
  ds_write_b128 v3, v[124:127] offset:2048
  ds_write_b128 v3, v[128:131] offset:3072
  ds_write_b128 v3, v[132:135] offset:4096
  ds_write_b128 v3, v[136:139] offset:5120
  s_branch L_ee_staged0
L_ee_quick0:
  s_mov_b32 s53, 0
  s_waitcnt vmcnt(5)
  v_max_u32 v8, v116, v120
  v_max3_u32 v8, v8, v124, v128
  v_max3_u32 v8, v8, v132, v136
  v_cmp_eq_u32 vcc, -1, v8
  s_cbranch_vccz L_ee_have0
  s_waitcnt vmcnt(4)
  v_cmp_eq_u32 vcc, -1, v113
  s_bitcmp0_b32 vcc_lo, 0
  s_cselect_b32 s58, 1, 0
L_ee_fetch0:
  s_cmp_eq_u32 s58, 1
  s_mov_b32 s49, 0
  s_cbranch_scc1 L_spind_54_s
L_spin_52:
  s_cmp_ge_u32 s36, 120
  s_cbranch_scc1 L_spind_54_s
  s_mov_b64 exec, 0x1
L_spind_54:
  buffer_load_dword v8, v4, s[4:7], s38 offen offset:0 sc1
  s_add_u32 s49, s49, 1
  s_cmp_ge_u32 s49, 1048576
  s_cbranch_scc1 L_fail
  s_waitcnt vmcnt(0)
  v_cmp_eq_u32 vcc, -1, v8
  s_cbranch_vccnz L_spind_54
  s_mov_b64 exec, -1
L_spind_54_s:
  buffer_load_dwordx4 v[44:47], v4, s[4:7], s38 offen offset:0 sc1
  buffer_load_dwordx4 v[48:51], v4, s[4:7], s38 offen offset:1024 sc1
  buffer_load_dwordx4 v[52:55], v4, s[4:7], s38 offen offset:2048 sc1
  buffer_load_dwordx4 v[56:59], v4, s[4:7], s38 offen offset:3072 sc1
  buffer_load_dwordx4 v[60:63], v4, s[4:7], s39 offen offset:0 sc1
  buffer_load_dwordx4 v[64:67], v4, s[4:7], s39 offen offset:1024 sc1
  s_add_u32 s49, s49, 1
  s_cmp_ge_u32 s49, 1048576
  s_cbranch_scc1 L_fail
  s_waitcnt vmcnt(4)
  v_max_u32 v8, v44, v48
  s_waitcnt vmcnt(2)
  v_max3_u32 v8, v8, v52, v56
  s_waitcnt vmcnt(0)
  v_max3_u32 v8, v8, v60, v64
  v_cmp_eq_u32 vcc, -1, v8
  s_cbranch_vccnz L_spin_52
L_spinc_53:
  ds_write_b128 v3, v[44:47] offset:0
  ds_write_b128 v3, v[48:51] offset:1024
  ds_write_b128 v3, v[52:55] offset:2048
  ds_write_b128 v3, v[56:59] offset:3072
  ds_write_b128 v3, v[60:63] offset:4096
  ds_write_b128 v3, v[64:67] offset:5120
L_ee_staged0:
  s_cmp_eq_u32 s53, 0
  s_cbranch_scc1 L_ee_go0
  s_waitcnt lgkmcnt(0)
  s_mul_i32 s38, s37, 6
  s_add_u32 s38, s38, s50
  s_mul_i32 s38, s38, 24576
  s_add_u32 s38, s38, 0x5000000
  s_add_u32 s39, s38, 4096
  buffer_load_dwordx4 v[116:119], v4, s[4:7], s38 offen offset:0 sc1
  buffer_load_dwordx4 v[120:123], v4, s[4:7], s38 offen offset:1024 sc1
  buffer_load_dwordx4 v[124:127], v4, s[4:7], s38 offen offset:2048 sc1
  buffer_load_dwordx4 v[128:131], v4, s[4:7], s38 offen offset:3072 sc1
  buffer_load_dwordx4 v[132:135], v4, s[4:7], s39 offen offset:0 sc1
  buffer_load_dwordx4 v[136:139], v4, s[4:7], s39 offen offset:1024 sc1
  s_mov_b32 s45, 0x40000000
  s_mov_b32 s59, 0x40000000
  s_branch L_ee_deep0
L_ee_done:
  s_branch L_exit
L_role_r1:
  s_mov_b32 s28, 0
L_reg_55:
  v_mov_b32 v26, 0
  buffer_load_dword v27, v26, s[20:23], 0 offen offset:64 sc1
  s_add_u32 s28, s28, 1
  s_cmp_gt_u32 s28, 1048576
  s_cbranch_scc1 L_fail
  s_waitcnt vmcnt(0)
  v_readfirstlane_b32 s67, v27
L_regc_56:
  s_and_b32 s26, s67, 0xffff
  s_cmp_lt_u32 s26, 256
  s_cbranch_scc1 L_reg_55
  s_lshr_b32 s67, s67, 16
  s_load_dwordx2 s[12:13], s[0:1], 0
  s_mov_b32 s14, 0x240000
  s_mov_b32 s15, 0x20000
  v_and_b32 v20, 15, v1
  v_mul_u32_u24 v2, 1152, v20
  v_and_b32 v21, 48, v1
  s_lshl_b32 s26, s24, 6
  v_add3_u32 v2, v2, v21, s26
  v_lshrrev_b32 v21, 4, v1
  v_lshrrev_b32 v22, 2, v20
  v_and_b32 v23, 3, v1
  v_cmp_eq_u32 vcc, v21, v22
  s_nop 1
  v_cndmask_b32 v23, 7, v23, vcc
  v_mov_b32 v4, 0
  v_mov_b32 v5, 0
  v_mov_b32 v8, 0
  v_mov_b32 v9, 0
  v_mov_b32 v22, 0x3f80
  v_cmp_eq_u32 vcc, 0, v23
  s_nop 1
  v_cndmask_b32 v6, 0, v22, vcc
  v_mov_b32 v22, 0x3f800000
  v_cmp_eq_u32 vcc, 1, v23
  s_nop 1
  v_cndmask_b32 v6, v6, v22, vcc
  v_mov_b32 v22, 0x3f80
  v_cmp_eq_u32 vcc, 2, v23
  s_nop 1
  v_cndmask_b32 v7, 0, v22, vcc
  v_mov_b32 v22, 0x3f800000
  v_cmp_eq_u32 vcc, 3, v23
  s_nop 1
  v_cndmask_b32 v7, v7, v22, vcc
  v_mov_b32 v10, 0x3f803f80
  v_mov_b32 v11, 0x3f803f80
  v_mov_b32 v12, 0x3f803f80
  v_mov_b32 v13, 0x3f803f80
  v_lshlrev_b32 v20, 3, v20
  v_mov_b32 v15, 0x40000000
  v_cmp_eq_u32 vcc, 0, v21
  s_nop 1
  v_cndmask_b32 v15, v15, v20, vcc
  v_lshlrev_b32 v3, 2, v1
  v_mov_b32 v24, 0x40000000
  v_cmp_eq_u32 vcc, 0, v0
  s_nop 1
  v_cndmask_b32 v24, v24, 0, vcc
  v_mov_b32 v25, 1
  v_lshrrev_b32 v20, 1, v1
  v_mul_u32_u24 v20, 18432, v20
  v_and_b32 v21, 1, v1
  v_lshl_add_u32 v31, v21, 9, v20
  s_mov_b32 s36, s25
  s_mov_b32 s42, 0x2010
  v_lshrrev_b32 v30, 1, v0
  s_waitcnt lgkmcnt(0)
  v_mov_b32 v120, -1
  v_mov_b32 v121, -1
  v_mov_b32 v122, -1
  v_mov_b32 v123, -1
L_r1_top:
  s_mul_i32 s38, s36, 18432
  s_lshl_b32 s26, s24, 10
  s_add_u32 s41, s38, s26
  s_mul_i32 s37, s38, 16
  s_add_u32 s37, s37, s26
  s_add_u32 s37, s37, 0x6400000
  s_add_u32 s41, s41, 0x480000
  s_lshl_b32 s26, s36, 5
  s_add_u32 s26, s26, s24
  s_lshl_b32 s27, s26, 7
  s_add_u32 s27, s27, 0x700000
  s_add_u32 s26, s41, 0x24000
  s_add_u32 s27, s27, 0x8000
  s_cmp_lt_u32 s36, 120
  s_cselect_b32 s26, s26, 0x40000000
  s_cselect_b32 s27, s27, 0x40000000
  buffer_store_dwordx4 v[120:123], v0, s[4:7], s26 offen sc1
  buffer_store_dwordx2 v[120:121], v15, s[4:7], s27 offen sc1
  buffer_load_dwordx4 v[40:43], v2, s[12:15], s38 offen
  s_lshr_b32 s39, s36, 1
  s_lshl_b32 s39, s39, 8
  s_add_u32 s39, s39, 0x30000
  s_mov_b32 s40, 0
L_poll_57:
  buffer_load_dword v14, v3, s[4:7], s39 offen sc1
  s_waitcnt vmcnt(0)
  v_cmp_eq_u32 vcc, 0, v14
  s_cbranch_vccz L_polld_58
  s_add_u32 s40, s40, 1
  s_cmp_lt_u32 s40, 1048576
  s_cbranch_scc1 L_poll_57
  s_branch L_fail
L_polld_58:
  s_bitcmp1_b32 s42, s24
  s_cbranch_scc1 L_r1_split
  s_mov_b32 s39, s37
  buffer_load_dwordx4 v[44:47], v0, s[4:7], s39 offen sc1
  s_add_u32 s39, s39, 18432
  buffer_load_dwordx4 v[48:51], v0, s[4:7], s39 offen sc1
  s_add_u32 s39, s39, 18432
  buffer_load_dwordx4 v[52:55], v0, s[4:7], s39 offen sc1
  s_add_u32 s39, s39, 18432
  buffer_load_dwordx4 v[56:59], v0, s[4:7], s39 offen sc1
  s_add_u32 s39, s39, 18432
  buffer_load_dwordx4 v[60:63], v0, s[4:7], s39 offen sc1
  s_add_u32 s39, s39, 18432
  buffer_load_dwordx4 v[64:67], v0, s[4:7], s39 offen sc1
  s_add_u32 s39, s39, 18432
  buffer_load_dwordx4 v[68:71], v0, s[4:7], s39 offen sc1
  s_add_u32 s39, s39, 18432
  buffer_load_dwordx4 v[72:75], v0, s[4:7], s39 offen sc1
  s_add_u32 s39, s39, 18432
  buffer_load_dwordx4 v[76:79], v0, s[4:7], s39 offen sc1
  s_add_u32 s39, s39, 18432
  buffer_load_dwordx4 v[80:83], v0, s[4:7], s39 offen sc1
  s_add_u32 s39, s39, 18432
  buffer_load_dwordx4 v[84:87], v0, s[4:7], s39 offen sc1
  s_add_u32 s39, s39, 18432
  buffer_load_dwordx4 v[88:91], v0, s[4:7], s39 offen sc1
  s_add_u32 s39, s39, 18432
  buffer_load_dwordx4 v[92:95], v0, s[4:7], s39 offen sc1
  s_add_u32 s39, s39, 18432
  buffer_load_dwordx4 v[96:99], v0, s[4:7], s39 offen sc1
  s_add_u32 s39, s39, 18432
  buffer_load_dwordx4 v[100:103], v0, s[4:7], s39 offen sc1
  s_add_u32 s39, s39, 18432
  buffer_load_dwordx4 v[104:107], v0, s[4:7], s39 offen sc1
L_r1_sum:
  v_mfma_f32_16x16x32_bf16 v[16:19], v[6:9], v[40:43], 0
  v_mfma_f32_16x16x32_bf16 v[20:23], v[4:7], v[40:43], 0
  s_waitcnt vmcnt(15)
  v_mfma_f32_16x16x32_bf16 v[16:19], v[6:9], v[44:47], v[16:19]
  v_mfma_f32_16x16x32_bf16 v[20:23], v[4:7], v[44:47], v[20:23]
  s_waitcnt vmcnt(14)
  v_mfma_f32_16x16x32_bf16 v[16:19], v[6:9], v[48:51], v[16:19]
  v_mfma_f32_16x16x32_bf16 v[20:23], v[4:7], v[48:51], v[20:23]
  s_waitcnt vmcnt(13)
  v_mfma_f32_16x16x32_bf16 v[16:19], v[6:9], v[52:55], v[16:19]
  v_mfma_f32_16x16x32_bf16 v[20:23], v[4:7], v[52:55], v[20:23]
  s_waitcnt vmcnt(12)
  v_mfma_f32_16x16x32_bf16 v[16:19], v[6:9], v[56:59], v[16:19]
  v_mfma_f32_16x16x32_bf16 v[20:23], v[4:7], v[56:59], v[20:23]
  s_waitcnt vmcnt(11)
  v_mfma_f32_16x16x32_bf16 v[16:19], v[6:9], v[60:63], v[16:19]
  v_mfma_f32_16x16x32_bf16 v[20:23], v[4:7], v[60:63], v[20:23]
  s_waitcnt vmcnt(10)
  v_mfma_f32_16x16x32_bf16 v[16:19], v[6:9], v[64:67], v[16:19]
  v_mfma_f32_16x16x32_bf16 v[20:23], v[4:7], v[64:67], v[20:23]
  s_waitcnt vmcnt(9)
  v_mfma_f32_16x16x32_bf16 v[16:19], v[6:9], v[68:71], v[16:19]
  v_mfma_f32_16x16x32_bf16 v[20:23], v[4:7], v[68:71], v[20:23]
  s_waitcnt vmcnt(8)
  v_mfma_f32_16x16x32_bf16 v[16:19], v[6:9], v[72:75], v[16:19]
  v_mfma_f32_16x16x32_bf16 v[20:23], v[4:7], v[72:75], v[20:23]
  s_waitcnt vmcnt(7)
  v_mfma_f32_16x16x32_bf16 v[16:19], v[6:9], v[76:79], v[16:19]
  v_mfma_f32_16x16x32_bf16 v[20:23], v[4:7], v[76:79], v[20:23]
  s_waitcnt vmcnt(6)
  v_mfma_f32_16x16x32_bf16 v[16:19], v[6:9], v[80:83], v[16:19]
  v_mfma_f32_16x16x32_bf16 v[20:23], v[4:7], v[80:83], v[20:23]
  s_waitcnt vmcnt(5)
  v_mfma_f32_16x16x32_bf16 v[16:19], v[6:9], v[84:87], v[16:19]
  v_mfma_f32_16x16x32_bf16 v[20:23], v[4:7], v[84:87], v[20:23]
  s_waitcnt vmcnt(4)
  v_mfma_f32_16x16x32_bf16 v[16:19], v[6:9], v[88:91], v[16:19]
  v_mfma_f32_16x16x32_bf16 v[20:23], v[4:7], v[88:91], v[20:23]
  s_waitcnt vmcnt(3)
  v_mfma_f32_16x16x32_bf16 v[16:19], v[6:9], v[92:95], v[16:19]
  v_mfma_f32_16x16x32_bf16 v[20:23], v[4:7], v[92:95], v[20:23]
  s_waitcnt vmcnt(2)
  v_mfma_f32_16x16x32_bf16 v[16:19], v[6:9], v[96:99], v[16:19]
  v_mfma_f32_16x16x32_bf16 v[20:23], v[4:7], v[96:99], v[20:23]
  s_waitcnt vmcnt(1)
  v_mfma_f32_16x16x32_bf16 v[16:19], v[6:9], v[100:103], v[16:19]
  v_mfma_f32_16x16x32_bf16 v[20:23], v[4:7], v[100:103], v[20:23]
  s_waitcnt vmcnt(0)
  v_mfma_f32_16x16x32_bf16 v[16:19], v[6:9], v[104:107], v[16:19]
  v_mfma_f32_16x16x32_bf16 v[20:23], v[4:7], v[104:107], v[20:23]
  s_nop 3
  v_cvt_pk_bf16_f32 v40, v16, v17
  v_cvt_pk_bf16_f32 v41, v18, v19
  s_nop 1
  v_cvt_pk_bf16_f32 v42, v20, v21
  v_cvt_pk_bf16_f32 v43, v22, v23
  v_min_u32 v40, -2, v40
  buffer_store_dwordx4 v[40:43], v0, s[4:7], s41 offen sc1
  s_nop 0
  v_mfma_f32_16x16x32_bf16 v[26:29], v[10:13], v[40:43], 0
  v_lshlrev_b32 v16, 16, v40
  v_and_b32 v17, 0xffff0000, v40
  v_lshlrev_b32 v18, 16, v41
  v_and_b32 v19, 0xffff0000, v41
  v_lshlrev_b32 v20, 16, v42
  v_and_b32 v21, 0xffff0000, v42
  v_lshlrev_b32 v22, 16, v43
  v_and_b32 v23, 0xffff0000, v43
  s_lshl_b32 s26, s36, 5
  s_add_u32 s26, s26, s24
  s_lshl_b32 s27, s26, 7
  s_add_u32 s27, s27, 0x700000
  v_mul_f32 v28, 0xbd000000, v26
  v_pk_add_f32 v[16:17], v[16:17], v[28:29] op_sel_hi:[1,0]
  v_pk_add_f32 v[18:19], v[18:19], v[28:29] op_sel_hi:[1,0]
  v_pk_add_f32 v[20:21], v[20:21], v[28:29] op_sel_hi:[1,0]
  v_pk_add_f32 v[22:23], v[22:23], v[28:29] op_sel_hi:[1,0]
  v_pk_mul_f32 v[16:17], v[16:17], v[16:17]
  v_pk_fma_f32 v[16:17], v[18:19], v[18:19], v[16:17]
  v_pk_fma_f32 v[16:17], v[20:21], v[20:21], v[16:17]
  v_pk_fma_f32 v[16:17], v[22:23], v[22:23], v[16:17]
  v_add_f32 v27, v16, v17
  v_min_u32 v26, -2, v26
  v_mov_b32 v28, v27
  s_nop 1
  v_permlane32_swap_b32 v27, v28
  v_add_f32 v27, v27, v28
  v_mov_b32 v28, v27
  s_nop 1
  v_permlane16_swap_b32 v27, v28
  v_add_f32 v27, v27, v28
  buffer_store_dwordx2 v[26:27], v15, s[4:7], s27 offen sc1
  s_add_u32 s36, s36, 4
  s_cmp_lt_u32 s36, 48
  s_cbranch_scc1 L_r1_top
  s_branch L_r1_done
L_r1_split:
  s_mov_b32 s39, s37
  buffer_load_dwordx2 v[44:45], v30, s[4:7], s39 offen offset:0 sc1
  buffer_load_dwordx2 v[46:47], v30, s[4:7], s39 offen offset:512 sc1
  s_add_u32 s39, s39, 18432
  buffer_load_dwordx2 v[48:49], v30, s[4:7], s39 offen offset:0 sc1
  buffer_load_dwordx2 v[50:51], v30, s[4:7], s39 offen offset:512 sc1
  s_add_u32 s39, s39, 18432
  buffer_load_dwordx2 v[52:53], v30, s[4:7], s39 offen offset:0 sc1
  buffer_load_dwordx2 v[54:55], v30, s[4:7], s39 offen offset:512 sc1
  s_add_u32 s39, s39, 18432
  buffer_load_dwordx2 v[56:57], v30, s[4:7], s39 offen offset:0 sc1
  buffer_load_dwordx2 v[58:59], v30, s[4:7], s39 offen offset:512 sc1
  s_add_u32 s39, s39, 18432
  buffer_load_dwordx2 v[60:61], v30, s[4:7], s39 offen offset:0 sc1
  buffer_load_dwordx2 v[62:63], v30, s[4:7], s39 offen offset:512 sc1
  s_add_u32 s39, s39, 18432
  buffer_load_dwordx2 v[64:65], v30, s[4:7], s39 offen offset:0 sc1
  buffer_load_dwordx2 v[66:67], v30, s[4:7], s39 offen offset:512 sc1
  s_add_u32 s39, s39, 18432
  buffer_load_dwordx2 v[68:69], v30, s[4:7], s39 offen offset:0 sc1
  buffer_load_dwordx2 v[70:71], v30, s[4:7], s39 offen offset:512 sc1
  s_add_u32 s39, s39, 18432
  buffer_load_dwordx2 v[72:73], v30, s[4:7], s39 offen offset:0 sc1
  buffer_load_dwordx2 v[74:75], v30, s[4:7], s39 offen offset:512 sc1
  s_add_u32 s39, s39, 18432
  buffer_load_dwordx2 v[76:77], v30, s[4:7], s39 offen offset:0 sc1
  buffer_load_dwordx2 v[78:79], v30, s[4:7], s39 offen offset:512 sc1
  s_add_u32 s39, s39, 18432
  buffer_load_dwordx2 v[80:81], v30, s[4:7], s39 offen offset:0 sc1
  buffer_load_dwordx2 v[82:83], v30, s[4:7], s39 offen offset:512 sc1
  s_add_u32 s39, s39, 18432
  buffer_load_dwordx2 v[84:85], v30, s[4:7], s39 offen offset:0 sc1
  buffer_load_dwordx2 v[86:87], v30, s[4:7], s39 offen offset:512 sc1
  s_add_u32 s39, s39, 18432
  buffer_load_dwordx2 v[88:89], v30, s[4:7], s39 offen offset:0 sc1
  buffer_load_dwordx2 v[90:91], v30, s[4:7], s39 offen offset:512 sc1
  s_add_u32 s39, s39, 18432
  buffer_load_dwordx2 v[92:93], v30, s[4:7], s39 offen offset:0 sc1
  buffer_load_dwordx2 v[94:95], v30, s[4:7], s39 offen offset:512 sc1
  s_add_u32 s39, s39, 18432
  buffer_load_dwordx2 v[96:97], v30, s[4:7], s39 offen offset:0 sc1
  buffer_load_dwordx2 v[98:99], v30, s[4:7], s39 offen offset:512 sc1
  s_add_u32 s39, s39, 18432
  buffer_load_dwordx2 v[100:101], v30, s[4:7], s39 offen offset:0 sc1
  buffer_load_dwordx2 v[102:103], v30, s[4:7], s39 offen offset:512 sc1
  s_add_u32 s39, s39, 18432
  buffer_load_dwordx2 v[104:105], v30, s[4:7], s39 offen offset:0 sc1
  buffer_load_dwordx2 v[106:107], v30, s[4:7], s39 offen offset:512 sc1
  s_branch L_r1_sum
L_r1_done:
L_r1t_top:
  s_mul_i32 s38, s36, 18432
  s_lshl_b32 s26, s24, 10
  s_add_u32 s41, s38, s26
  s_mul_i32 s37, s38, 16
  s_add_u32 s37, s37, s26
  s_add_u32 s37, s37, 0x6400000
  s_add_u32 s41, s41, 0x480000
  s_lshl_b32 s26, s36, 5
  s_add_u32 s26, s26, s24
  s_lshl_b32 s27, s26, 7
  s_add_u32 s27, s27, 0x700000
  s_add_u32 s26, s41, 0x24000
  s_add_u32 s27, s27, 0x8000
  s_cmp_lt_u32 s36, 120
  s_cselect_b32 s26, s26, 0x40000000
  s_cselect_b32 s27, s27, 0x40000000
  buffer_store_dwordx4 v[120:123], v0, s[4:7], s26 offen sc1
  buffer_store_dwordx2 v[120:121], v15, s[4:7], s27 offen sc1
  buffer_load_dwordx4 v[40:43], v2, s[12:15], s38 offen
  s_bitcmp1_b32 s42, s24
  s_cbranch_scc1 L_r1t_split
  s_mov_b32 s40, 0
L_spin_59:
  s_mov_b64 exec, 0x1
L_spind_61:
  buffer_load_dword v14, v0, s[4:7], s37 offen sc1
  s_add_u32 s40, s40, 1
  s_cmp_ge_u32 s40, 1048576
  s_cbranch_scc1 L_fail
  s_waitcnt vmcnt(0)
  v_cmp_eq_u32 vcc, -1, v14
  s_cbranch_vccnz L_spind_61
  s_mov_b64 exec, -1
L_spind_61_s:
  s_mov_b32 s39, s37
  buffer_load_dwordx4 v[44:47], v0, s[4:7], s39 offen sc1
  s_add_u32 s39, s39, 18432
  buffer_load_dwordx4 v[48:51], v0, s[4:7], s39 offen sc1
  s_add_u32 s39, s39, 18432
  buffer_load_dwordx4 v[52:55], v0, s[4:7], s39 offen sc1
  s_add_u32 s39, s39, 18432
  buffer_load_dwordx4 v[56:59], v0, s[4:7], s39 offen sc1
  s_add_u32 s39, s39, 18432
  buffer_load_dwordx4 v[60:63], v0, s[4:7], s39 offen sc1
  s_add_u32 s39, s39, 18432
  buffer_load_dwordx4 v[64:67], v0, s[4:7], s39 offen sc1
  s_add_u32 s39, s39, 18432
  buffer_load_dwordx4 v[68:71], v0, s[4:7], s39 offen sc1
  s_add_u32 s39, s39, 18432
  buffer_load_dwordx4 v[72:75], v0, s[4:7], s39 offen sc1
  s_add_u32 s39, s39, 18432
  buffer_load_dwordx4 v[76:79], v0, s[4:7], s39 offen sc1
  s_add_u32 s39, s39, 18432
  buffer_load_dwordx4 v[80:83], v0, s[4:7], s39 offen sc1
  s_add_u32 s39, s39, 18432
  buffer_load_dwordx4 v[84:87], v0, s[4:7], s39 offen sc1
  s_add_u32 s39, s39, 18432
  buffer_load_dwordx4 v[88:91], v0, s[4:7], s39 offen sc1
  s_add_u32 s39, s39, 18432
  buffer_load_dwordx4 v[92:95], v0, s[4:7], s39 offen sc1
  s_add_u32 s39, s39, 18432
  buffer_load_dwordx4 v[96:99], v0, s[4:7], s39 offen sc1
  s_add_u32 s39, s39, 18432
  buffer_load_dwordx4 v[100:103], v0, s[4:7], s39 offen sc1
  s_add_u32 s39, s39, 18432
  buffer_load_dwordx4 v[104:107], v0, s[4:7], s39 offen sc1
  s_add_u32 s40, s40, 1
  s_cmp_ge_u32 s40, 1048576
  s_cbranch_scc1 L_fail
  s_waitcnt vmcnt(14)
  v_max_u32 v14, v44, v48
  s_waitcnt vmcnt(12)
  v_max3_u32 v14, v14, v52, v56
  s_waitcnt vmcnt(10)
  v_max3_u32 v14, v14, v60, v64
  s_waitcnt vmcnt(8)
  v_max3_u32 v14, v14, v68, v72
  s_waitcnt vmcnt(6)
  v_max3_u32 v14, v14, v76, v80
  s_waitcnt vmcnt(4)
  v_max3_u32 v14, v14, v84, v88
  s_waitcnt vmcnt(2)
  v_max3_u32 v14, v14, v92, v96
  s_waitcnt vmcnt(0)
  v_max3_u32 v14, v14, v100, v104
  v_cmp_eq_u32 vcc, -1, v14
  s_cbranch_vccnz L_spind_61_s
L_spinc_60:
L_r1t_sum:
  v_mfma_f32_16x16x32_bf16 v[16:19], v[6:9], v[40:43], 0
  v_mfma_f32_16x16x32_bf16 v[20:23], v[4:7], v[40:43], 0
  v_mfma_f32_16x16x32_bf16 v[16:19], v[6:9], v[44:47], v[16:19]
  v_mfma_f32_16x16x32_bf16 v[20:23], v[4:7], v[44:47], v[20:23]
  v_mfma_f32_16x16x32_bf16 v[16:19], v[6:9], v[48:51], v[16:19]
  v_mfma_f32_16x16x32_bf16 v[20:23], v[4:7], v[48:51], v[20:23]
  v_mfma_f32_16x16x32_bf16 v[16:19], v[6:9], v[52:55], v[16:19]
  v_mfma_f32_16x16x32_bf16 v[20:23], v[4:7], v[52:55], v[20:23]
  v_mfma_f32_16x16x32_bf16 v[16:19], v[6:9], v[56:59], v[16:19]
  v_mfma_f32_16x16x32_bf16 v[20:23], v[4:7], v[56:59], v[20:23]
  v_mfma_f32_16x16x32_bf16 v[16:19], v[6:9], v[60:63], v[16:19]
  v_mfma_f32_16x16x32_bf16 v[20:23], v[4:7], v[60:63], v[20:23]
  v_mfma_f32_16x16x32_bf16 v[16:19], v[6:9], v[64:67], v[16:19]
  v_mfma_f32_16x16x32_bf16 v[20:23], v[4:7], v[64:67], v[20:23]
  v_mfma_f32_16x16x32_bf16 v[16:19], v[6:9], v[68:71], v[16:19]
  v_mfma_f32_16x16x32_bf16 v[20:23], v[4:7], v[68:71], v[20:23]
  v_mfma_f32_16x16x32_bf16 v[16:19], v[6:9], v[72:75], v[16:19]
  v_mfma_f32_16x16x32_bf16 v[20:23], v[4:7], v[72:75], v[20:23]
  v_mfma_f32_16x16x32_bf16 v[16:19], v[6:9], v[76:79], v[16:19]
  v_mfma_f32_16x16x32_bf16 v[20:23], v[4:7], v[76:79], v[20:23]
  v_mfma_f32_16x16x32_bf16 v[16:19], v[6:9], v[80:83], v[16:19]
  v_mfma_f32_16x16x32_bf16 v[20:23], v[4:7], v[80:83], v[20:23]
  v_mfma_f32_16x16x32_bf16 v[16:19], v[6:9], v[84:87], v[16:19]
  v_mfma_f32_16x16x32_bf16 v[20:23], v[4:7], v[84:87], v[20:23]
  v_mfma_f32_16x16x32_bf16 v[16:19], v[6:9], v[88:91], v[16:19]
  v_mfma_f32_16x16x32_bf16 v[20:23], v[4:7], v[88:91], v[20:23]
  v_mfma_f32_16x16x32_bf16 v[16:19], v[6:9], v[92:95], v[16:19]
  v_mfma_f32_16x16x32_bf16 v[20:23], v[4:7], v[92:95], v[20:23]
  v_mfma_f32_16x16x32_bf16 v[16:19], v[6:9], v[96:99], v[16:19]
  v_mfma_f32_16x16x32_bf16 v[20:23], v[4:7], v[96:99], v[20:23]
  v_mfma_f32_16x16x32_bf16 v[16:19], v[6:9], v[100:103], v[16:19]
  v_mfma_f32_16x16x32_bf16 v[20:23], v[4:7], v[100:103], v[20:23]
  v_mfma_f32_16x16x32_bf16 v[16:19], v[6:9], v[104:107], v[16:19]
  v_mfma_f32_16x16x32_bf16 v[20:23], v[4:7], v[104:107], v[20:23]
  s_nop 3
  v_cvt_pk_bf16_f32 v40, v16, v17
  v_cvt_pk_bf16_f32 v41, v18, v19
  s_nop 1
  v_cvt_pk_bf16_f32 v42, v20, v21
  v_cvt_pk_bf16_f32 v43, v22, v23
  v_min_u32 v40, -2, v40
  buffer_store_dwordx4 v[40:43], v0, s[4:7], s41 offen sc1
  s_nop 0
  v_mfma_f32_16x16x32_bf16 v[26:29], v[10:13], v[40:43], 0
  v_lshlrev_b32 v16, 16, v40
  v_and_b32 v17, 0xffff0000, v40
  v_lshlrev_b32 v18, 16, v41
  v_and_b32 v19, 0xffff0000, v41
  v_lshlrev_b32 v20, 16, v42
  v_and_b32 v21, 0xffff0000, v42
  v_lshlrev_b32 v22, 16, v43
  v_and_b32 v23, 0xffff0000, v43
  s_lshl_b32 s26, s36, 5
  s_add_u32 s26, s26, s24
  s_lshl_b32 s27, s26, 7
  s_add_u32 s27, s27, 0x700000
  v_mul_f32 v28, 0xbd000000, v26
  v_pk_add_f32 v[16:17], v[16:17], v[28:29] op_sel_hi:[1,0]
  v_pk_add_f32 v[18:19], v[18:19], v[28:29] op_sel_hi:[1,0]
  v_pk_add_f32 v[20:21], v[20:21], v[28:29] op_sel_hi:[1,0]
  v_pk_add_f32 v[22:23], v[22:23], v[28:29] op_sel_hi:[1,0]
  v_pk_mul_f32 v[16:17], v[16:17], v[16:17]
  v_pk_fma_f32 v[16:17], v[18:19], v[18:19], v[16:17]
  v_pk_fma_f32 v[16:17], v[20:21], v[20:21], v[16:17]
  v_pk_fma_f32 v[16:17], v[22:23], v[22:23], v[16:17]
  v_add_f32 v27, v16, v17
  v_min_u32 v26, -2, v26
  v_mov_b32 v28, v27
  s_nop 1
  v_permlane32_swap_b32 v27, v28
  v_add_f32 v27, v27, v28
  v_mov_b32 v28, v27
  s_nop 1
  v_permlane16_swap_b32 v27, v28
  v_add_f32 v27, v27, v28
  buffer_store_dwordx2 v[26:27], v15, s[4:7], s27 offen sc1
  s_add_u32 s36, s36, 4
  s_cmp_lt_u32 s36, 128
  s_cbranch_scc1 L_r1t_top
  s_branch L_r1t_done
L_r1t_split:
  s_mov_b32 s40, 0
L_spin_62:
  s_mov_b64 exec, 0x1
L_spind_64:
  buffer_load_dword v14, v0, s[4:7], s37 offen sc1
  s_add_u32 s40, s40, 1
  s_cmp_ge_u32 s40, 1048576
  s_cbranch_scc1 L_fail
  s_waitcnt vmcnt(0)
  v_cmp_eq_u32 vcc, -1, v14
  s_cbranch_vccnz L_spind_64
  s_mov_b64 exec, -1
L_spind_64_s:
  s_mov_b32 s39, s37
  buffer_load_dwordx2 v[44:45], v30, s[4:7], s39 offen offset:0 sc1
  buffer_load_dwordx2 v[46:47], v30, s[4:7], s39 offen offset:512 sc1
  s_add_u32 s39, s39, 18432
  buffer_load_dwordx2 v[48:49], v30, s[4:7], s39 offen offset:0 sc1
  buffer_load_dwordx2 v[50:51], v30, s[4:7], s39 offen offset:512 sc1
  s_add_u32 s39, s39, 18432
  buffer_load_dwordx2 v[52:53], v30, s[4:7], s39 offen offset:0 sc1
  buffer_load_dwordx2 v[54:55], v30, s[4:7], s39 offen offset:512 sc1
  s_add_u32 s39, s39, 18432
  buffer_load_dwordx2 v[56:57], v30, s[4:7], s39 offen offset:0 sc1
  buffer_load_dwordx2 v[58:59], v30, s[4:7], s39 offen offset:512 sc1
  s_add_u32 s39, s39, 18432
  buffer_load_dwordx2 v[60:61], v30, s[4:7], s39 offen offset:0 sc1
  buffer_load_dwordx2 v[62:63], v30, s[4:7], s39 offen offset:512 sc1
  s_add_u32 s39, s39, 18432
  buffer_load_dwordx2 v[64:65], v30, s[4:7], s39 offen offset:0 sc1
  buffer_load_dwordx2 v[66:67], v30, s[4:7], s39 offen offset:512 sc1
  s_add_u32 s39, s39, 18432
  buffer_load_dwordx2 v[68:69], v30, s[4:7], s39 offen offset:0 sc1
  buffer_load_dwordx2 v[70:71], v30, s[4:7], s39 offen offset:512 sc1
  s_add_u32 s39, s39, 18432
  buffer_load_dwordx2 v[72:73], v30, s[4:7], s39 offen offset:0 sc1
  buffer_load_dwordx2 v[74:75], v30, s[4:7], s39 offen offset:512 sc1
  s_add_u32 s39, s39, 18432
  buffer_load_dwordx2 v[76:77], v30, s[4:7], s39 offen offset:0 sc1
  buffer_load_dwordx2 v[78:79], v30, s[4:7], s39 offen offset:512 sc1
  s_add_u32 s39, s39, 18432
  buffer_load_dwordx2 v[80:81], v30, s[4:7], s39 offen offset:0 sc1
  buffer_load_dwordx2 v[82:83], v30, s[4:7], s39 offen offset:512 sc1
  s_add_u32 s39, s39, 18432
  buffer_load_dwordx2 v[84:85], v30, s[4:7], s39 offen offset:0 sc1
  buffer_load_dwordx2 v[86:87], v30, s[4:7], s39 offen offset:512 sc1
  s_add_u32 s39, s39, 18432
  buffer_load_dwordx2 v[88:89], v30, s[4:7], s39 offen offset:0 sc1
  buffer_load_dwordx2 v[90:91], v30, s[4:7], s39 offen offset:512 sc1
  s_add_u32 s39, s39, 18432
  buffer_load_dwordx2 v[92:93], v30, s[4:7], s39 offen offset:0 sc1
  buffer_load_dwordx2 v[94:95], v30, s[4:7], s39 offen offset:512 sc1
  s_add_u32 s39, s39, 18432
  buffer_load_dwordx2 v[96:97], v30, s[4:7], s39 offen offset:0 sc1
  buffer_load_dwordx2 v[98:99], v30, s[4:7], s39 offen offset:512 sc1
  s_add_u32 s39, s39, 18432
  buffer_load_dwordx2 v[100:101], v30, s[4:7], s39 offen offset:0 sc1
  buffer_load_dwordx2 v[102:103], v30, s[4:7], s39 offen offset:512 sc1
  s_add_u32 s39, s39, 18432
  buffer_load_dwordx2 v[104:105], v30, s[4:7], s39 offen offset:0 sc1
  buffer_load_dwordx2 v[106:107], v30, s[4:7], s39 offen offset:512 sc1
  s_add_u32 s40, s40, 1
  s_cmp_ge_u32 s40, 1048576
  s_cbranch_scc1 L_fail
  s_waitcnt vmcnt(30)
  v_max_u32 v14, v44, v46
  s_waitcnt vmcnt(28)
  v_max3_u32 v14, v14, v48, v50
  s_waitcnt vmcnt(26)
  v_max3_u32 v14, v14, v52, v54
  s_waitcnt vmcnt(24)
  v_max3_u32 v14, v14, v56, v58
  s_waitcnt vmcnt(22)
  v_max3_u32 v14, v14, v60, v62
  s_waitcnt vmcnt(20)
  v_max3_u32 v14, v14, v64, v66
  s_waitcnt vmcnt(18)
  v_max3_u32 v14, v14, v68, v70
  s_waitcnt vmcnt(16)
  v_max3_u32 v14, v14, v72, v74
  s_waitcnt vmcnt(14)
  v_max3_u32 v14, v14, v76, v78
  s_waitcnt vmcnt(12)
  v_max3_u32 v14, v14, v80, v82
  s_waitcnt vmcnt(10)
  v_max3_u32 v14, v14, v84, v86
  s_waitcnt vmcnt(8)
  v_max3_u32 v14, v14, v88, v90
  s_waitcnt vmcnt(6)
  v_max3_u32 v14, v14, v92, v94
  s_waitcnt vmcnt(4)
  v_max3_u32 v14, v14, v96, v98
  s_waitcnt vmcnt(2)
  v_max3_u32 v14, v14, v100, v102
  s_waitcnt vmcnt(0)
  v_max3_u32 v14, v14, v104, v106
  v_cmp_eq_u32 vcc, -1, v14
  s_cbranch_vccnz L_spind_64_s
L_spinc_63:
  s_branch L_r1t_sum
L_r1t_done:
  s_branch L_exit
L_role_r2:
  s_mov_b32 s28, 0
L_reg_65:
  v_mov_b32 v26, 0
  buffer_load_dword v27, v26, s[20:23], 0 offen offset:64 sc1
  s_add_u32 s28, s28, 1
  s_cmp_gt_u32 s28, 1048576
  s_cbranch_scc1 L_fail
  s_waitcnt vmcnt(0)
  v_readfirstlane_b32 s67, v27
L_regc_66:
  s_and_b32 s26, s67, 0xffff
  s_cmp_lt_u32 s26, 256
  s_cbranch_scc1 L_reg_65
  s_lshr_b32 s67, s67, 16
  s_load_dwordx2 s[12:13], s[0:1], 88
  s_mov_b32 s14, 0x240000
  s_mov_b32 s15, 0x20000
  v_and_b32 v20, 15, v1
  v_mul_u32_u24 v2, 1152, v20
  v_and_b32 v21, 48, v1
  s_lshl_b32 s26, s24, 6
  v_add3_u32 v2, v2, v21, s26
  v_lshrrev_b32 v21, 4, v1
  v_lshrrev_b32 v22, 2, v20
  v_and_b32 v23, 3, v1
  v_cmp_eq_u32 vcc, v21, v22
  s_nop 1
  v_cndmask_b32 v23, 7, v23, vcc
  v_mov_b32 v4, 0
  v_mov_b32 v5, 0
  v_mov_b32 v8, 0
  v_mov_b32 v9, 0
  v_mov_b32 v22, 0x3f80
  v_cmp_eq_u32 vcc, 0, v23
  s_nop 1
  v_cndmask_b32 v6, 0, v22, vcc
  v_mov_b32 v22, 0x3f800000
  v_cmp_eq_u32 vcc, 1, v23
  s_nop 1
  v_cndmask_b32 v6, v6, v22, vcc
  v_mov_b32 v22, 0x3f80
  v_cmp_eq_u32 vcc, 2, v23
  s_nop 1
  v_cndmask_b32 v7, 0, v22, vcc
  v_mov_b32 v22, 0x3f800000
  v_cmp_eq_u32 vcc, 3, v23
  s_nop 1
  v_cndmask_b32 v7, v7, v22, vcc
  s_mul_i32 s26, s24, 43
  s_lshr_b32 s26, s26, 8
  s_lshl_b32 s26, s26, 7
  v_min_u32 v3, 23, v1
  v_lshlrev_b32 v3, 2, v3
  v_add_u32 v3, s26, v3
  v_lshrrev_b32 v20, 1, v1
  v_mul_u32_u24 v20, 18432, v20
  v_and_b32 v21, 1, v1
  v_lshl_add_u32 v31, v21, 9, v20
  s_mov_b32 s36, s25
  s_mov_b32 s42, 0x12492
  v_lshrrev_b32 v30, 1, v0
  s_waitcnt lgkmcnt(0)
L_r2t_top:
  s_mul_i32 s38, s36, 18432
  s_lshl_b32 s26, s24, 10
  s_add_u32 s41, s38, s26
  s_mul_i32 s37, s38, 6
  s_add_u32 s37, s37, s26
  s_add_u32 s37, s37, 0x9000000
  s_add_u32 s41, s41, 0x480000
  s_bitcmp1_b32 s42, s24
  s_cbranch_scc1 L_r2t_split
  s_mov_b32 s40, 0
L_spin_67:
  s_cmp_ge_u32 s36, 126
  s_cbranch_scc1 L_spind_69_s
  s_mov_b64 exec, 0x1
L_spind_69:
  buffer_load_dword v14, v0, s[4:7], s37 offen sc1
  s_add_u32 s40, s40, 1
  s_cmp_ge_u32 s40, 1048576
  s_cbranch_scc1 L_fail
  s_waitcnt vmcnt(0)
  v_cmp_eq_u32 vcc, -1, v14
  s_cbranch_vccnz L_spind_69
  s_mov_b64 exec, -1
L_spind_69_s:
  buffer_load_dwordx4 v[40:43], v0, s[4:7], s41 offen sc1
  s_mov_b32 s39, s37
  buffer_load_dwordx4 v[44:47], v0, s[4:7], s39 offen sc1
  s_add_u32 s39, s39, 18432
  buffer_load_dwordx4 v[48:51], v0, s[4:7], s39 offen sc1
  s_add_u32 s39, s39, 18432
  buffer_load_dwordx4 v[52:55], v0, s[4:7], s39 offen sc1
  s_add_u32 s39, s39, 18432
  buffer_load_dwordx4 v[56:59], v0, s[4:7], s39 offen sc1
  s_add_u32 s39, s39, 18432
  buffer_load_dwordx4 v[60:63], v0, s[4:7], s39 offen sc1
  s_add_u32 s39, s39, 18432
  buffer_load_dwordx4 v[64:67], v0, s[4:7], s39 offen sc1
  s_add_u32 s40, s40, 1
  s_cmp_ge_u32 s40, 1048576
  s_cbranch_scc1 L_fail
  s_waitcnt vmcnt(4)
  v_max3_u32 v14, v40, v44, v48
  s_waitcnt vmcnt(2)
  v_max3_u32 v14, v14, v52, v56
  s_waitcnt vmcnt(0)
  v_max3_u32 v14, v14, v60, v64
  v_cmp_eq_u32 vcc, -1, v14
  s_cbranch_vccnz L_spin_67
L_spinc_68:
L_r2t_sum:
  v_mfma_f32_16x16x32_bf16 v[16:19], v[6:9], v[40:43], 0
  v_mfma_f32_16x16x32_bf16 v[20:23], v[4:7], v[40:43], 0
  v_mfma_f32_16x16x32_bf16 v[16:19], v[6:9], v[44:47], v[16:19]
  v_mfma_f32_16x16x32_bf16 v[20:23], v[4:7], v[44:47], v[20:23]
  v_mfma_f32_16x16x32_bf16 v[16:19], v[6:9], v[48:51], v[16:19]
  v_mfma_f32_16x16x32_bf16 v[20:23], v[4:7], v[48:51], v[20:23]
  v_mfma_f32_16x16x32_bf16 v[16:19], v[6:9], v[52:55], v[16:19]
  v_mfma_f32_16x16x32_bf16 v[20:23], v[4:7], v[52:55], v[20:23]
  v_mfma_f32_16x16x32_bf16 v[16:19], v[6:9], v[56:59], v[16:19]
  v_mfma_f32_16x16x32_bf16 v[20:23], v[4:7], v[56:59], v[20:23]
  v_mfma_f32_16x16x32_bf16 v[16:19], v[6:9], v[60:63], v[16:19]
  v_mfma_f32_16x16x32_bf16 v[20:23], v[4:7], v[60:63], v[20:23]
  v_mfma_f32_16x16x32_bf16 v[16:19], v[6:9], v[64:67], v[16:19]
  v_mfma_f32_16x16x32_bf16 v[20:23], v[4:7], v[64:67], v[20:23]
  s_nop 3
  v_cvt_pk_bf16_f32 v40, v16, v17
  v_cvt_pk_bf16_f32 v41, v18, v19
  s_nop 1
  v_cvt_pk_bf16_f32 v42, v20, v21
  v_cvt_pk_bf16_f32 v43, v22, v23
  buffer_store_dwordx4 v[40:43], v2, s[12:15], s38 offen
  s_add_u32 s36, s36, 4
  s_cmp_lt_u32 s36, 128
  s_cbranch_scc1 L_r2t_top
  s_branch L_r2t_done
L_r2t_split:
  s_mov_b32 s40, 0
L_spin_70:
  s_cmp_ge_u32 s36, 126
  s_cbranch_scc1 L_spind_72_s
  s_mov_b64 exec, 0x1
L_spind_72:
  buffer_load_dword v14, v0, s[4:7], s37 offen sc1
  s_add_u32 s40, s40, 1
  s_cmp_ge_u32 s40, 1048576
  s_cbranch_scc1 L_fail
  s_waitcnt vmcnt(0)
  v_cmp_eq_u32 vcc, -1, v14
  s_cbranch_vccnz L_spind_72
  s_mov_b64 exec, -1
L_spind_72_s:
  buffer_load_dwordx4 v[40:43], v0, s[4:7], s41 offen sc1
  s_mov_b32 s39, s37
  buffer_load_dwordx2 v[44:45], v30, s[4:7], s39 offen offset:0 sc1
  buffer_load_dwordx2 v[46:47], v30, s[4:7], s39 offen offset:512 sc1
  s_add_u32 s39, s39, 18432
  buffer_load_dwordx2 v[48:49], v30, s[4:7], s39 offen offset:0 sc1
  buffer_load_dwordx2 v[50:51], v30, s[4:7], s39 offen offset:512 sc1
  s_add_u32 s39, s39, 18432
  buffer_load_dwordx2 v[52:53], v30, s[4:7], s39 offen offset:0 sc1
  buffer_load_dwordx2 v[54:55], v30, s[4:7], s39 offen offset:512 sc1
  s_add_u32 s39, s39, 18432
  buffer_load_dwordx2 v[56:57], v30, s[4:7], s39 offen offset:0 sc1
  buffer_load_dwordx2 v[58:59], v30, s[4:7], s39 offen offset:512 sc1
  s_add_u32 s39, s39, 18432
  buffer_load_dwordx2 v[60:61], v30, s[4:7], s39 offen offset:0 sc1
  buffer_load_dwordx2 v[62:63], v30, s[4:7], s39 offen offset:512 sc1
  s_add_u32 s39, s39, 18432
  buffer_load_dwordx2 v[64:65], v30, s[4:7], s39 offen offset:0 sc1
  buffer_load_dwordx2 v[66:67], v30, s[4:7], s39 offen offset:512 sc1
  s_add_u32 s40, s40, 1
  s_cmp_ge_u32 s40, 1048576
  s_cbranch_scc1 L_fail
  s_waitcnt vmcnt(10)
  v_max3_u32 v14, v40, v44, v46
  s_waitcnt vmcnt(8)
  v_max3_u32 v14, v14, v48, v50
  s_waitcnt vmcnt(6)
  v_max3_u32 v14, v14, v52, v54
  s_waitcnt vmcnt(4)
  v_max3_u32 v14, v14, v56, v58
  s_waitcnt vmcnt(2)
  v_max3_u32 v14, v14, v60, v62
  s_waitcnt vmcnt(0)
  v_max3_u32 v14, v14, v64, v66
  v_cmp_eq_u32 vcc, -1, v14
  s_cbranch_vccnz L_spin_70
L_spinc_71:
  s_branch L_r2t_sum
L_r2t_done:
  s_branch L_exit
L_fail:
L_exit:
  s_endpgm
L_rec:
  s_load_dwordx2 s[8:9], s[0:1], 16
  s_mov_b32 s10, 0x480000
  s_mov_b32 s11, 0x20000
  s_load_dwordx2 s[12:13], s[0:1], 24
  s_mov_b32 s14, 0x480000
  s_mov_b32 s15, 0x20000
  s_load_dwordx2 s[16:17], s[0:1], 32
  s_mov_b32 s18, 0x480000
  s_mov_b32 s19, 0x20000
  s_load_dwordx2 s[52:53], s[0:1], 40
  s_mov_b32 s54, 0x480000
  s_mov_b32 s55, 0x20000
  s_load_dwordx2 s[84:85], s[0:1], 8
  s_mov_b32 s86, 0x2400
  s_mov_b32 s87, 0x20000
  s_waitcnt lgkmcnt(0)
  s_cmp_eq_u32 s25, 1
  s_cbranch_scc1 L_recw1
  s_cmp_eq_u32 s25, 2
  s_cbranch_scc1 L_recw2
  s_cmp_eq_u32 s25, 3
  s_cbranch_scc1 L_recw3
L_recw0:
  v_add_u32 v2, 16384, v0
  v_lshrrev_b32 v20, 4, v1
  v_lshlrev_b32 v21, 13, v20
  v_and_b32 v20, 1, v20
  v_lshlrev_b32 v20, 6, v20
  v_and_b32 v22, 0xf0, v0
  v_xor_b32 v20, v20, v22
  s_lshl_b32 s27, s36, 8
  v_add3_u32 v8, v20, v21, s27
  v_xor_b32 v9, 0x80, v8
  s_mul_i32 s27, s36, 147456
  v_lshrrev_b32 v20, 3, v1
  v_mul_u32_u24 v20, 1152, v20
  v_and_b32 v21, 0x70, v0
  v_add3_u32 v10, v20, v21, s27
  v_lshrrev_b32 v20, 2, v1
  v_mul_u32_u24 v20, 1152, v20
  v_and_b32 v21, 0x30, v0
  v_add3_u32 v11, v20, v21, s27
  v_bfe_u32 v20, v1, 2, 2
  v_and_b32 v21, 1, v1
  v_lshl_add_u32 v20, v20, 1, v21
  v_mul_u32_u24 v20, 1152, v20
  v_lshrrev_b32 v21, 4, v1
  v_lshl_add_u32 v20, v21, 5, v20
  v_bfe_u32 v21, v1, 1, 1
  v_lshl_add_u32 v20, v21, 4, v20
  buffer_load_dwordx4 v[64:67], v20, s[84:87], 0 offen offset:0
  buffer_load_dwordx4 v[68:71], v20, s[84:87], 0 offen offset:128
  buffer_load_dwordx4 v[72:75], v20, s[84:87], 0 offen offset:1024
  s_mov_b32 m0, 0x8000
  s_mov_b32 s27, 0x12000
  buffer_load_dwordx4 v10, s[52:55], s27 offen  lds
  s_mov_b32 m0, 0x8400
  s_mov_b32 s27, 0x14400
  buffer_load_dwordx4 v10, s[52:55], s27 offen  lds
  s_mov_b32 m0, 0x8800
  s_mov_b32 s27, 0x16800
  buffer_load_dwordx4 v10, s[52:55], s27 offen  lds
  s_mov_b32 m0, 0x8c00
  s_mov_b32 s27, 0x18c00
  buffer_load_dwordx4 v10, s[52:55], s27 offen  lds
  s_mov_b32 m0, 0x9000
  s_mov_b32 s27, 0x1b000
  buffer_load_dwordx4 v10, s[52:55], s27 offen  lds
  s_mov_b32 m0, 0x9400
  s_mov_b32 s27, 0x1d400
  buffer_load_dwordx4 v10, s[52:55], s27 offen  lds
  s_mov_b32 m0, 0x9800
  s_mov_b32 s27, 0x1f800
  buffer_load_dwordx4 v10, s[52:55], s27 offen  lds
  s_mov_b32 m0, 0x9c00
  s_mov_b32 s27, 0x21c00
  buffer_load_dwordx4 v10, s[52:55], s27 offen  lds
  s_mov_b32 m0, 0xa000
  s_mov_b32 s27, 0x12080
  buffer_load_dwordx4 v10, s[52:55], s27 offen  lds
  s_mov_b32 m0, 0xa400
  s_mov_b32 s27, 0x14480
  buffer_load_dwordx4 v10, s[52:55], s27 offen  lds
  s_mov_b32 m0, 0xa800
  s_mov_b32 s27, 0x16880
  buffer_load_dwordx4 v10, s[52:55], s27 offen  lds
  s_mov_b32 m0, 0xac00
  s_mov_b32 s27, 0x18c80
  buffer_load_dwordx4 v10, s[52:55], s27 offen  lds
  s_mov_b32 m0, 0xb000
  s_mov_b32 s27, 0x1b080
  buffer_load_dwordx4 v10, s[52:55], s27 offen  lds
  s_mov_b32 m0, 0xb400
  s_mov_b32 s27, 0x1d480
  buffer_load_dwordx4 v10, s[52:55], s27 offen  lds
  s_mov_b32 m0, 0xb800
  s_mov_b32 s27, 0x1f880
  buffer_load_dwordx4 v10, s[52:55], s27 offen  lds
  s_mov_b32 m0, 0xbc00
  s_mov_b32 s27, 0x21c80
  buffer_load_dwordx4 v10, s[52:55], s27 offen  lds
  s_mov_b32 m0, 0xc000
  s_mov_b32 s27, 0x100
  buffer_load_dwordx4 v11, s[52:55], s27 offen  lds
  s_mov_b32 m0, 0xc400
  s_mov_b32 s27, 0x4900
  buffer_load_dwordx4 v11, s[52:55], s27 offen  lds
  s_mov_b32 m0, 0xc800
  s_mov_b32 s27, 0x9100
  buffer_load_dwordx4 v11, s[52:55], s27 offen  lds
  s_mov_b32 m0, 0xcc00
  s_mov_b32 s27, 0xd900
  buffer_load_dwordx4 v11, s[52:55], s27 offen  lds
  s_mov_b32 m0, 0xd000
  s_mov_b32 s27, 0x12100
  buffer_load_dwordx4 v11, s[52:55], s27 offen  lds
  s_mov_b32 m0, 0xd400
  s_mov_b32 s27, 0x16900
  buffer_load_dwordx4 v11, s[52:55], s27 offen  lds
  s_mov_b32 m0, 0xd800
  s_mov_b32 s27, 0x1b100
  buffer_load_dwordx4 v11, s[52:55], s27 offen  lds
  s_mov_b32 m0, 0xdc00
  s_mov_b32 s27, 0x1f900
  buffer_load_dwordx4 v11, s[52:55], s27 offen  lds
  s_mov_b32 m0, 0x4000
  s_mov_b32 s27, 0x0
  buffer_load_dwordx4 v8, s[16:19], s27 offen  lds
  s_mov_b32 m0, 0x4400
  s_mov_b32 s27, 0x8000
  buffer_load_dwordx4 v8, s[16:19], s27 offen  lds
  s_mov_b32 m0, 0x4800
  s_mov_b32 s27, 0x10000
  buffer_load_dwordx4 v9, s[16:19], s27 offen  lds
  s_mov_b32 m0, 0x4c00
  s_mov_b32 s27, 0x18000
  buffer_load_dwordx4 v9, s[16:19], s27 offen  lds
  s_mov_b32 m0, 0x5000
  s_mov_b32 s27, 0x80000
  buffer_load_dwordx4 v8, s[16:19], s27 offen  lds
  s_mov_b32 m0, 0x5400
  s_mov_b32 s27, 0x88000
  buffer_load_dwordx4 v8, s[16:19], s27 offen  lds
  s_mov_b32 m0, 0x5800
  s_mov_b32 s27, 0x90000
  buffer_load_dwordx4 v9, s[16:19], s27 offen  lds
  s_mov_b32 m0, 0x5c00
  s_mov_b32 s27, 0x98000
  buffer_load_dwordx4 v9, s[16:19], s27 offen  lds
  s_mov_b32 m0, 0x6000
  s_mov_b32 s27, 0x100000
  buffer_load_dwordx4 v8, s[16:19], s27 offen  lds
  s_mov_b32 m0, 0x6400
  s_mov_b32 s27, 0x108000
  buffer_load_dwordx4 v8, s[16:19], s27 offen  lds
  s_mov_b32 m0, 0x6800
  s_mov_b32 s27, 0x110000
  buffer_load_dwordx4 v9, s[16:19], s27 offen  lds
  s_mov_b32 m0, 0x6c00
  s_mov_b32 s27, 0x118000
  buffer_load_dwordx4 v9, s[16:19], s27 offen  lds
  s_mov_b32 m0, 0x7000
  s_mov_b32 s27, 0x180000
  buffer_load_dwordx4 v8, s[16:19], s27 offen  lds
  s_mov_b32 m0, 0x7400
  s_mov_b32 s27, 0x188000
  buffer_load_dwordx4 v8, s[16:19], s27 offen  lds
  s_mov_b32 m0, 0x7800
  s_mov_b32 s27, 0x190000
  buffer_load_dwordx4 v9, s[16:19], s27 offen  lds
  s_mov_b32 m0, 0x7c00
  s_mov_b32 s27, 0x198000
  buffer_load_dwordx4 v9, s[16:19], s27 offen  lds
  v_bfe_u32 v20, v1, 4, 1
  v_lshlrev_b32 v20, 10, v20
  v_bfe_u32 v21, v1, 3, 1
  v_lshl_add_u32 v20, v21, 11, v20
  v_bfe_u32 v22, v1, 2, 1
  v_lshl_add_u32 v20, v22, 8, v20
  v_bfe_u32 v23, v1, 2, 2
  v_xor_b32 v23, 0, v23
  v_lshl_add_u32 v20, v23, 6, v20
  v_bfe_u32 v23, v1, 5, 1
  v_and_b32 v24, 3, v1
  v_mul_u32_u24 v25, 40960, v23
  v_add_u32 v25, 16384, v25
  v_add_u32 v25, v25, v20
  v_lshl_add_u32 v12, v24, 4, v25
  v_lshl_add_u32 v14, v24, 3, v25
  v_mul_u32_u24 v25, 32768, v23
  v_add_u32 v25, 98304, v25
  v_add_u32 v25, v25, v20
  v_lshl_add_u32 v13, v24, 4, v25
  v_lshl_add_u32 v15, v24, 3, v25
  v_and_b32 v20, 16, v1
  v_lshl_add_u32 v20, v23, 2, v20
  v_add_u32 v20, v20, v22
  v_lshlrev_b32 v25, 5, v21
  v_lshl_add_u32 v25, v24, 3, v25
  v_add_u32 v25, 16384, v25
  v_lshl_add_u32 v16, v20, 7, v25
  v_lshl_add_u32 v17, v20, 6, v25
  v_and_b32 v24, 15, v1
  v_lshrrev_b32 v25, 4, v1
  v_lshlrev_b32 v26, 2, v25
  v_sub_u32 v27, v24, v26
  v_mov_b32 v28, 0x3f80
  v_cmp_eq_u32 vcc, 0, v27
  s_nop 1
  v_cndmask_b32 v4, 0, v28, vcc
  v_mov_b32 v28, 0x3f800000
  v_cmp_eq_u32 vcc, 1, v27
  s_nop 1
  v_cndmask_b32 v4, v4, v28, vcc
  v_mov_b32 v28, 0x3f80
  v_cmp_eq_u32 vcc, 2, v27
  s_nop 1
  v_cndmask_b32 v5, 0, v28, vcc
  v_mov_b32 v28, 0x3f800000
  v_cmp_eq_u32 vcc, 3, v27
  s_nop 1
  v_cndmask_b32 v5, v5, v28, vcc
  v_mov_b32 v7, 0x40000000
  v_cmp_eq_u32 vcc, 0, v0
  s_nop 1
  v_cndmask_b32 v7, v7, v0, vcc
  v_and_b32 v26, 0x70, v0
  v_lshlrev_b32 v76, 1, v26
  v_and_b32 v26, 0x80, v0
  v_lshl_add_u32 v76, v26, 3, v76
  v_and_b32 v26, 0x100, v0
  v_lshl_add_u32 v76, v26, 5, v76
  s_mov_b32 s62, 0xcccccccc
  s_mov_b32 s63, 0xcccccccc
  s_mov_b32 s64, 0x3f803f80
  s_mov_b32 s65, 0x3f803f80
  s_mov_b32 s90, 0x3e0293ee
  s_mov_b32 s91, 0x3e0293ee
  v_mov_b32 v27, 0x44444444
  v_mov_b32 v28, 0xeeeeeeee
  v_cndmask_b32 v1, v27, v28, s[62:63]
  s_mov_b32 s37, 0
  s_mov_b32 s41, 0x110000
  s_mov_b32 s46, 0
  s_mov_b32 s40, 0x100000
  s_mov_b32 s39, 0x104000
  s_mov_b32 s38, 0x108000
  s_lshl_b32 s26, s36, 13
  s_add_u32 s42, s26, 0x2000000
  s_add_u32 s43, s26, 0x3000000
  s_lshl_b32 s26, s36, 12
  s_add_u32 s44, s26, 0x4000000
  s_lshl_b32 s47, s36, 10
  s_mov_b32 s60, 0x40000000
  s_mov_b32 s61, 0x40000000
  s_lshr_b32 s26, s36, 1
  s_lshl_b32 s26, s26, 9
  s_and_b32 s27, s36, 1
  s_lshl_b32 s28, s27, 1
  s_lshl_b32 s92, 0x330, s28
  s_mov_b32 s93, 0
  s_add_u32 s57, s26, 0x84000
  s_lshl_b32 s27, s27, 4
  s_add_u32 s45, s26, s27
  s_add_u32 s45, s45, 0x7e0c0
  s_waitcnt vmcnt(32)
  ds_read_b64_tr_b16 a[208:209], v16 offset:16384
  ds_read_b64_tr_b16 a[210:211], v16 offset:16640
  ds_read_b64_tr_b16 a[212:213], v16 offset:17408
  ds_read_b64_tr_b16 a[214:215], v16 offset:17664
  ds_read_b64_tr_b16 a[216:217], v16 offset:20480
  ds_read_b64_tr_b16 a[218:219], v16 offset:20736
  ds_read_b64_tr_b16 a[220:221], v16 offset:21504
  ds_read_b64_tr_b16 a[222:223], v16 offset:21760
  ds_read_b64_tr_b16 a[224:225], v16 offset:16448
  ds_read_b64_tr_b16 a[226:227], v16 offset:16704
  ds_read_b64_tr_b16 a[228:229], v16 offset:17472
  ds_read_b64_tr_b16 a[230:231], v16 offset:17728
  ds_read_b64_tr_b16 a[232:233], v16 offset:20544
  ds_read_b64_tr_b16 a[234:235], v16 offset:20800
  ds_read_b64_tr_b16 a[236:237], v16 offset:21568
  ds_read_b64_tr_b16 a[238:239], v16 offset:21824
  s_waitcnt vmcnt(24)
  ds_read_b64_tr_b16 a[240:241], v16 offset:24576
  ds_read_b64_tr_b16 a[242:243], v16 offset:24832
  ds_read_b64_tr_b16 a[244:245], v16 offset:25600
  ds_read_b64_tr_b16 a[246:247], v16 offset:25856
  ds_read_b64_tr_b16 a[248:249], v16 offset:28672
  ds_read_b64_tr_b16 a[250:251], v16 offset:28928
  ds_read_b64_tr_b16 a[252:253], v16 offset:29696
  ds_read_b64_tr_b16 a[254:255], v16 offset:29952
  ds_read_b64_tr_b16 v[20:21], v16 offset:24640
  ds_read_b64_tr_b16 v[22:23], v16 offset:24896
  ds_read_b64_tr_b16 v[24:25], v16 offset:25664
  ds_read_b64_tr_b16 v[26:27], v16 offset:25920
  ds_read_b64_tr_b16 v[28:29], v16 offset:28736
  ds_read_b64_tr_b16 v[30:31], v16 offset:28992
  ds_read_b64_tr_b16 v[32:33], v16 offset:29760
  ds_read_b64_tr_b16 v[34:35], v16 offset:30016
  s_waitcnt lgkmcnt(0)
  s_mov_b32 m0, 0x8000
  s_mov_b32 s27, 0x200000
  buffer_load_dwordx4 v8, s[16:19], s27 offen  lds
  s_mov_b32 m0, 0x8400
  s_mov_b32 s27, 0x208000
  buffer_load_dwordx4 v8, s[16:19], s27 offen  lds
  s_mov_b32 m0, 0x8800
  s_mov_b32 s27, 0x210000
  buffer_load_dwordx4 v9, s[16:19], s27 offen  lds
  s_mov_b32 m0, 0x8c00
  s_mov_b32 s27, 0x218000
  buffer_load_dwordx4 v9, s[16:19], s27 offen  lds
  s_mov_b32 m0, 0x9000
  s_mov_b32 s27, 0x280000
  buffer_load_dwordx4 v8, s[16:19], s27 offen  lds
  s_mov_b32 m0, 0x9400
  s_mov_b32 s27, 0x288000
  buffer_load_dwordx4 v8, s[16:19], s27 offen  lds
  s_mov_b32 m0, 0x9800
  s_mov_b32 s27, 0x290000
  buffer_load_dwordx4 v9, s[16:19], s27 offen  lds
  s_mov_b32 m0, 0x9c00
  s_mov_b32 s27, 0x298000
  buffer_load_dwordx4 v9, s[16:19], s27 offen  lds
  s_mov_b32 m0, 0xa000
  s_mov_b32 s27, 0x300000
  buffer_load_dwordx4 v8, s[16:19], s27 offen  lds
  s_mov_b32 m0, 0xa400
  s_mov_b32 s27, 0x308000
  buffer_load_dwordx4 v8, s[16:19], s27 offen  lds
  s_mov_b32 m0, 0xa800
  s_mov_b32 s27, 0x310000
  buffer_load_dwordx4 v9, s[16:19], s27 offen  lds
  s_mov_b32 m0, 0xac00
  s_mov_b32 s27, 0x318000
  buffer_load_dwordx4 v9, s[16:19], s27 offen  lds
  s_mov_b32 m0, 0xb000
  s_mov_b32 s27, 0x380000
  buffer_load_dwordx4 v8, s[16:19], s27 offen  lds
  s_mov_b32 m0, 0xb400
  s_mov_b32 s27, 0x388000
  buffer_load_dwordx4 v8, s[16:19], s27 offen  lds
  s_mov_b32 m0, 0xb800
  s_mov_b32 s27, 0x390000
  buffer_load_dwordx4 v9, s[16:19], s27 offen  lds
  s_mov_b32 m0, 0xbc00
  s_mov_b32 s27, 0x398000
  buffer_load_dwordx4 v9, s[16:19], s27 offen  lds
  s_waitcnt vmcnt(32)
  ds_read_b64_tr_b16 a[192:193], v17 offset:32768
  ds_read_b64_tr_b16 a[194:195], v17 offset:32896
  ds_read_b64_tr_b16 a[196:197], v17 offset:33280
  ds_read_b64_tr_b16 a[198:199], v17 offset:33408
  ds_read_b64_tr_b16 a[200:201], v17 offset:34816
  ds_read_b64_tr_b16 a[202:203], v17 offset:34944
  ds_read_b64_tr_b16 a[204:205], v17 offset:35328
  ds_read_b64_tr_b16 a[206:207], v17 offset:35456
  ds_read_b64_tr_b16 v[36:37], v17 offset:36864
  ds_read_b64_tr_b16 v[38:39], v17 offset:36992
  ds_read_b64_tr_b16 v[40:41], v17 offset:37376
  ds_read_b64_tr_b16 v[42:43], v17 offset:37504
  ds_read_b64_tr_b16 v[44:45], v17 offset:38912
  ds_read_b64_tr_b16 v[46:47], v17 offset:39040
  ds_read_b64_tr_b16 v[48:49], v17 offset:39424
  ds_read_b64_tr_b16 v[50:51], v17 offset:39552
  s_waitcnt lgkmcnt(0)
  ds_write_b128 v2, v[20:23] offset:32768
  ds_write_b128 v2, v[24:27] offset:33792
  ds_write_b128 v2, v[28:31] offset:34816
  ds_write_b128 v2, v[32:35] offset:35840
  ds_write_b128 v2, v[36:39] offset:36864
  ds_write_b128 v2, v[40:43] offset:37888
  ds_write_b128 v2, v[44:47] offset:38912
  ds_write_b128 v2, v[48:51] offset:39936
  s_waitcnt vmcnt(28)
  s_waitcnt lgkmcnt(0)
  s_barrier
  ds_read_b64_tr_b16 a[48:49], v14 offset:0
  ds_read_b64_tr_b16 a[50:51], v14 offset:512
  ds_read_b64_tr_b16 a[52:53], v15 offset:0
  ds_read_b64_tr_b16 a[54:55], v15 offset:512
  ds_read_b64_tr_b16 a[56:57], v14 offset:32
  ds_read_b64_tr_b16 a[58:59], v14 offset:544
  ds_read_b64_tr_b16 a[60:61], v15 offset:32
  ds_read_b64_tr_b16 a[62:63], v15 offset:544
  s_waitcnt vmcnt(24)
  s_waitcnt lgkmcnt(0)
  s_barrier
  s_mov_b32 m0, 0x4000
  s_mov_b32 s27, 0x400000
  buffer_load_dwordx4 v8, s[16:19], s27 offen  lds
  s_mov_b32 m0, 0x4400
  s_mov_b32 s27, 0x408000
  buffer_load_dwordx4 v8, s[16:19], s27 offen  lds
  s_mov_b32 m0, 0x4800
  s_mov_b32 s27, 0x410000
  buffer_load_dwordx4 v9, s[16:19], s27 offen  lds
  s_mov_b32 m0, 0x4c00
  s_mov_b32 s27, 0x418000
  buffer_load_dwordx4 v9, s[16:19], s27 offen  lds
  ds_read_b64_tr_b16 a[64:65], v14 offset:4096
  ds_read_b64_tr_b16 a[66:67], v14 offset:4608
  ds_read_b64_tr_b16 a[68:69], v15 offset:4096
  ds_read_b64_tr_b16 a[70:71], v15 offset:4608
  ds_read_b64_tr_b16 a[72:73], v14 offset:4128
  ds_read_b64_tr_b16 a[74:75], v14 offset:4640
  ds_read_b64_tr_b16 a[76:77], v15 offset:4128
  ds_read_b64_tr_b16 a[78:79], v15 offset:4640
  s_waitcnt vmcnt(24)
  s_waitcnt lgkmcnt(0)
  s_barrier
  s_mov_b32 m0, 0x5000
  s_mov_b32 s27, 0x0
  buffer_load_dwordx4 v8, s[8:11], s27 offen  lds
  s_mov_b32 m0, 0x5400
  s_mov_b32 s27, 0x8000
  buffer_load_dwordx4 v8, s[8:11], s27 offen  lds
  s_mov_b32 m0, 0x5800
  s_mov_b32 s27, 0x10000
  buffer_load_dwordx4 v9, s[8:11], s27 offen  lds
  s_mov_b32 m0, 0x5c00
  s_mov_b32 s27, 0x18000
  buffer_load_dwordx4 v9, s[8:11], s27 offen  lds
  ds_read_b64_tr_b16 a[96:97], v14 offset:8192
  ds_read_b64_tr_b16 a[98:99], v14 offset:8704
  ds_read_b64_tr_b16 a[100:101], v15 offset:8192
  ds_read_b64_tr_b16 a[102:103], v15 offset:8704
  ds_read_b64_tr_b16 a[104:105], v14 offset:8224
  ds_read_b64_tr_b16 a[106:107], v14 offset:8736
  ds_read_b64_tr_b16 a[108:109], v15 offset:8224
  ds_read_b64_tr_b16 a[110:111], v15 offset:8736
  s_waitcnt vmcnt(24)
  s_waitcnt lgkmcnt(0)
  s_barrier
  s_mov_b32 m0, 0x6000
  s_mov_b32 s27, 0x80000
  buffer_load_dwordx4 v8, s[8:11], s27 offen  lds
  s_mov_b32 m0, 0x6400
  s_mov_b32 s27, 0x88000
  buffer_load_dwordx4 v8, s[8:11], s27 offen  lds
  s_mov_b32 m0, 0x6800
  s_mov_b32 s27, 0x90000
  buffer_load_dwordx4 v9, s[8:11], s27 offen  lds
  s_mov_b32 m0, 0x6c00
  s_mov_b32 s27, 0x98000
  buffer_load_dwordx4 v9, s[8:11], s27 offen  lds
  ds_read_b64_tr_b16 a[112:113], v14 offset:12288
  ds_read_b64_tr_b16 a[114:115], v14 offset:12800
  ds_read_b64_tr_b16 a[116:117], v15 offset:12288
  ds_read_b64_tr_b16 a[118:119], v15 offset:12800
  ds_read_b64_tr_b16 a[120:121], v14 offset:12320
  ds_read_b64_tr_b16 a[122:123], v14 offset:12832
  ds_read_b64_tr_b16 a[124:125], v15 offset:12320
  ds_read_b64_tr_b16 a[126:127], v15 offset:12832
  s_waitcnt vmcnt(24)
  s_waitcnt lgkmcnt(0)
  s_barrier
  s_mov_b32 m0, 0x7000
  s_mov_b32 s27, 0x100000
  buffer_load_dwordx4 v8, s[8:11], s27 offen  lds
  s_mov_b32 m0, 0x7400
  s_mov_b32 s27, 0x108000
  buffer_load_dwordx4 v8, s[8:11], s27 offen  lds
  s_mov_b32 m0, 0x7800
  s_mov_b32 s27, 0x110000
  buffer_load_dwordx4 v9, s[8:11], s27 offen  lds
  s_mov_b32 m0, 0x7c00
  s_mov_b32 s27, 0x118000
  buffer_load_dwordx4 v9, s[8:11], s27 offen  lds
  ds_read_b64_tr_b16 a[128:129], v14 offset:16384
  ds_read_b64_tr_b16 a[130:131], v14 offset:16896
  ds_read_b64_tr_b16 a[132:133], v15 offset:16384
  ds_read_b64_tr_b16 a[134:135], v15 offset:16896
  ds_read_b64_tr_b16 a[136:137], v14 offset:16416
  ds_read_b64_tr_b16 a[138:139], v14 offset:16928
  ds_read_b64_tr_b16 a[140:141], v15 offset:16416
  ds_read_b64_tr_b16 a[142:143], v15 offset:16928
  s_waitcnt vmcnt(24)
  s_waitcnt lgkmcnt(0)
  s_barrier
  s_mov_b32 m0, 0x8000
  s_mov_b32 s27, 0x180000
  buffer_load_dwordx4 v8, s[8:11], s27 offen  lds
  s_mov_b32 m0, 0x8400
  s_mov_b32 s27, 0x188000
  buffer_load_dwordx4 v8, s[8:11], s27 offen  lds
  s_mov_b32 m0, 0x8800
  s_mov_b32 s27, 0x190000
  buffer_load_dwordx4 v9, s[8:11], s27 offen  lds
  s_mov_b32 m0, 0x8c00
  s_mov_b32 s27, 0x198000
  buffer_load_dwordx4 v9, s[8:11], s27 offen  lds
  ds_read_b64_tr_b16 a[144:145], v14 offset:20480
  ds_read_b64_tr_b16 a[146:147], v14 offset:20992
  ds_read_b64_tr_b16 a[148:149], v15 offset:20480
  ds_read_b64_tr_b16 a[150:151], v15 offset:20992
  ds_read_b64_tr_b16 a[152:153], v14 offset:20512
  ds_read_b64_tr_b16 a[154:155], v14 offset:21024
  ds_read_b64_tr_b16 a[156:157], v15 offset:20512
  ds_read_b64_tr_b16 a[158:159], v15 offset:21024
  s_waitcnt vmcnt(24)
  s_waitcnt lgkmcnt(0)
  s_barrier
  s_mov_b32 m0, 0x9000
  s_mov_b32 s27, 0x200000
  buffer_load_dwordx4 v8, s[8:11], s27 offen  lds
  s_mov_b32 m0, 0x9400
  s_mov_b32 s27, 0x208000
  buffer_load_dwordx4 v8, s[8:11], s27 offen  lds
  s_mov_b32 m0, 0x9800
  s_mov_b32 s27, 0x210000
  buffer_load_dwordx4 v9, s[8:11], s27 offen  lds
  s_mov_b32 m0, 0x9c00
  s_mov_b32 s27, 0x218000
  buffer_load_dwordx4 v9, s[8:11], s27 offen  lds
  ds_read_b64_tr_b16 a[160:161], v14 offset:24576
  ds_read_b64_tr_b16 a[162:163], v14 offset:25088
  ds_read_b64_tr_b16 a[164:165], v15 offset:24576
  ds_read_b64_tr_b16 a[166:167], v15 offset:25088
  ds_read_b64_tr_b16 a[168:169], v14 offset:24608
  ds_read_b64_tr_b16 a[170:171], v14 offset:25120
  ds_read_b64_tr_b16 a[172:173], v15 offset:24608
  ds_read_b64_tr_b16 a[174:175], v15 offset:25120
  s_waitcnt vmcnt(24)
  s_waitcnt lgkmcnt(0)
  s_barrier
  s_mov_b32 m0, 0xa000
  s_mov_b32 s27, 0x280000
  buffer_load_dwordx4 v8, s[8:11], s27 offen  lds
  s_mov_b32 m0, 0xa400
  s_mov_b32 s27, 0x288000
  buffer_load_dwordx4 v8, s[8:11], s27 offen  lds
  s_mov_b32 m0, 0xa800
  s_mov_b32 s27, 0x290000
  buffer_load_dwordx4 v9, s[8:11], s27 offen  lds
  s_mov_b32 m0, 0xac00
  s_mov_b32 s27, 0x298000
  buffer_load_dwordx4 v9, s[8:11], s27 offen  lds
  ds_read_b64_tr_b16 a[176:177], v14 offset:28672
  ds_read_b64_tr_b16 a[178:179], v14 offset:29184
  ds_read_b64_tr_b16 a[180:181], v15 offset:28672
  ds_read_b64_tr_b16 a[182:183], v15 offset:29184
  ds_read_b64_tr_b16 a[184:185], v14 offset:28704
  ds_read_b64_tr_b16 a[186:187], v14 offset:29216
  ds_read_b64_tr_b16 a[188:189], v15 offset:28704
  ds_read_b64_tr_b16 a[190:191], v15 offset:29216
  s_waitcnt vmcnt(24)
  s_waitcnt lgkmcnt(0)
  s_barrier
  s_mov_b32 m0, 0xb000
  s_mov_b32 s27, 0x300000
  buffer_load_dwordx4 v8, s[8:11], s27 offen  lds
  s_mov_b32 m0, 0xb400
  s_mov_b32 s27, 0x308000
  buffer_load_dwordx4 v8, s[8:11], s27 offen  lds
  s_mov_b32 m0, 0xb800
  s_mov_b32 s27, 0x310000
  buffer_load_dwordx4 v9, s[8:11], s27 offen  lds
  s_mov_b32 m0, 0xbc00
  s_mov_b32 s27, 0x318000
  buffer_load_dwordx4 v9, s[8:11], s27 offen  lds
  ds_read_b64_tr_b16 a[80:81], v14 offset:0
  ds_read_b64_tr_b16 a[82:83], v14 offset:512
  ds_read_b64_tr_b16 a[84:85], v15 offset:0
  ds_read_b64_tr_b16 a[86:87], v15 offset:512
  ds_read_b64_tr_b16 a[88:89], v14 offset:32
  ds_read_b64_tr_b16 a[90:91], v14 offset:544
  ds_read_b64_tr_b16 a[92:93], v15 offset:32
  ds_read_b64_tr_b16 a[94:95], v15 offset:544
  s_waitcnt vmcnt(24)
  s_waitcnt lgkmcnt(0)
  s_barrier
  s_mov_b32 m0, 0x4000
  s_mov_b32 s27, 0x380000
  buffer_load_dwordx4 v8, s[8:11], s27 offen  lds
  s_mov_b32 m0, 0x4400
  s_mov_b32 s27, 0x388000
  buffer_load_dwordx4 v8, s[8:11], s27 offen  lds
  s_mov_b32 m0, 0x4800
  s_mov_b32 s27, 0x390000
  buffer_load_dwordx4 v9, s[8:11], s27 offen  lds
  s_mov_b32 m0, 0x4c00
  s_mov_b32 s27, 0x398000
  buffer_load_dwordx4 v9, s[8:11], s27 offen  lds
  ds_read_b64_tr_b16 v[80:81], v12 offset:4096
  ds_read_b64_tr_b16 v[82:83], v12 offset:4608
  ds_read_b64_tr_b16 v[84:85], v13 offset:4096
  ds_read_b64_tr_b16 v[86:87], v13 offset:4608
  ds_read_b64_tr_b16 v[88:89], v12 offset:4104
  ds_read_b64_tr_b16 v[90:91], v12 offset:4616
  ds_read_b64_tr_b16 v[92:93], v13 offset:4104
  ds_read_b64_tr_b16 v[94:95], v13 offset:4616
  s_waitcnt vmcnt(24)
  s_waitcnt lgkmcnt(0)
  s_barrier
  s_mov_b32 m0, 0x5000
  s_mov_b32 s27, 0x0
  buffer_load_dwordx4 v8, s[12:15], s27 offen  lds
  s_mov_b32 m0, 0x5400
  s_mov_b32 s27, 0x8000
  buffer_load_dwordx4 v8, s[12:15], s27 offen  lds
  s_mov_b32 m0, 0x5800
  s_mov_b32 s27, 0x10000
  buffer_load_dwordx4 v9, s[12:15], s27 offen  lds
  s_mov_b32 m0, 0x5c00
  s_mov_b32 s27, 0x18000
  buffer_load_dwordx4 v9, s[12:15], s27 offen  lds
  ds_read_b64_tr_b16 v[96:97], v12 offset:8192
  ds_read_b64_tr_b16 v[98:99], v12 offset:8704
  ds_read_b64_tr_b16 v[100:101], v13 offset:8192
  ds_read_b64_tr_b16 v[102:103], v13 offset:8704
  ds_read_b64_tr_b16 v[104:105], v12 offset:8200
  ds_read_b64_tr_b16 v[106:107], v12 offset:8712
  ds_read_b64_tr_b16 v[108:109], v13 offset:8200
  ds_read_b64_tr_b16 v[110:111], v13 offset:8712
  s_waitcnt vmcnt(24)
  s_waitcnt lgkmcnt(0)
  s_barrier
  s_mov_b32 m0, 0x6000
  s_mov_b32 s27, 0x80000
  buffer_load_dwordx4 v8, s[12:15], s27 offen  lds
  s_mov_b32 m0, 0x6400
  s_mov_b32 s27, 0x88000
  buffer_load_dwordx4 v8, s[12:15], s27 offen  lds
  s_mov_b32 m0, 0x6800
  s_mov_b32 s27, 0x90000
  buffer_load_dwordx4 v9, s[12:15], s27 offen  lds
  s_mov_b32 m0, 0x6c00
  s_mov_b32 s27, 0x98000
  buffer_load_dwordx4 v9, s[12:15], s27 offen  lds
  ds_read_b64_tr_b16 v[112:113], v12 offset:12288
  ds_read_b64_tr_b16 v[114:115], v12 offset:12800
  ds_read_b64_tr_b16 v[116:117], v13 offset:12288
  ds_read_b64_tr_b16 v[118:119], v13 offset:12800
  ds_read_b64_tr_b16 v[120:121], v12 offset:12296
  ds_read_b64_tr_b16 v[122:123], v12 offset:12808
  ds_read_b64_tr_b16 v[124:125], v13 offset:12296
  ds_read_b64_tr_b16 v[126:127], v13 offset:12808
  s_waitcnt vmcnt(24)
  s_waitcnt lgkmcnt(0)
  s_barrier
  s_mov_b32 m0, 0x7000
  s_mov_b32 s27, 0x100000
  buffer_load_dwordx4 v8, s[12:15], s27 offen  lds
  s_mov_b32 m0, 0x7400
  s_mov_b32 s27, 0x108000
  buffer_load_dwordx4 v8, s[12:15], s27 offen  lds
  s_mov_b32 m0, 0x7800
  s_mov_b32 s27, 0x110000
  buffer_load_dwordx4 v9, s[12:15], s27 offen  lds
  s_mov_b32 m0, 0x7c00
  s_mov_b32 s27, 0x118000
  buffer_load_dwordx4 v9, s[12:15], s27 offen  lds
  ds_read_b64_tr_b16 v[128:129], v12 offset:16384
  ds_read_b64_tr_b16 v[130:131], v12 offset:16896
  ds_read_b64_tr_b16 v[132:133], v13 offset:16384
  ds_read_b64_tr_b16 v[134:135], v13 offset:16896
  ds_read_b64_tr_b16 v[136:137], v12 offset:16392
  ds_read_b64_tr_b16 v[138:139], v12 offset:16904
  ds_read_b64_tr_b16 v[140:141], v13 offset:16392
  ds_read_b64_tr_b16 v[142:143], v13 offset:16904
  s_waitcnt vmcnt(24)
  s_waitcnt lgkmcnt(0)
  s_barrier
  s_mov_b32 m0, 0x8000
  s_mov_b32 s27, 0x180000
  buffer_load_dwordx4 v8, s[12:15], s27 offen  lds
  s_mov_b32 m0, 0x8400
  s_mov_b32 s27, 0x188000
  buffer_load_dwordx4 v8, s[12:15], s27 offen  lds
  s_mov_b32 m0, 0x8800
  s_mov_b32 s27, 0x190000
  buffer_load_dwordx4 v9, s[12:15], s27 offen  lds
  s_mov_b32 m0, 0x8c00
  s_mov_b32 s27, 0x198000
  buffer_load_dwordx4 v9, s[12:15], s27 offen  lds
  ds_read_b64_tr_b16 v[144:145], v12 offset:20480
  ds_read_b64_tr_b16 v[146:147], v12 offset:20992
  ds_read_b64_tr_b16 v[148:149], v13 offset:20480
  ds_read_b64_tr_b16 v[150:151], v13 offset:20992
  ds_read_b64_tr_b16 v[152:153], v12 offset:20488
  ds_read_b64_tr_b16 v[154:155], v12 offset:21000
  ds_read_b64_tr_b16 v[156:157], v13 offset:20488
  ds_read_b64_tr_b16 v[158:159], v13 offset:21000
  s_waitcnt vmcnt(24)
  s_waitcnt lgkmcnt(0)
  s_barrier
  s_mov_b32 m0, 0x9000
  s_mov_b32 s27, 0x200000
  buffer_load_dwordx4 v8, s[12:15], s27 offen  lds
  s_mov_b32 m0, 0x9400
  s_mov_b32 s27, 0x208000
  buffer_load_dwordx4 v8, s[12:15], s27 offen  lds
  s_mov_b32 m0, 0x9800
  s_mov_b32 s27, 0x210000
  buffer_load_dwordx4 v9, s[12:15], s27 offen  lds
  s_mov_b32 m0, 0x9c00
  s_mov_b32 s27, 0x218000
  buffer_load_dwordx4 v9, s[12:15], s27 offen  lds
  ds_read_b64_tr_b16 v[160:161], v12 offset:24576
  ds_read_b64_tr_b16 v[162:163], v12 offset:25088
  ds_read_b64_tr_b16 v[164:165], v13 offset:24576
  ds_read_b64_tr_b16 v[166:167], v13 offset:25088
  ds_read_b64_tr_b16 v[168:169], v12 offset:24584
  ds_read_b64_tr_b16 v[170:171], v12 offset:25096
  ds_read_b64_tr_b16 v[172:173], v13 offset:24584
  ds_read_b64_tr_b16 v[174:175], v13 offset:25096
  s_waitcnt vmcnt(24)
  s_waitcnt lgkmcnt(0)
  s_barrier
  s_mov_b32 m0, 0xa000
  s_mov_b32 s27, 0x280000
  buffer_load_dwordx4 v8, s[12:15], s27 offen  lds
  s_mov_b32 m0, 0xa400
  s_mov_b32 s27, 0x288000
  buffer_load_dwordx4 v8, s[12:15], s27 offen  lds
  s_mov_b32 m0, 0xa800
  s_mov_b32 s27, 0x290000
  buffer_load_dwordx4 v9, s[12:15], s27 offen  lds
  s_mov_b32 m0, 0xac00
  s_mov_b32 s27, 0x298000
  buffer_load_dwordx4 v9, s[12:15], s27 offen  lds
  ds_read_b64_tr_b16 v[176:177], v12 offset:28672
  ds_read_b64_tr_b16 v[178:179], v12 offset:29184
  ds_read_b64_tr_b16 v[180:181], v13 offset:28672
  ds_read_b64_tr_b16 v[182:183], v13 offset:29184
  ds_read_b64_tr_b16 v[184:185], v12 offset:28680
  ds_read_b64_tr_b16 v[186:187], v12 offset:29192
  ds_read_b64_tr_b16 v[188:189], v13 offset:28680
  ds_read_b64_tr_b16 v[190:191], v13 offset:29192
  s_waitcnt vmcnt(24)
  s_waitcnt lgkmcnt(0)
  s_barrier
  s_mov_b32 m0, 0xb000
  s_mov_b32 s27, 0x300000
  buffer_load_dwordx4 v8, s[12:15], s27 offen  lds
  s_mov_b32 m0, 0xb400
  s_mov_b32 s27, 0x308000
  buffer_load_dwordx4 v8, s[12:15], s27 offen  lds
  s_mov_b32 m0, 0xb800
  s_mov_b32 s27, 0x310000
  buffer_load_dwordx4 v9, s[12:15], s27 offen  lds
  s_mov_b32 m0, 0xbc00
  s_mov_b32 s27, 0x318000
  buffer_load_dwordx4 v9, s[12:15], s27 offen  lds
  ds_read_b64_tr_b16 v[192:193], v12 offset:0
  ds_read_b64_tr_b16 v[194:195], v12 offset:512
  ds_read_b64_tr_b16 v[196:197], v13 offset:0
  ds_read_b64_tr_b16 v[198:199], v13 offset:512
  ds_read_b64_tr_b16 v[200:201], v12 offset:8
  ds_read_b64_tr_b16 v[202:203], v12 offset:520
  ds_read_b64_tr_b16 v[204:205], v13 offset:8
  ds_read_b64_tr_b16 v[206:207], v13 offset:520
  s_waitcnt vmcnt(24)
  s_waitcnt lgkmcnt(0)
  s_barrier
  s_mov_b32 m0, 0x4000
  s_mov_b32 s27, 0x380000
  buffer_load_dwordx4 v8, s[12:15], s27 offen  lds
  s_mov_b32 m0, 0x4400
  s_mov_b32 s27, 0x388000
  buffer_load_dwordx4 v8, s[12:15], s27 offen  lds
  s_mov_b32 m0, 0x4800
  s_mov_b32 s27, 0x390000
  buffer_load_dwordx4 v9, s[12:15], s27 offen  lds
  s_mov_b32 m0, 0x4c00
  s_mov_b32 s27, 0x398000
  buffer_load_dwordx4 v9, s[12:15], s27 offen  lds
  ds_read_b64_tr_b16 v[20:21], v12 offset:4096
  ds_read_b64_tr_b16 v[22:23], v12 offset:4608
  ds_read_b64_tr_b16 v[24:25], v13 offset:4096
  ds_read_b64_tr_b16 v[26:27], v13 offset:4608
  ds_read_b64_tr_b16 v[28:29], v12 offset:4104
  ds_read_b64_tr_b16 v[30:31], v12 offset:4616
  ds_read_b64_tr_b16 v[32:33], v13 offset:4104
  ds_read_b64_tr_b16 v[34:35], v13 offset:4616
  s_waitcnt vmcnt(24)
  s_waitcnt lgkmcnt(0)
  s_barrier
  s_mov_b32 m0, 0x5000
  s_mov_b32 s27, 0x400000
  buffer_load_dwordx4 v8, s[12:15], s27 offen  lds
  s_mov_b32 m0, 0x5400
  s_mov_b32 s27, 0x408000
  buffer_load_dwordx4 v8, s[12:15], s27 offen  lds
  s_mov_b32 m0, 0x5800
  s_mov_b32 s27, 0x410000
  buffer_load_dwordx4 v9, s[12:15], s27 offen  lds
  s_mov_b32 m0, 0x5c00
  s_mov_b32 s27, 0x418000
  buffer_load_dwordx4 v9, s[12:15], s27 offen  lds
  ds_read_b64_tr_b16 v[36:37], v12 offset:8192
  ds_read_b64_tr_b16 v[38:39], v12 offset:8704
  ds_read_b64_tr_b16 v[40:41], v13 offset:8192
  ds_read_b64_tr_b16 v[42:43], v13 offset:8704
  ds_read_b64_tr_b16 v[44:45], v12 offset:8200
  ds_read_b64_tr_b16 v[46:47], v12 offset:8712
  ds_read_b64_tr_b16 v[48:49], v13 offset:8200
  ds_read_b64_tr_b16 v[50:51], v13 offset:8712
  s_waitcnt vmcnt(24)
  s_waitcnt lgkmcnt(0)
  s_barrier
  s_mov_b32 m0, 0x6000
  s_mov_b32 s27, 0x400000
  buffer_load_dwordx4 v8, s[8:11], s27 offen  lds
  s_mov_b32 m0, 0x6400
  s_mov_b32 s27, 0x408000
  buffer_load_dwordx4 v8, s[8:11], s27 offen  lds
  s_mov_b32 m0, 0x6800
  s_mov_b32 s27, 0x410000
  buffer_load_dwordx4 v9, s[8:11], s27 offen  lds
  s_mov_b32 m0, 0x6c00
  s_mov_b32 s27, 0x418000
  buffer_load_dwordx4 v9, s[8:11], s27 offen  lds
  ds_read_b64_tr_b16 v[208:209], v12 offset:12288
  ds_read_b64_tr_b16 v[210:211], v12 offset:12800
  ds_read_b64_tr_b16 v[212:213], v13 offset:12288
  ds_read_b64_tr_b16 v[214:215], v13 offset:12800
  ds_read_b64_tr_b16 v[216:217], v12 offset:12296
  ds_read_b64_tr_b16 v[218:219], v12 offset:12808
  ds_read_b64_tr_b16 v[220:221], v13 offset:12296
  ds_read_b64_tr_b16 v[222:223], v13 offset:12808
  s_waitcnt vmcnt(24)
  s_waitcnt lgkmcnt(0)
  s_barrier
  ds_read_b64_tr_b16 v[224:225], v12 offset:16384
  ds_read_b64_tr_b16 v[226:227], v12 offset:16896
  ds_read_b64_tr_b16 v[228:229], v13 offset:16384
  ds_read_b64_tr_b16 v[230:231], v13 offset:16896
  ds_read_b64_tr_b16 v[232:233], v12 offset:16392
  ds_read_b64_tr_b16 v[234:235], v12 offset:16904
  ds_read_b64_tr_b16 v[236:237], v13 offset:16392
  ds_read_b64_tr_b16 v[238:239], v13 offset:16904
  s_waitcnt vmcnt(20)
  s_waitcnt lgkmcnt(0)
  s_barrier
  ds_read_b64_tr_b16 v[240:241], v12 offset:20480
  ds_read_b64_tr_b16 v[242:243], v12 offset:20992
  ds_read_b64_tr_b16 v[244:245], v13 offset:20480
  ds_read_b64_tr_b16 v[246:247], v13 offset:20992
  ds_read_b64_tr_b16 v[248:249], v12 offset:20488
  ds_read_b64_tr_b16 v[250:251], v12 offset:21000
  ds_read_b64_tr_b16 v[252:253], v13 offset:20488
  ds_read_b64_tr_b16 v[254:255], v13 offset:21000
  s_waitcnt vmcnt(16)
  s_waitcnt lgkmcnt(0)
  s_barrier
  s_mov_b32 m0, 0x8000
  s_mov_b32 s27, 0x0
  buffer_load_dwordx4 v10, s[52:55], s27 offen  lds
  s_mov_b32 m0, 0x8400
  s_mov_b32 s27, 0x2400
  buffer_load_dwordx4 v10, s[52:55], s27 offen  lds
  s_mov_b32 m0, 0x8800
  s_mov_b32 s27, 0x4800
  buffer_load_dwordx4 v10, s[52:55], s27 offen  lds
  s_mov_b32 m0, 0x8c00
  s_mov_b32 s27, 0x6c00
  buffer_load_dwordx4 v10, s[52:55], s27 offen  lds
  s_mov_b32 m0, 0x9000
  s_mov_b32 s27, 0x9000
  buffer_load_dwordx4 v10, s[52:55], s27 offen  lds
  s_mov_b32 m0, 0x9400
  s_mov_b32 s27, 0xb400
  buffer_load_dwordx4 v10, s[52:55], s27 offen  lds
  s_mov_b32 m0, 0x9800
  s_mov_b32 s27, 0xd800
  buffer_load_dwordx4 v10, s[52:55], s27 offen  lds
  s_mov_b32 m0, 0x9c00
  s_mov_b32 s27, 0xfc00
  buffer_load_dwordx4 v10, s[52:55], s27 offen  lds
  ds_read_b64_tr_b16 a[0:1], v12 offset:24576
  ds_read_b64_tr_b16 a[2:3], v12 offset:25088
  ds_read_b64_tr_b16 a[4:5], v13 offset:24576
  ds_read_b64_tr_b16 a[6:7], v13 offset:25088
  ds_read_b64_tr_b16 a[8:9], v12 offset:24584
  ds_read_b64_tr_b16 a[10:11], v12 offset:25096
  ds_read_b64_tr_b16 a[12:13], v13 offset:24584
  ds_read_b64_tr_b16 a[14:15], v13 offset:25096
  s_waitcnt vmcnt(20)
  s_waitcnt lgkmcnt(0)
  s_barrier
  ds_read_b64_tr_b16 a[16:17], v12 offset:28672
  ds_read_b64_tr_b16 a[18:19], v12 offset:29184
  ds_read_b64_tr_b16 a[20:21], v13 offset:28672
  ds_read_b64_tr_b16 a[22:23], v13 offset:29184
  ds_read_b64_tr_b16 a[24:25], v12 offset:28680
  ds_read_b64_tr_b16 a[26:27], v12 offset:29192
  ds_read_b64_tr_b16 a[28:29], v13 offset:28680
  ds_read_b64_tr_b16 a[30:31], v13 offset:29192
  s_waitcnt vmcnt(16)
  s_waitcnt lgkmcnt(0)
  s_barrier
  s_mov_b32 m0, 0xa000
  s_mov_b32 s27, 0x80
  buffer_load_dwordx4 v10, s[52:55], s27 offen  lds
  s_mov_b32 m0, 0xa400
  s_mov_b32 s27, 0x2480
  buffer_load_dwordx4 v10, s[52:55], s27 offen  lds
  s_mov_b32 m0, 0xa800
  s_mov_b32 s27, 0x4880
  buffer_load_dwordx4 v10, s[52:55], s27 offen  lds
  s_mov_b32 m0, 0xac00
  s_mov_b32 s27, 0x6c80
  buffer_load_dwordx4 v10, s[52:55], s27 offen  lds
  s_mov_b32 m0, 0xb000
  s_mov_b32 s27, 0x9080
  buffer_load_dwordx4 v10, s[52:55], s27 offen  lds
  s_mov_b32 m0, 0xb400
  s_mov_b32 s27, 0xb480
  buffer_load_dwordx4 v10, s[52:55], s27 offen  lds
  s_mov_b32 m0, 0xb800
  s_mov_b32 s27, 0xd880
  buffer_load_dwordx4 v10, s[52:55], s27 offen  lds
  s_mov_b32 m0, 0xbc00
  s_mov_b32 s27, 0xfc80
  buffer_load_dwordx4 v10, s[52:55], s27 offen  lds
  ds_read_b64_tr_b16 a[32:33], v12 offset:0
  ds_read_b64_tr_b16 a[34:35], v12 offset:512
  ds_read_b64_tr_b16 a[36:37], v13 offset:0
  ds_read_b64_tr_b16 a[38:39], v13 offset:512
  ds_read_b64_tr_b16 a[40:41], v12 offset:8
  ds_read_b64_tr_b16 a[42:43], v12 offset:520
  ds_read_b64_tr_b16 a[44:45], v13 offset:8
  ds_read_b64_tr_b16 a[46:47], v13 offset:520
  s_waitcnt vmcnt(20)
  s_waitcnt lgkmcnt(0)
  s_barrier
  ds_write_b128 v2, v[20:23] offset:0
  ds_write_b128 v2, v[24:27] offset:1024
  ds_write_b128 v2, v[28:31] offset:2048
  ds_write_b128 v2, v[32:35] offset:3072
  ds_write_b128 v2, v[36:39] offset:12288
  ds_write_b128 v2, v[40:43] offset:13312
  ds_write_b128 v2, v[44:47] offset:14336
  ds_write_b128 v2, v[48:51] offset:15360
  ds_read_b64_tr_b16 v[20:21], v12 offset:4096
  ds_read_b64_tr_b16 v[22:23], v12 offset:4608
  ds_read_b64_tr_b16 v[24:25], v13 offset:4096
  ds_read_b64_tr_b16 v[26:27], v13 offset:4608
  ds_read_b64_tr_b16 v[28:29], v12 offset:4104
  ds_read_b64_tr_b16 v[30:31], v12 offset:4616
  ds_read_b64_tr_b16 v[32:33], v13 offset:4104
  ds_read_b64_tr_b16 v[34:35], v13 offset:4616
  s_waitcnt vmcnt(16)
  s_waitcnt lgkmcnt(0)
  s_barrier
  ds_write_b128 v2, v[20:23] offset:4096
  ds_write_b128 v2, v[24:27] offset:5120
  ds_write_b128 v2, v[28:31] offset:6144
  ds_write_b128 v2, v[32:35] offset:7168
  ds_read_b64_tr_b16 v[36:37], v12 offset:8192
  ds_read_b64_tr_b16 v[38:39], v12 offset:8704
  ds_read_b64_tr_b16 v[40:41], v13 offset:8192
  ds_read_b64_tr_b16 v[42:43], v13 offset:8704
  ds_read_b64_tr_b16 v[44:45], v12 offset:8200
  ds_read_b64_tr_b16 v[46:47], v12 offset:8712
  ds_read_b64_tr_b16 v[48:49], v13 offset:8200
  ds_read_b64_tr_b16 v[50:51], v13 offset:8712
  s_waitcnt lgkmcnt(0)
  s_barrier
  ds_write_b128 v2, v[36:39] offset:8192
  ds_write_b128 v2, v[40:43] offset:9216
  ds_write_b128 v2, v[44:47] offset:10240
  ds_write_b128 v2, v[48:51] offset:11264
  s_waitcnt vmcnt(8)
  ds_read_b64_tr_b16 v[20:21], v16 offset:16384
  ds_read_b64_tr_b16 v[22:23], v16 offset:16640
  ds_read_b64_tr_b16 v[24:25], v16 offset:17408
  ds_read_b64_tr_b16 v[26:27], v16 offset:17664
  ds_read_b64_tr_b16 v[28:29], v16 offset:20480
  ds_read_b64_tr_b16 v[30:31], v16 offset:20736
  ds_read_b64_tr_b16 v[32:33], v16 offset:21504
  ds_read_b64_tr_b16 v[34:35], v16 offset:21760
  ds_read_b64_tr_b16 v[36:37], v16 offset:16448
  ds_read_b64_tr_b16 v[38:39], v16 offset:16704
  ds_read_b64_tr_b16 v[40:41], v16 offset:17472
  ds_read_b64_tr_b16 v[42:43], v16 offset:17728
  ds_read_b64_tr_b16 v[44:45], v16 offset:20544
  ds_read_b64_tr_b16 v[46:47], v16 offset:20800
  ds_read_b64_tr_b16 v[48:49], v16 offset:21568
  ds_read_b64_tr_b16 v[50:51], v16 offset:21824
  s_waitcnt lgkmcnt(0)
  ds_write_b128 v2, v[20:23] offset:16384
  ds_write_b128 v2, v[24:27] offset:17408
  ds_write_b128 v2, v[28:31] offset:18432
  ds_write_b128 v2, v[32:35] offset:19456
  ds_write_b128 v2, v[36:39] offset:20480
  ds_write_b128 v2, v[40:43] offset:21504
  ds_write_b128 v2, v[44:47] offset:22528
  ds_write_b128 v2, v[48:51] offset:23552
  s_waitcnt vmcnt(0)
  ds_read_b64_tr_b16 v[20:21], v16 offset:24576
  ds_read_b64_tr_b16 v[22:23], v16 offset:24832
  ds_read_b64_tr_b16 v[24:25], v16 offset:25600
  ds_read_b64_tr_b16 v[26:27], v16 offset:25856
  ds_read_b64_tr_b16 v[28:29], v16 offset:28672
  ds_read_b64_tr_b16 v[30:31], v16 offset:28928
  ds_read_b64_tr_b16 v[32:33], v16 offset:29696
  ds_read_b64_tr_b16 v[34:35], v16 offset:29952
  ds_read_b64_tr_b16 v[36:37], v16 offset:24640
  ds_read_b64_tr_b16 v[38:39], v16 offset:24896
  ds_read_b64_tr_b16 v[40:41], v16 offset:25664
  ds_read_b64_tr_b16 v[42:43], v16 offset:25920
  ds_read_b64_tr_b16 v[44:45], v16 offset:28736
  ds_read_b64_tr_b16 v[46:47], v16 offset:28992
  ds_read_b64_tr_b16 v[48:49], v16 offset:29760
  ds_read_b64_tr_b16 v[50:51], v16 offset:30016
  s_waitcnt lgkmcnt(0)
  ds_write_b128 v2, v[20:23] offset:24576
  ds_write_b128 v2, v[24:27] offset:25600
  ds_write_b128 v2, v[28:31] offset:26624
  ds_write_b128 v2, v[32:35] offset:27648
  ds_write_b128 v2, v[36:39] offset:28672
  ds_write_b128 v2, v[40:43] offset:29696
  ds_write_b128 v2, v[44:47] offset:30720
  ds_write_b128 v2, v[48:51] offset:31744
  s_waitcnt lgkmcnt(0)
  s_mov_b32 s28, 0
L_reg_73:
  v_mov_b32 v8, 0
  buffer_load_dword v9, v8, s[20:23], 0 offen offset:64 sc1
  s_add_u32 s28, s28, 1
  s_cmp_gt_u32 s28, 1048576
  s_cbranch_scc1 L_fail
  s_waitcnt vmcnt(0)
  v_readfirstlane_b32 s67, v9
L_regc_74:
  s_and_b32 s26, s67, 0xffff
  s_cmp_lt_u32 s26, 256
  s_cbranch_scc1 L_reg_73
  s_lshr_b32 s67, s67, 16
  s_sub_u32 s26, s57, 16384
  s_mov_b32 s27, 0
L_poll_75:
  buffer_load_dword v3, v0, s[4:7], s26 offen sc1
  s_waitcnt vmcnt(0)
  v_cmp_eq_u32 vcc, 0, v3
  s_and_b64 vcc, vcc, s[92:93]
  s_cbranch_vccz L_polld_76
  s_add_u32 s27, s27, 1
  s_cmp_lt_u32 s27, 1048576
  s_cbranch_scc1 L_poll_75
  s_branch L_fail
L_polld_76:
  s_sub_u32 s26, s57, 8192
  s_mov_b32 s27, 0
L_poll_77:
  buffer_load_dword v3, v0, s[4:7], s26 offen sc1
  s_waitcnt vmcnt(0)
  v_cmp_eq_u32 vcc, 0, v3
  s_and_b64 vcc, vcc, s[92:93]
  s_cbranch_vccz L_polld_78
  s_add_u32 s27, s27, 1
  s_cmp_lt_u32 s27, 1048576
  s_cbranch_scc1 L_poll_77
  s_branch L_fail
L_polld_78:
  v_min_u32 v8, -2, v64
  v_min_u32 v9, -2, v65
  v_min_u32 v10, -2, v66
  v_min_u32 v11, -2, v67
  v_min_u32 v12, -2, v68
  v_min_u32 v13, -2, v69
  v_min_u32 v14, -2, v70
  v_min_u32 v15, -2, v71
  v_min_u32 v16, -2, v72
  v_min_u32 v17, -2, v73
  v_min_u32 v18, -2, v74
  v_min_u32 v19, -2, v75
  s_cmp_ge_u32 s67, 32
  s_cbranch_scc0 L_slowmode0
  s_mov_b32 m0, 0
  ds_read_b128 v[60:63], v2 offset:0
  ds_read_b128 v[64:67], v2 offset:1024
  ds_read_b128 v[20:23], v2 offset:2048
  ds_read_b128 v[24:27], v2 offset:3072
  ds_read_b128 v[28:31], v2 offset:12288
  ds_read_b128 v[32:35], v2 offset:13312
  ds_read_b128 v[36:39], v2 offset:14336
  ds_read_b128 v[40:43], v2 offset:15360
  v_mov_b64 v[44:45], 0
  v_mov_b64 v[46:47], 0
  v_mov_b64 v[48:49], 0
  v_mov_b64 v[50:51], 0
  v_mov_b64 v[52:53], 0
  v_mov_b64 v[54:55], 0
  v_mov_b64 v[56:57], 0
  v_mov_b64 v[58:59], 0
  v_mov_b64 v[68:69], 0
  v_mov_b64 v[70:71], 0
  v_mov_b64 v[72:73], 0
  v_mov_b64 v[74:75], 0
  ds_write_b128 v0, v[68:71] offset:14336
  s_branch L_chk0f
.p2align 7
  s_nop 0
  s_nop 0
  s_nop 0
  s_nop 0
  s_nop 0
  s_nop 0
L_top0f:
  s_waitcnt vmcnt(0)
  s_barrier
  buffer_load_dwordx4 v[8:11], v0, s[4:7], s58 offen offset:0 sc1
  s_mov_b32 s56, 0
  buffer_load_dwordx4 v[12:15], v0, s[4:7], s58 offen offset:1024 sc1
  s_bfe_u32 s46, s37, 0x10001
  buffer_load_dwordx4 v[16:19], v0, s[4:7], s59 offen sc1
L_chk0f:
  s_waitcnt vmcnt(2) lgkmcnt(0)
  v_smfmac_f32_16x16x64_bf16 v[48:51], v[8:11], v[60:67], v1
  ds_write_b128 v0, v[8:11] offset:0
  s_waitcnt lgkmcnt(6)
  v_smfmac_f32_16x16x64_bf16 v[56:59], v[8:11], v[20:27], v1
  v_smfmac_f32_16x16x64_bf16 v[44:47], v[8:11], v[80:87], v1
  v_smfmac_f32_16x16x64_bf16 v[52:55], v[8:11], v[88:95], v1
  s_waitcnt vmcnt(1)
  ds_write_b128 v0, v[12:15] offset:1024
  s_waitcnt lgkmcnt(5)
  v_smfmac_f32_16x16x64_bf16 v[48:51], v[12:15], v[28:35], v1
  s_waitcnt vmcnt(0)
  ds_write_b128 v0, v[16:19] offset:8192
  v_max3_u32 v6, v8, v9, v10
  v_max3_u32 v6, v6, v11, v12
  v_max3_u32 v6, v6, v13, v14
  v_max3_u32 v6, v6, v15, v16
  s_waitcnt lgkmcnt(4)
  v_smfmac_f32_16x16x64_bf16 v[56:59], v[12:15], v[36:43], v1
  ds_read_b128 v[60:63], v2 offset:4096
  v_max3_u32 v6, v6, v17, v18
  v_max_u32 v6, v6, v19
  v_cmp_eq_u32 vcc, -1, v6
  v_smfmac_f32_16x16x64_bf16 v[44:47], v[12:15], v[96:103], v1
  ds_read_b128 v[64:67], v2 offset:5120
  s_cbranch_vccnz L_retry0f
  v_smfmac_f32_16x16x64_bf16 v[52:55], v[12:15], v[104:111], v1
  s_waitcnt lgkmcnt(2)
  s_barrier
  ds_read_b128 v[20:23], v0 offset:2048
  v_smfmac_f32_16x16x64_bf16 v[68:71], v[8:11], a[48:55], v1
  ds_read_b128 v[24:27], v0 offset:3072
  s_mov_b64 vcc, s[62:63]
  v_smfmac_f32_16x16x64_bf16 v[72:75], v[8:11], a[56:63], v1
  ds_read_b128 v[28:31], v0 offset:4096
  v_smfmac_f32_16x16x64_bf16 v[68:71], v[12:15], a[64:71], v1
  ds_read_b128 v[32:35], v0 offset:5120
  v_smfmac_f32_16x16x64_bf16 v[72:75], v[12:15], a[72:79], v1
  ds_read_b128 v[8:11], v2 offset:6144
  s_waitcnt lgkmcnt(4)
  v_smfmac_f32_16x16x64_bf16 v[44:47], v[20:23], v[112:119], v1
  ds_read_b128 v[12:15], v2 offset:7168
  v_smfmac_f32_16x16x64_bf16 v[48:51], v[20:23], v[208:215], v1
  ds_read_b128 v[36:39], v0 offset:6144
  v_smfmac_f32_16x16x64_bf16 v[52:55], v[20:23], v[120:127], v1
  ds_read_b128 v[40:43], v0 offset:7168
  v_smfmac_f32_16x16x64_bf16 v[56:59], v[20:23], v[216:223], v1
  v_smfmac_f32_16x16x64_bf16 v[48:51], v[16:19], v[60:67], v1
  ds_read_b128 v[60:63], v2 offset:8192
  ds_read_b128 v[64:67], v2 offset:9216
  s_waitcnt lgkmcnt(8)
  v_smfmac_f32_16x16x64_bf16 v[44:47], v[24:27], v[128:135], v1
  s_waitcnt lgkmcnt(4)
  v_smfmac_f32_16x16x64_bf16 v[56:59], v[16:19], v[8:15], v1
  ds_read_b128 v[8:11], v2 offset:10240
  ds_read_b128 v[12:15], v2 offset:11264
  v_smfmac_f32_16x16x64_bf16 v[52:55], v[24:27], v[136:143], v1
  v_smfmac_f32_16x16x64_bf16 v[48:51], v[24:27], v[224:231], v1
  s_waitcnt lgkmcnt(2)
  v_smfmac_f32_16x16x64_bf16 v[44:47], v[16:19], v[60:67], v1
  buffer_load_dwordx4 v[60:63], v0, s[4:7], s42 offen sc1
  s_add_u32 s26, s42, 4096
  v_smfmac_f32_16x16x64_bf16 v[56:59], v[24:27], v[232:239], v1
  s_waitcnt lgkmcnt(0)
  v_smfmac_f32_16x16x64_bf16 v[52:55], v[16:19], v[8:15], v1
  buffer_load_dwordx4 v[64:67], v0, s[4:7], s26 offen sc1
  v_smfmac_f32_16x16x64_bf16 v[48:51], v[28:31], v[240:247], v1
  v_smfmac_f32_16x16x64_bf16 v[44:47], v[28:31], v[144:151], v1
  buffer_load_dwordx4 v[8:11], v0, s[4:7], s43 offen sc1
  v_lshlrev_b32 v6, 3, v0
  v_smfmac_f32_16x16x64_bf16 v[48:51], v[32:35], a[0:7], v1
  v_smfmac_f32_16x16x64_bf16 v[44:47], v[32:35], v[160:167], v1
  buffer_load_dwordx4 v[12:15], v0, s[4:7], s43 offen offset:1024 sc1
  v_smfmac_f32_16x16x64_bf16 v[48:51], v[36:39], a[16:23], v1
  s_add_u32 s42, s42, 0x40000
  s_add_u32 s43, s43, 0x40000
  v_smfmac_f32_16x16x64_bf16 v[44:47], v[36:39], v[176:183], v1
  s_add_u32 s27, s44, 0x800000
  buffer_store_dword v1, v7, s[4:7], s45 offen sc1
  v_smfmac_f32_16x16x64_bf16 v[48:51], v[40:43], a[32:39], v1
  v_smfmac_f32_16x16x64_bf16 v[44:47], v[40:43], v[192:199], v1
  buffer_load_dword v3, v6, s[4:7], s42 offen sc1
  v_smfmac_f32_16x16x64_bf16 v[56:59], v[28:31], v[248:255], v1
  v_smfmac_f32_16x16x64_bf16 v[52:55], v[28:31], v[152:159], v1
  buffer_load_dword v3, v6, s[4:7], s43 offen sc1
  v_add_f32 v48, v48, v50
  v_smfmac_f32_16x16x64_bf16 v[56:59], v[32:35], a[8:15], v1
  s_min_u32 s26, s37, 61
  s_lshl_b32 s26, s26, 13
  s_add_u32 s26, s26, s57
  v_add_f32 v49, v49, v51
  v_smfmac_f32_16x16x64_bf16 v[52:55], v[32:35], v[168:175], v1
  buffer_load_dword v3, v0, s[4:7], s26 offen sc1
  v_cvt_pk_bf16_f32 v50, v48, v49
  v_smfmac_f32_16x16x64_bf16 v[56:59], v[36:39], a[24:31], v1
  v_add_f32 v44, v44, v46
  v_smfmac_f32_16x16x64_bf16 v[52:55], v[36:39], v[184:191], v1
  v_add_f32 v45, v45, v47
  v_smfmac_f32_16x16x64_bf16 v[56:59], v[40:43], a[40:47], v1
  v_cvt_pk_bf16_f32 v51, v44, v45
  v_smfmac_f32_16x16x64_bf16 v[52:55], v[40:43], v[200:207], v1
  v_mfma_f32_16x16x16_bf16 v[44:47], v[50:51], v[4:5], 0
  v_add_f32 v56, v56, v58
  v_add_f32 v57, v57, v59
  v_cvt_pk_bf16_f32 v58, v56, v57
  s_nop 0
  v_add_f32 v52, v52, v54
  v_add_f32 v53, v53, v55
  v_cvt_pk_bf16_f32 v59, v52, v53
  s_nop 0
  v_cvt_pk_bf16_f32 v48, v44, v45
  v_cvt_pk_bf16_f32 v49, v46, v47
  v_mfma_f32_16x16x16_bf16 v[52:55], v[58:59], v[4:5], 0
  v_min_u32 v48, -2, v48
  v_smfmac_f32_16x16x64_bf16 v[68:71], v[16:19], a[80:87], v1
  v_smfmac_f32_16x16x64_bf16 v[72:75], v[16:19], a[88:95], v1
  v_cvt_pk_bf16_f32 v50, v52, v53
  v_cvt_pk_bf16_f32 v51, v54, v55
  s_waitcnt vmcnt(6)
  s_nop 0
  v_mfma_f32_16x16x32_bf16 v[52:55], v[64:67], v[48:51], 0
  v_lshrrev_b32 v6, 1, v0
  v_mfma_f32_16x16x32_bf16 v[44:47], v[60:63], v[48:51], 0
  v_bfi_b32 v17, 31, v0, v6
  v_mfma_f32_16x16x32_bf16 v[56:59], v[48:51], v[48:51], 0
  v_smfmac_f32_16x16x64_bf16 v[68:71], v[20:23], a[96:103], v1
  v_cndmask_b32_dpp v44, v52, v44, vcc quad_perm:[2,3,2,3] row_mask:0xf bank_mask:0xf
  v_cndmask_b32_dpp v45, v53, v45, vcc quad_perm:[2,3,2,3] row_mask:0xf bank_mask:0xf
  v_cndmask_b32_dpp v46, v54, v46, vcc quad_perm:[2,3,2,3] row_mask:0xf bank_mask:0xf
  v_cndmask_b32_dpp v47, v55, v47, vcc quad_perm:[2,3,2,3] row_mask:0xf bank_mask:0xf
  ds_write_b128 v0, v[44:47] offset:9216
  v_cndmask_b32_dpp v56, v57, v56, vcc quad_perm:[2,3,2,3] row_mask:0xf bank_mask:0xf
  ds_write_addtid_b32 v56 offset:10240
  v_smfmac_f32_16x16x64_bf16 v[72:75], v[20:23], a[104:111], v1
  v_smfmac_f32_16x16x64_bf16 v[68:71], v[24:27], a[112:119], v1
  v_smfmac_f32_16x16x64_bf16 v[72:75], v[24:27], a[120:127], v1
  s_waitcnt lgkmcnt(0)
  s_barrier
  v_smfmac_f32_16x16x64_bf16 v[68:71], v[28:31], a[128:135], v1
  ds_read_b128 v[60:63], v0 offset:11776
  ds_read_b128 v[64:67], v0 offset:13056
  ds_read_b128 v[52:55], v0 offset:10496
  v_smfmac_f32_16x16x64_bf16 v[72:75], v[28:31], a[136:143], v1
  s_not_b64 exec, s[62:63]
  buffer_store_dwordx4 v[48:51], v17, s[4:7], s44 offen sc1
  s_mov_b64 exec, -1
  ds_read_addtid_b32 v57 offset:12800
  ds_read_addtid_b32 v58 offset:14080
  ds_read_addtid_b32 v59 offset:11520
  v_smfmac_f32_16x16x64_bf16 v[68:71], v[32:35], a[144:151], v1
  ds_read_b128 v[20:23], v0 offset:14336
  v_mul_f32 v56, s90, v56
  v_smfmac_f32_16x16x64_bf16 v[72:75], v[32:35], a[152:159], v1
  ds_read_b128 v[24:27], v0 offset:15360
  v_mul_f32 v44, s90, v44
  v_smfmac_f32_16x16x64_bf16 v[68:71], v[36:39], a[160:167], v1
  ds_read_b128 v[28:31], v2 offset:20480
  v_mul_f32 v45, s90, v45
  v_smfmac_f32_16x16x64_bf16 v[72:75], v[36:39], a[168:175], v1
  ds_read_b128 v[32:35], v2 offset:21504
  v_mul_f32 v46, s90, v46
  v_smfmac_f32_16x16x64_bf16 v[68:71], v[40:43], a[176:183], v1
  ds_read_b128 v[36:39], v2 offset:24576
  v_mul_f32 v47, s90, v47
  v_smfmac_f32_16x16x64_bf16 v[72:75], v[40:43], a[184:191], v1
  ds_read_b128 v[40:43], v2 offset:25600
  s_waitcnt lgkmcnt(6)
  v_fmac_f32 v56, s90, v57
  v_fmac_f32 v56, s90, v58
  v_fmac_f32 v56, s90, v59
  v_pk_fma_f32 v[44:45], v[60:61], s[90:91], v[44:45]
  v_pk_fma_f32 v[46:47], v[62:63], s[90:91], v[46:47]
  v_pk_fma_f32 v[44:45], v[64:65], s[90:91], v[44:45]
  v_pk_fma_f32 v[46:47], v[66:67], s[90:91], v[46:47]
  v_pk_fma_f32 v[44:45], v[52:53], s[90:91], v[44:45]
  v_pk_fma_f32 v[46:47], v[54:55], s[90:91], v[46:47]
  v_pk_add_f32 v[68:69], v[68:69], v[70:71]
  v_pk_add_f32 v[72:73], v[72:73], v[74:75]
  v_exp_f32 v44, v44
  v_exp_f32 v45, v45
  v_exp_f32 v46, v46
  v_cvt_pk_bf16_f32 v44, v44, v45
  v_exp_f32 v47, v47
  v_cvt_pk_bf16_f32 v70, v68, v69
  v_mov_b32_dpp v16, v44 quad_perm:[2,3,2,3] row_mask:0xf bank_mask:0xf
  v_cvt_pk_bf16_f32 v45, v46, v47
  v_mov_b32_dpp v17, v44 quad_perm:[0,1,0,1] row_mask:0xf bank_mask:0xf
  v_cvt_pk_bf16_f32 v71, v72, v73
  v_mov_b32_dpp v18, v45 quad_perm:[2,3,2,3] row_mask:0xf bank_mask:0xf
  v_mov_b32_dpp v19, v45 quad_perm:[0,1,0,1] row_mask:0xf bank_mask:0xf
  v_exp_f32_dpp v57, v56 quad_perm:[2,3,2,3] row_mask:0xf bank_mask:0xf
  v_min_u32 v70, -2, v70
  s_waitcnt lgkmcnt(4)
  v_mfma_f32_16x16x32_bf16 v[48:51], v[24:27], v[16:19], 0
  ds_read_b128 v[44:47], v0 offset:14336
  s_add_u32 s94, s41, s47
  v_exp_f32_dpp v58, v56 quad_perm:[0,1,0,1] row_mask:0xf bank_mask:0xf
  s_waitcnt vmcnt(6)
  v_mfma_f32_16x16x32_bf16 v[52:55], v[8:11], v[16:19], 0
  ds_read_b128 v[72:75], v0 offset:14336
  buffer_store_dwordx2 v[70:71], v6, s[4:7], s27 offen sc1
  v_cvt_pk_bf16_f32 v20, v57, v58
  s_waitcnt vmcnt(6)
  v_mfma_f32_16x16x32_bf16 v[60:63], v[12:15], v[16:19], 0
  ds_read_b128 v[64:67], v2 offset:29696
  v_cvt_pk_bf16_f32 v23, v57, v58
  v_mfma_f32_16x16x16_bf16 v[48:51], v[24:25], v[20:21], v[48:51]
  ds_read_b128 v[24:27], v2 offset:17408
  v_mov_b64 v[56:57], 0
  v_mov_b64 v[58:59], 0
  v_mfma_f32_16x16x16_bf16 v[52:55], v[70:71], v[20:21], v[52:55]
  s_cmp_eq_u32 s37, 63
  s_cbranch_scc1 L_last0f
  v_mfma_f32_16x16x16_bf16 v[60:63], v[70:71], v[22:23], v[60:63]
  ds_read_b128 v[20:23], v2 offset:16384
  ds_read_b128 v[68:71], v0 offset:14336
  v_rcp_f32 v6, v48
  ds_read_b128 v[48:51], v0 offset:14336
  v_pk_mul_f32 v[52:53], v[52:53], v[6:7] op_sel_hi:[1,0]
  v_pk_mul_f32 v[54:55], v[54:55], v[6:7] op_sel_hi:[1,0]
  v_cvt_pk_bf16_f32 v52, v52, v53
  v_cvt_pk_bf16_f32 v53, v54, v55
  v_pk_mul_f32 v[60:61], v[60:61], v[6:7] op_sel_hi:[1,0]
  v_pk_mul_f32 v[62:63], v[62:63], v[6:7] op_sel_hi:[1,0]
  v_cvt_pk_bf16_f32 v54, v60, v61
  v_cvt_pk_bf16_f32 v55, v62, v63
  ds_write_b128 v0, v[52:55] offset:0
  s_waitcnt lgkmcnt(10)
  v_smfmac_f32_16x16x64_bf16 v[56:59], v[52:55], v[28:35], v1
  ds_read_b128 v[60:63], v2 offset:28672
  v_subrev_u32 v16, 0x2b800000, v6
  v_cmp_lt_u32 vcc, 0x23000000, v16
  s_waitcnt lgkmcnt(3)
  v_smfmac_f32_16x16x64_bf16 v[68:71], v[52:55], v[36:43], v1
  ds_read_b128 v[28:31], v2 offset:18432
  v_smfmac_f32_16x16x64_bf16 v[44:47], v[52:55], v[20:27], v1
  ds_read_b128 v[32:35], v2 offset:19456
  s_cbranch_vccnz L_guard0f
L_safe0f:
  s_waitcnt lgkmcnt(3)
  s_barrier
  ds_read_b128 v[8:11], v0 offset:2048
  ds_read_b128 v[12:15], v0 offset:3072
  ds_read_b128 v[16:19], v0 offset:1024
  s_waitcnt lgkmcnt(5)
  v_smfmac_f32_16x16x64_bf16 v[72:75], v[52:55], v[60:67], v1
  ds_read_b128 v[36:39], v2 offset:22528
  v_smfmac_f32_16x16x64_bf16 v[48:51], v[52:55], a[192:199], v1
  ds_read_b128 v[40:43], v2 offset:23552
  s_waitcnt lgkmcnt(4)
  v_smfmac_f32_16x16x64_bf16 v[44:47], v[8:11], a[208:215], v1
  ds_read_b128 v[20:23], v2 offset:26624
  s_waitcnt lgkmcnt(4)
  v_smfmac_f32_16x16x64_bf16 v[44:47], v[12:15], a[216:223], v1
  ds_read_b128 v[24:27], v2 offset:27648
  s_waitcnt lgkmcnt(4)
  v_smfmac_f32_16x16x64_bf16 v[44:47], v[16:19], v[28:35], v1
  ds_read_b128 v[60:63], v2 offset:32768
  v_smfmac_f32_16x16x64_bf16 v[56:59], v[8:11], a[224:231], v1
  ds_read_b128 v[64:67], v2 offset:33792
  v_smfmac_f32_16x16x64_bf16 v[56:59], v[12:15], a[232:239], v1
  ds_read_b128 v[28:31], v2 offset:34816
  v_cvt_pk_bf16_f32 v44, v44, v45
  s_waitcnt lgkmcnt(5)
  v_smfmac_f32_16x16x64_bf16 v[56:59], v[16:19], v[36:43], v1
  ds_read_b128 v[32:35], v2 offset:35840
  v_cvt_pk_bf16_f32 v45, v46, v47
  v_smfmac_f32_16x16x64_bf16 v[68:71], v[8:11], a[240:247], v1
  ds_read_b128 v[36:39], v2 offset:30720
  v_bfi_b32 v44, 1, s46, v44
  v_smfmac_f32_16x16x64_bf16 v[68:71], v[12:15], a[248:255], v1
  ds_read_b128 v[40:43], v2 offset:31744
  v_cvt_pk_bf16_f32 v46, v56, v57
  s_waitcnt lgkmcnt(6)
  v_smfmac_f32_16x16x64_bf16 v[68:71], v[16:19], v[20:27], v1
  ds_read_b128 v[20:23], v2 offset:36864
  ds_read_b128 v[24:27], v2 offset:37888
  v_cvt_pk_bf16_f32 v47, v58, v59
  s_waitcnt lgkmcnt(6)
  v_smfmac_f32_16x16x64_bf16 v[72:75], v[8:11], v[60:67], v1
  s_add_u32 s26, s94, 0x0
  ds_read_b128 v[60:63], v2 offset:38912
  ds_read_b128 v[64:67], v2 offset:39936
  v_bfi_b32 v46, 1, s46, v46
  s_waitcnt lgkmcnt(6)
  v_smfmac_f32_16x16x64_bf16 v[72:75], v[12:15], v[28:35], v1
  buffer_store_dwordx4 v[44:47], v0, s[4:7], s26 offen
  v_cvt_pk_bf16_f32 v68, v68, v69
  s_waitcnt lgkmcnt(4)
  v_smfmac_f32_16x16x64_bf16 v[72:75], v[16:19], v[36:43], v1
  v_cvt_pk_bf16_f32 v69, v70, v71
  v_smfmac_f32_16x16x64_bf16 v[48:51], v[16:19], a[200:207], v1
  v_bfi_b32 v68, 1, s46, v68
  s_waitcnt lgkmcnt(2)
  v_smfmac_f32_16x16x64_bf16 v[48:51], v[8:11], v[20:27], v1
  v_cvt_pk_bf16_f32 v70, v72, v73
  s_waitcnt lgkmcnt(0)
  v_smfmac_f32_16x16x64_bf16 v[48:51], v[12:15], v[60:67], v1
  v_cvt_pk_bf16_f32 v71, v74, v75
  v_bfi_b32 v70, 1, s46, v70
  s_add_u32 s26, s94, 0x8000
  buffer_store_dwordx4 v[68:71], v0, s[4:7], s26 offen
  s_nop 3
  v_cvt_pk_bf16_f32 v48, v48, v49
  v_cvt_pk_bf16_f32 v49, v50, v51
  v_bfi_b32 v48, 1, s46, v48
  s_add_u32 s26, s94, 0x10000
  buffer_store_dwordx2 v[48:49], v0, s[4:7], s26 offen offset:0
  s_add_u32 s37, s37, 1
  s_xor_b32 s41, s41, 0x48000
  s_add_u32 s61, s40, s60
  s_mov_b32 s26, s38
  s_mov_b32 s38, s40
  s_mov_b32 s40, s39
  s_mov_b32 s39, s26
  s_add_u32 s58, s40, 0
  s_add_u32 s44, s44, 0x20000
  s_add_u32 s59, s40, 8192
  s_add_u32 s45, s45, 8192
  ds_read_b128 v[60:63], v2 offset:0
  ds_read_b128 v[64:67], v2 offset:1024
  ds_read_b128 v[20:23], v2 offset:2048
  ds_read_b128 v[24:27], v2 offset:3072
  ds_read_b128 v[28:31], v2 offset:12288
  ds_read_b128 v[32:35], v2 offset:13312
  ds_read_b128 v[36:39], v2 offset:14336
  ds_read_b128 v[40:43], v2 offset:15360
  v_mov_b64 v[68:69], 0
  v_mov_b64 v[70:71], 0
  v_mov_b64 v[72:73], 0
  v_mov_b64 v[74:75], 0
  s_waitcnt vmcnt(0)
  s_barrier
  v_mov_b64 v[44:45], 0
  v_mov_b64 v[46:47], 0
  v_mov_b64 v[48:49], 0
  v_mov_b64 v[50:51], 0
  v_mov_b64 v[52:53], 0
  v_mov_b64 v[54:55], 0
  v_mov_b64 v[56:57], 0
  v_mov_b64 v[58:59], 0
  v_cmp_eq_u32 vcc, 0, v3
  s_and_b64 vcc, vcc, s[92:93]
  s_cbranch_vccnz L_slow0f
L_end0f:
  s_branch L_top0f
L_retry0f:
  buffer_load_dwordx4 v[8:11], v0, s[4:7], s58 offen offset:0 sc1
  buffer_load_dwordx4 v[12:15], v0, s[4:7], s58 offen offset:1024 sc1
  buffer_load_dwordx4 v[16:19], v0, s[4:7], s59 offen sc1
  ds_read_b128 v[60:63], v2 offset:0
  ds_read_b128 v[64:67], v2 offset:1024
  s_nop 0
  v_mov_b64 v[44:45], 0
  v_mov_b64 v[46:47], 0
  v_mov_b64 v[48:49], 0
  v_mov_b64 v[50:51], 0
  v_mov_b64 v[52:53], 0
  v_mov_b64 v[54:55], 0
  v_mov_b64 v[56:57], 0
  v_mov_b64 v[58:59], 0
  v_mov_b64 v[68:69], 0
  v_mov_b64 v[70:71], 0
  v_mov_b64 v[72:73], 0
  v_mov_b64 v[74:75], 0
  s_add_u32 s56, s56, 1
  s_cmp_lt_u32 s56, 1048576
  s_cbranch_scc1 L_chk0f
  s_branch L_fail
L_guard0f:
  s_waitcnt vmcnt(0) lgkmcnt(0)
  v_lshrrev_b32 v6, 1, v0
  buffer_load_dwordx2 v[70:71], v6, s[4:7], s27 offen sc1
  s_nop 2
  ds_read_b128 v[44:47], v0 offset:9216
  ds_read_addtid_b32 v56 offset:10240
  ds_read_b128 v[60:63], v0 offset:11776
  ds_read_b128 v[64:67], v0 offset:13056
  ds_read_b128 v[52:55], v0 offset:10496
  ds_read_addtid_b32 v57 offset:12800
  ds_read_addtid_b32 v58 offset:14080
  ds_read_addtid_b32 v59 offset:11520
  ds_read_b128 v[20:23], v0 offset:14336
  ds_read_b128 v[24:27], v0 offset:15360
  s_waitcnt lgkmcnt(7)
  v_pk_add_f32 v[44:45], v[44:45], v[60:61]
  v_pk_add_f32 v[46:47], v[46:47], v[62:63]
  s_waitcnt lgkmcnt(4)
  v_add_f32 v56, v56, v57
  v_pk_add_f32 v[44:45], v[44:45], v[64:65]
  v_pk_add_f32 v[46:47], v[46:47], v[66:67]
  s_waitcnt lgkmcnt(3)
  v_add_f32 v56, v56, v58
  v_pk_add_f32 v[44:45], v[44:45], v[52:53]
  v_pk_add_f32 v[46:47], v[46:47], v[54:55]
  s_waitcnt lgkmcnt(2)
  v_add_f32 v56, v56, v59
  v_max3_f32 v50, v44, v45, v46
  v_max3_f32 v50, v50, v47, v56
  s_nop 1
  v_max_f32_dpp v48, v50, v50 quad_perm:[2,3,0,1] row_mask:0xf bank_mask:0xf
  v_max_f32_dpp v49, v50, v50 quad_perm:[2,3,0,1] row_mask:0xf bank_mask:0xf
  s_nop 1
  v_permlane32_swap_b32 v48, v49
  v_max_f32 v50, v48, v49
  v_max_f32 v51, v48, v49
  s_nop 1
  v_permlane16_swap_b32 v50, v51
  v_max_f32 v50, v50, v51
  v_sub_f32 v44, v44, v50
  v_mul_f32 v44, s90, v44
  v_sub_f32 v45, v45, v50
  v_mul_f32 v45, s90, v45
  v_sub_f32 v46, v46, v50
  v_mul_f32 v46, s90, v46
  v_sub_f32 v47, v47, v50
  v_mul_f32 v47, s90, v47
  v_sub_f32 v56, v56, v50
  v_mul_f32 v56, s90, v56
  v_exp_f32 v44, v44
  v_exp_f32 v45, v45
  v_exp_f32 v46, v46
  v_exp_f32 v47, v47
  v_exp_f32_dpp v57, v56 quad_perm:[2,3,2,3] row_mask:0xf bank_mask:0xf
  v_exp_f32_dpp v58, v56 quad_perm:[0,1,0,1] row_mask:0xf bank_mask:0xf
  v_cvt_pk_bf16_f32 v44, v44, v45
  v_cvt_pk_bf16_f32 v45, v46, v47
  s_waitcnt lgkmcnt(1)
  v_cvt_pk_bf16_f32 v20, v57, v58
  v_cvt_pk_bf16_f32 v23, v57, v58
  v_mov_b32_dpp v16, v44 quad_perm:[2,3,2,3] row_mask:0xf bank_mask:0xf
  v_mov_b32_dpp v17, v44 quad_perm:[0,1,0,1] row_mask:0xf bank_mask:0xf
  v_mov_b32_dpp v18, v45 quad_perm:[2,3,2,3] row_mask:0xf bank_mask:0xf
  v_mov_b32_dpp v19, v45 quad_perm:[0,1,0,1] row_mask:0xf bank_mask:0xf
  s_waitcnt lgkmcnt(0)
  s_nop 0
  v_mfma_f32_16x16x32_bf16 v[48:51], v[24:27], v[16:19], 0
  v_mfma_f32_16x16x32_bf16 v[52:55], v[8:11], v[16:19], 0
  v_mfma_f32_16x16x32_bf16 v[60:63], v[12:15], v[16:19], 0
  v_mfma_f32_16x16x16_bf16 v[48:51], v[24:25], v[20:21], v[48:51]
  s_waitcnt vmcnt(0)
  v_mfma_f32_16x16x16_bf16 v[52:55], v[70:71], v[20:21], v[52:55]
  v_mfma_f32_16x16x16_bf16 v[60:63], v[70:71], v[22:23], v[60:63]
  v_rcp_f32 v6, v48
  s_add_u32 s94, s41, s47
  s_nop 1
  v_pk_mul_f32 v[52:53], v[52:53], v[6:7] op_sel_hi:[1,0]
  v_pk_mul_f32 v[54:55], v[54:55], v[6:7] op_sel_hi:[1,0]
  v_cvt_pk_bf16_f32 v52, v52, v53
  v_cvt_pk_bf16_f32 v53, v54, v55
  v_pk_mul_f32 v[60:61], v[60:61], v[6:7] op_sel_hi:[1,0]
  v_pk_mul_f32 v[62:63], v[62:63], v[6:7] op_sel_hi:[1,0]
  v_cvt_pk_bf16_f32 v54, v60, v61
  v_cvt_pk_bf16_f32 v55, v62, v63
  ds_write_b128 v0, v[52:55] offset:0
  ds_read_b128 v[44:47], v0 offset:14336
  ds_read_b128 v[56:59], v0 offset:14336
  ds_read_b128 v[68:71], v0 offset:14336
  ds_read_b128 v[72:75], v0 offset:14336
  ds_read_b128 v[48:51], v0 offset:14336
  ds_read_b128 v[20:23], v2 offset:16384
  ds_read_b128 v[24:27], v2 offset:17408
  ds_read_b128 v[28:31], v2 offset:20480
  ds_read_b128 v[32:35], v2 offset:21504
  ds_read_b128 v[36:39], v2 offset:24576
  ds_read_b128 v[40:43], v2 offset:25600
  ds_read_b128 v[60:63], v2 offset:28672
  ds_read_b128 v[64:67], v2 offset:29696
  s_waitcnt lgkmcnt(4)
  v_smfmac_f32_16x16x64_bf16 v[56:59], v[52:55], v[28:35], v1
  s_waitcnt lgkmcnt(2)
  v_smfmac_f32_16x16x64_bf16 v[68:71], v[52:55], v[36:43], v1
  v_smfmac_f32_16x16x64_bf16 v[44:47], v[52:55], v[20:27], v1
  ds_read_b128 v[28:31], v2 offset:18432
  ds_read_b128 v[32:35], v2 offset:19456
  s_waitcnt vmcnt(0) lgkmcnt(0)
  s_branch L_safe0f
L_slow0f:
  s_min_u32 s26, s37, 62
  s_lshl_b32 s26, s26, 13
  s_add_u32 s26, s26, s57
  s_sub_u32 s26, s26, 8192
  s_mov_b32 s27, 0
L_poll_79:
  buffer_load_dword v3, v0, s[4:7], s26 offen sc1
  s_waitcnt vmcnt(0)
  v_cmp_eq_u32 vcc, 0, v3
  s_and_b64 vcc, vcc, s[92:93]
  s_cbranch_vccz L_polld_80
  s_add_u32 s27, s27, 1
  s_cmp_lt_u32 s27, 1048576
  s_cbranch_scc1 L_poll_79
  s_branch L_fail
L_polld_80:
  s_branch L_end0f
L_last0f:
  s_waitcnt vmcnt(0)
  s_barrier
  s_add_u32 s45, s45, 8192
  buffer_store_dword v1, v7, s[4:7], s45 offen sc1
  s_branch L_exit
L_slowmode0:
  s_mov_b32 m0, 0
  ds_read_b128 v[60:63], v2 offset:0
  ds_read_b128 v[64:67], v2 offset:1024
  ds_read_b128 v[20:23], v2 offset:2048
  ds_read_b128 v[24:27], v2 offset:3072
  ds_read_b128 v[28:31], v2 offset:12288
  ds_read_b128 v[32:35], v2 offset:13312
  ds_read_b128 v[36:39], v2 offset:14336
  ds_read_b128 v[40:43], v2 offset:15360
  v_mov_b64 v[44:45], 0
  v_mov_b64 v[46:47], 0
  v_mov_b64 v[48:49], 0
  v_mov_b64 v[50:51], 0
  v_mov_b64 v[52:53], 0
  v_mov_b64 v[54:55], 0
  v_mov_b64 v[56:57], 0
  v_mov_b64 v[58:59], 0
  v_mov_b64 v[68:69], 0
  v_mov_b64 v[70:71], 0
  v_mov_b64 v[72:73], 0
  v_mov_b64 v[74:75], 0
  ds_write_b128 v0, v[68:71] offset:14336
  s_branch L_chk0s
L_top0s:
  s_waitcnt vmcnt(0)
  s_barrier
  buffer_load_dwordx4 v[8:11], v0, s[4:7], s58 offen offset:0 sc1
  s_mov_b32 s56, 0
  buffer_load_dwordx4 v[12:15], v0, s[4:7], s58 offen offset:1024 sc1
  s_bfe_u32 s46, s37, 0x10001
  buffer_load_dwordx4 v[16:19], v0, s[4:7], s59 offen sc1
L_chk0s:
  s_waitcnt vmcnt(2) lgkmcnt(0)
  v_smfmac_f32_16x16x64_bf16 v[48:51], v[8:11], v[60:67], v1
  ds_write_b128 v0, v[8:11] offset:0
  s_waitcnt lgkmcnt(6)
  v_smfmac_f32_16x16x64_bf16 v[56:59], v[8:11], v[20:27], v1
  v_smfmac_f32_16x16x64_bf16 v[44:47], v[8:11], v[80:87], v1
  v_smfmac_f32_16x16x64_bf16 v[52:55], v[8:11], v[88:95], v1
  s_waitcnt vmcnt(1)
  ds_write_b128 v0, v[12:15] offset:1024
  s_waitcnt lgkmcnt(5)
  v_smfmac_f32_16x16x64_bf16 v[48:51], v[12:15], v[28:35], v1
  s_waitcnt vmcnt(0)
  ds_write_b128 v0, v[16:19] offset:8192
  v_max3_u32 v6, v8, v9, v10
  v_max3_u32 v6, v6, v11, v12
  v_max3_u32 v6, v6, v13, v14
  v_max3_u32 v6, v6, v15, v16
  s_waitcnt lgkmcnt(4)
  v_smfmac_f32_16x16x64_bf16 v[56:59], v[12:15], v[36:43], v1
  ds_read_b128 v[60:63], v2 offset:4096
  v_max3_u32 v6, v6, v17, v18
  v_max_u32 v6, v6, v19
  v_cmp_eq_u32 vcc, -1, v6
  v_smfmac_f32_16x16x64_bf16 v[44:47], v[12:15], v[96:103], v1
  ds_read_b128 v[64:67], v2 offset:5120
  s_cbranch_vccnz L_retry0s
  v_smfmac_f32_16x16x64_bf16 v[52:55], v[12:15], v[104:111], v1
  s_waitcnt lgkmcnt(2)
  s_barrier
  ds_read_b128 v[20:23], v0 offset:2048
  v_smfmac_f32_16x16x64_bf16 v[68:71], v[8:11], a[48:55], v1
  ds_read_b128 v[24:27], v0 offset:3072
  s_mov_b64 vcc, s[62:63]
  v_smfmac_f32_16x16x64_bf16 v[72:75], v[8:11], a[56:63], v1
  ds_read_b128 v[28:31], v0 offset:4096
  v_smfmac_f32_16x16x64_bf16 v[68:71], v[12:15], a[64:71], v1
  ds_read_b128 v[32:35], v0 offset:5120
  v_smfmac_f32_16x16x64_bf16 v[72:75], v[12:15], a[72:79], v1
  ds_read_b128 v[8:11], v2 offset:6144
  s_waitcnt lgkmcnt(4)
  v_smfmac_f32_16x16x64_bf16 v[44:47], v[20:23], v[112:119], v1
  ds_read_b128 v[12:15], v2 offset:7168
  v_smfmac_f32_16x16x64_bf16 v[48:51], v[20:23], v[208:215], v1
  ds_read_b128 v[36:39], v0 offset:6144
  v_smfmac_f32_16x16x64_bf16 v[52:55], v[20:23], v[120:127], v1
  ds_read_b128 v[40:43], v0 offset:7168
  v_smfmac_f32_16x16x64_bf16 v[56:59], v[20:23], v[216:223], v1
  v_smfmac_f32_16x16x64_bf16 v[48:51], v[16:19], v[60:67], v1
  ds_read_b128 v[60:63], v2 offset:8192
  ds_read_b128 v[64:67], v2 offset:9216
  s_waitcnt lgkmcnt(8)
  v_smfmac_f32_16x16x64_bf16 v[44:47], v[24:27], v[128:135], v1
  s_waitcnt lgkmcnt(4)
  v_smfmac_f32_16x16x64_bf16 v[56:59], v[16:19], v[8:15], v1
  ds_read_b128 v[8:11], v2 offset:10240
  ds_read_b128 v[12:15], v2 offset:11264
  v_smfmac_f32_16x16x64_bf16 v[52:55], v[24:27], v[136:143], v1
  v_smfmac_f32_16x16x64_bf16 v[48:51], v[24:27], v[224:231], v1
  s_waitcnt lgkmcnt(2)
  v_smfmac_f32_16x16x64_bf16 v[44:47], v[16:19], v[60:67], v1
  buffer_load_dwordx4 v[60:63], v0, s[4:7], s42 offen sc1
  s_add_u32 s26, s42, 4096
  v_smfmac_f32_16x16x64_bf16 v[56:59], v[24:27], v[232:239], v1
  s_waitcnt lgkmcnt(0)
  v_smfmac_f32_16x16x64_bf16 v[52:55], v[16:19], v[8:15], v1
  buffer_load_dwordx4 v[64:67], v0, s[4:7], s26 offen sc1
  v_smfmac_f32_16x16x64_bf16 v[48:51], v[28:31], v[240:247], v1
  v_smfmac_f32_16x16x64_bf16 v[44:47], v[28:31], v[144:151], v1
  buffer_load_dwordx4 v[8:11], v0, s[4:7], s43 offen sc1
  v_lshlrev_b32 v6, 3, v0
  v_smfmac_f32_16x16x64_bf16 v[48:51], v[32:35], a[0:7], v1
  v_smfmac_f32_16x16x64_bf16 v[44:47], v[32:35], v[160:167], v1
  buffer_load_dwordx4 v[12:15], v0, s[4:7], s43 offen offset:1024 sc1
  v_smfmac_f32_16x16x64_bf16 v[48:51], v[36:39], a[16:23], v1
  s_add_u32 s42, s42, 0x40000
  s_add_u32 s43, s43, 0x40000
  v_smfmac_f32_16x16x64_bf16 v[44:47], v[36:39], v[176:183], v1
  s_add_u32 s27, s44, 0x800000
  buffer_store_dword v1, v7, s[4:7], s45 offen sc1
  v_smfmac_f32_16x16x64_bf16 v[48:51], v[40:43], a[32:39], v1
  v_smfmac_f32_16x16x64_bf16 v[44:47], v[40:43], v[192:199], v1
  buffer_load_dword v3, v6, s[4:7], s42 offen sc1
  v_smfmac_f32_16x16x64_bf16 v[56:59], v[28:31], v[248:255], v1
  v_smfmac_f32_16x16x64_bf16 v[52:55], v[28:31], v[152:159], v1
  buffer_load_dword v3, v6, s[4:7], s43 offen sc1
  v_add_f32 v48, v48, v50
  v_smfmac_f32_16x16x64_bf16 v[56:59], v[32:35], a[8:15], v1
  s_min_u32 s26, s37, 61
  s_lshl_b32 s26, s26, 13
  s_add_u32 s26, s26, s57
  v_add_f32 v49, v49, v51
  v_smfmac_f32_16x16x64_bf16 v[52:55], v[32:35], v[168:175], v1
  buffer_load_dword v3, v0, s[4:7], s26 offen sc1
  v_cvt_pk_bf16_f32 v50, v48, v49
  v_smfmac_f32_16x16x64_bf16 v[56:59], v[36:39], a[24:31], v1
  v_add_f32 v44, v44, v46
  v_smfmac_f32_16x16x64_bf16 v[52:55], v[36:39], v[184:191], v1
  v_add_f32 v45, v45, v47
  v_smfmac_f32_16x16x64_bf16 v[56:59], v[40:43], a[40:47], v1
  v_cvt_pk_bf16_f32 v51, v44, v45
  v_smfmac_f32_16x16x64_bf16 v[52:55], v[40:43], v[200:207], v1
  v_mfma_f32_16x16x16_bf16 v[44:47], v[50:51], v[4:5], 0
  v_add_f32 v56, v56, v58
  v_add_f32 v57, v57, v59
  v_cvt_pk_bf16_f32 v58, v56, v57
  s_nop 0
  v_add_f32 v52, v52, v54
  v_add_f32 v53, v53, v55
  v_cvt_pk_bf16_f32 v59, v52, v53
  s_nop 0
  v_cvt_pk_bf16_f32 v48, v44, v45
  v_cvt_pk_bf16_f32 v49, v46, v47
  v_mfma_f32_16x16x16_bf16 v[52:55], v[58:59], v[4:5], 0
  v_min_u32 v48, -2, v48
  v_smfmac_f32_16x16x64_bf16 v[68:71], v[16:19], a[80:87], v1
  v_smfmac_f32_16x16x64_bf16 v[72:75], v[16:19], a[88:95], v1
  v_cvt_pk_bf16_f32 v50, v52, v53
  v_cvt_pk_bf16_f32 v51, v54, v55
  s_waitcnt vmcnt(6)
  s_nop 0
  v_mfma_f32_16x16x32_bf16 v[52:55], v[64:67], v[48:51], 0
  v_lshrrev_b32 v6, 1, v0
  v_mfma_f32_16x16x32_bf16 v[44:47], v[60:63], v[48:51], 0
  v_bfi_b32 v17, 31, v0, v6
  v_mfma_f32_16x16x32_bf16 v[56:59], v[48:51], v[48:51], 0
  v_smfmac_f32_16x16x64_bf16 v[68:71], v[20:23], a[96:103], v1
  v_cndmask_b32_dpp v44, v52, v44, vcc quad_perm:[2,3,2,3] row_mask:0xf bank_mask:0xf
  v_cndmask_b32_dpp v45, v53, v45, vcc quad_perm:[2,3,2,3] row_mask:0xf bank_mask:0xf
  v_cndmask_b32_dpp v46, v54, v46, vcc quad_perm:[2,3,2,3] row_mask:0xf bank_mask:0xf
  v_cndmask_b32_dpp v47, v55, v47, vcc quad_perm:[2,3,2,3] row_mask:0xf bank_mask:0xf
  ds_write_b128 v0, v[44:47] offset:9216
  v_cndmask_b32_dpp v56, v57, v56, vcc quad_perm:[2,3,2,3] row_mask:0xf bank_mask:0xf
  ds_write_addtid_b32 v56 offset:10240
  v_smfmac_f32_16x16x64_bf16 v[72:75], v[20:23], a[104:111], v1
  v_smfmac_f32_16x16x64_bf16 v[68:71], v[24:27], a[112:119], v1
  v_smfmac_f32_16x16x64_bf16 v[72:75], v[24:27], a[120:127], v1
  s_waitcnt lgkmcnt(0)
  s_barrier
  v_smfmac_f32_16x16x64_bf16 v[68:71], v[28:31], a[128:135], v1
  ds_read_b128 v[60:63], v0 offset:11776
  ds_read_b128 v[64:67], v0 offset:13056
  ds_read_b128 v[52:55], v0 offset:10496
  v_smfmac_f32_16x16x64_bf16 v[72:75], v[28:31], a[136:143], v1
  s_not_b64 exec, s[62:63]
  buffer_store_dwordx4 v[48:51], v17, s[4:7], s44 offen sc1
  s_mov_b64 exec, -1
  ds_read_addtid_b32 v57 offset:12800
  ds_read_addtid_b32 v58 offset:14080
  ds_read_addtid_b32 v59 offset:11520
  v_smfmac_f32_16x16x64_bf16 v[68:71], v[32:35], a[144:151], v1
  ds_read_b128 v[20:23], v0 offset:14336
  v_mul_f32 v56, s90, v56
  v_smfmac_f32_16x16x64_bf16 v[72:75], v[32:35], a[152:159], v1
  ds_read_b128 v[24:27], v0 offset:15360
  v_mul_f32 v44, s90, v44
  v_smfmac_f32_16x16x64_bf16 v[68:71], v[36:39], a[160:167], v1
  ds_read_b128 v[28:31], v2 offset:20480
  v_mul_f32 v45, s90, v45
  v_smfmac_f32_16x16x64_bf16 v[72:75], v[36:39], a[168:175], v1
  ds_read_b128 v[32:35], v2 offset:21504
  v_mul_f32 v46, s90, v46
  v_smfmac_f32_16x16x64_bf16 v[68:71], v[40:43], a[176:183], v1
  ds_read_b128 v[36:39], v2 offset:24576
  v_mul_f32 v47, s90, v47
  v_smfmac_f32_16x16x64_bf16 v[72:75], v[40:43], a[184:191], v1
  ds_read_b128 v[40:43], v2 offset:25600
  s_waitcnt lgkmcnt(6)
  v_fmac_f32 v56, s90, v57
  v_fmac_f32 v56, s90, v58
  v_fmac_f32 v56, s90, v59
  v_pk_fma_f32 v[44:45], v[60:61], s[90:91], v[44:45]
  v_pk_fma_f32 v[46:47], v[62:63], s[90:91], v[46:47]
  v_pk_fma_f32 v[44:45], v[64:65], s[90:91], v[44:45]
  v_pk_fma_f32 v[46:47], v[66:67], s[90:91], v[46:47]
  v_pk_fma_f32 v[44:45], v[52:53], s[90:91], v[44:45]
  v_pk_fma_f32 v[46:47], v[54:55], s[90:91], v[46:47]
  v_pk_add_f32 v[68:69], v[68:69], v[70:71]
  v_pk_add_f32 v[72:73], v[72:73], v[74:75]
  v_exp_f32 v44, v44
  v_exp_f32 v45, v45
  v_exp_f32 v46, v46
  v_cvt_pk_bf16_f32 v44, v44, v45
  v_exp_f32 v47, v47
  v_cvt_pk_bf16_f32 v70, v68, v69
  v_mov_b32_dpp v16, v44 quad_perm:[2,3,2,3] row_mask:0xf bank_mask:0xf
  v_cvt_pk_bf16_f32 v45, v46, v47
  v_mov_b32_dpp v17, v44 quad_perm:[0,1,0,1] row_mask:0xf bank_mask:0xf
  v_cvt_pk_bf16_f32 v71, v72, v73
  v_mov_b32_dpp v18, v45 quad_perm:[2,3,2,3] row_mask:0xf bank_mask:0xf
  v_mov_b32_dpp v19, v45 quad_perm:[0,1,0,1] row_mask:0xf bank_mask:0xf
  v_exp_f32_dpp v57, v56 quad_perm:[2,3,2,3] row_mask:0xf bank_mask:0xf
  v_min_u32 v70, -2, v70
  s_waitcnt lgkmcnt(4)
  v_mfma_f32_16x16x32_bf16 v[48:51], v[24:27], v[16:19], 0
  ds_read_b128 v[44:47], v0 offset:14336
  s_add_u32 s94, s41, s47
  v_exp_f32_dpp v58, v56 quad_perm:[0,1,0,1] row_mask:0xf bank_mask:0xf
  s_waitcnt vmcnt(6)
  v_mfma_f32_16x16x32_bf16 v[52:55], v[8:11], v[16:19], 0
  ds_read_b128 v[72:75], v0 offset:14336
  buffer_store_dwordx2 v[70:71], v6, s[4:7], s27 offen sc1
  v_cvt_pk_bf16_f32 v20, v57, v58
  s_waitcnt vmcnt(6)
  v_mfma_f32_16x16x32_bf16 v[60:63], v[12:15], v[16:19], 0
  ds_read_b128 v[64:67], v2 offset:29696
  v_cvt_pk_bf16_f32 v23, v57, v58
  v_mfma_f32_16x16x16_bf16 v[48:51], v[24:25], v[20:21], v[48:51]
  ds_read_b128 v[24:27], v2 offset:17408
  v_mov_b64 v[56:57], 0
  v_mov_b64 v[58:59], 0
  v_mfma_f32_16x16x16_bf16 v[52:55], v[70:71], v[20:21], v[52:55]
  s_cmp_eq_u32 s37, 63
  s_cbranch_scc1 L_last0s
  v_mfma_f32_16x16x16_bf16 v[60:63], v[70:71], v[22:23], v[60:63]
  ds_read_b128 v[20:23], v2 offset:16384
  ds_read_b128 v[68:71], v0 offset:14336
  v_rcp_f32 v6, v48
  ds_read_b128 v[48:51], v0 offset:14336
  v_pk_mul_f32 v[52:53], v[52:53], v[6:7] op_sel_hi:[1,0]
  v_pk_mul_f32 v[54:55], v[54:55], v[6:7] op_sel_hi:[1,0]
  v_cvt_pk_bf16_f32 v52, v52, v53
  v_cvt_pk_bf16_f32 v53, v54, v55
  v_pk_mul_f32 v[60:61], v[60:61], v[6:7] op_sel_hi:[1,0]
  v_pk_mul_f32 v[62:63], v[62:63], v[6:7] op_sel_hi:[1,0]
  v_cvt_pk_bf16_f32 v54, v60, v61
  v_cvt_pk_bf16_f32 v55, v62, v63
  ds_write_b128 v0, v[52:55] offset:0
  s_waitcnt lgkmcnt(10)
  v_smfmac_f32_16x16x64_bf16 v[56:59], v[52:55], v[28:35], v1
  ds_read_b128 v[60:63], v2 offset:28672
  v_subrev_u32 v16, 0x2b800000, v6
  v_cmp_lt_u32 vcc, 0x23000000, v16
  s_waitcnt lgkmcnt(3)
  v_smfmac_f32_16x16x64_bf16 v[68:71], v[52:55], v[36:43], v1
  ds_read_b128 v[28:31], v2 offset:18432
  v_smfmac_f32_16x16x64_bf16 v[44:47], v[52:55], v[20:27], v1
  ds_read_b128 v[32:35], v2 offset:19456
  s_cbranch_vccnz L_guard0s
L_safe0s:
  s_waitcnt lgkmcnt(3)
  s_barrier
  ds_read_b128 v[8:11], v0 offset:2048
  ds_read_b128 v[12:15], v0 offset:3072
  ds_read_b128 v[16:19], v0 offset:1024
  s_waitcnt lgkmcnt(5)
  v_smfmac_f32_16x16x64_bf16 v[72:75], v[52:55], v[60:67], v1
  ds_read_b128 v[36:39], v2 offset:22528
  v_smfmac_f32_16x16x64_bf16 v[48:51], v[52:55], a[192:199], v1
  ds_read_b128 v[40:43], v2 offset:23552
  s_waitcnt lgkmcnt(4)
  v_smfmac_f32_16x16x64_bf16 v[44:47], v[8:11], a[208:215], v1
  ds_read_b128 v[20:23], v2 offset:26624
  s_waitcnt lgkmcnt(4)
  v_smfmac_f32_16x16x64_bf16 v[44:47], v[12:15], a[216:223], v1
  ds_read_b128 v[24:27], v2 offset:27648
  s_waitcnt lgkmcnt(4)
  v_smfmac_f32_16x16x64_bf16 v[44:47], v[16:19], v[28:35], v1
  ds_read_b128 v[60:63], v2 offset:32768
  v_smfmac_f32_16x16x64_bf16 v[56:59], v[8:11], a[224:231], v1
  ds_read_b128 v[64:67], v2 offset:33792
  v_smfmac_f32_16x16x64_bf16 v[56:59], v[12:15], a[232:239], v1
  ds_read_b128 v[28:31], v2 offset:34816
  v_cvt_pk_bf16_f32 v44, v44, v45
  s_waitcnt lgkmcnt(5)
  v_smfmac_f32_16x16x64_bf16 v[56:59], v[16:19], v[36:43], v1
  ds_read_b128 v[32:35], v2 offset:35840
  v_cvt_pk_bf16_f32 v45, v46, v47
  v_smfmac_f32_16x16x64_bf16 v[68:71], v[8:11], a[240:247], v1
  ds_read_b128 v[36:39], v2 offset:30720
  v_bfi_b32 v44, 1, s46, v44
  v_smfmac_f32_16x16x64_bf16 v[68:71], v[12:15], a[248:255], v1
  ds_read_b128 v[40:43], v2 offset:31744
  v_cvt_pk_bf16_f32 v46, v56, v57
  s_waitcnt lgkmcnt(6)
  v_smfmac_f32_16x16x64_bf16 v[68:71], v[16:19], v[20:27], v1
  ds_read_b128 v[20:23], v2 offset:36864
  ds_read_b128 v[24:27], v2 offset:37888
  v_cvt_pk_bf16_f32 v47, v58, v59
  s_waitcnt lgkmcnt(6)
  v_smfmac_f32_16x16x64_bf16 v[72:75], v[8:11], v[60:67], v1
  s_add_u32 s26, s94, 0x0
  ds_read_b128 v[60:63], v2 offset:38912
  ds_read_b128 v[64:67], v2 offset:39936
  v_bfi_b32 v46, 1, s46, v46
  s_waitcnt lgkmcnt(6)
  v_smfmac_f32_16x16x64_bf16 v[72:75], v[12:15], v[28:35], v1
  buffer_store_dwordx4 v[44:47], v0, s[4:7], s26 offen sc1
  v_cvt_pk_bf16_f32 v68, v68, v69
  s_waitcnt lgkmcnt(4)
  v_smfmac_f32_16x16x64_bf16 v[72:75], v[16:19], v[36:43], v1
  v_cvt_pk_bf16_f32 v69, v70, v71
  v_smfmac_f32_16x16x64_bf16 v[48:51], v[16:19], a[200:207], v1
  v_bfi_b32 v68, 1, s46, v68
  s_waitcnt lgkmcnt(2)
  v_smfmac_f32_16x16x64_bf16 v[48:51], v[8:11], v[20:27], v1
  v_cvt_pk_bf16_f32 v70, v72, v73
  s_waitcnt lgkmcnt(0)
  v_smfmac_f32_16x16x64_bf16 v[48:51], v[12:15], v[60:67], v1
  v_cvt_pk_bf16_f32 v71, v74, v75
  v_bfi_b32 v70, 1, s46, v70
  s_add_u32 s26, s94, 0x8000
  buffer_store_dwordx4 v[68:71], v0, s[4:7], s26 offen sc1
  s_nop 3
  v_cvt_pk_bf16_f32 v48, v48, v49
  v_cvt_pk_bf16_f32 v49, v50, v51
  v_bfi_b32 v48, 1, s46, v48
  s_add_u32 s26, s94, 0x10000
  buffer_store_dwordx2 v[48:49], v0, s[4:7], s26 offen offset:0 sc1
  s_add_u32 s37, s37, 1
  s_xor_b32 s41, s41, 0x48000
  s_add_u32 s61, s40, s60
  s_mov_b32 s26, s38
  s_mov_b32 s38, s40
  s_mov_b32 s40, s39
  s_mov_b32 s39, s26
  s_add_u32 s58, s40, 0
  s_add_u32 s44, s44, 0x20000
  s_add_u32 s59, s40, 8192
  s_add_u32 s45, s45, 8192
  ds_read_b128 v[60:63], v2 offset:0
  ds_read_b128 v[64:67], v2 offset:1024
  ds_read_b128 v[20:23], v2 offset:2048
  ds_read_b128 v[24:27], v2 offset:3072
  ds_read_b128 v[28:31], v2 offset:12288
  ds_read_b128 v[32:35], v2 offset:13312
  ds_read_b128 v[36:39], v2 offset:14336
  ds_read_b128 v[40:43], v2 offset:15360
  v_mov_b64 v[68:69], 0
  v_mov_b64 v[70:71], 0
  v_mov_b64 v[72:73], 0
  v_mov_b64 v[74:75], 0
  s_waitcnt vmcnt(0)
  s_barrier
  v_mov_b64 v[44:45], 0
  v_mov_b64 v[46:47], 0
  v_mov_b64 v[48:49], 0
  v_mov_b64 v[50:51], 0
  v_mov_b64 v[52:53], 0
  v_mov_b64 v[54:55], 0
  v_mov_b64 v[56:57], 0
  v_mov_b64 v[58:59], 0
  v_cmp_eq_u32 vcc, 0, v3
  s_and_b64 vcc, vcc, s[92:93]
  s_cbranch_vccnz L_slow0s
L_end0s:
  s_branch L_top0s
L_retry0s:
  buffer_load_dwordx4 v[8:11], v0, s[4:7], s58 offen offset:0 sc1
  buffer_load_dwordx4 v[12:15], v0, s[4:7], s58 offen offset:1024 sc1
  buffer_load_dwordx4 v[16:19], v0, s[4:7], s59 offen sc1
  ds_read_b128 v[60:63], v2 offset:0
  ds_read_b128 v[64:67], v2 offset:1024
  s_nop 0
  v_mov_b64 v[44:45], 0
  v_mov_b64 v[46:47], 0
  v_mov_b64 v[48:49], 0
  v_mov_b64 v[50:51], 0
  v_mov_b64 v[52:53], 0
  v_mov_b64 v[54:55], 0
  v_mov_b64 v[56:57], 0
  v_mov_b64 v[58:59], 0
  v_mov_b64 v[68:69], 0
  v_mov_b64 v[70:71], 0
  v_mov_b64 v[72:73], 0
  v_mov_b64 v[74:75], 0
  s_add_u32 s56, s56, 1
  s_cmp_lt_u32 s56, 1048576
  s_cbranch_scc1 L_chk0s
  s_branch L_fail
L_guard0s:
  s_waitcnt vmcnt(0) lgkmcnt(0)
  v_lshrrev_b32 v6, 1, v0
  buffer_load_dwordx2 v[70:71], v6, s[4:7], s27 offen sc1
  s_nop 2
  ds_read_b128 v[44:47], v0 offset:9216
  ds_read_addtid_b32 v56 offset:10240
  ds_read_b128 v[60:63], v0 offset:11776
  ds_read_b128 v[64:67], v0 offset:13056
  ds_read_b128 v[52:55], v0 offset:10496
  ds_read_addtid_b32 v57 offset:12800
  ds_read_addtid_b32 v58 offset:14080
  ds_read_addtid_b32 v59 offset:11520
  ds_read_b128 v[20:23], v0 offset:14336
  ds_read_b128 v[24:27], v0 offset:15360
  s_waitcnt lgkmcnt(7)
  v_pk_add_f32 v[44:45], v[44:45], v[60:61]
  v_pk_add_f32 v[46:47], v[46:47], v[62:63]
  s_waitcnt lgkmcnt(4)
  v_add_f32 v56, v56, v57
  v_pk_add_f32 v[44:45], v[44:45], v[64:65]
  v_pk_add_f32 v[46:47], v[46:47], v[66:67]
  s_waitcnt lgkmcnt(3)
  v_add_f32 v56, v56, v58
  v_pk_add_f32 v[44:45], v[44:45], v[52:53]
  v_pk_add_f32 v[46:47], v[46:47], v[54:55]
  s_waitcnt lgkmcnt(2)
  v_add_f32 v56, v56, v59
  v_max3_f32 v50, v44, v45, v46
  v_max3_f32 v50, v50, v47, v56
  s_nop 1
  v_max_f32_dpp v48, v50, v50 quad_perm:[2,3,0,1] row_mask:0xf bank_mask:0xf
  v_max_f32_dpp v49, v50, v50 quad_perm:[2,3,0,1] row_mask:0xf bank_mask:0xf
  s_nop 1
  v_permlane32_swap_b32 v48, v49
  v_max_f32 v50, v48, v49
  v_max_f32 v51, v48, v49
  s_nop 1
  v_permlane16_swap_b32 v50, v51
  v_max_f32 v50, v50, v51
  v_sub_f32 v44, v44, v50
  v_mul_f32 v44, s90, v44
  v_sub_f32 v45, v45, v50
  v_mul_f32 v45, s90, v45
  v_sub_f32 v46, v46, v50
  v_mul_f32 v46, s90, v46
  v_sub_f32 v47, v47, v50
  v_mul_f32 v47, s90, v47
  v_sub_f32 v56, v56, v50
  v_mul_f32 v56, s90, v56
  v_exp_f32 v44, v44
  v_exp_f32 v45, v45
  v_exp_f32 v46, v46
  v_exp_f32 v47, v47
  v_exp_f32_dpp v57, v56 quad_perm:[2,3,2,3] row_mask:0xf bank_mask:0xf
  v_exp_f32_dpp v58, v56 quad_perm:[0,1,0,1] row_mask:0xf bank_mask:0xf
  v_cvt_pk_bf16_f32 v44, v44, v45
  v_cvt_pk_bf16_f32 v45, v46, v47
  s_waitcnt lgkmcnt(1)
  v_cvt_pk_bf16_f32 v20, v57, v58
  v_cvt_pk_bf16_f32 v23, v57, v58
  v_mov_b32_dpp v16, v44 quad_perm:[2,3,2,3] row_mask:0xf bank_mask:0xf
  v_mov_b32_dpp v17, v44 quad_perm:[0,1,0,1] row_mask:0xf bank_mask:0xf
  v_mov_b32_dpp v18, v45 quad_perm:[2,3,2,3] row_mask:0xf bank_mask:0xf
  v_mov_b32_dpp v19, v45 quad_perm:[0,1,0,1] row_mask:0xf bank_mask:0xf
  s_waitcnt lgkmcnt(0)
  s_nop 0
  v_mfma_f32_16x16x32_bf16 v[48:51], v[24:27], v[16:19], 0
  v_mfma_f32_16x16x32_bf16 v[52:55], v[8:11], v[16:19], 0
  v_mfma_f32_16x16x32_bf16 v[60:63], v[12:15], v[16:19], 0
  v_mfma_f32_16x16x16_bf16 v[48:51], v[24:25], v[20:21], v[48:51]
  s_waitcnt vmcnt(0)
  v_mfma_f32_16x16x16_bf16 v[52:55], v[70:71], v[20:21], v[52:55]
  v_mfma_f32_16x16x16_bf16 v[60:63], v[70:71], v[22:23], v[60:63]
  v_rcp_f32 v6, v48
  s_add_u32 s94, s41, s47
  s_nop 1
  v_pk_mul_f32 v[52:53], v[52:53], v[6:7] op_sel_hi:[1,0]
  v_pk_mul_f32 v[54:55], v[54:55], v[6:7] op_sel_hi:[1,0]
  v_cvt_pk_bf16_f32 v52, v52, v53
  v_cvt_pk_bf16_f32 v53, v54, v55
  v_pk_mul_f32 v[60:61], v[60:61], v[6:7] op_sel_hi:[1,0]
  v_pk_mul_f32 v[62:63], v[62:63], v[6:7] op_sel_hi:[1,0]
  v_cvt_pk_bf16_f32 v54, v60, v61
  v_cvt_pk_bf16_f32 v55, v62, v63
  ds_write_b128 v0, v[52:55] offset:0
  ds_read_b128 v[44:47], v0 offset:14336
  ds_read_b128 v[56:59], v0 offset:14336
  ds_read_b128 v[68:71], v0 offset:14336
  ds_read_b128 v[72:75], v0 offset:14336
  ds_read_b128 v[48:51], v0 offset:14336
  ds_read_b128 v[20:23], v2 offset:16384
  ds_read_b128 v[24:27], v2 offset:17408
  ds_read_b128 v[28:31], v2 offset:20480
  ds_read_b128 v[32:35], v2 offset:21504
  ds_read_b128 v[36:39], v2 offset:24576
  ds_read_b128 v[40:43], v2 offset:25600
  ds_read_b128 v[60:63], v2 offset:28672
  ds_read_b128 v[64:67], v2 offset:29696
  s_waitcnt lgkmcnt(4)
  v_smfmac_f32_16x16x64_bf16 v[56:59], v[52:55], v[28:35], v1
  s_waitcnt lgkmcnt(2)
  v_smfmac_f32_16x16x64_bf16 v[68:71], v[52:55], v[36:43], v1
  v_smfmac_f32_16x16x64_bf16 v[44:47], v[52:55], v[20:27], v1
  ds_read_b128 v[28:31], v2 offset:18432
  ds_read_b128 v[32:35], v2 offset:19456
  s_waitcnt vmcnt(0) lgkmcnt(0)
  s_branch L_safe0s
L_slow0s:
  s_min_u32 s26, s37, 62
  s_lshl_b32 s26, s26, 13
  s_add_u32 s26, s26, s57
  s_sub_u32 s26, s26, 8192
  s_mov_b32 s27, 0
L_poll_81:
  buffer_load_dword v3, v0, s[4:7], s26 offen sc1
  s_waitcnt vmcnt(0)
  v_cmp_eq_u32 vcc, 0, v3
  s_and_b64 vcc, vcc, s[92:93]
  s_cbranch_vccz L_polld_82
  s_add_u32 s27, s27, 1
  s_cmp_lt_u32 s27, 1048576
  s_cbranch_scc1 L_poll_81
  s_branch L_fail
L_polld_82:
  s_branch L_end0s
L_last0s:
  s_waitcnt vmcnt(0)
  s_barrier
  s_add_u32 s45, s45, 8192
  buffer_store_dword v1, v7, s[4:7], s45 offen sc1
  s_branch L_exit
L_recw1:
  v_add_u32 v2, 57344, v0
  v_lshrrev_b32 v20, 4, v1
  v_lshlrev_b32 v21, 13, v20
  v_and_b32 v20, 1, v20
  v_lshlrev_b32 v20, 6, v20
  v_and_b32 v22, 0xf0, v0
  v_xor_b32 v20, v20, v22
  s_lshl_b32 s27, s36, 8
  v_add3_u32 v8, v20, v21, s27
  v_xor_b32 v9, 0x80, v8
  s_mul_i32 s27, s36, 147456
  v_lshrrev_b32 v20, 3, v1
  v_mul_u32_u24 v20, 1152, v20
  v_and_b32 v21, 0x70, v0
  v_add3_u32 v10, v20, v21, s27
  v_lshrrev_b32 v20, 2, v1
  v_mul_u32_u24 v20, 1152, v20
  v_and_b32 v21, 0x30, v0
  v_add3_u32 v11, v20, v21, s27
  v_bfe_u32 v20, v1, 2, 2
  v_and_b32 v21, 1, v1
  v_lshl_add_u32 v20, v20, 1, v21
  v_mul_u32_u24 v20, 1152, v20
  v_lshrrev_b32 v21, 4, v1
  v_lshl_add_u32 v20, v21, 5, v20
  v_bfe_u32 v21, v1, 1, 1
  v_lshl_add_u32 v20, v21, 4, v20
  buffer_load_dwordx4 v[64:67], v20, s[84:87], 0 offen offset:384
  buffer_load_dwordx4 v[68:71], v20, s[84:87], 0 offen offset:256
  s_mov_b32 m0, 0x12000
  s_mov_b32 s27, 0x12180
  buffer_load_dwordx4 v10, s[52:55], s27 offen  lds
  s_mov_b32 m0, 0x12400
  s_mov_b32 s27, 0x14580
  buffer_load_dwordx4 v10, s[52:55], s27 offen  lds
  s_mov_b32 m0, 0x12800
  s_mov_b32 s27, 0x16980
  buffer_load_dwordx4 v10, s[52:55], s27 offen  lds
  s_mov_b32 m0, 0x12c00
  s_mov_b32 s27, 0x18d80
  buffer_load_dwordx4 v10, s[52:55], s27 offen  lds
  s_mov_b32 m0, 0x13000
  s_mov_b32 s27, 0x1b180
  buffer_load_dwordx4 v10, s[52:55], s27 offen  lds
  s_mov_b32 m0, 0x13400
  s_mov_b32 s27, 0x1d580
  buffer_load_dwordx4 v10, s[52:55], s27 offen  lds
  s_mov_b32 m0, 0x13800
  s_mov_b32 s27, 0x1f980
  buffer_load_dwordx4 v10, s[52:55], s27 offen  lds
  s_mov_b32 m0, 0x13c00
  s_mov_b32 s27, 0x21d80
  buffer_load_dwordx4 v10, s[52:55], s27 offen  lds
  s_mov_b32 m0, 0x14000
  s_mov_b32 s27, 0x12200
  buffer_load_dwordx4 v10, s[52:55], s27 offen  lds
  s_mov_b32 m0, 0x14400
  s_mov_b32 s27, 0x14600
  buffer_load_dwordx4 v10, s[52:55], s27 offen  lds
  s_mov_b32 m0, 0x14800
  s_mov_b32 s27, 0x16a00
  buffer_load_dwordx4 v10, s[52:55], s27 offen  lds
  s_mov_b32 m0, 0x14c00
  s_mov_b32 s27, 0x18e00
  buffer_load_dwordx4 v10, s[52:55], s27 offen  lds
  s_mov_b32 m0, 0x15000
  s_mov_b32 s27, 0x1b200
  buffer_load_dwordx4 v10, s[52:55], s27 offen  lds
  s_mov_b32 m0, 0x15400
  s_mov_b32 s27, 0x1d600
  buffer_load_dwordx4 v10, s[52:55], s27 offen  lds
  s_mov_b32 m0, 0x15800
  s_mov_b32 s27, 0x1fa00
  buffer_load_dwordx4 v10, s[52:55], s27 offen  lds
  s_mov_b32 m0, 0x15c00
  s_mov_b32 s27, 0x21e00
  buffer_load_dwordx4 v10, s[52:55], s27 offen  lds
  s_mov_b32 m0, 0x16000
  s_mov_b32 s27, 0x140
  buffer_load_dwordx4 v11, s[52:55], s27 offen  lds
  s_mov_b32 m0, 0x16400
  s_mov_b32 s27, 0x4940
  buffer_load_dwordx4 v11, s[52:55], s27 offen  lds
  s_mov_b32 m0, 0x16800
  s_mov_b32 s27, 0x9140
  buffer_load_dwordx4 v11, s[52:55], s27 offen  lds
  s_mov_b32 m0, 0x16c00
  s_mov_b32 s27, 0xd940
  buffer_load_dwordx4 v11, s[52:55], s27 offen  lds
  s_mov_b32 m0, 0x17000
  s_mov_b32 s27, 0x12140
  buffer_load_dwordx4 v11, s[52:55], s27 offen  lds
  s_mov_b32 m0, 0x17400
  s_mov_b32 s27, 0x16940
  buffer_load_dwordx4 v11, s[52:55], s27 offen  lds
  s_mov_b32 m0, 0x17800
  s_mov_b32 s27, 0x1b140
  buffer_load_dwordx4 v11, s[52:55], s27 offen  lds
  s_mov_b32 m0, 0x17c00
  s_mov_b32 s27, 0x1f940
  buffer_load_dwordx4 v11, s[52:55], s27 offen  lds
  s_mov_b32 m0, 0xe000
  s_mov_b32 s27, 0x20000
  buffer_load_dwordx4 v8, s[16:19], s27 offen  lds
  s_mov_b32 m0, 0xe400
  s_mov_b32 s27, 0x28000
  buffer_load_dwordx4 v8, s[16:19], s27 offen  lds
  s_mov_b32 m0, 0xe800
  s_mov_b32 s27, 0x30000
  buffer_load_dwordx4 v9, s[16:19], s27 offen  lds
  s_mov_b32 m0, 0xec00
  s_mov_b32 s27, 0x38000
  buffer_load_dwordx4 v9, s[16:19], s27 offen  lds
  s_mov_b32 m0, 0xf000
  s_mov_b32 s27, 0xa0000
  buffer_load_dwordx4 v8, s[16:19], s27 offen  lds
  s_mov_b32 m0, 0xf400
  s_mov_b32 s27, 0xa8000
  buffer_load_dwordx4 v8, s[16:19], s27 offen  lds
  s_mov_b32 m0, 0xf800
  s_mov_b32 s27, 0xb0000
  buffer_load_dwordx4 v9, s[16:19], s27 offen  lds
  s_mov_b32 m0, 0xfc00
  s_mov_b32 s27, 0xb8000
  buffer_load_dwordx4 v9, s[16:19], s27 offen  lds
  s_mov_b32 m0, 0x10000
  s_mov_b32 s27, 0x120000
  buffer_load_dwordx4 v8, s[16:19], s27 offen  lds
  s_mov_b32 m0, 0x10400
  s_mov_b32 s27, 0x128000
  buffer_load_dwordx4 v8, s[16:19], s27 offen  lds
  s_mov_b32 m0, 0x10800
  s_mov_b32 s27, 0x130000
  buffer_load_dwordx4 v9, s[16:19], s27 offen  lds
  s_mov_b32 m0, 0x10c00
  s_mov_b32 s27, 0x138000
  buffer_load_dwordx4 v9, s[16:19], s27 offen  lds
  s_mov_b32 m0, 0x11000
  s_mov_b32 s27, 0x1a0000
  buffer_load_dwordx4 v8, s[16:19], s27 offen  lds
  s_mov_b32 m0, 0x11400
  s_mov_b32 s27, 0x1a8000
  buffer_load_dwordx4 v8, s[16:19], s27 offen  lds
  s_mov_b32 m0, 0x11800
  s_mov_b32 s27, 0x1b0000
  buffer_load_dwordx4 v9, s[16:19], s27 offen  lds
  s_mov_b32 m0, 0x11c00
  s_mov_b32 s27, 0x1b8000
  buffer_load_dwordx4 v9, s[16:19], s27 offen  lds
  v_bfe_u32 v20, v1, 4, 1
  v_lshlrev_b32 v20, 10, v20
  v_bfe_u32 v21, v1, 3, 1
  v_lshl_add_u32 v20, v21, 11, v20
  v_bfe_u32 v22, v1, 2, 1
  v_lshl_add_u32 v20, v22, 8, v20
  v_bfe_u32 v23, v1, 2, 2
  v_xor_b32 v23, 1, v23
  v_lshl_add_u32 v20, v23, 6, v20
  v_bfe_u32 v23, v1, 5, 1
  v_and_b32 v24, 3, v1
  v_mul_u32_u24 v25, 40960, v23
  v_add_u32 v25, 16384, v25
  v_add_u32 v25, v25, v20
  v_lshl_add_u32 v12, v24, 4, v25
  v_lshl_add_u32 v14, v24, 3, v25
  v_mul_u32_u24 v25, 32768, v23
  v_add_u32 v25, 98304, v25
  v_add_u32 v25, v25, v20
  v_lshl_add_u32 v13, v24, 4, v25
  v_lshl_add_u32 v15, v24, 3, v25
  v_and_b32 v20, 16, v1
  v_lshl_add_u32 v20, v23, 2, v20
  v_add_u32 v20, v20, v22
  v_lshlrev_b32 v25, 5, v21
  v_lshl_add_u32 v25, v24, 3, v25
  v_add_u32 v25, 57344, v25
  v_lshl_add_u32 v16, v20, 7, v25
  v_lshl_add_u32 v17, v20, 6, v25
  v_and_b32 v24, 15, v1
  v_lshrrev_b32 v25, 4, v1
  v_lshlrev_b32 v26, 2, v25
  v_sub_u32 v27, v24, v26
  v_mov_b32 v28, 0x3f80
  v_cmp_eq_u32 vcc, 0, v27
  s_nop 1
  v_cndmask_b32 v4, 0, v28, vcc
  v_mov_b32 v28, 0x3f800000
  v_cmp_eq_u32 vcc, 1, v27
  s_nop 1
  v_cndmask_b32 v4, v4, v28, vcc
  v_mov_b32 v28, 0x3f80
  v_cmp_eq_u32 vcc, 2, v27
  s_nop 1
  v_cndmask_b32 v5, 0, v28, vcc
  v_mov_b32 v28, 0x3f800000
  v_cmp_eq_u32 vcc, 3, v27
  s_nop 1
  v_cndmask_b32 v5, v5, v28, vcc
  v_and_b32 v6, 0x380, v0
  v_and_b32 v26, 0x70, v0
  v_lshl_add_u32 v6, v6, 3, v26
  v_bfe_u32 v7, v1, 4, 1
  v_bfe_u32 v26, v1, 5, 1
  v_lshl_add_u32 v7, v7, 1, v26
  v_and_b32 v26, 0x10, v0
  v_lshl_add_u32 v7, v7, 2, v26
  v_and_b32 v26, 0x60, v0
  v_lshl_add_u32 v7, v26, 3, v7
  v_and_b32 v26, 0x80, v0
  v_lshl_add_u32 v7, v26, 23, v7
  v_and_b32 v26, 0x10, v0
  v_mov_b32 v28, 0x3f80
  v_lshlrev_b32 v28, v26, v28
  v_lshrrev_b32 v26, 1, v24
  v_cmp_eq_u32 vcc, 0, v26
  s_nop 1
  v_cndmask_b32 v76, 0, v28, vcc
  v_cmp_eq_u32 vcc, 1, v26
  s_nop 1
  v_cndmask_b32 v77, 0, v28, vcc
  v_cmp_eq_u32 vcc, 2, v26
  s_nop 1
  v_cndmask_b32 v78, 0, v28, vcc
  v_cmp_eq_u32 vcc, 3, v26
  s_nop 1
  v_cndmask_b32 v79, 0, v28, vcc
  s_mov_b32 s62, 0xcccccccc
  s_mov_b32 s63, 0xcccccccc
  s_mov_b32 s64, 0x3f803f80
  s_mov_b32 s65, 0x3f803f80
  s_mov_b32 s90, 0x3e0293ee
  s_mov_b32 s91, 0x3e0293ee
  v_mov_b32 v27, 0x44444444
  v_mov_b32 v28, 0xeeeeeeee
  v_cndmask_b32 v1, v27, v28, s[62:63]
  s_mov_b32 s37, 0
  s_mov_b32 s41, 0x110000
  s_mov_b32 s46, 0
  s_mov_b32 s40, 0x100000
  s_mov_b32 s39, 0x104000
  s_mov_b32 s38, 0x108000
  s_lshl_b32 s26, s36, 13
  s_add_u32 s42, s26, 0x2000400
  s_add_u32 s43, s26, 0x3000800
  s_lshl_b32 s26, s36, 12
  s_add_u32 s44, s26, 0x4000400
  s_lshl_b32 s47, s36, 10
  s_add_u32 s26, s36, 64
  s_lshr_b32 s27, s26, 3
  s_and_b32 s28, s26, 7
  s_lshl_b32 s66, s27, 15
  s_lshl_b32 s29, s28, 7
  s_add_u32 s66, s66, s29
  s_lshl_b32 s60, s27, 10
  s_lshl_b32 s29, s28, 5
  s_add_u32 s60, s60, s29
  s_cmp_lt_u32 s36, 8
  s_cselect_b32 s60, s60, 0x40000000
  s_cselect_b32 s66, s66, 0x40000000
  s_mov_b32 s61, 0x40000000
  s_lshr_b32 s26, s36, 1
  s_lshl_b32 s26, s26, 9
  s_and_b32 s27, s36, 1
  s_lshl_b32 s28, s27, 1
  s_lshl_b32 s92, 0x330, s28
  s_mov_b32 s93, 0
  s_add_u32 s57, s26, 0x84000
  s_lshl_b32 s27, s27, 4
  s_add_u32 s45, s26, s27
  s_add_u32 s45, s45, 0x7e0c0
  s_waitcnt vmcnt(32)
  ds_read_b64_tr_b16 a[208:209], v16 offset:16384
  ds_read_b64_tr_b16 a[210:211], v16 offset:16640
  ds_read_b64_tr_b16 a[212:213], v16 offset:17408
  ds_read_b64_tr_b16 a[214:215], v16 offset:17664
  ds_read_b64_tr_b16 a[216:217], v16 offset:20480
  ds_read_b64_tr_b16 a[218:219], v16 offset:20736
  ds_read_b64_tr_b16 a[220:221], v16 offset:21504
  ds_read_b64_tr_b16 a[222:223], v16 offset:21760
  ds_read_b64_tr_b16 a[224:225], v16 offset:16448
  ds_read_b64_tr_b16 a[226:227], v16 offset:16704
  ds_read_b64_tr_b16 a[228:229], v16 offset:17472
  ds_read_b64_tr_b16 a[230:231], v16 offset:17728
  ds_read_b64_tr_b16 a[232:233], v16 offset:20544
  ds_read_b64_tr_b16 a[234:235], v16 offset:20800
  ds_read_b64_tr_b16 a[236:237], v16 offset:21568
  ds_read_b64_tr_b16 a[238:239], v16 offset:21824
  s_waitcnt vmcnt(24)
  ds_read_b64_tr_b16 a[240:241], v16 offset:24576
  ds_read_b64_tr_b16 a[242:243], v16 offset:24832
  ds_read_b64_tr_b16 a[244:245], v16 offset:25600
  ds_read_b64_tr_b16 a[246:247], v16 offset:25856
  ds_read_b64_tr_b16 a[248:249], v16 offset:28672
  ds_read_b64_tr_b16 a[250:251], v16 offset:28928
  ds_read_b64_tr_b16 a[252:253], v16 offset:29696
  ds_read_b64_tr_b16 a[254:255], v16 offset:29952
  ds_read_b64_tr_b16 v[20:21], v16 offset:24640
  ds_read_b64_tr_b16 v[22:23], v16 offset:24896
  ds_read_b64_tr_b16 v[24:25], v16 offset:25664
  ds_read_b64_tr_b16 v[26:27], v16 offset:25920
  ds_read_b64_tr_b16 v[28:29], v16 offset:28736
  ds_read_b64_tr_b16 v[30:31], v16 offset:28992
  ds_read_b64_tr_b16 v[32:33], v16 offset:29760
  ds_read_b64_tr_b16 v[34:35], v16 offset:30016
  s_waitcnt lgkmcnt(0)
  s_mov_b32 m0, 0x12000
  s_mov_b32 s27, 0x220000
  buffer_load_dwordx4 v8, s[16:19], s27 offen  lds
  s_mov_b32 m0, 0x12400
  s_mov_b32 s27, 0x228000
  buffer_load_dwordx4 v8, s[16:19], s27 offen  lds
  s_mov_b32 m0, 0x12800
  s_mov_b32 s27, 0x230000
  buffer_load_dwordx4 v9, s[16:19], s27 offen  lds
  s_mov_b32 m0, 0x12c00
  s_mov_b32 s27, 0x238000
  buffer_load_dwordx4 v9, s[16:19], s27 offen  lds
  s_mov_b32 m0, 0x13000
  s_mov_b32 s27, 0x2a0000
  buffer_load_dwordx4 v8, s[16:19], s27 offen  lds
  s_mov_b32 m0, 0x13400
  s_mov_b32 s27, 0x2a8000
  buffer_load_dwordx4 v8, s[16:19], s27 offen  lds
  s_mov_b32 m0, 0x13800
  s_mov_b32 s27, 0x2b0000
  buffer_load_dwordx4 v9, s[16:19], s27 offen  lds
  s_mov_b32 m0, 0x13c00
  s_mov_b32 s27, 0x2b8000
  buffer_load_dwordx4 v9, s[16:19], s27 offen  lds
  s_mov_b32 m0, 0x14000
  s_mov_b32 s27, 0x320000
  buffer_load_dwordx4 v8, s[16:19], s27 offen  lds
  s_mov_b32 m0, 0x14400
  s_mov_b32 s27, 0x328000
  buffer_load_dwordx4 v8, s[16:19], s27 offen  lds
  s_mov_b32 m0, 0x14800
  s_mov_b32 s27, 0x330000
  buffer_load_dwordx4 v9, s[16:19], s27 offen  lds
  s_mov_b32 m0, 0x14c00
  s_mov_b32 s27, 0x338000
  buffer_load_dwordx4 v9, s[16:19], s27 offen  lds
  s_mov_b32 m0, 0x15000
  s_mov_b32 s27, 0x3a0000
  buffer_load_dwordx4 v8, s[16:19], s27 offen  lds
  s_mov_b32 m0, 0x15400
  s_mov_b32 s27, 0x3a8000
  buffer_load_dwordx4 v8, s[16:19], s27 offen  lds
  s_mov_b32 m0, 0x15800
  s_mov_b32 s27, 0x3b0000
  buffer_load_dwordx4 v9, s[16:19], s27 offen  lds
  s_mov_b32 m0, 0x15c00
  s_mov_b32 s27, 0x3b8000
  buffer_load_dwordx4 v9, s[16:19], s27 offen  lds
  s_waitcnt vmcnt(32)
  ds_read_b64_tr_b16 a[192:193], v17 offset:32768
  ds_read_b64_tr_b16 a[194:195], v17 offset:32896
  ds_read_b64_tr_b16 a[196:197], v17 offset:33280
  ds_read_b64_tr_b16 a[198:199], v17 offset:33408
  ds_read_b64_tr_b16 a[200:201], v17 offset:34816
  ds_read_b64_tr_b16 a[202:203], v17 offset:34944
  ds_read_b64_tr_b16 a[204:205], v17 offset:35328
  ds_read_b64_tr_b16 a[206:207], v17 offset:35456
  ds_read_b64_tr_b16 v[36:37], v17 offset:36864
  ds_read_b64_tr_b16 v[38:39], v17 offset:36992
  ds_read_b64_tr_b16 v[40:41], v17 offset:37376
  ds_read_b64_tr_b16 v[42:43], v17 offset:37504
  ds_read_b64_tr_b16 v[44:45], v17 offset:38912
  ds_read_b64_tr_b16 v[46:47], v17 offset:39040
  ds_read_b64_tr_b16 v[48:49], v17 offset:39424
  ds_read_b64_tr_b16 v[50:51], v17 offset:39552
  s_waitcnt lgkmcnt(0)
  ds_write_b128 v2, v[20:23] offset:32768
  ds_write_b128 v2, v[24:27] offset:33792
  ds_write_b128 v2, v[28:31] offset:34816
  ds_write_b128 v2, v[32:35] offset:35840
  ds_write_b128 v2, v[36:39] offset:36864
  ds_write_b128 v2, v[40:43] offset:37888
  ds_write_b128 v2, v[44:47] offset:38912
  ds_write_b128 v2, v[48:51] offset:39936
  s_waitcnt vmcnt(28)
  s_waitcnt lgkmcnt(0)
  s_barrier
  ds_read_b64_tr_b16 a[96:97], v14 offset:0
  ds_read_b64_tr_b16 a[98:99], v14 offset:512
  ds_read_b64_tr_b16 a[100:101], v15 offset:0
  ds_read_b64_tr_b16 a[102:103], v15 offset:512
  ds_read_b64_tr_b16 a[104:105], v14 offset:32
  ds_read_b64_tr_b16 a[106:107], v14 offset:544
  ds_read_b64_tr_b16 a[108:109], v15 offset:32
  ds_read_b64_tr_b16 a[110:111], v15 offset:544
  s_waitcnt vmcnt(24)
  s_waitcnt lgkmcnt(0)
  s_barrier
  s_mov_b32 m0, 0xe000
  s_mov_b32 s27, 0x420000
  buffer_load_dwordx4 v8, s[16:19], s27 offen  lds
  s_mov_b32 m0, 0xe400
  s_mov_b32 s27, 0x428000
  buffer_load_dwordx4 v8, s[16:19], s27 offen  lds
  s_mov_b32 m0, 0xe800
  s_mov_b32 s27, 0x430000
  buffer_load_dwordx4 v9, s[16:19], s27 offen  lds
  s_mov_b32 m0, 0xec00
  s_mov_b32 s27, 0x438000
  buffer_load_dwordx4 v9, s[16:19], s27 offen  lds
  ds_read_b64_tr_b16 a[112:113], v14 offset:4096
  ds_read_b64_tr_b16 a[114:115], v14 offset:4608
  ds_read_b64_tr_b16 a[116:117], v15 offset:4096
  ds_read_b64_tr_b16 a[118:119], v15 offset:4608
  ds_read_b64_tr_b16 a[120:121], v14 offset:4128
  ds_read_b64_tr_b16 a[122:123], v14 offset:4640
  ds_read_b64_tr_b16 a[124:125], v15 offset:4128
  ds_read_b64_tr_b16 a[126:127], v15 offset:4640
  s_waitcnt vmcnt(24)
  s_waitcnt lgkmcnt(0)
  s_barrier
  s_mov_b32 m0, 0xf000
  s_mov_b32 s27, 0x20000
  buffer_load_dwordx4 v8, s[8:11], s27 offen  lds
  s_mov_b32 m0, 0xf400
  s_mov_b32 s27, 0x28000
  buffer_load_dwordx4 v8, s[8:11], s27 offen  lds
  s_mov_b32 m0, 0xf800
  s_mov_b32 s27, 0x30000
  buffer_load_dwordx4 v9, s[8:11], s27 offen  lds
  s_mov_b32 m0, 0xfc00
  s_mov_b32 s27, 0x38000
  buffer_load_dwordx4 v9, s[8:11], s27 offen  lds
  ds_read_b64_tr_b16 a[64:65], v14 offset:8192
  ds_read_b64_tr_b16 a[66:67], v14 offset:8704
  ds_read_b64_tr_b16 a[68:69], v15 offset:8192
  ds_read_b64_tr_b16 a[70:71], v15 offset:8704
  ds_read_b64_tr_b16 a[72:73], v14 offset:8224
  ds_read_b64_tr_b16 a[74:75], v14 offset:8736
  ds_read_b64_tr_b16 a[76:77], v15 offset:8224
  ds_read_b64_tr_b16 a[78:79], v15 offset:8736
  s_waitcnt vmcnt(24)
  s_waitcnt lgkmcnt(0)
  s_barrier
  s_mov_b32 m0, 0x10000
  s_mov_b32 s27, 0xa0000
  buffer_load_dwordx4 v8, s[8:11], s27 offen  lds
  s_mov_b32 m0, 0x10400
  s_mov_b32 s27, 0xa8000
  buffer_load_dwordx4 v8, s[8:11], s27 offen  lds
  s_mov_b32 m0, 0x10800
  s_mov_b32 s27, 0xb0000
  buffer_load_dwordx4 v9, s[8:11], s27 offen  lds
  s_mov_b32 m0, 0x10c00
  s_mov_b32 s27, 0xb8000
  buffer_load_dwordx4 v9, s[8:11], s27 offen  lds
  ds_read_b64_tr_b16 a[48:49], v14 offset:12288
  ds_read_b64_tr_b16 a[50:51], v14 offset:12800
  ds_read_b64_tr_b16 a[52:53], v15 offset:12288
  ds_read_b64_tr_b16 a[54:55], v15 offset:12800
  ds_read_b64_tr_b16 a[56:57], v14 offset:12320
  ds_read_b64_tr_b16 a[58:59], v14 offset:12832
  ds_read_b64_tr_b16 a[60:61], v15 offset:12320
  ds_read_b64_tr_b16 a[62:63], v15 offset:12832
  s_waitcnt vmcnt(24)
  s_waitcnt lgkmcnt(0)
  s_barrier
  s_mov_b32 m0, 0x11000
  s_mov_b32 s27, 0x120000
  buffer_load_dwordx4 v8, s[8:11], s27 offen  lds
  s_mov_b32 m0, 0x11400
  s_mov_b32 s27, 0x128000
  buffer_load_dwordx4 v8, s[8:11], s27 offen  lds
  s_mov_b32 m0, 0x11800
  s_mov_b32 s27, 0x130000
  buffer_load_dwordx4 v9, s[8:11], s27 offen  lds
  s_mov_b32 m0, 0x11c00
  s_mov_b32 s27, 0x138000
  buffer_load_dwordx4 v9, s[8:11], s27 offen  lds
  ds_read_b64_tr_b16 a[128:129], v14 offset:16384
  ds_read_b64_tr_b16 a[130:131], v14 offset:16896
  ds_read_b64_tr_b16 a[132:133], v15 offset:16384
  ds_read_b64_tr_b16 a[134:135], v15 offset:16896
  ds_read_b64_tr_b16 a[136:137], v14 offset:16416
  ds_read_b64_tr_b16 a[138:139], v14 offset:16928
  ds_read_b64_tr_b16 a[140:141], v15 offset:16416
  ds_read_b64_tr_b16 a[142:143], v15 offset:16928
  s_waitcnt vmcnt(24)
  s_waitcnt lgkmcnt(0)
  s_barrier
  s_mov_b32 m0, 0x12000
  s_mov_b32 s27, 0x1a0000
  buffer_load_dwordx4 v8, s[8:11], s27 offen  lds
  s_mov_b32 m0, 0x12400
  s_mov_b32 s27, 0x1a8000
  buffer_load_dwordx4 v8, s[8:11], s27 offen  lds
  s_mov_b32 m0, 0x12800
  s_mov_b32 s27, 0x1b0000
  buffer_load_dwordx4 v9, s[8:11], s27 offen  lds
  s_mov_b32 m0, 0x12c00
  s_mov_b32 s27, 0x1b8000
  buffer_load_dwordx4 v9, s[8:11], s27 offen  lds
  ds_read_b64_tr_b16 a[144:145], v14 offset:20480
  ds_read_b64_tr_b16 a[146:147], v14 offset:20992
  ds_read_b64_tr_b16 a[148:149], v15 offset:20480
  ds_read_b64_tr_b16 a[150:151], v15 offset:20992
  ds_read_b64_tr_b16 a[152:153], v14 offset:20512
  ds_read_b64_tr_b16 a[154:155], v14 offset:21024
  ds_read_b64_tr_b16 a[156:157], v15 offset:20512
  ds_read_b64_tr_b16 a[158:159], v15 offset:21024
  s_waitcnt vmcnt(24)
  s_waitcnt lgkmcnt(0)
  s_barrier
  s_mov_b32 m0, 0x13000
  s_mov_b32 s27, 0x220000
  buffer_load_dwordx4 v8, s[8:11], s27 offen  lds
  s_mov_b32 m0, 0x13400
  s_mov_b32 s27, 0x228000
  buffer_load_dwordx4 v8, s[8:11], s27 offen  lds
  s_mov_b32 m0, 0x13800
  s_mov_b32 s27, 0x230000
  buffer_load_dwordx4 v9, s[8:11], s27 offen  lds
  s_mov_b32 m0, 0x13c00
  s_mov_b32 s27, 0x238000
  buffer_load_dwordx4 v9, s[8:11], s27 offen  lds
  ds_read_b64_tr_b16 a[160:161], v14 offset:24576
  ds_read_b64_tr_b16 a[162:163], v14 offset:25088
  ds_read_b64_tr_b16 a[164:165], v15 offset:24576
  ds_read_b64_tr_b16 a[166:167], v15 offset:25088
  ds_read_b64_tr_b16 a[168:169], v14 offset:24608
  ds_read_b64_tr_b16 a[170:171], v14 offset:25120
  ds_read_b64_tr_b16 a[172:173], v15 offset:24608
  ds_read_b64_tr_b16 a[174:175], v15 offset:25120
  s_waitcnt vmcnt(24)
  s_waitcnt lgkmcnt(0)
  s_barrier
  s_mov_b32 m0, 0x14000
  s_mov_b32 s27, 0x2a0000
  buffer_load_dwordx4 v8, s[8:11], s27 offen  lds
  s_mov_b32 m0, 0x14400
  s_mov_b32 s27, 0x2a8000
  buffer_load_dwordx4 v8, s[8:11], s27 offen  lds
  s_mov_b32 m0, 0x14800
  s_mov_b32 s27, 0x2b0000
  buffer_load_dwordx4 v9, s[8:11], s27 offen  lds
  s_mov_b32 m0, 0x14c00
  s_mov_b32 s27, 0x2b8000
  buffer_load_dwordx4 v9, s[8:11], s27 offen  lds
  ds_read_b64_tr_b16 a[176:177], v14 offset:28672
  ds_read_b64_tr_b16 a[178:179], v14 offset:29184
  ds_read_b64_tr_b16 a[180:181], v15 offset:28672
  ds_read_b64_tr_b16 a[182:183], v15 offset:29184
  ds_read_b64_tr_b16 a[184:185], v14 offset:28704
  ds_read_b64_tr_b16 a[186:187], v14 offset:29216
  ds_read_b64_tr_b16 a[188:189], v15 offset:28704
  ds_read_b64_tr_b16 a[190:191], v15 offset:29216
  s_waitcnt vmcnt(24)
  s_waitcnt lgkmcnt(0)
  s_barrier
  s_mov_b32 m0, 0x15000
  s_mov_b32 s27, 0x320000
  buffer_load_dwordx4 v8, s[8:11], s27 offen  lds
  s_mov_b32 m0, 0x15400
  s_mov_b32 s27, 0x328000
  buffer_load_dwordx4 v8, s[8:11], s27 offen  lds
  s_mov_b32 m0, 0x15800
  s_mov_b32 s27, 0x330000
  buffer_load_dwordx4 v9, s[8:11], s27 offen  lds
  s_mov_b32 m0, 0x15c00
  s_mov_b32 s27, 0x338000
  buffer_load_dwordx4 v9, s[8:11], s27 offen  lds
  ds_read_b64_tr_b16 a[80:81], v14 offset:0
  ds_read_b64_tr_b16 a[82:83], v14 offset:512
  ds_read_b64_tr_b16 a[84:85], v15 offset:0
  ds_read_b64_tr_b16 a[86:87], v15 offset:512
  ds_read_b64_tr_b16 a[88:89], v14 offset:32
  ds_read_b64_tr_b16 a[90:91], v14 offset:544
  ds_read_b64_tr_b16 a[92:93], v15 offset:32
  ds_read_b64_tr_b16 a[94:95], v15 offset:544
  s_waitcnt vmcnt(24)
  s_waitcnt lgkmcnt(0)
  s_barrier
  s_mov_b32 m0, 0xe000
  s_mov_b32 s27, 0x3a0000
  buffer_load_dwordx4 v8, s[8:11], s27 offen  lds
  s_mov_b32 m0, 0xe400
  s_mov_b32 s27, 0x3a8000
  buffer_load_dwordx4 v8, s[8:11], s27 offen  lds
  s_mov_b32 m0, 0xe800
  s_mov_b32 s27, 0x3b0000
  buffer_load_dwordx4 v9, s[8:11], s27 offen  lds
  s_mov_b32 m0, 0xec00
  s_mov_b32 s27, 0x3b8000
  buffer_load_dwordx4 v9, s[8:11], s27 offen  lds
  ds_read_b64_tr_b16 v[112:113], v12 offset:4096
  ds_read_b64_tr_b16 v[114:115], v12 offset:4608
  ds_read_b64_tr_b16 v[116:117], v13 offset:4096
  ds_read_b64_tr_b16 v[118:119], v13 offset:4608
  ds_read_b64_tr_b16 v[120:121], v12 offset:4104
  ds_read_b64_tr_b16 v[122:123], v12 offset:4616
  ds_read_b64_tr_b16 v[124:125], v13 offset:4104
  ds_read_b64_tr_b16 v[126:127], v13 offset:4616
  s_waitcnt vmcnt(24)
  s_waitcnt lgkmcnt(0)
  s_barrier
  s_mov_b32 m0, 0xf000
  s_mov_b32 s27, 0x20000
  buffer_load_dwordx4 v8, s[12:15], s27 offen  lds
  s_mov_b32 m0, 0xf400
  s_mov_b32 s27, 0x28000
  buffer_load_dwordx4 v8, s[12:15], s27 offen  lds
  s_mov_b32 m0, 0xf800
  s_mov_b32 s27, 0x30000
  buffer_load_dwordx4 v9, s[12:15], s27 offen  lds
  s_mov_b32 m0, 0xfc00
  s_mov_b32 s27, 0x38000
  buffer_load_dwordx4 v9, s[12:15], s27 offen  lds
  ds_read_b64_tr_b16 v[128:129], v12 offset:8192
  ds_read_b64_tr_b16 v[130:131], v12 offset:8704
  ds_read_b64_tr_b16 v[132:133], v13 offset:8192
  ds_read_b64_tr_b16 v[134:135], v13 offset:8704
  ds_read_b64_tr_b16 v[136:137], v12 offset:8200
  ds_read_b64_tr_b16 v[138:139], v12 offset:8712
  ds_read_b64_tr_b16 v[140:141], v13 offset:8200
  ds_read_b64_tr_b16 v[142:143], v13 offset:8712
  s_waitcnt vmcnt(24)
  s_waitcnt lgkmcnt(0)
  s_barrier
  s_mov_b32 m0, 0x10000
  s_mov_b32 s27, 0xa0000
  buffer_load_dwordx4 v8, s[12:15], s27 offen  lds
  s_mov_b32 m0, 0x10400
  s_mov_b32 s27, 0xa8000
  buffer_load_dwordx4 v8, s[12:15], s27 offen  lds
  s_mov_b32 m0, 0x10800
  s_mov_b32 s27, 0xb0000
  buffer_load_dwordx4 v9, s[12:15], s27 offen  lds
  s_mov_b32 m0, 0x10c00
  s_mov_b32 s27, 0xb8000
  buffer_load_dwordx4 v9, s[12:15], s27 offen  lds
  ds_read_b64_tr_b16 v[96:97], v12 offset:12288
  ds_read_b64_tr_b16 v[98:99], v12 offset:12800
  ds_read_b64_tr_b16 v[100:101], v13 offset:12288
  ds_read_b64_tr_b16 v[102:103], v13 offset:12800
  ds_read_b64_tr_b16 v[104:105], v12 offset:12296
  ds_read_b64_tr_b16 v[106:107], v12 offset:12808
  ds_read_b64_tr_b16 v[108:109], v13 offset:12296
  ds_read_b64_tr_b16 v[110:111], v13 offset:12808
  s_waitcnt vmcnt(24)
  s_waitcnt lgkmcnt(0)
  s_barrier
  s_mov_b32 m0, 0x11000
  s_mov_b32 s27, 0x120000
  buffer_load_dwordx4 v8, s[12:15], s27 offen  lds
  s_mov_b32 m0, 0x11400
  s_mov_b32 s27, 0x128000
  buffer_load_dwordx4 v8, s[12:15], s27 offen  lds
  s_mov_b32 m0, 0x11800
  s_mov_b32 s27, 0x130000
  buffer_load_dwordx4 v9, s[12:15], s27 offen  lds
  s_mov_b32 m0, 0x11c00
  s_mov_b32 s27, 0x138000
  buffer_load_dwordx4 v9, s[12:15], s27 offen  lds
  ds_read_b64_tr_b16 v[80:81], v12 offset:16384
  ds_read_b64_tr_b16 v[82:83], v12 offset:16896
  ds_read_b64_tr_b16 v[84:85], v13 offset:16384
  ds_read_b64_tr_b16 v[86:87], v13 offset:16896
  ds_read_b64_tr_b16 v[88:89], v12 offset:16392
  ds_read_b64_tr_b16 v[90:91], v12 offset:16904
  ds_read_b64_tr_b16 v[92:93], v13 offset:16392
  ds_read_b64_tr_b16 v[94:95], v13 offset:16904
  s_waitcnt vmcnt(24)
  s_waitcnt lgkmcnt(0)
  s_barrier
  s_mov_b32 m0, 0x12000
  s_mov_b32 s27, 0x1a0000
  buffer_load_dwordx4 v8, s[12:15], s27 offen  lds
  s_mov_b32 m0, 0x12400
  s_mov_b32 s27, 0x1a8000
  buffer_load_dwordx4 v8, s[12:15], s27 offen  lds
  s_mov_b32 m0, 0x12800
  s_mov_b32 s27, 0x1b0000
  buffer_load_dwordx4 v9, s[12:15], s27 offen  lds
  s_mov_b32 m0, 0x12c00
  s_mov_b32 s27, 0x1b8000
  buffer_load_dwordx4 v9, s[12:15], s27 offen  lds
  ds_read_b64_tr_b16 v[144:145], v12 offset:20480
  ds_read_b64_tr_b16 v[146:147], v12 offset:20992
  ds_read_b64_tr_b16 v[148:149], v13 offset:20480
  ds_read_b64_tr_b16 v[150:151], v13 offset:20992
  ds_read_b64_tr_b16 v[152:153], v12 offset:20488
  ds_read_b64_tr_b16 v[154:155], v12 offset:21000
  ds_read_b64_tr_b16 v[156:157], v13 offset:20488
  ds_read_b64_tr_b16 v[158:159], v13 offset:21000
  s_waitcnt vmcnt(24)
  s_waitcnt lgkmcnt(0)
  s_barrier
  s_mov_b32 m0, 0x13000
  s_mov_b32 s27, 0x220000
  buffer_load_dwordx4 v8, s[12:15], s27 offen  lds
  s_mov_b32 m0, 0x13400
  s_mov_b32 s27, 0x228000
  buffer_load_dwordx4 v8, s[12:15], s27 offen  lds
  s_mov_b32 m0, 0x13800
  s_mov_b32 s27, 0x230000
  buffer_load_dwordx4 v9, s[12:15], s27 offen  lds
  s_mov_b32 m0, 0x13c00
  s_mov_b32 s27, 0x238000
  buffer_load_dwordx4 v9, s[12:15], s27 offen  lds
  ds_read_b64_tr_b16 v[160:161], v12 offset:24576
  ds_read_b64_tr_b16 v[162:163], v12 offset:25088
  ds_read_b64_tr_b16 v[164:165], v13 offset:24576
  ds_read_b64_tr_b16 v[166:167], v13 offset:25088
  ds_read_b64_tr_b16 v[168:169], v12 offset:24584
  ds_read_b64_tr_b16 v[170:171], v12 offset:25096
  ds_read_b64_tr_b16 v[172:173], v13 offset:24584
  ds_read_b64_tr_b16 v[174:175], v13 offset:25096
  s_waitcnt vmcnt(24)
  s_waitcnt lgkmcnt(0)
  s_barrier
  s_mov_b32 m0, 0x14000
  s_mov_b32 s27, 0x2a0000
  buffer_load_dwordx4 v8, s[12:15], s27 offen  lds
  s_mov_b32 m0, 0x14400
  s_mov_b32 s27, 0x2a8000
  buffer_load_dwordx4 v8, s[12:15], s27 offen  lds
  s_mov_b32 m0, 0x14800
  s_mov_b32 s27, 0x2b0000
  buffer_load_dwordx4 v9, s[12:15], s27 offen  lds
  s_mov_b32 m0, 0x14c00
  s_mov_b32 s27, 0x2b8000
  buffer_load_dwordx4 v9, s[12:15], s27 offen  lds
  ds_read_b64_tr_b16 v[176:177], v12 offset:28672
  ds_read_b64_tr_b16 v[178:179], v12 offset:29184
  ds_read_b64_tr_b16 v[180:181], v13 offset:28672
  ds_read_b64_tr_b16 v[182:183], v13 offset:29184
  ds_read_b64_tr_b16 v[184:185], v12 offset:28680
  ds_read_b64_tr_b16 v[186:187], v12 offset:29192
  ds_read_b64_tr_b16 v[188:189], v13 offset:28680
  ds_read_b64_tr_b16 v[190:191], v13 offset:29192
  s_waitcnt vmcnt(24)
  s_waitcnt lgkmcnt(0)
  s_barrier
  s_mov_b32 m0, 0x15000
  s_mov_b32 s27, 0x320000
  buffer_load_dwordx4 v8, s[12:15], s27 offen  lds
  s_mov_b32 m0, 0x15400
  s_mov_b32 s27, 0x328000
  buffer_load_dwordx4 v8, s[12:15], s27 offen  lds
  s_mov_b32 m0, 0x15800
  s_mov_b32 s27, 0x330000
  buffer_load_dwordx4 v9, s[12:15], s27 offen  lds
  s_mov_b32 m0, 0x15c00
  s_mov_b32 s27, 0x338000
  buffer_load_dwordx4 v9, s[12:15], s27 offen  lds
  ds_read_b64_tr_b16 v[192:193], v12 offset:0
  ds_read_b64_tr_b16 v[194:195], v12 offset:512
  ds_read_b64_tr_b16 v[196:197], v13 offset:0
  ds_read_b64_tr_b16 v[198:199], v13 offset:512
  ds_read_b64_tr_b16 v[200:201], v12 offset:8
  ds_read_b64_tr_b16 v[202:203], v12 offset:520
  ds_read_b64_tr_b16 v[204:205], v13 offset:8
  ds_read_b64_tr_b16 v[206:207], v13 offset:520
  s_waitcnt vmcnt(24)
  s_waitcnt lgkmcnt(0)
  s_barrier
  s_mov_b32 m0, 0xe000
  s_mov_b32 s27, 0x3a0000
  buffer_load_dwordx4 v8, s[12:15], s27 offen  lds
  s_mov_b32 m0, 0xe400
  s_mov_b32 s27, 0x3a8000
  buffer_load_dwordx4 v8, s[12:15], s27 offen  lds
  s_mov_b32 m0, 0xe800
  s_mov_b32 s27, 0x3b0000
  buffer_load_dwordx4 v9, s[12:15], s27 offen  lds
  s_mov_b32 m0, 0xec00
  s_mov_b32 s27, 0x3b8000
  buffer_load_dwordx4 v9, s[12:15], s27 offen  lds
  ds_read_b64_tr_b16 v[208:209], v12 offset:4096
  ds_read_b64_tr_b16 v[210:211], v12 offset:4608
  ds_read_b64_tr_b16 v[212:213], v13 offset:4096
  ds_read_b64_tr_b16 v[214:215], v13 offset:4608
  ds_read_b64_tr_b16 v[216:217], v12 offset:4104
  ds_read_b64_tr_b16 v[218:219], v12 offset:4616
  ds_read_b64_tr_b16 v[220:221], v13 offset:4104
  ds_read_b64_tr_b16 v[222:223], v13 offset:4616
  s_waitcnt vmcnt(24)
  s_waitcnt lgkmcnt(0)
  s_barrier
  s_mov_b32 m0, 0xf000
  s_mov_b32 s27, 0x420000
  buffer_load_dwordx4 v8, s[12:15], s27 offen  lds
  s_mov_b32 m0, 0xf400
  s_mov_b32 s27, 0x428000
  buffer_load_dwordx4 v8, s[12:15], s27 offen  lds
  s_mov_b32 m0, 0xf800
  s_mov_b32 s27, 0x430000
  buffer_load_dwordx4 v9, s[12:15], s27 offen  lds
  s_mov_b32 m0, 0xfc00
  s_mov_b32 s27, 0x438000
  buffer_load_dwordx4 v9, s[12:15], s27 offen  lds
  ds_read_b64_tr_b16 v[224:225], v12 offset:8192
  ds_read_b64_tr_b16 v[226:227], v12 offset:8704
  ds_read_b64_tr_b16 v[228:229], v13 offset:8192
  ds_read_b64_tr_b16 v[230:231], v13 offset:8704
  ds_read_b64_tr_b16 v[232:233], v12 offset:8200
  ds_read_b64_tr_b16 v[234:235], v12 offset:8712
  ds_read_b64_tr_b16 v[236:237], v13 offset:8200
  ds_read_b64_tr_b16 v[238:239], v13 offset:8712
  s_waitcnt vmcnt(24)
  s_waitcnt lgkmcnt(0)
  s_barrier
  s_mov_b32 m0, 0x10000
  s_mov_b32 s27, 0x420000
  buffer_load_dwordx4 v8, s[8:11], s27 offen  lds
  s_mov_b32 m0, 0x10400
  s_mov_b32 s27, 0x428000
  buffer_load_dwordx4 v8, s[8:11], s27 offen  lds
  s_mov_b32 m0, 0x10800
  s_mov_b32 s27, 0x430000
  buffer_load_dwordx4 v9, s[8:11], s27 offen  lds
  s_mov_b32 m0, 0x10c00
  s_mov_b32 s27, 0x438000
  buffer_load_dwordx4 v9, s[8:11], s27 offen  lds
  ds_read_b64_tr_b16 v[36:37], v12 offset:12288
  ds_read_b64_tr_b16 v[38:39], v12 offset:12800
  ds_read_b64_tr_b16 v[40:41], v13 offset:12288
  ds_read_b64_tr_b16 v[42:43], v13 offset:12800
  ds_read_b64_tr_b16 v[44:45], v12 offset:12296
  ds_read_b64_tr_b16 v[46:47], v12 offset:12808
  ds_read_b64_tr_b16 v[48:49], v13 offset:12296
  ds_read_b64_tr_b16 v[50:51], v13 offset:12808
  s_waitcnt vmcnt(24)
  s_waitcnt lgkmcnt(0)
  s_barrier
  ds_read_b64_tr_b16 v[20:21], v12 offset:16384
  ds_read_b64_tr_b16 v[22:23], v12 offset:16896
  ds_read_b64_tr_b16 v[24:25], v13 offset:16384
  ds_read_b64_tr_b16 v[26:27], v13 offset:16896
  ds_read_b64_tr_b16 v[28:29], v12 offset:16392
  ds_read_b64_tr_b16 v[30:31], v12 offset:16904
  ds_read_b64_tr_b16 v[32:33], v13 offset:16392
  ds_read_b64_tr_b16 v[34:35], v13 offset:16904
  s_waitcnt vmcnt(20)
  s_waitcnt lgkmcnt(0)
  s_barrier
  ds_read_b64_tr_b16 v[240:241], v12 offset:20480
  ds_read_b64_tr_b16 v[242:243], v12 offset:20992
  ds_read_b64_tr_b16 v[244:245], v13 offset:20480
  ds_read_b64_tr_b16 v[246:247], v13 offset:20992
  ds_read_b64_tr_b16 v[248:249], v12 offset:20488
  ds_read_b64_tr_b16 v[250:251], v12 offset:21000
  ds_read_b64_tr_b16 v[252:253], v13 offset:20488
  ds_read_b64_tr_b16 v[254:255], v13 offset:21000
  s_waitcnt vmcnt(16)
  s_waitcnt lgkmcnt(0)
  s_barrier
  s_mov_b32 m0, 0x12000
  s_mov_b32 s27, 0x180
  buffer_load_dwordx4 v10, s[52:55], s27 offen  lds
  s_mov_b32 m0, 0x12400
  s_mov_b32 s27, 0x2580
  buffer_load_dwordx4 v10, s[52:55], s27 offen  lds
  s_mov_b32 m0, 0x12800
  s_mov_b32 s27, 0x4980
  buffer_load_dwordx4 v10, s[52:55], s27 offen  lds
  s_mov_b32 m0, 0x12c00
  s_mov_b32 s27, 0x6d80
  buffer_load_dwordx4 v10, s[52:55], s27 offen  lds
  s_mov_b32 m0, 0x13000
  s_mov_b32 s27, 0x9180
  buffer_load_dwordx4 v10, s[52:55], s27 offen  lds
  s_mov_b32 m0, 0x13400
  s_mov_b32 s27, 0xb580
  buffer_load_dwordx4 v10, s[52:55], s27 offen  lds
  s_mov_b32 m0, 0x13800
  s_mov_b32 s27, 0xd980
  buffer_load_dwordx4 v10, s[52:55], s27 offen  lds
  s_mov_b32 m0, 0x13c00
  s_mov_b32 s27, 0xfd80
  buffer_load_dwordx4 v10, s[52:55], s27 offen  lds
  ds_read_b64_tr_b16 a[0:1], v12 offset:24576
  ds_read_b64_tr_b16 a[2:3], v12 offset:25088
  ds_read_b64_tr_b16 a[4:5], v13 offset:24576
  ds_read_b64_tr_b16 a[6:7], v13 offset:25088
  ds_read_b64_tr_b16 a[8:9], v12 offset:24584
  ds_read_b64_tr_b16 a[10:11], v12 offset:25096
  ds_read_b64_tr_b16 a[12:13], v13 offset:24584
  ds_read_b64_tr_b16 a[14:15], v13 offset:25096
  s_waitcnt vmcnt(20)
  s_waitcnt lgkmcnt(0)
  s_barrier
  ds_read_b64_tr_b16 a[16:17], v12 offset:28672
  ds_read_b64_tr_b16 a[18:19], v12 offset:29184
  ds_read_b64_tr_b16 a[20:21], v13 offset:28672
  ds_read_b64_tr_b16 a[22:23], v13 offset:29184
  ds_read_b64_tr_b16 a[24:25], v12 offset:28680
  ds_read_b64_tr_b16 a[26:27], v12 offset:29192
  ds_read_b64_tr_b16 a[28:29], v13 offset:28680
  ds_read_b64_tr_b16 a[30:31], v13 offset:29192
  s_waitcnt vmcnt(16)
  s_waitcnt lgkmcnt(0)
  s_barrier
  s_mov_b32 m0, 0x14000
  s_mov_b32 s27, 0x200
  buffer_load_dwordx4 v10, s[52:55], s27 offen  lds
  s_mov_b32 m0, 0x14400
  s_mov_b32 s27, 0x2600
  buffer_load_dwordx4 v10, s[52:55], s27 offen  lds
  s_mov_b32 m0, 0x14800
  s_mov_b32 s27, 0x4a00
  buffer_load_dwordx4 v10, s[52:55], s27 offen  lds
  s_mov_b32 m0, 0x14c00
  s_mov_b32 s27, 0x6e00
  buffer_load_dwordx4 v10, s[52:55], s27 offen  lds
  s_mov_b32 m0, 0x15000
  s_mov_b32 s27, 0x9200
  buffer_load_dwordx4 v10, s[52:55], s27 offen  lds
  s_mov_b32 m0, 0x15400
  s_mov_b32 s27, 0xb600
  buffer_load_dwordx4 v10, s[52:55], s27 offen  lds
  s_mov_b32 m0, 0x15800
  s_mov_b32 s27, 0xda00
  buffer_load_dwordx4 v10, s[52:55], s27 offen  lds
  s_mov_b32 m0, 0x15c00
  s_mov_b32 s27, 0xfe00
  buffer_load_dwordx4 v10, s[52:55], s27 offen  lds
  ds_read_b64_tr_b16 a[32:33], v12 offset:0
  ds_read_b64_tr_b16 a[34:35], v12 offset:512
  ds_read_b64_tr_b16 a[36:37], v13 offset:0
  ds_read_b64_tr_b16 a[38:39], v13 offset:512
  ds_read_b64_tr_b16 a[40:41], v12 offset:8
  ds_read_b64_tr_b16 a[42:43], v12 offset:520
  ds_read_b64_tr_b16 a[44:45], v13 offset:8
  ds_read_b64_tr_b16 a[46:47], v13 offset:520
  s_waitcnt vmcnt(20)
  s_waitcnt lgkmcnt(0)
  s_barrier
  ds_write_b128 v2, v[20:23] offset:0
  ds_write_b128 v2, v[24:27] offset:1024
  ds_write_b128 v2, v[28:31] offset:2048
  ds_write_b128 v2, v[32:35] offset:3072
  ds_write_b128 v2, v[36:39] offset:12288
  ds_write_b128 v2, v[40:43] offset:13312
  ds_write_b128 v2, v[44:47] offset:14336
  ds_write_b128 v2, v[48:51] offset:15360
  ds_read_b64_tr_b16 v[20:21], v12 offset:4096
  ds_read_b64_tr_b16 v[22:23], v12 offset:4608
  ds_read_b64_tr_b16 v[24:25], v13 offset:4096
  ds_read_b64_tr_b16 v[26:27], v13 offset:4608
  ds_read_b64_tr_b16 v[28:29], v12 offset:4104
  ds_read_b64_tr_b16 v[30:31], v12 offset:4616
  ds_read_b64_tr_b16 v[32:33], v13 offset:4104
  ds_read_b64_tr_b16 v[34:35], v13 offset:4616
  s_waitcnt vmcnt(16)
  s_waitcnt lgkmcnt(0)
  s_barrier
  ds_write_b128 v2, v[20:23] offset:4096
  ds_write_b128 v2, v[24:27] offset:5120
  ds_write_b128 v2, v[28:31] offset:6144
  ds_write_b128 v2, v[32:35] offset:7168
  ds_read_b64_tr_b16 v[36:37], v12 offset:8192
  ds_read_b64_tr_b16 v[38:39], v12 offset:8704
  ds_read_b64_tr_b16 v[40:41], v13 offset:8192
  ds_read_b64_tr_b16 v[42:43], v13 offset:8704
  ds_read_b64_tr_b16 v[44:45], v12 offset:8200
  ds_read_b64_tr_b16 v[46:47], v12 offset:8712
  ds_read_b64_tr_b16 v[48:49], v13 offset:8200
  ds_read_b64_tr_b16 v[50:51], v13 offset:8712
  s_waitcnt lgkmcnt(0)
  s_barrier
  ds_write_b128 v2, v[36:39] offset:8192
  ds_write_b128 v2, v[40:43] offset:9216
  ds_write_b128 v2, v[44:47] offset:10240
  ds_write_b128 v2, v[48:51] offset:11264
  s_waitcnt vmcnt(8)
  ds_read_b64_tr_b16 v[20:21], v16 offset:16384
  ds_read_b64_tr_b16 v[22:23], v16 offset:16640
  ds_read_b64_tr_b16 v[24:25], v16 offset:17408
  ds_read_b64_tr_b16 v[26:27], v16 offset:17664
  ds_read_b64_tr_b16 v[28:29], v16 offset:20480
  ds_read_b64_tr_b16 v[30:31], v16 offset:20736
  ds_read_b64_tr_b16 v[32:33], v16 offset:21504
  ds_read_b64_tr_b16 v[34:35], v16 offset:21760
  ds_read_b64_tr_b16 v[36:37], v16 offset:16448
  ds_read_b64_tr_b16 v[38:39], v16 offset:16704
  ds_read_b64_tr_b16 v[40:41], v16 offset:17472
  ds_read_b64_tr_b16 v[42:43], v16 offset:17728
  ds_read_b64_tr_b16 v[44:45], v16 offset:20544
  ds_read_b64_tr_b16 v[46:47], v16 offset:20800
  ds_read_b64_tr_b16 v[48:49], v16 offset:21568
  ds_read_b64_tr_b16 v[50:51], v16 offset:21824
  s_waitcnt lgkmcnt(0)
  ds_write_b128 v2, v[20:23] offset:16384
  ds_write_b128 v2, v[24:27] offset:17408
  ds_write_b128 v2, v[28:31] offset:18432
  ds_write_b128 v2, v[32:35] offset:19456
  ds_write_b128 v2, v[36:39] offset:20480
  ds_write_b128 v2, v[40:43] offset:21504
  ds_write_b128 v2, v[44:47] offset:22528
  ds_write_b128 v2, v[48:51] offset:23552
  s_waitcnt vmcnt(0)
  ds_read_b64_tr_b16 v[20:21], v16 offset:24576
  ds_read_b64_tr_b16 v[22:23], v16 offset:24832
  ds_read_b64_tr_b16 v[24:25], v16 offset:25600
  ds_read_b64_tr_b16 v[26:27], v16 offset:25856
  ds_read_b64_tr_b16 v[28:29], v16 offset:28672
  ds_read_b64_tr_b16 v[30:31], v16 offset:28928
  ds_read_b64_tr_b16 v[32:33], v16 offset:29696
  ds_read_b64_tr_b16 v[34:35], v16 offset:29952
  ds_read_b64_tr_b16 v[36:37], v16 offset:24640
  ds_read_b64_tr_b16 v[38:39], v16 offset:24896
  ds_read_b64_tr_b16 v[40:41], v16 offset:25664
  ds_read_b64_tr_b16 v[42:43], v16 offset:25920
  ds_read_b64_tr_b16 v[44:45], v16 offset:28736
  ds_read_b64_tr_b16 v[46:47], v16 offset:28992
  ds_read_b64_tr_b16 v[48:49], v16 offset:29760
  ds_read_b64_tr_b16 v[50:51], v16 offset:30016
  s_waitcnt lgkmcnt(0)
  ds_write_b128 v2, v[20:23] offset:24576
  ds_write_b128 v2, v[24:27] offset:25600
  ds_write_b128 v2, v[28:31] offset:26624
  ds_write_b128 v2, v[32:35] offset:27648
  ds_write_b128 v2, v[36:39] offset:28672
  ds_write_b128 v2, v[40:43] offset:29696
  ds_write_b128 v2, v[44:47] offset:30720
  ds_write_b128 v2, v[48:51] offset:31744
  s_waitcnt lgkmcnt(0)
  s_mov_b32 s28, 0
L_reg_83:
  v_mov_b32 v8, 0
  buffer_load_dword v9, v8, s[20:23], 0 offen offset:64 sc1
  s_add_u32 s28, s28, 1
  s_cmp_gt_u32 s28, 1048576
  s_cbranch_scc1 L_fail
  s_waitcnt vmcnt(0)
  v_readfirstlane_b32 s67, v9
L_regc_84:
  s_and_b32 s26, s67, 0xffff
  s_cmp_lt_u32 s26, 256
  s_cbranch_scc1 L_reg_83
  s_lshr_b32 s67, s67, 16
  s_sub_u32 s26, s57, 16384
  s_mov_b32 s27, 0
L_poll_85:
  buffer_load_dword v3, v0, s[4:7], s26 offen sc1
  s_waitcnt vmcnt(0)
  v_cmp_eq_u32 vcc, 0, v3
  s_and_b64 vcc, vcc, s[92:93]
  s_cbranch_vccz L_polld_86
  s_add_u32 s27, s27, 1
  s_cmp_lt_u32 s27, 1048576
  s_cbranch_scc1 L_poll_85
  s_branch L_fail
L_polld_86:
  s_sub_u32 s26, s57, 8192
  s_mov_b32 s27, 0
L_poll_87:
  buffer_load_dword v3, v0, s[4:7], s26 offen sc1
  s_waitcnt vmcnt(0)
  v_cmp_eq_u32 vcc, 0, v3
  s_and_b64 vcc, vcc, s[92:93]
  s_cbranch_vccz L_polld_88
  s_add_u32 s27, s27, 1
  s_cmp_lt_u32 s27, 1048576
  s_cbranch_scc1 L_poll_87
  s_branch L_fail
L_polld_88:
  v_min_u32 v8, -2, v64
  v_min_u32 v9, -2, v65
  v_min_u32 v10, -2, v66
  v_min_u32 v11, -2, v67
  v_min_u32 v12, -2, v68
  v_min_u32 v13, -2, v69
  v_min_u32 v14, -2, v70
  v_min_u32 v15, -2, v71
  s_cmp_ge_u32 s67, 32
  s_cbranch_scc0 L_slowmode1
  s_mov_b32 m0, 0
  ds_read_b128 v[60:63], v2 offset:0
  ds_read_b128 v[64:67], v2 offset:1024
  ds_read_b128 v[20:23], v2 offset:2048
  ds_read_b128 v[24:27], v2 offset:3072
  ds_read_b128 v[28:31], v2 offset:12288
  ds_read_b128 v[32:35], v2 offset:13312
  ds_read_b128 v[36:39], v2 offset:14336
  ds_read_b128 v[40:43], v2 offset:15360
  v_mov_b64 v[44:45], 0
  v_mov_b64 v[46:47], 0
  v_mov_b64 v[48:49], 0
  v_mov_b64 v[50:51], 0
  v_mov_b64 v[52:53], 0
  v_mov_b64 v[54:55], 0
  v_mov_b64 v[56:57], 0
  v_mov_b64 v[58:59], 0
  v_mov_b64 v[68:69], 0
  v_mov_b64 v[70:71], 0
  v_mov_b64 v[72:73], 0
  v_mov_b64 v[74:75], 0
  v_mov_b32 v16, -1
  v_mov_b64 v[68:69], s[64:65]
  v_mov_b64 v[70:71], s[64:65]
  ds_write_b128 v0, v[68:71] offset:15360
  v_mov_b64 v[68:69], 0
  v_mov_b64 v[70:71], 0
  s_branch L_chk1f
.p2align 7
  s_nop 0
  s_nop 0
  s_nop 0
  s_nop 0
  s_nop 0
  s_nop 0
L_top1f:
  s_waitcnt vmcnt(0)
  s_barrier
  buffer_load_dwordx4 v[8:11], v0, s[4:7], s58 offen offset:1024 sc1
  s_mov_b32 s56, 0
  buffer_load_dwordx4 v[12:15], v0, s[4:7], s58 offen offset:0 sc1
  s_bfe_u32 s46, s37, 0x10001
L_chk1f:
  s_waitcnt vmcnt(1) lgkmcnt(0)
  v_smfmac_f32_16x16x64_bf16 v[48:51], v[8:11], v[60:67], v1
  ds_write_b128 v0, v[8:11] offset:3072
  s_waitcnt lgkmcnt(6)
  v_smfmac_f32_16x16x64_bf16 v[56:59], v[8:11], v[20:27], v1
  v_smfmac_f32_16x16x64_bf16 v[44:47], v[8:11], v[80:87], v1
  v_smfmac_f32_16x16x64_bf16 v[52:55], v[8:11], v[88:95], v1
  s_waitcnt vmcnt(0)
  ds_write_b128 v0, v[12:15] offset:2048
  s_waitcnt lgkmcnt(5)
  v_smfmac_f32_16x16x64_bf16 v[48:51], v[12:15], v[28:35], v1
  v_max3_u32 v3, v8, v9, v10
  v_max3_u32 v3, v3, v11, v12
  v_max3_u32 v3, v3, v13, v14
  v_max_u32 v3, v3, v15
  s_waitcnt lgkmcnt(3)
  v_smfmac_f32_16x16x64_bf16 v[56:59], v[12:15], v[36:43], v1
  ds_read_b128 v[60:63], v2 offset:4096
  v_cmp_eq_u32 vcc, -1, v3
  v_smfmac_f32_16x16x64_bf16 v[44:47], v[12:15], v[96:103], v1
  ds_read_b128 v[64:67], v2 offset:5120
  s_cbranch_vccnz L_retry1f
  v_smfmac_f32_16x16x64_bf16 v[52:55], v[12:15], v[104:111], v1
  s_waitcnt lgkmcnt(2)
  s_barrier
  ds_read_b128 v[20:23], v0 offset:0
  v_smfmac_f32_16x16x64_bf16 v[68:71], v[8:11], a[48:55], v1
  buffer_store_dword v16, v7, s[4:7], s61 offen
  ds_read_b128 v[24:27], v0 offset:1024
  s_mov_b64 vcc, s[62:63]
  v_smfmac_f32_16x16x64_bf16 v[72:75], v[8:11], a[56:63], v1
  ds_read_b128 v[28:31], v0 offset:4096
  v_smfmac_f32_16x16x64_bf16 v[68:71], v[12:15], a[64:71], v1
  ds_read_b128 v[16:19], v0 offset:8192
  v_smfmac_f32_16x16x64_bf16 v[72:75], v[12:15], a[72:79], v1
  ds_read_b128 v[8:11], v2 offset:6144
  s_waitcnt lgkmcnt(4)
  v_smfmac_f32_16x16x64_bf16 v[44:47], v[20:23], v[112:119], v1
  ds_read_b128 v[12:15], v2 offset:7168
  v_smfmac_f32_16x16x64_bf16 v[48:51], v[20:23], v[208:215], v1
  ds_read_b128 v[32:35], v0 offset:5120
  v_smfmac_f32_16x16x64_bf16 v[52:55], v[20:23], v[120:127], v1
  ds_read_b128 v[36:39], v0 offset:6144
  v_smfmac_f32_16x16x64_bf16 v[56:59], v[20:23], v[216:223], v1
  ds_read_b128 v[40:43], v0 offset:7168
  s_waitcnt lgkmcnt(5)
  v_smfmac_f32_16x16x64_bf16 v[48:51], v[16:19], v[60:67], v1
  ds_read_b128 v[60:63], v2 offset:8192
  ds_read_b128 v[64:67], v2 offset:9216
  v_smfmac_f32_16x16x64_bf16 v[44:47], v[24:27], v[128:135], v1
  s_waitcnt lgkmcnt(5)
  v_smfmac_f32_16x16x64_bf16 v[56:59], v[16:19], v[8:15], v1
  ds_read_b128 v[8:11], v2 offset:10240
  ds_read_b128 v[12:15], v2 offset:11264
  v_smfmac_f32_16x16x64_bf16 v[52:55], v[24:27], v[136:143], v1
  v_smfmac_f32_16x16x64_bf16 v[48:51], v[24:27], v[224:231], v1
  s_waitcnt lgkmcnt(2)
  v_smfmac_f32_16x16x64_bf16 v[44:47], v[16:19], v[60:67], v1
  buffer_load_dwordx4 v[60:63], v0, s[4:7], s42 offen sc1
  s_add_u32 s26, s42, 4096
  v_smfmac_f32_16x16x64_bf16 v[56:59], v[24:27], v[232:239], v1
  s_waitcnt lgkmcnt(0)
  v_smfmac_f32_16x16x64_bf16 v[52:55], v[16:19], v[8:15], v1
  buffer_load_dwordx4 v[64:67], v0, s[4:7], s26 offen sc1
  v_smfmac_f32_16x16x64_bf16 v[48:51], v[28:31], v[240:247], v1
  v_smfmac_f32_16x16x64_bf16 v[44:47], v[28:31], v[144:151], v1
  buffer_load_dwordx4 v[8:11], v0, s[4:7], s43 offen sc1
  v_smfmac_f32_16x16x64_bf16 v[48:51], v[32:35], a[0:7], v1
  v_smfmac_f32_16x16x64_bf16 v[44:47], v[32:35], v[160:167], v1
  buffer_load_dwordx4 v[12:15], v0, s[4:7], s43 offen offset:1024 sc1
  v_smfmac_f32_16x16x64_bf16 v[48:51], v[36:39], a[16:23], v1
  s_add_u32 s42, s42, 0x40000
  s_add_u32 s43, s43, 0x40000
  v_smfmac_f32_16x16x64_bf16 v[44:47], v[36:39], v[176:183], v1
  s_add_u32 s27, s44, 0x800000
  v_smfmac_f32_16x16x64_bf16 v[48:51], v[40:43], a[32:39], v1
  v_smfmac_f32_16x16x64_bf16 v[44:47], v[40:43], v[192:199], v1
  v_smfmac_f32_16x16x64_bf16 v[56:59], v[28:31], v[248:255], v1
  v_smfmac_f32_16x16x64_bf16 v[52:55], v[28:31], v[152:159], v1
  v_add_f32 v48, v48, v50
  v_smfmac_f32_16x16x64_bf16 v[56:59], v[32:35], a[8:15], v1
  v_add_f32 v49, v49, v51
  v_smfmac_f32_16x16x64_bf16 v[52:55], v[32:35], v[168:175], v1
  v_cvt_pk_bf16_f32 v50, v48, v49
  v_smfmac_f32_16x16x64_bf16 v[56:59], v[36:39], a[24:31], v1
  v_add_f32 v44, v44, v46
  v_smfmac_f32_16x16x64_bf16 v[52:55], v[36:39], v[184:191], v1
  v_add_f32 v45, v45, v47
  v_smfmac_f32_16x16x64_bf16 v[56:59], v[40:43], a[40:47], v1
  v_cvt_pk_bf16_f32 v51, v44, v45
  v_smfmac_f32_16x16x64_bf16 v[52:55], v[40:43], v[200:207], v1
  v_mfma_f32_16x16x16_bf16 v[44:47], v[50:51], v[4:5], 0
  v_add_f32 v56, v56, v58
  v_add_f32 v57, v57, v59
  v_cvt_pk_bf16_f32 v58, v56, v57
  s_nop 0
  v_add_f32 v52, v52, v54
  v_add_f32 v53, v53, v55
  v_cvt_pk_bf16_f32 v59, v52, v53
  s_nop 0
  v_cvt_pk_bf16_f32 v48, v44, v45
  v_cvt_pk_bf16_f32 v49, v46, v47
  v_mfma_f32_16x16x16_bf16 v[52:55], v[58:59], v[4:5], 0
  v_min_u32 v48, -2, v48
  v_smfmac_f32_16x16x64_bf16 v[68:71], v[16:19], a[80:87], v1
  v_smfmac_f32_16x16x64_bf16 v[72:75], v[16:19], a[88:95], v1
  v_cvt_pk_bf16_f32 v50, v52, v53
  v_cvt_pk_bf16_f32 v51, v54, v55
  s_waitcnt vmcnt(2)
  s_nop 0
  v_mfma_f32_16x16x32_bf16 v[52:55], v[64:67], v[48:51], 0
  v_lshrrev_b32 v3, 1, v0
  v_mfma_f32_16x16x32_bf16 v[44:47], v[60:63], v[48:51], 0
  v_bfi_b32 v17, 31, v0, v3
  v_mfma_f32_16x16x32_bf16 v[56:59], v[48:51], v[48:51], 0
  v_smfmac_f32_16x16x64_bf16 v[68:71], v[20:23], a[96:103], v1
  v_cndmask_b32_dpp v44, v52, v44, vcc quad_perm:[2,3,2,3] row_mask:0xf bank_mask:0xf
  v_cndmask_b32_dpp v45, v53, v45, vcc quad_perm:[2,3,2,3] row_mask:0xf bank_mask:0xf
  v_cndmask_b32_dpp v46, v54, v46, vcc quad_perm:[2,3,2,3] row_mask:0xf bank_mask:0xf
  v_cndmask_b32_dpp v47, v55, v47, vcc quad_perm:[2,3,2,3] row_mask:0xf bank_mask:0xf
  ds_write_b128 v0, v[44:47] offset:10496
  v_cndmask_b32_dpp v56, v57, v56, vcc quad_perm:[2,3,2,3] row_mask:0xf bank_mask:0xf
  ds_write_addtid_b32 v56 offset:11520
  v_smfmac_f32_16x16x64_bf16 v[72:75], v[20:23], a[104:111], v1
  v_smfmac_f32_16x16x64_bf16 v[68:71], v[24:27], a[112:119], v1
  v_smfmac_f32_16x16x64_bf16 v[72:75], v[24:27], a[120:127], v1
  s_waitcnt lgkmcnt(0)
  s_barrier
  v_smfmac_f32_16x16x64_bf16 v[68:71], v[28:31], a[128:135], v1
  ds_read_b128 v[60:63], v0 offset:11776
  ds_read_b128 v[64:67], v0 offset:13056
  ds_read_b128 v[52:55], v0 offset:9216
  v_smfmac_f32_16x16x64_bf16 v[72:75], v[28:31], a[136:143], v1
  ds_read_addtid_b32 v57 offset:12800
  ds_read_addtid_b32 v58 offset:14080
  ds_read_addtid_b32 v59 offset:10240
  v_smfmac_f32_16x16x64_bf16 v[68:71], v[32:35], a[144:151], v1
  s_not_b64 exec, s[62:63]
  buffer_store_dwordx4 v[48:51], v17, s[4:7], s44 offen sc1
  s_mov_b64 exec, -1
  ds_read_b128 v[20:23], v0 offset:14336
  v_mul_f32 v56, s90, v56
  v_smfmac_f32_16x16x64_bf16 v[72:75], v[32:35], a[152:159], v1
  ds_read_b128 v[24:27], v0 offset:15360
  v_mul_f32 v44, s90, v44
  v_smfmac_f32_16x16x64_bf16 v[68:71], v[36:39], a[160:167], v1
  ds_read_b128 v[28:31], v2 offset:22528
  v_mul_f32 v45, s90, v45
  v_smfmac_f32_16x16x64_bf16 v[72:75], v[36:39], a[168:175], v1
  ds_read_b128 v[32:35], v2 offset:23552
  v_mul_f32 v46, s90, v46
  v_smfmac_f32_16x16x64_bf16 v[68:71], v[40:43], a[176:183], v1
  ds_read_b128 v[36:39], v2 offset:26624
  v_mul_f32 v47, s90, v47
  v_smfmac_f32_16x16x64_bf16 v[72:75], v[40:43], a[184:191], v1
  ds_read_b128 v[40:43], v2 offset:27648
  s_waitcnt lgkmcnt(6)
  v_fmac_f32 v56, s90, v57
  v_fmac_f32 v56, s90, v58
  v_fmac_f32 v56, s90, v59
  v_pk_fma_f32 v[44:45], v[60:61], s[90:91], v[44:45]
  v_pk_fma_f32 v[46:47], v[62:63], s[90:91], v[46:47]
  v_pk_fma_f32 v[44:45], v[64:65], s[90:91], v[44:45]
  v_pk_fma_f32 v[46:47], v[66:67], s[90:91], v[46:47]
  v_pk_fma_f32 v[44:45], v[52:53], s[90:91], v[44:45]
  v_pk_fma_f32 v[46:47], v[54:55], s[90:91], v[46:47]
  v_pk_add_f32 v[68:69], v[68:69], v[70:71]
  v_pk_add_f32 v[72:73], v[72:73], v[74:75]
  v_exp_f32 v44, v44
  v_exp_f32 v45, v45
  v_exp_f32 v46, v46
  v_cvt_pk_bf16_f32 v44, v44, v45
  v_exp_f32 v47, v47
  v_cvt_pk_bf16_f32 v70, v68, v69
  v_mov_b32_dpp v16, v44 quad_perm:[2,3,2,3] row_mask:0xf bank_mask:0xf
  v_cvt_pk_bf16_f32 v45, v46, v47
  v_mov_b32_dpp v17, v44 quad_perm:[0,1,0,1] row_mask:0xf bank_mask:0xf
  v_cvt_pk_bf16_f32 v71, v72, v73
  v_mov_b32_dpp v18, v45 quad_perm:[2,3,2,3] row_mask:0xf bank_mask:0xf
  v_mov_b32_dpp v19, v45 quad_perm:[0,1,0,1] row_mask:0xf bank_mask:0xf
  v_exp_f32_dpp v57, v56 quad_perm:[2,3,2,3] row_mask:0xf bank_mask:0xf
  v_min_u32 v70, -2, v70
  s_waitcnt lgkmcnt(4)
  v_mfma_f32_16x16x32_bf16 v[48:51], v[24:27], v[16:19], 0
  ds_read_b128 v[44:47], v0 offset:14336
  s_add_u32 s94, s41, s47
  v_exp_f32_dpp v58, v56 quad_perm:[0,1,0,1] row_mask:0xf bank_mask:0xf
  s_waitcnt vmcnt(2)
  v_mfma_f32_16x16x32_bf16 v[52:55], v[8:11], v[16:19], 0
  ds_read_b128 v[72:75], v0 offset:14336
  v_cvt_pk_bf16_f32 v20, v57, v58
  s_waitcnt vmcnt(1)
  v_mfma_f32_16x16x32_bf16 v[60:63], v[12:15], v[16:19], 0
  buffer_store_dwordx2 v[70:71], v3, s[4:7], s27 offen sc1
  ds_read_b128 v[64:67], v2 offset:31744
  v_cvt_pk_bf16_f32 v23, v57, v58
  v_mfma_f32_16x16x16_bf16 v[48:51], v[24:25], v[20:21], v[48:51]
  ds_read_b128 v[24:27], v2 offset:19456
  v_mov_b64 v[56:57], 0
  v_mov_b64 v[58:59], 0
  v_mfma_f32_16x16x16_bf16 v[52:55], v[70:71], v[20:21], v[52:55]
  s_cmp_eq_u32 s37, 63
  s_cbranch_scc1 L_last1f
  v_mfma_f32_16x16x16_bf16 v[60:63], v[70:71], v[22:23], v[60:63]
  ds_read_b128 v[20:23], v2 offset:18432
  ds_read_b128 v[68:71], v0 offset:14336
  v_rcp_f32 v3, v48
  ds_read_b128 v[48:51], v0 offset:14336
  v_pk_mul_f32 v[52:53], v[52:53], v[2:3] op_sel:[0,1] op_sel_hi:[1,1]
  v_pk_mul_f32 v[54:55], v[54:55], v[2:3] op_sel:[0,1] op_sel_hi:[1,1]
  v_cvt_pk_bf16_f32 v52, v52, v53
  v_cvt_pk_bf16_f32 v53, v54, v55
  v_pk_mul_f32 v[60:61], v[60:61], v[2:3] op_sel:[0,1] op_sel_hi:[1,1]
  v_pk_mul_f32 v[62:63], v[62:63], v[2:3] op_sel:[0,1] op_sel_hi:[1,1]
  v_cvt_pk_bf16_f32 v54, v60, v61
  v_cvt_pk_bf16_f32 v55, v62, v63
  ds_write_b128 v0, v[52:55] offset:1024
  s_waitcnt lgkmcnt(10)
  v_smfmac_f32_16x16x64_bf16 v[56:59], v[52:55], v[28:35], v1
  ds_read_b128 v[60:63], v2 offset:30720
  v_subrev_u32 v16, 0x2b800000, v3
  v_cmp_lt_u32 vcc, 0x23000000, v16
  s_waitcnt lgkmcnt(3)
  v_smfmac_f32_16x16x64_bf16 v[68:71], v[52:55], v[36:43], v1
  ds_read_b128 v[28:31], v2 offset:16384
  v_smfmac_f32_16x16x64_bf16 v[44:47], v[52:55], v[20:27], v1
  ds_read_b128 v[32:35], v2 offset:17408
  s_cbranch_vccnz L_guard1f
L_safe1f:
  s_waitcnt lgkmcnt(3)
  s_barrier
  ds_read_b128 v[8:11], v0 offset:2048
  ds_read_b128 v[12:15], v0 offset:3072
  ds_read_b128 v[16:19], v0 offset:0
  s_waitcnt lgkmcnt(5)
  v_smfmac_f32_16x16x64_bf16 v[72:75], v[52:55], v[60:67], v1
  ds_read_b128 v[36:39], v2 offset:20480
  v_smfmac_f32_16x16x64_bf16 v[48:51], v[52:55], a[200:207], v1
  ds_read_b128 v[40:43], v2 offset:21504
  s_waitcnt lgkmcnt(4)
  v_smfmac_f32_16x16x64_bf16 v[44:47], v[8:11], a[208:215], v1
  ds_read_b128 v[20:23], v2 offset:24576
  s_waitcnt lgkmcnt(4)
  v_smfmac_f32_16x16x64_bf16 v[44:47], v[12:15], a[216:223], v1
  ds_read_b128 v[24:27], v2 offset:25600
  s_waitcnt lgkmcnt(4)
  v_smfmac_f32_16x16x64_bf16 v[44:47], v[16:19], v[28:35], v1
  ds_read_b128 v[60:63], v2 offset:32768
  v_smfmac_f32_16x16x64_bf16 v[56:59], v[8:11], a[224:231], v1
  ds_read_b128 v[64:67], v2 offset:33792
  v_smfmac_f32_16x16x64_bf16 v[56:59], v[12:15], a[232:239], v1
  ds_read_b128 v[28:31], v2 offset:34816
  v_cvt_pk_bf16_f32 v44, v44, v45
  s_waitcnt lgkmcnt(5)
  v_smfmac_f32_16x16x64_bf16 v[56:59], v[16:19], v[36:43], v1
  ds_read_b128 v[32:35], v2 offset:35840
  v_cvt_pk_bf16_f32 v45, v46, v47
  v_smfmac_f32_16x16x64_bf16 v[68:71], v[8:11], a[240:247], v1
  ds_read_b128 v[36:39], v2 offset:28672
  v_bfi_b32 v44, 1, s46, v44
  v_smfmac_f32_16x16x64_bf16 v[68:71], v[12:15], a[248:255], v1
  ds_read_b128 v[40:43], v2 offset:29696
  v_cvt_pk_bf16_f32 v46, v56, v57
  s_waitcnt lgkmcnt(6)
  v_smfmac_f32_16x16x64_bf16 v[68:71], v[16:19], v[20:27], v1
  ds_read_b128 v[20:23], v2 offset:36864
  ds_read_b128 v[24:27], v2 offset:37888
  v_cvt_pk_bf16_f32 v47, v58, v59
  s_waitcnt lgkmcnt(6)
  v_smfmac_f32_16x16x64_bf16 v[72:75], v[8:11], v[60:67], v1
  ds_read_b128 v[60:63], v2 offset:38912
  ds_read_b128 v[64:67], v2 offset:39936
  v_bfi_b32 v46, 1, s46, v46
  s_waitcnt lgkmcnt(6)
  v_smfmac_f32_16x16x64_bf16 v[72:75], v[12:15], v[28:35], v1
  s_add_u32 s26, s94, 0x18000
  v_cvt_pk_bf16_f32 v68, v68, v69
  s_waitcnt lgkmcnt(4)
  v_smfmac_f32_16x16x64_bf16 v[72:75], v[16:19], v[36:43], v1
  buffer_store_dwordx4 v[44:47], v0, s[4:7], s26 offen
  v_cvt_pk_bf16_f32 v69, v70, v71
  v_smfmac_f32_16x16x64_bf16 v[48:51], v[16:19], a[192:199], v1
  v_bfi_b32 v68, 1, s46, v68
  s_waitcnt lgkmcnt(2)
  v_smfmac_f32_16x16x64_bf16 v[48:51], v[8:11], v[20:27], v1
  v_cvt_pk_bf16_f32 v70, v72, v73
  s_waitcnt lgkmcnt(0)
  v_smfmac_f32_16x16x64_bf16 v[48:51], v[12:15], v[60:67], v1
  v_cvt_pk_bf16_f32 v71, v74, v75
  v_bfi_b32 v70, 1, s46, v70
  s_add_u32 s26, s94, 0x20000
  buffer_store_dwordx4 v[68:71], v0, s[4:7], s26 offen
  s_nop 3
  v_cvt_pk_bf16_f32 v48, v48, v49
  v_cvt_pk_bf16_f32 v49, v50, v51
  v_bfi_b32 v48, 1, s46, v48
  s_add_u32 s26, s94, 0x10000
  buffer_store_dwordx2 v[48:49], v0, s[4:7], s26 offen offset:8
  s_add_u32 s28, s41, s66
  s_add_u32 s48, s28, 0
  s_add_u32 s49, s28, 8192
  s_add_u32 s50, s28, 16384
  s_add_u32 s51, s28, 24576
  s_cmp_ge_u32 s36, 8
  s_cbranch_scc1 L_skip1f
  s_waitcnt vmcnt(0)
  s_barrier
  buffer_load_dwordx4 v[44:47], v6, s[4:7], s48 offen sc1
  buffer_load_dwordx4 v[48:51], v6, s[4:7], s49 offen sc1
  buffer_load_dwordx4 v[52:55], v6, s[4:7], s50 offen sc1
  buffer_load_dwordx4 v[56:59], v6, s[4:7], s51 offen sc1
  s_add_u32 s37, s37, 1
  s_xor_b32 s41, s41, 0x48000
  s_add_u32 s61, s40, s60
  s_mov_b32 s26, s38
  s_mov_b32 s38, s40
  s_mov_b32 s40, s39
  s_mov_b32 s39, s26
  s_add_u32 s58, s40, 2048
  s_add_u32 s44, s44, 0x20000
  s_add_u32 s26, s40, s60
  s_mov_b32 s56, 0
  ds_read_b128 v[60:63], v2 offset:0
  ds_read_b128 v[64:67], v2 offset:1024
  ds_read_b128 v[20:23], v2 offset:2048
  ds_read_b128 v[24:27], v2 offset:3072
  ds_read_b128 v[28:31], v2 offset:12288
  ds_read_b128 v[32:35], v2 offset:13312
  ds_read_b128 v[36:39], v2 offset:14336
  ds_read_b128 v[40:43], v2 offset:15360
  v_mov_b32 v68, 0
  v_mov_b32 v69, 0
  v_mov_b32 v70, 0
  v_mov_b32 v71, 0
  v_mov_b32 v72, 0
  v_mov_b32 v73, 0
  v_mov_b32 v74, 0
  v_mov_b32 v75, 0
  v_mov_b32 v16, -1
L_rchk1f:
  s_waitcnt vmcnt(3)
  v_mfma_f32_16x16x32_bf16 v[8:11], v[44:47], v[76:79], 0
  v_bitop3_b32 v12, v44, v46, s46 bitop3:0x7e
  s_waitcnt vmcnt(2)
  v_mfma_f32_16x16x32_bf16 v[8:11], v[48:51], v[76:79], v[8:11]
  v_bitop3_b32 v13, v48, v50, s46 bitop3:0x7e
  s_waitcnt vmcnt(1)
  v_mfma_f32_16x16x32_bf16 v[8:11], v[52:55], v[76:79], v[8:11]
  v_bitop3_b32 v14, v52, v54, s46 bitop3:0x7e
  v_or3_b32 v12, v12, v13, v14
  s_waitcnt vmcnt(0)
  v_mfma_f32_16x16x32_bf16 v[8:11], v[56:59], v[76:79], v[8:11]
  v_bitop3_b32 v3, v56, v58, s46 bitop3:0x7e
  v_bitop3_b32 v3, v3, v12, 1 bitop3:0xa8
  v_cmp_ne_u32 vcc, 0, v3
  v_mov_b64 v[44:45], 0
  v_mov_b64 v[46:47], 0
  v_mov_b64 v[48:49], 0
  s_nop 1
  v_permlane32_swap_b32 v8, v10
  v_permlane32_swap_b32 v9, v11
  v_pk_add_f32 v[8:9], v[8:9], v[10:11]
  v_cvt_pk_bf16_f32 v8, v8, v9
  v_min_u32 v8, -2, v8
  s_cbranch_vccnz L_r1f
  buffer_store_dword v8, v7, s[4:7], s26 offen
L_join1f:
  v_mov_b64 v[50:51], 0
  v_mov_b64 v[52:53], 0
  v_mov_b64 v[54:55], 0
  v_mov_b64 v[56:57], 0
  v_mov_b64 v[58:59], 0
  v_mov_b64 v[44:45], 0
  v_mov_b64 v[46:47], 0
  v_mov_b64 v[48:49], 0
L_end1f:
  s_branch L_top1f
L_retry1f:
  buffer_load_dwordx4 v[8:11], v0, s[4:7], s58 offen offset:1024 sc1
  buffer_load_dwordx4 v[12:15], v0, s[4:7], s58 offen offset:0 sc1
  ds_read_b128 v[60:63], v2 offset:0
  ds_read_b128 v[64:67], v2 offset:1024
  s_nop 1
  v_mov_b64 v[44:45], 0
  v_mov_b64 v[46:47], 0
  v_mov_b64 v[48:49], 0
  v_mov_b64 v[50:51], 0
  v_mov_b64 v[52:53], 0
  v_mov_b64 v[54:55], 0
  v_mov_b64 v[56:57], 0
  v_mov_b64 v[58:59], 0
  v_mov_b64 v[68:69], 0
  v_mov_b64 v[70:71], 0
  v_mov_b64 v[72:73], 0
  v_mov_b64 v[74:75], 0
  s_add_u32 s56, s56, 1
  s_cmp_lt_u32 s56, 1048576
  s_cbranch_scc1 L_chk1f
  s_branch L_fail
L_guard1f:
  s_waitcnt vmcnt(0) lgkmcnt(0)
  v_lshrrev_b32 v3, 1, v0
  buffer_load_dwordx2 v[70:71], v3, s[4:7], s27 offen sc1
  s_nop 2
  ds_read_b128 v[44:47], v0 offset:10496
  ds_read_addtid_b32 v56 offset:11520
  ds_read_b128 v[60:63], v0 offset:11776
  ds_read_b128 v[64:67], v0 offset:13056
  ds_read_b128 v[52:55], v0 offset:9216
  ds_read_addtid_b32 v57 offset:12800
  ds_read_addtid_b32 v58 offset:14080
  ds_read_addtid_b32 v59 offset:10240
  ds_read_b128 v[20:23], v0 offset:14336
  ds_read_b128 v[24:27], v0 offset:15360
  s_waitcnt lgkmcnt(7)
  v_pk_add_f32 v[44:45], v[44:45], v[60:61]
  v_pk_add_f32 v[46:47], v[46:47], v[62:63]
  s_waitcnt lgkmcnt(4)
  v_add_f32 v56, v56, v57
  v_pk_add_f32 v[44:45], v[44:45], v[64:65]
  v_pk_add_f32 v[46:47], v[46:47], v[66:67]
  s_waitcnt lgkmcnt(3)
  v_add_f32 v56, v56, v58
  v_pk_add_f32 v[44:45], v[44:45], v[52:53]
  v_pk_add_f32 v[46:47], v[46:47], v[54:55]
  s_waitcnt lgkmcnt(2)
  v_add_f32 v56, v56, v59
  v_max3_f32 v50, v44, v45, v46
  v_max3_f32 v50, v50, v47, v56
  s_nop 1
  v_max_f32_dpp v48, v50, v50 quad_perm:[2,3,0,1] row_mask:0xf bank_mask:0xf
  v_max_f32_dpp v49, v50, v50 quad_perm:[2,3,0,1] row_mask:0xf bank_mask:0xf
  s_nop 1
  v_permlane32_swap_b32 v48, v49
  v_max_f32 v50, v48, v49
  v_max_f32 v51, v48, v49
  s_nop 1
  v_permlane16_swap_b32 v50, v51
  v_max_f32 v50, v50, v51
  v_sub_f32 v44, v44, v50
  v_mul_f32 v44, s90, v44
  v_sub_f32 v45, v45, v50
  v_mul_f32 v45, s90, v45
  v_sub_f32 v46, v46, v50
  v_mul_f32 v46, s90, v46
  v_sub_f32 v47, v47, v50
  v_mul_f32 v47, s90, v47
  v_sub_f32 v56, v56, v50
  v_mul_f32 v56, s90, v56
  v_exp_f32 v44, v44
  v_exp_f32 v45, v45
  v_exp_f32 v46, v46
  v_exp_f32 v47, v47
  v_exp_f32_dpp v57, v56 quad_perm:[2,3,2,3] row_mask:0xf bank_mask:0xf
  v_exp_f32_dpp v58, v56 quad_perm:[0,1,0,1] row_mask:0xf bank_mask:0xf
  v_cvt_pk_bf16_f32 v44, v44, v45
  v_cvt_pk_bf16_f32 v45, v46, v47
  s_waitcnt lgkmcnt(1)
  v_cvt_pk_bf16_f32 v20, v57, v58
  v_cvt_pk_bf16_f32 v23, v57, v58
  v_mov_b32_dpp v16, v44 quad_perm:[2,3,2,3] row_mask:0xf bank_mask:0xf
  v_mov_b32_dpp v17, v44 quad_perm:[0,1,0,1] row_mask:0xf bank_mask:0xf
  v_mov_b32_dpp v18, v45 quad_perm:[2,3,2,3] row_mask:0xf bank_mask:0xf
  v_mov_b32_dpp v19, v45 quad_perm:[0,1,0,1] row_mask:0xf bank_mask:0xf
  s_waitcnt lgkmcnt(0)
  s_nop 0
  v_mfma_f32_16x16x32_bf16 v[48:51], v[24:27], v[16:19], 0
  v_mfma_f32_16x16x32_bf16 v[52:55], v[8:11], v[16:19], 0
  v_mfma_f32_16x16x32_bf16 v[60:63], v[12:15], v[16:19], 0
  v_mfma_f32_16x16x16_bf16 v[48:51], v[24:25], v[20:21], v[48:51]
  s_waitcnt vmcnt(0)
  v_mfma_f32_16x16x16_bf16 v[52:55], v[70:71], v[20:21], v[52:55]
  v_mfma_f32_16x16x16_bf16 v[60:63], v[70:71], v[22:23], v[60:63]
  v_rcp_f32 v3, v48
  s_add_u32 s94, s41, s47
  s_nop 1
  v_pk_mul_f32 v[52:53], v[52:53], v[2:3] op_sel:[0,1] op_sel_hi:[1,1]
  v_pk_mul_f32 v[54:55], v[54:55], v[2:3] op_sel:[0,1] op_sel_hi:[1,1]
  v_cvt_pk_bf16_f32 v52, v52, v53
  v_cvt_pk_bf16_f32 v53, v54, v55
  v_pk_mul_f32 v[60:61], v[60:61], v[2:3] op_sel:[0,1] op_sel_hi:[1,1]
  v_pk_mul_f32 v[62:63], v[62:63], v[2:3] op_sel:[0,1] op_sel_hi:[1,1]
  v_cvt_pk_bf16_f32 v54, v60, v61
  v_cvt_pk_bf16_f32 v55, v62, v63
  ds_write_b128 v0, v[52:55] offset:1024
  ds_read_b128 v[44:47], v0 offset:14336
  ds_read_b128 v[56:59], v0 offset:14336
  ds_read_b128 v[68:71], v0 offset:14336
  ds_read_b128 v[72:75], v0 offset:14336
  ds_read_b128 v[48:51], v0 offset:14336
  ds_read_b128 v[20:23], v2 offset:18432
  ds_read_b128 v[24:27], v2 offset:19456
  ds_read_b128 v[28:31], v2 offset:22528
  ds_read_b128 v[32:35], v2 offset:23552
  ds_read_b128 v[36:39], v2 offset:26624
  ds_read_b128 v[40:43], v2 offset:27648
  ds_read_b128 v[60:63], v2 offset:30720
  ds_read_b128 v[64:67], v2 offset:31744
  s_waitcnt lgkmcnt(4)
  v_smfmac_f32_16x16x64_bf16 v[56:59], v[52:55], v[28:35], v1
  s_waitcnt lgkmcnt(2)
  v_smfmac_f32_16x16x64_bf16 v[68:71], v[52:55], v[36:43], v1
  v_smfmac_f32_16x16x64_bf16 v[44:47], v[52:55], v[20:27], v1
  ds_read_b128 v[28:31], v2 offset:16384
  ds_read_b128 v[32:35], v2 offset:17408
  s_waitcnt vmcnt(0) lgkmcnt(0)
  s_branch L_safe1f
L_skip1f:
  s_add_u32 s37, s37, 1
  s_xor_b32 s41, s41, 0x48000
  s_add_u32 s61, s40, s60
  s_mov_b32 s26, s38
  s_mov_b32 s38, s40
  s_mov_b32 s40, s39
  s_mov_b32 s39, s26
  s_add_u32 s58, s40, 2048
  s_add_u32 s44, s44, 0x20000
  s_add_u32 s26, s40, s60
  s_mov_b32 s56, 0
  ds_read_b128 v[60:63], v2 offset:0
  ds_read_b128 v[64:67], v2 offset:1024
  ds_read_b128 v[20:23], v2 offset:2048
  ds_read_b128 v[24:27], v2 offset:3072
  ds_read_b128 v[28:31], v2 offset:12288
  ds_read_b128 v[32:35], v2 offset:13312
  ds_read_b128 v[36:39], v2 offset:14336
  ds_read_b128 v[40:43], v2 offset:15360
  v_mov_b32 v68, 0
  v_mov_b32 v69, 0
  v_mov_b32 v70, 0
  v_mov_b32 v71, 0
  v_mov_b32 v72, 0
  v_mov_b32 v73, 0
  v_mov_b32 v74, 0
  v_mov_b32 v75, 0
  v_mov_b32 v16, -1
  s_waitcnt vmcnt(0)
  s_barrier
  s_branch L_join1f
L_r1f:
  buffer_load_dwordx4 v[44:47], v6, s[4:7], s48 offen sc1
  buffer_load_dwordx4 v[48:51], v6, s[4:7], s49 offen sc1
  buffer_load_dwordx4 v[52:55], v6, s[4:7], s50 offen sc1
  buffer_load_dwordx4 v[56:59], v6, s[4:7], s51 offen sc1
  s_add_u32 s56, s56, 1
  s_cmp_lt_u32 s56, 1048576
  s_cbranch_scc1 L_rchk1f
  s_branch L_fail
L_last1f:
  s_waitcnt vmcnt(0)
  s_barrier
  s_branch L_exit
L_slowmode1:
  s_mov_b32 m0, 0
  ds_read_b128 v[60:63], v2 offset:0
  ds_read_b128 v[64:67], v2 offset:1024
  ds_read_b128 v[20:23], v2 offset:2048
  ds_read_b128 v[24:27], v2 offset:3072
  ds_read_b128 v[28:31], v2 offset:12288
  ds_read_b128 v[32:35], v2 offset:13312
  ds_read_b128 v[36:39], v2 offset:14336
  ds_read_b128 v[40:43], v2 offset:15360
  v_mov_b64 v[44:45], 0
  v_mov_b64 v[46:47], 0
  v_mov_b64 v[48:49], 0
  v_mov_b64 v[50:51], 0
  v_mov_b64 v[52:53], 0
  v_mov_b64 v[54:55], 0
  v_mov_b64 v[56:57], 0
  v_mov_b64 v[58:59], 0
  v_mov_b64 v[68:69], 0
  v_mov_b64 v[70:71], 0
  v_mov_b64 v[72:73], 0
  v_mov_b64 v[74:75], 0
  v_mov_b32 v16, -1
  v_mov_b64 v[68:69], s[64:65]
  v_mov_b64 v[70:71], s[64:65]
  ds_write_b128 v0, v[68:71] offset:15360
  v_mov_b64 v[68:69], 0
  v_mov_b64 v[70:71], 0
  s_branch L_chk1s
L_top1s:
  s_waitcnt vmcnt(0)
  s_barrier
  buffer_load_dwordx4 v[8:11], v0, s[4:7], s58 offen offset:1024 sc1
  s_mov_b32 s56, 0
  buffer_load_dwordx4 v[12:15], v0, s[4:7], s58 offen offset:0 sc1
  s_bfe_u32 s46, s37, 0x10001
L_chk1s:
  s_waitcnt vmcnt(1) lgkmcnt(0)
  v_smfmac_f32_16x16x64_bf16 v[48:51], v[8:11], v[60:67], v1
  ds_write_b128 v0, v[8:11] offset:3072
  s_waitcnt lgkmcnt(6)
  v_smfmac_f32_16x16x64_bf16 v[56:59], v[8:11], v[20:27], v1
  v_smfmac_f32_16x16x64_bf16 v[44:47], v[8:11], v[80:87], v1
  v_smfmac_f32_16x16x64_bf16 v[52:55], v[8:11], v[88:95], v1
  s_waitcnt vmcnt(0)
  ds_write_b128 v0, v[12:15] offset:2048
  s_waitcnt lgkmcnt(5)
  v_smfmac_f32_16x16x64_bf16 v[48:51], v[12:15], v[28:35], v1
  v_max3_u32 v3, v8, v9, v10
  v_max3_u32 v3, v3, v11, v12
  v_max3_u32 v3, v3, v13, v14
  v_max_u32 v3, v3, v15
  s_waitcnt lgkmcnt(3)
  v_smfmac_f32_16x16x64_bf16 v[56:59], v[12:15], v[36:43], v1
  ds_read_b128 v[60:63], v2 offset:4096
  v_cmp_eq_u32 vcc, -1, v3
  v_smfmac_f32_16x16x64_bf16 v[44:47], v[12:15], v[96:103], v1
  ds_read_b128 v[64:67], v2 offset:5120
  s_cbranch_vccnz L_retry1s
  v_smfmac_f32_16x16x64_bf16 v[52:55], v[12:15], v[104:111], v1
  s_waitcnt lgkmcnt(2)
  s_barrier
  ds_read_b128 v[20:23], v0 offset:0
  v_smfmac_f32_16x16x64_bf16 v[68:71], v[8:11], a[48:55], v1
  buffer_store_dword v16, v7, s[4:7], s61 offen sc1
  ds_read_b128 v[24:27], v0 offset:1024
  s_mov_b64 vcc, s[62:63]
  v_smfmac_f32_16x16x64_bf16 v[72:75], v[8:11], a[56:63], v1
  ds_read_b128 v[28:31], v0 offset:4096
  v_smfmac_f32_16x16x64_bf16 v[68:71], v[12:15], a[64:71], v1
  ds_read_b128 v[16:19], v0 offset:8192
  v_smfmac_f32_16x16x64_bf16 v[72:75], v[12:15], a[72:79], v1
  ds_read_b128 v[8:11], v2 offset:6144
  s_waitcnt lgkmcnt(4)
  v_smfmac_f32_16x16x64_bf16 v[44:47], v[20:23], v[112:119], v1
  ds_read_b128 v[12:15], v2 offset:7168
  v_smfmac_f32_16x16x64_bf16 v[48:51], v[20:23], v[208:215], v1
  ds_read_b128 v[32:35], v0 offset:5120
  v_smfmac_f32_16x16x64_bf16 v[52:55], v[20:23], v[120:127], v1
  ds_read_b128 v[36:39], v0 offset:6144
  v_smfmac_f32_16x16x64_bf16 v[56:59], v[20:23], v[216:223], v1
  ds_read_b128 v[40:43], v0 offset:7168
  s_waitcnt lgkmcnt(5)
  v_smfmac_f32_16x16x64_bf16 v[48:51], v[16:19], v[60:67], v1
  ds_read_b128 v[60:63], v2 offset:8192
  ds_read_b128 v[64:67], v2 offset:9216
  v_smfmac_f32_16x16x64_bf16 v[44:47], v[24:27], v[128:135], v1
  s_waitcnt lgkmcnt(5)
  v_smfmac_f32_16x16x64_bf16 v[56:59], v[16:19], v[8:15], v1
  ds_read_b128 v[8:11], v2 offset:10240
  ds_read_b128 v[12:15], v2 offset:11264
  v_smfmac_f32_16x16x64_bf16 v[52:55], v[24:27], v[136:143], v1
  v_smfmac_f32_16x16x64_bf16 v[48:51], v[24:27], v[224:231], v1
  s_waitcnt lgkmcnt(2)
  v_smfmac_f32_16x16x64_bf16 v[44:47], v[16:19], v[60:67], v1
  buffer_load_dwordx4 v[60:63], v0, s[4:7], s42 offen sc1
  s_add_u32 s26, s42, 4096
  v_smfmac_f32_16x16x64_bf16 v[56:59], v[24:27], v[232:239], v1
  s_waitcnt lgkmcnt(0)
  v_smfmac_f32_16x16x64_bf16 v[52:55], v[16:19], v[8:15], v1
  buffer_load_dwordx4 v[64:67], v0, s[4:7], s26 offen sc1
  v_smfmac_f32_16x16x64_bf16 v[48:51], v[28:31], v[240:247], v1
  v_smfmac_f32_16x16x64_bf16 v[44:47], v[28:31], v[144:151], v1
  buffer_load_dwordx4 v[8:11], v0, s[4:7], s43 offen sc1
  v_smfmac_f32_16x16x64_bf16 v[48:51], v[32:35], a[0:7], v1
  v_smfmac_f32_16x16x64_bf16 v[44:47], v[32:35], v[160:167], v1
  buffer_load_dwordx4 v[12:15], v0, s[4:7], s43 offen offset:1024 sc1
  v_smfmac_f32_16x16x64_bf16 v[48:51], v[36:39], a[16:23], v1
  s_add_u32 s42, s42, 0x40000
  s_add_u32 s43, s43, 0x40000
  v_smfmac_f32_16x16x64_bf16 v[44:47], v[36:39], v[176:183], v1
  s_add_u32 s27, s44, 0x800000
  v_smfmac_f32_16x16x64_bf16 v[48:51], v[40:43], a[32:39], v1
  v_smfmac_f32_16x16x64_bf16 v[44:47], v[40:43], v[192:199], v1
  v_smfmac_f32_16x16x64_bf16 v[56:59], v[28:31], v[248:255], v1
  v_smfmac_f32_16x16x64_bf16 v[52:55], v[28:31], v[152:159], v1
  v_add_f32 v48, v48, v50
  v_smfmac_f32_16x16x64_bf16 v[56:59], v[32:35], a[8:15], v1
  v_add_f32 v49, v49, v51
  v_smfmac_f32_16x16x64_bf16 v[52:55], v[32:35], v[168:175], v1
  v_cvt_pk_bf16_f32 v50, v48, v49
  v_smfmac_f32_16x16x64_bf16 v[56:59], v[36:39], a[24:31], v1
  v_add_f32 v44, v44, v46
  v_smfmac_f32_16x16x64_bf16 v[52:55], v[36:39], v[184:191], v1
  v_add_f32 v45, v45, v47
  v_smfmac_f32_16x16x64_bf16 v[56:59], v[40:43], a[40:47], v1
  v_cvt_pk_bf16_f32 v51, v44, v45
  v_smfmac_f32_16x16x64_bf16 v[52:55], v[40:43], v[200:207], v1
  v_mfma_f32_16x16x16_bf16 v[44:47], v[50:51], v[4:5], 0
  v_add_f32 v56, v56, v58
  v_add_f32 v57, v57, v59
  v_cvt_pk_bf16_f32 v58, v56, v57
  s_nop 0
  v_add_f32 v52, v52, v54
  v_add_f32 v53, v53, v55
  v_cvt_pk_bf16_f32 v59, v52, v53
  s_nop 0
  v_cvt_pk_bf16_f32 v48, v44, v45
  v_cvt_pk_bf16_f32 v49, v46, v47
  v_mfma_f32_16x16x16_bf16 v[52:55], v[58:59], v[4:5], 0
  v_min_u32 v48, -2, v48
  v_smfmac_f32_16x16x64_bf16 v[68:71], v[16:19], a[80:87], v1
  v_smfmac_f32_16x16x64_bf16 v[72:75], v[16:19], a[88:95], v1
  v_cvt_pk_bf16_f32 v50, v52, v53
  v_cvt_pk_bf16_f32 v51, v54, v55
  s_waitcnt vmcnt(2)
  s_nop 0
  v_mfma_f32_16x16x32_bf16 v[52:55], v[64:67], v[48:51], 0
  v_lshrrev_b32 v3, 1, v0
  v_mfma_f32_16x16x32_bf16 v[44:47], v[60:63], v[48:51], 0
  v_bfi_b32 v17, 31, v0, v3
  v_mfma_f32_16x16x32_bf16 v[56:59], v[48:51], v[48:51], 0
  v_smfmac_f32_16x16x64_bf16 v[68:71], v[20:23], a[96:103], v1
  v_cndmask_b32_dpp v44, v52, v44, vcc quad_perm:[2,3,2,3] row_mask:0xf bank_mask:0xf
  v_cndmask_b32_dpp v45, v53, v45, vcc quad_perm:[2,3,2,3] row_mask:0xf bank_mask:0xf
  v_cndmask_b32_dpp v46, v54, v46, vcc quad_perm:[2,3,2,3] row_mask:0xf bank_mask:0xf
  v_cndmask_b32_dpp v47, v55, v47, vcc quad_perm:[2,3,2,3] row_mask:0xf bank_mask:0xf
  ds_write_b128 v0, v[44:47] offset:10496
  v_cndmask_b32_dpp v56, v57, v56, vcc quad_perm:[2,3,2,3] row_mask:0xf bank_mask:0xf
  ds_write_addtid_b32 v56 offset:11520
  v_smfmac_f32_16x16x64_bf16 v[72:75], v[20:23], a[104:111], v1
  v_smfmac_f32_16x16x64_bf16 v[68:71], v[24:27], a[112:119], v1
  v_smfmac_f32_16x16x64_bf16 v[72:75], v[24:27], a[120:127], v1
  s_waitcnt lgkmcnt(0)
  s_barrier
  v_smfmac_f32_16x16x64_bf16 v[68:71], v[28:31], a[128:135], v1
  ds_read_b128 v[60:63], v0 offset:11776
  ds_read_b128 v[64:67], v0 offset:13056
  ds_read_b128 v[52:55], v0 offset:9216
  v_smfmac_f32_16x16x64_bf16 v[72:75], v[28:31], a[136:143], v1
  ds_read_addtid_b32 v57 offset:12800
  ds_read_addtid_b32 v58 offset:14080
  ds_read_addtid_b32 v59 offset:10240
  v_smfmac_f32_16x16x64_bf16 v[68:71], v[32:35], a[144:151], v1
  s_not_b64 exec, s[62:63]
  buffer_store_dwordx4 v[48:51], v17, s[4:7], s44 offen sc1
  s_mov_b64 exec, -1
  ds_read_b128 v[20:23], v0 offset:14336
  v_mul_f32 v56, s90, v56
  v_smfmac_f32_16x16x64_bf16 v[72:75], v[32:35], a[152:159], v1
  ds_read_b128 v[24:27], v0 offset:15360
  v_mul_f32 v44, s90, v44
  v_smfmac_f32_16x16x64_bf16 v[68:71], v[36:39], a[160:167], v1
  ds_read_b128 v[28:31], v2 offset:22528
  v_mul_f32 v45, s90, v45
  v_smfmac_f32_16x16x64_bf16 v[72:75], v[36:39], a[168:175], v1
  ds_read_b128 v[32:35], v2 offset:23552
  v_mul_f32 v46, s90, v46
  v_smfmac_f32_16x16x64_bf16 v[68:71], v[40:43], a[176:183], v1
  ds_read_b128 v[36:39], v2 offset:26624
  v_mul_f32 v47, s90, v47
  v_smfmac_f32_16x16x64_bf16 v[72:75], v[40:43], a[184:191], v1
  ds_read_b128 v[40:43], v2 offset:27648
  s_waitcnt lgkmcnt(6)
  v_fmac_f32 v56, s90, v57
  v_fmac_f32 v56, s90, v58
  v_fmac_f32 v56, s90, v59
  v_pk_fma_f32 v[44:45], v[60:61], s[90:91], v[44:45]
  v_pk_fma_f32 v[46:47], v[62:63], s[90:91], v[46:47]
  v_pk_fma_f32 v[44:45], v[64:65], s[90:91], v[44:45]
  v_pk_fma_f32 v[46:47], v[66:67], s[90:91], v[46:47]
  v_pk_fma_f32 v[44:45], v[52:53], s[90:91], v[44:45]
  v_pk_fma_f32 v[46:47], v[54:55], s[90:91], v[46:47]
  v_pk_add_f32 v[68:69], v[68:69], v[70:71]
  v_pk_add_f32 v[72:73], v[72:73], v[74:75]
  v_exp_f32 v44, v44
  v_exp_f32 v45, v45
  v_exp_f32 v46, v46
  v_cvt_pk_bf16_f32 v44, v44, v45
  v_exp_f32 v47, v47
  v_cvt_pk_bf16_f32 v70, v68, v69
  v_mov_b32_dpp v16, v44 quad_perm:[2,3,2,3] row_mask:0xf bank_mask:0xf
  v_cvt_pk_bf16_f32 v45, v46, v47
  v_mov_b32_dpp v17, v44 quad_perm:[0,1,0,1] row_mask:0xf bank_mask:0xf
  v_cvt_pk_bf16_f32 v71, v72, v73
  v_mov_b32_dpp v18, v45 quad_perm:[2,3,2,3] row_mask:0xf bank_mask:0xf
  v_mov_b32_dpp v19, v45 quad_perm:[0,1,0,1] row_mask:0xf bank_mask:0xf
  v_exp_f32_dpp v57, v56 quad_perm:[2,3,2,3] row_mask:0xf bank_mask:0xf
  v_min_u32 v70, -2, v70
  s_waitcnt lgkmcnt(4)
  v_mfma_f32_16x16x32_bf16 v[48:51], v[24:27], v[16:19], 0
  ds_read_b128 v[44:47], v0 offset:14336
  s_add_u32 s94, s41, s47
  v_exp_f32_dpp v58, v56 quad_perm:[0,1,0,1] row_mask:0xf bank_mask:0xf
  s_waitcnt vmcnt(2)
  v_mfma_f32_16x16x32_bf16 v[52:55], v[8:11], v[16:19], 0
  ds_read_b128 v[72:75], v0 offset:14336
  v_cvt_pk_bf16_f32 v20, v57, v58
  s_waitcnt vmcnt(1)
  v_mfma_f32_16x16x32_bf16 v[60:63], v[12:15], v[16:19], 0
  buffer_store_dwordx2 v[70:71], v3, s[4:7], s27 offen sc1
  ds_read_b128 v[64:67], v2 offset:31744
  v_cvt_pk_bf16_f32 v23, v57, v58
  v_mfma_f32_16x16x16_bf16 v[48:51], v[24:25], v[20:21], v[48:51]
  ds_read_b128 v[24:27], v2 offset:19456
  v_mov_b64 v[56:57], 0
  v_mov_b64 v[58:59], 0
  v_mfma_f32_16x16x16_bf16 v[52:55], v[70:71], v[20:21], v[52:55]
  s_cmp_eq_u32 s37, 63
  s_cbranch_scc1 L_last1s
  v_mfma_f32_16x16x16_bf16 v[60:63], v[70:71], v[22:23], v[60:63]
  ds_read_b128 v[20:23], v2 offset:18432
  ds_read_b128 v[68:71], v0 offset:14336
  v_rcp_f32 v3, v48
  ds_read_b128 v[48:51], v0 offset:14336
  v_pk_mul_f32 v[52:53], v[52:53], v[2:3] op_sel:[0,1] op_sel_hi:[1,1]
  v_pk_mul_f32 v[54:55], v[54:55], v[2:3] op_sel:[0,1] op_sel_hi:[1,1]
  v_cvt_pk_bf16_f32 v52, v52, v53
  v_cvt_pk_bf16_f32 v53, v54, v55
  v_pk_mul_f32 v[60:61], v[60:61], v[2:3] op_sel:[0,1] op_sel_hi:[1,1]
  v_pk_mul_f32 v[62:63], v[62:63], v[2:3] op_sel:[0,1] op_sel_hi:[1,1]
  v_cvt_pk_bf16_f32 v54, v60, v61
  v_cvt_pk_bf16_f32 v55, v62, v63
  ds_write_b128 v0, v[52:55] offset:1024
  s_waitcnt lgkmcnt(10)
  v_smfmac_f32_16x16x64_bf16 v[56:59], v[52:55], v[28:35], v1
  ds_read_b128 v[60:63], v2 offset:30720
  v_subrev_u32 v16, 0x2b800000, v3
  v_cmp_lt_u32 vcc, 0x23000000, v16
  s_waitcnt lgkmcnt(3)
  v_smfmac_f32_16x16x64_bf16 v[68:71], v[52:55], v[36:43], v1
  ds_read_b128 v[28:31], v2 offset:16384
  v_smfmac_f32_16x16x64_bf16 v[44:47], v[52:55], v[20:27], v1
  ds_read_b128 v[32:35], v2 offset:17408
  s_cbranch_vccnz L_guard1s
L_safe1s:
  s_waitcnt lgkmcnt(3)
  s_barrier
  ds_read_b128 v[8:11], v0 offset:2048
  ds_read_b128 v[12:15], v0 offset:3072
  ds_read_b128 v[16:19], v0 offset:0
  s_waitcnt lgkmcnt(5)
  v_smfmac_f32_16x16x64_bf16 v[72:75], v[52:55], v[60:67], v1
  ds_read_b128 v[36:39], v2 offset:20480
  v_smfmac_f32_16x16x64_bf16 v[48:51], v[52:55], a[200:207], v1
  ds_read_b128 v[40:43], v2 offset:21504
  s_waitcnt lgkmcnt(4)
  v_smfmac_f32_16x16x64_bf16 v[44:47], v[8:11], a[208:215], v1
  ds_read_b128 v[20:23], v2 offset:24576
  s_waitcnt lgkmcnt(4)
  v_smfmac_f32_16x16x64_bf16 v[44:47], v[12:15], a[216:223], v1
  ds_read_b128 v[24:27], v2 offset:25600
  s_waitcnt lgkmcnt(4)
  v_smfmac_f32_16x16x64_bf16 v[44:47], v[16:19], v[28:35], v1
  ds_read_b128 v[60:63], v2 offset:32768
  v_smfmac_f32_16x16x64_bf16 v[56:59], v[8:11], a[224:231], v1
  ds_read_b128 v[64:67], v2 offset:33792
  v_smfmac_f32_16x16x64_bf16 v[56:59], v[12:15], a[232:239], v1
  ds_read_b128 v[28:31], v2 offset:34816
  v_cvt_pk_bf16_f32 v44, v44, v45
  s_waitcnt lgkmcnt(5)
  v_smfmac_f32_16x16x64_bf16 v[56:59], v[16:19], v[36:43], v1
  ds_read_b128 v[32:35], v2 offset:35840
  v_cvt_pk_bf16_f32 v45, v46, v47
  v_smfmac_f32_16x16x64_bf16 v[68:71], v[8:11], a[240:247], v1
  ds_read_b128 v[36:39], v2 offset:28672
  v_bfi_b32 v44, 1, s46, v44
  v_smfmac_f32_16x16x64_bf16 v[68:71], v[12:15], a[248:255], v1
  ds_read_b128 v[40:43], v2 offset:29696
  v_cvt_pk_bf16_f32 v46, v56, v57
  s_waitcnt lgkmcnt(6)
  v_smfmac_f32_16x16x64_bf16 v[68:71], v[16:19], v[20:27], v1
  ds_read_b128 v[20:23], v2 offset:36864
  ds_read_b128 v[24:27], v2 offset:37888
  v_cvt_pk_bf16_f32 v47, v58, v59
  s_waitcnt lgkmcnt(6)
  v_smfmac_f32_16x16x64_bf16 v[72:75], v[8:11], v[60:67], v1
  ds_read_b128 v[60:63], v2 offset:38912
  ds_read_b128 v[64:67], v2 offset:39936
  v_bfi_b32 v46, 1, s46, v46
  s_waitcnt lgkmcnt(6)
  v_smfmac_f32_16x16x64_bf16 v[72:75], v[12:15], v[28:35], v1
  s_add_u32 s26, s94, 0x18000
  v_cvt_pk_bf16_f32 v68, v68, v69
  s_waitcnt lgkmcnt(4)
  v_smfmac_f32_16x16x64_bf16 v[72:75], v[16:19], v[36:43], v1
  buffer_store_dwordx4 v[44:47], v0, s[4:7], s26 offen sc1
  v_cvt_pk_bf16_f32 v69, v70, v71
  v_smfmac_f32_16x16x64_bf16 v[48:51], v[16:19], a[192:199], v1
  v_bfi_b32 v68, 1, s46, v68
  s_waitcnt lgkmcnt(2)
  v_smfmac_f32_16x16x64_bf16 v[48:51], v[8:11], v[20:27], v1
  v_cvt_pk_bf16_f32 v70, v72, v73
  s_waitcnt lgkmcnt(0)
  v_smfmac_f32_16x16x64_bf16 v[48:51], v[12:15], v[60:67], v1
  v_cvt_pk_bf16_f32 v71, v74, v75
  v_bfi_b32 v70, 1, s46, v70
  s_add_u32 s26, s94, 0x20000
  buffer_store_dwordx4 v[68:71], v0, s[4:7], s26 offen sc1
  s_nop 3
  v_cvt_pk_bf16_f32 v48, v48, v49
  v_cvt_pk_bf16_f32 v49, v50, v51
  v_bfi_b32 v48, 1, s46, v48
  s_add_u32 s26, s94, 0x10000
  buffer_store_dwordx2 v[48:49], v0, s[4:7], s26 offen offset:8 sc1
  s_add_u32 s28, s41, s66
  s_add_u32 s48, s28, 0
  s_add_u32 s49, s28, 8192
  s_add_u32 s50, s28, 16384
  s_add_u32 s51, s28, 24576
  s_cmp_ge_u32 s36, 8
  s_cbranch_scc1 L_skip1s
  s_waitcnt vmcnt(0)
  s_barrier
  buffer_load_dwordx4 v[44:47], v6, s[4:7], s48 offen sc1
  buffer_load_dwordx4 v[48:51], v6, s[4:7], s49 offen sc1
  buffer_load_dwordx4 v[52:55], v6, s[4:7], s50 offen sc1
  buffer_load_dwordx4 v[56:59], v6, s[4:7], s51 offen sc1
  s_add_u32 s37, s37, 1
  s_xor_b32 s41, s41, 0x48000
  s_add_u32 s61, s40, s60
  s_mov_b32 s26, s38
  s_mov_b32 s38, s40
  s_mov_b32 s40, s39
  s_mov_b32 s39, s26
  s_add_u32 s58, s40, 2048
  s_add_u32 s44, s44, 0x20000
  s_add_u32 s26, s40, s60
  s_mov_b32 s56, 0
  ds_read_b128 v[60:63], v2 offset:0
  ds_read_b128 v[64:67], v2 offset:1024
  ds_read_b128 v[20:23], v2 offset:2048
  ds_read_b128 v[24:27], v2 offset:3072
  ds_read_b128 v[28:31], v2 offset:12288
  ds_read_b128 v[32:35], v2 offset:13312
  ds_read_b128 v[36:39], v2 offset:14336
  ds_read_b128 v[40:43], v2 offset:15360
  v_mov_b32 v68, 0
  v_mov_b32 v69, 0
  v_mov_b32 v70, 0
  v_mov_b32 v71, 0
  v_mov_b32 v72, 0
  v_mov_b32 v73, 0
  v_mov_b32 v74, 0
  v_mov_b32 v75, 0
  v_mov_b32 v16, -1
L_rchk1s:
  s_waitcnt vmcnt(3)
  v_mfma_f32_16x16x32_bf16 v[8:11], v[44:47], v[76:79], 0
  v_bitop3_b32 v12, v44, v46, s46 bitop3:0x7e
  s_waitcnt vmcnt(2)
  v_mfma_f32_16x16x32_bf16 v[8:11], v[48:51], v[76:79], v[8:11]
  v_bitop3_b32 v13, v48, v50, s46 bitop3:0x7e
  s_waitcnt vmcnt(1)
  v_mfma_f32_16x16x32_bf16 v[8:11], v[52:55], v[76:79], v[8:11]
  v_bitop3_b32 v14, v52, v54, s46 bitop3:0x7e
  v_or3_b32 v12, v12, v13, v14
  s_waitcnt vmcnt(0)
  v_mfma_f32_16x16x32_bf16 v[8:11], v[56:59], v[76:79], v[8:11]
  v_bitop3_b32 v3, v56, v58, s46 bitop3:0x7e
  v_bitop3_b32 v3, v3, v12, 1 bitop3:0xa8
  v_cmp_ne_u32 vcc, 0, v3
  v_mov_b64 v[44:45], 0
  v_mov_b64 v[46:47], 0
  v_mov_b64 v[48:49], 0
  s_nop 1
  v_permlane32_swap_b32 v8, v10
  v_permlane32_swap_b32 v9, v11
  v_pk_add_f32 v[8:9], v[8:9], v[10:11]
  v_cvt_pk_bf16_f32 v8, v8, v9
  v_min_u32 v8, -2, v8
  s_cbranch_vccnz L_r1s
  buffer_store_dword v8, v7, s[4:7], s26 offen sc1
L_join1s:
  v_mov_b64 v[50:51], 0
  v_mov_b64 v[52:53], 0
  v_mov_b64 v[54:55], 0
  v_mov_b64 v[56:57], 0
  v_mov_b64 v[58:59], 0
  v_mov_b64 v[44:45], 0
  v_mov_b64 v[46:47], 0
  v_mov_b64 v[48:49], 0
L_end1s:
  s_branch L_top1s
L_retry1s:
  buffer_load_dwordx4 v[8:11], v0, s[4:7], s58 offen offset:1024 sc1
  buffer_load_dwordx4 v[12:15], v0, s[4:7], s58 offen offset:0 sc1
  ds_read_b128 v[60:63], v2 offset:0
  ds_read_b128 v[64:67], v2 offset:1024
  s_nop 1
  v_mov_b64 v[44:45], 0
  v_mov_b64 v[46:47], 0
  v_mov_b64 v[48:49], 0
  v_mov_b64 v[50:51], 0
  v_mov_b64 v[52:53], 0
  v_mov_b64 v[54:55], 0
  v_mov_b64 v[56:57], 0
  v_mov_b64 v[58:59], 0
  v_mov_b64 v[68:69], 0
  v_mov_b64 v[70:71], 0
  v_mov_b64 v[72:73], 0
  v_mov_b64 v[74:75], 0
  s_add_u32 s56, s56, 1
  s_cmp_lt_u32 s56, 1048576
  s_cbranch_scc1 L_chk1s
  s_branch L_fail
L_guard1s:
  s_waitcnt vmcnt(0) lgkmcnt(0)
  v_lshrrev_b32 v3, 1, v0
  buffer_load_dwordx2 v[70:71], v3, s[4:7], s27 offen sc1
  s_nop 2
  ds_read_b128 v[44:47], v0 offset:10496
  ds_read_addtid_b32 v56 offset:11520
  ds_read_b128 v[60:63], v0 offset:11776
  ds_read_b128 v[64:67], v0 offset:13056
  ds_read_b128 v[52:55], v0 offset:9216
  ds_read_addtid_b32 v57 offset:12800
  ds_read_addtid_b32 v58 offset:14080
  ds_read_addtid_b32 v59 offset:10240
  ds_read_b128 v[20:23], v0 offset:14336
  ds_read_b128 v[24:27], v0 offset:15360
  s_waitcnt lgkmcnt(7)
  v_pk_add_f32 v[44:45], v[44:45], v[60:61]
  v_pk_add_f32 v[46:47], v[46:47], v[62:63]
  s_waitcnt lgkmcnt(4)
  v_add_f32 v56, v56, v57
  v_pk_add_f32 v[44:45], v[44:45], v[64:65]
  v_pk_add_f32 v[46:47], v[46:47], v[66:67]
  s_waitcnt lgkmcnt(3)
  v_add_f32 v56, v56, v58
  v_pk_add_f32 v[44:45], v[44:45], v[52:53]
  v_pk_add_f32 v[46:47], v[46:47], v[54:55]
  s_waitcnt lgkmcnt(2)
  v_add_f32 v56, v56, v59
  v_max3_f32 v50, v44, v45, v46
  v_max3_f32 v50, v50, v47, v56
  s_nop 1
  v_max_f32_dpp v48, v50, v50 quad_perm:[2,3,0,1] row_mask:0xf bank_mask:0xf
  v_max_f32_dpp v49, v50, v50 quad_perm:[2,3,0,1] row_mask:0xf bank_mask:0xf
  s_nop 1
  v_permlane32_swap_b32 v48, v49
  v_max_f32 v50, v48, v49
  v_max_f32 v51, v48, v49
  s_nop 1
  v_permlane16_swap_b32 v50, v51
  v_max_f32 v50, v50, v51
  v_sub_f32 v44, v44, v50
  v_mul_f32 v44, s90, v44
  v_sub_f32 v45, v45, v50
  v_mul_f32 v45, s90, v45
  v_sub_f32 v46, v46, v50
  v_mul_f32 v46, s90, v46
  v_sub_f32 v47, v47, v50
  v_mul_f32 v47, s90, v47
  v_sub_f32 v56, v56, v50
  v_mul_f32 v56, s90, v56
  v_exp_f32 v44, v44
  v_exp_f32 v45, v45
  v_exp_f32 v46, v46
  v_exp_f32 v47, v47
  v_exp_f32_dpp v57, v56 quad_perm:[2,3,2,3] row_mask:0xf bank_mask:0xf
  v_exp_f32_dpp v58, v56 quad_perm:[0,1,0,1] row_mask:0xf bank_mask:0xf
  v_cvt_pk_bf16_f32 v44, v44, v45
  v_cvt_pk_bf16_f32 v45, v46, v47
  s_waitcnt lgkmcnt(1)
  v_cvt_pk_bf16_f32 v20, v57, v58
  v_cvt_pk_bf16_f32 v23, v57, v58
  v_mov_b32_dpp v16, v44 quad_perm:[2,3,2,3] row_mask:0xf bank_mask:0xf
  v_mov_b32_dpp v17, v44 quad_perm:[0,1,0,1] row_mask:0xf bank_mask:0xf
  v_mov_b32_dpp v18, v45 quad_perm:[2,3,2,3] row_mask:0xf bank_mask:0xf
  v_mov_b32_dpp v19, v45 quad_perm:[0,1,0,1] row_mask:0xf bank_mask:0xf
  s_waitcnt lgkmcnt(0)
  s_nop 0
  v_mfma_f32_16x16x32_bf16 v[48:51], v[24:27], v[16:19], 0
  v_mfma_f32_16x16x32_bf16 v[52:55], v[8:11], v[16:19], 0
  v_mfma_f32_16x16x32_bf16 v[60:63], v[12:15], v[16:19], 0
  v_mfma_f32_16x16x16_bf16 v[48:51], v[24:25], v[20:21], v[48:51]
  s_waitcnt vmcnt(0)
  v_mfma_f32_16x16x16_bf16 v[52:55], v[70:71], v[20:21], v[52:55]
  v_mfma_f32_16x16x16_bf16 v[60:63], v[70:71], v[22:23], v[60:63]
  v_rcp_f32 v3, v48
  s_add_u32 s94, s41, s47
  s_nop 1
  v_pk_mul_f32 v[52:53], v[52:53], v[2:3] op_sel:[0,1] op_sel_hi:[1,1]
  v_pk_mul_f32 v[54:55], v[54:55], v[2:3] op_sel:[0,1] op_sel_hi:[1,1]
  v_cvt_pk_bf16_f32 v52, v52, v53
  v_cvt_pk_bf16_f32 v53, v54, v55
  v_pk_mul_f32 v[60:61], v[60:61], v[2:3] op_sel:[0,1] op_sel_hi:[1,1]
  v_pk_mul_f32 v[62:63], v[62:63], v[2:3] op_sel:[0,1] op_sel_hi:[1,1]
  v_cvt_pk_bf16_f32 v54, v60, v61
  v_cvt_pk_bf16_f32 v55, v62, v63
  ds_write_b128 v0, v[52:55] offset:1024
  ds_read_b128 v[44:47], v0 offset:14336
  ds_read_b128 v[56:59], v0 offset:14336
  ds_read_b128 v[68:71], v0 offset:14336
  ds_read_b128 v[72:75], v0 offset:14336
  ds_read_b128 v[48:51], v0 offset:14336
  ds_read_b128 v[20:23], v2 offset:18432
  ds_read_b128 v[24:27], v2 offset:19456
  ds_read_b128 v[28:31], v2 offset:22528
  ds_read_b128 v[32:35], v2 offset:23552
  ds_read_b128 v[36:39], v2 offset:26624
  ds_read_b128 v[40:43], v2 offset:27648
  ds_read_b128 v[60:63], v2 offset:30720
  ds_read_b128 v[64:67], v2 offset:31744
  s_waitcnt lgkmcnt(4)
  v_smfmac_f32_16x16x64_bf16 v[56:59], v[52:55], v[28:35], v1
  s_waitcnt lgkmcnt(2)
  v_smfmac_f32_16x16x64_bf16 v[68:71], v[52:55], v[36:43], v1
  v_smfmac_f32_16x16x64_bf16 v[44:47], v[52:55], v[20:27], v1
  ds_read_b128 v[28:31], v2 offset:16384
  ds_read_b128 v[32:35], v2 offset:17408
  s_waitcnt vmcnt(0) lgkmcnt(0)
  s_branch L_safe1s
L_skip1s:
  s_add_u32 s37, s37, 1
  s_xor_b32 s41, s41, 0x48000
  s_add_u32 s61, s40, s60
  s_mov_b32 s26, s38
  s_mov_b32 s38, s40
  s_mov_b32 s40, s39
  s_mov_b32 s39, s26
  s_add_u32 s58, s40, 2048
  s_add_u32 s44, s44, 0x20000
  s_add_u32 s26, s40, s60
  s_mov_b32 s56, 0
  ds_read_b128 v[60:63], v2 offset:0
  ds_read_b128 v[64:67], v2 offset:1024
  ds_read_b128 v[20:23], v2 offset:2048
  ds_read_b128 v[24:27], v2 offset:3072
  ds_read_b128 v[28:31], v2 offset:12288
  ds_read_b128 v[32:35], v2 offset:13312
  ds_read_b128 v[36:39], v2 offset:14336
  ds_read_b128 v[40:43], v2 offset:15360
  v_mov_b32 v68, 0
  v_mov_b32 v69, 0
  v_mov_b32 v70, 0
  v_mov_b32 v71, 0
  v_mov_b32 v72, 0
  v_mov_b32 v73, 0
  v_mov_b32 v74, 0
  v_mov_b32 v75, 0
  v_mov_b32 v16, -1
  s_waitcnt vmcnt(0)
  s_barrier
  s_branch L_join1s
L_r1s:
  buffer_load_dwordx4 v[44:47], v6, s[4:7], s48 offen sc1
  buffer_load_dwordx4 v[48:51], v6, s[4:7], s49 offen sc1
  buffer_load_dwordx4 v[52:55], v6, s[4:7], s50 offen sc1
  buffer_load_dwordx4 v[56:59], v6, s[4:7], s51 offen sc1
  s_add_u32 s56, s56, 1
  s_cmp_lt_u32 s56, 1048576
  s_cbranch_scc1 L_rchk1s
  s_branch L_fail
L_last1s:
  s_waitcnt vmcnt(0)
  s_barrier
  s_branch L_exit
L_recw2:
  v_add_u32 v2, 98304, v0
  v_lshrrev_b32 v20, 4, v1
  v_lshlrev_b32 v21, 13, v20
  v_and_b32 v20, 1, v20
  v_lshlrev_b32 v20, 6, v20
  v_and_b32 v22, 0xf0, v0
  v_xor_b32 v20, v20, v22
  s_lshl_b32 s27, s36, 8
  v_add3_u32 v8, v20, v21, s27
  v_xor_b32 v9, 0x80, v8
  s_mul_i32 s27, s36, 147456
  v_lshrrev_b32 v20, 3, v1
  v_mul_u32_u24 v20, 1152, v20
  v_and_b32 v21, 0x70, v0
  v_add3_u32 v10, v20, v21, s27
  v_lshrrev_b32 v20, 2, v1
  v_mul_u32_u24 v20, 1152, v20
  v_and_b32 v21, 0x30, v0
  v_add3_u32 v11, v20, v21, s27
  v_bfe_u32 v20, v1, 2, 2
  v_and_b32 v21, 1, v1
  v_lshl_add_u32 v20, v20, 1, v21
  v_mul_u32_u24 v20, 1152, v20
  v_lshrrev_b32 v21, 4, v1
  v_lshl_add_u32 v20, v21, 5, v20
  v_bfe_u32 v21, v1, 1, 1
  v_lshl_add_u32 v20, v21, 4, v20
  buffer_load_dwordx4 v[64:67], v20, s[84:87], 0 offen offset:640
  buffer_load_dwordx4 v[68:71], v20, s[84:87], 0 offen offset:512
  s_mov_b32 m0, 0x1c000
  s_mov_b32 s27, 0x280
  buffer_load_dwordx4 v10, s[52:55], s27 offen  lds
  s_mov_b32 m0, 0x1c400
  s_mov_b32 s27, 0x2680
  buffer_load_dwordx4 v10, s[52:55], s27 offen  lds
  s_mov_b32 m0, 0x1c800
  s_mov_b32 s27, 0x4a80
  buffer_load_dwordx4 v10, s[52:55], s27 offen  lds
  s_mov_b32 m0, 0x1cc00
  s_mov_b32 s27, 0x6e80
  buffer_load_dwordx4 v10, s[52:55], s27 offen  lds
  s_mov_b32 m0, 0x1d000
  s_mov_b32 s27, 0x9280
  buffer_load_dwordx4 v10, s[52:55], s27 offen  lds
  s_mov_b32 m0, 0x1d400
  s_mov_b32 s27, 0xb680
  buffer_load_dwordx4 v10, s[52:55], s27 offen  lds
  s_mov_b32 m0, 0x1d800
  s_mov_b32 s27, 0xda80
  buffer_load_dwordx4 v10, s[52:55], s27 offen  lds
  s_mov_b32 m0, 0x1dc00
  s_mov_b32 s27, 0xfe80
  buffer_load_dwordx4 v10, s[52:55], s27 offen  lds
  s_mov_b32 m0, 0x1e000
  s_mov_b32 s27, 0x300
  buffer_load_dwordx4 v10, s[52:55], s27 offen  lds
  s_mov_b32 m0, 0x1e400
  s_mov_b32 s27, 0x2700
  buffer_load_dwordx4 v10, s[52:55], s27 offen  lds
  s_mov_b32 m0, 0x1e800
  s_mov_b32 s27, 0x4b00
  buffer_load_dwordx4 v10, s[52:55], s27 offen  lds
  s_mov_b32 m0, 0x1ec00
  s_mov_b32 s27, 0x6f00
  buffer_load_dwordx4 v10, s[52:55], s27 offen  lds
  s_mov_b32 m0, 0x1f000
  s_mov_b32 s27, 0x9300
  buffer_load_dwordx4 v10, s[52:55], s27 offen  lds
  s_mov_b32 m0, 0x1f400
  s_mov_b32 s27, 0xb700
  buffer_load_dwordx4 v10, s[52:55], s27 offen  lds
  s_mov_b32 m0, 0x1f800
  s_mov_b32 s27, 0xdb00
  buffer_load_dwordx4 v10, s[52:55], s27 offen  lds
  s_mov_b32 m0, 0x1fc00
  s_mov_b32 s27, 0xff00
  buffer_load_dwordx4 v10, s[52:55], s27 offen  lds
  s_mov_b32 m0, 0x18000
  s_mov_b32 s27, 0x40000
  buffer_load_dwordx4 v8, s[16:19], s27 offen  lds
  s_mov_b32 m0, 0x18400
  s_mov_b32 s27, 0x48000
  buffer_load_dwordx4 v8, s[16:19], s27 offen  lds
  s_mov_b32 m0, 0x18800
  s_mov_b32 s27, 0x50000
  buffer_load_dwordx4 v9, s[16:19], s27 offen  lds
  s_mov_b32 m0, 0x18c00
  s_mov_b32 s27, 0x58000
  buffer_load_dwordx4 v9, s[16:19], s27 offen  lds
  s_mov_b32 m0, 0x19000
  s_mov_b32 s27, 0xc0000
  buffer_load_dwordx4 v8, s[16:19], s27 offen  lds
  s_mov_b32 m0, 0x19400
  s_mov_b32 s27, 0xc8000
  buffer_load_dwordx4 v8, s[16:19], s27 offen  lds
  s_mov_b32 m0, 0x19800
  s_mov_b32 s27, 0xd0000
  buffer_load_dwordx4 v9, s[16:19], s27 offen  lds
  s_mov_b32 m0, 0x19c00
  s_mov_b32 s27, 0xd8000
  buffer_load_dwordx4 v9, s[16:19], s27 offen  lds
  s_mov_b32 m0, 0x1a000
  s_mov_b32 s27, 0x140000
  buffer_load_dwordx4 v8, s[16:19], s27 offen  lds
  s_mov_b32 m0, 0x1a400
  s_mov_b32 s27, 0x148000
  buffer_load_dwordx4 v8, s[16:19], s27 offen  lds
  s_mov_b32 m0, 0x1a800
  s_mov_b32 s27, 0x150000
  buffer_load_dwordx4 v9, s[16:19], s27 offen  lds
  s_mov_b32 m0, 0x1ac00
  s_mov_b32 s27, 0x158000
  buffer_load_dwordx4 v9, s[16:19], s27 offen  lds
  s_mov_b32 m0, 0x1b000
  s_mov_b32 s27, 0x1c0000
  buffer_load_dwordx4 v8, s[16:19], s27 offen  lds
  s_mov_b32 m0, 0x1b400
  s_mov_b32 s27, 0x1c8000
  buffer_load_dwordx4 v8, s[16:19], s27 offen  lds
  s_mov_b32 m0, 0x1b800
  s_mov_b32 s27, 0x1d0000
  buffer_load_dwordx4 v9, s[16:19], s27 offen  lds
  s_mov_b32 m0, 0x1bc00
  s_mov_b32 s27, 0x1d8000
  buffer_load_dwordx4 v9, s[16:19], s27 offen  lds
  v_bfe_u32 v20, v1, 4, 1
  v_lshlrev_b32 v20, 10, v20
  v_bfe_u32 v21, v1, 3, 1
  v_lshl_add_u32 v20, v21, 11, v20
  v_bfe_u32 v22, v1, 2, 1
  v_lshl_add_u32 v20, v22, 8, v20
  v_bfe_u32 v23, v1, 2, 2
  v_xor_b32 v23, 2, v23
  v_lshl_add_u32 v20, v23, 6, v20
  v_bfe_u32 v23, v1, 5, 1
  v_and_b32 v24, 3, v1
  v_mul_u32_u24 v25, 40960, v23
  v_add_u32 v25, 16384, v25
  v_add_u32 v25, v25, v20
  v_lshl_add_u32 v12, v24, 4, v25
  v_lshl_add_u32 v14, v24, 3, v25
  v_mul_u32_u24 v25, 32768, v23
  v_add_u32 v25, 98304, v25
  v_add_u32 v25, v25, v20
  v_lshl_add_u32 v13, v24, 4, v25
  v_lshl_add_u32 v15, v24, 3, v25
  v_and_b32 v20, 16, v1
  v_lshl_add_u32 v20, v23, 2, v20
  v_add_u32 v20, v20, v22
  v_lshlrev_b32 v25, 5, v21
  v_lshl_add_u32 v25, v24, 3, v25
  v_add_u32 v25, 98304, v25
  v_lshl_add_u32 v16, v20, 7, v25
  v_lshl_add_u32 v17, v20, 6, v25
  v_and_b32 v24, 15, v1
  v_lshrrev_b32 v25, 4, v1
  v_lshlrev_b32 v26, 2, v25
  v_sub_u32 v27, v24, v26
  v_mov_b32 v28, 0x3f80
  v_cmp_eq_u32 vcc, 0, v27
  s_nop 1
  v_cndmask_b32 v4, 0, v28, vcc
  v_mov_b32 v28, 0x3f800000
  v_cmp_eq_u32 vcc, 1, v27
  s_nop 1
  v_cndmask_b32 v4, v4, v28, vcc
  v_mov_b32 v28, 0x3f80
  v_cmp_eq_u32 vcc, 2, v27
  s_nop 1
  v_cndmask_b32 v5, 0, v28, vcc
  v_mov_b32 v28, 0x3f800000
  v_cmp_eq_u32 vcc, 3, v27
  s_nop 1
  v_cndmask_b32 v5, v5, v28, vcc
  v_and_b32 v6, 0x380, v0
  v_and_b32 v26, 0x70, v0
  v_lshl_add_u32 v6, v6, 3, v26
  v_bfe_u32 v7, v1, 4, 1
  v_bfe_u32 v26, v1, 5, 1
  v_lshl_add_u32 v7, v7, 1, v26
  v_and_b32 v26, 0x10, v0
  v_lshl_add_u32 v7, v7, 2, v26
  v_and_b32 v26, 0x60, v0
  v_lshl_add_u32 v7, v26, 3, v7
  v_and_b32 v26, 0x80, v0
  v_lshl_add_u32 v7, v26, 23, v7
  v_and_b32 v26, 0x10, v0
  v_mov_b32 v28, 0x3f80
  v_lshlrev_b32 v28, v26, v28
  v_lshrrev_b32 v26, 1, v24
  v_cmp_eq_u32 vcc, 0, v26
  s_nop 1
  v_cndmask_b32 v76, 0, v28, vcc
  v_cmp_eq_u32 vcc, 1, v26
  s_nop 1
  v_cndmask_b32 v77, 0, v28, vcc
  v_cmp_eq_u32 vcc, 2, v26
  s_nop 1
  v_cndmask_b32 v78, 0, v28, vcc
  v_cmp_eq_u32 vcc, 3, v26
  s_nop 1
  v_cndmask_b32 v79, 0, v28, vcc
  s_mov_b32 s62, 0xcccccccc
  s_mov_b32 s63, 0xcccccccc
  s_mov_b32 s64, 0x3f803f80
  s_mov_b32 s65, 0x3f803f80
  s_mov_b32 s90, 0x3e0293ee
  s_mov_b32 s91, 0x3e0293ee
  v_mov_b32 v27, 0x44444444
  v_mov_b32 v28, 0xeeeeeeee
  v_cndmask_b32 v1, v27, v28, s[62:63]
  s_mov_b32 s37, 0
  s_mov_b32 s41, 0x110000
  s_mov_b32 s46, 0
  s_mov_b32 s40, 0x100000
  s_mov_b32 s39, 0x104000
  s_mov_b32 s38, 0x108000
  s_lshl_b32 s26, s36, 13
  s_add_u32 s42, s26, 0x2000800
  s_add_u32 s43, s26, 0x3001000
  s_lshl_b32 s26, s36, 12
  s_add_u32 s44, s26, 0x4000800
  s_lshl_b32 s47, s36, 10
  s_add_u32 s26, s36, 0
  s_lshr_b32 s27, s26, 3
  s_and_b32 s28, s26, 7
  s_lshl_b32 s66, s27, 15
  s_lshl_b32 s29, s28, 7
  s_add_u32 s66, s66, s29
  s_lshl_b32 s60, s27, 10
  s_lshl_b32 s29, s28, 5
  s_add_u32 s60, s60, s29
  s_mov_b32 s61, 0x40000000
  s_lshr_b32 s26, s36, 1
  s_lshl_b32 s26, s26, 9
  s_and_b32 s27, s36, 1
  s_lshl_b32 s28, s27, 1
  s_lshl_b32 s92, 0x330, s28
  s_mov_b32 s93, 0
  s_add_u32 s57, s26, 0x84000
  s_lshl_b32 s27, s27, 4
  s_add_u32 s45, s26, s27
  s_add_u32 s45, s45, 0x7e0c0
  s_waitcnt vmcnt(24)
  ds_read_b64_tr_b16 a[192:193], v16 offset:16384
  ds_read_b64_tr_b16 a[194:195], v16 offset:16640
  ds_read_b64_tr_b16 a[196:197], v16 offset:17408
  ds_read_b64_tr_b16 a[198:199], v16 offset:17664
  ds_read_b64_tr_b16 a[200:201], v16 offset:20480
  ds_read_b64_tr_b16 a[202:203], v16 offset:20736
  ds_read_b64_tr_b16 a[204:205], v16 offset:21504
  ds_read_b64_tr_b16 a[206:207], v16 offset:21760
  ds_read_b64_tr_b16 a[208:209], v16 offset:16448
  ds_read_b64_tr_b16 a[210:211], v16 offset:16704
  ds_read_b64_tr_b16 a[212:213], v16 offset:17472
  ds_read_b64_tr_b16 a[214:215], v16 offset:17728
  ds_read_b64_tr_b16 a[216:217], v16 offset:20544
  ds_read_b64_tr_b16 a[218:219], v16 offset:20800
  ds_read_b64_tr_b16 a[220:221], v16 offset:21568
  ds_read_b64_tr_b16 a[222:223], v16 offset:21824
  s_waitcnt vmcnt(16)
  ds_read_b64_tr_b16 a[224:225], v16 offset:24576
  ds_read_b64_tr_b16 a[226:227], v16 offset:24832
  ds_read_b64_tr_b16 a[228:229], v16 offset:25600
  ds_read_b64_tr_b16 a[230:231], v16 offset:25856
  ds_read_b64_tr_b16 a[232:233], v16 offset:28672
  ds_read_b64_tr_b16 a[234:235], v16 offset:28928
  ds_read_b64_tr_b16 a[236:237], v16 offset:29696
  ds_read_b64_tr_b16 a[238:239], v16 offset:29952
  ds_read_b64_tr_b16 a[240:241], v16 offset:24640
  ds_read_b64_tr_b16 a[242:243], v16 offset:24896
  ds_read_b64_tr_b16 a[244:245], v16 offset:25664
  ds_read_b64_tr_b16 a[246:247], v16 offset:25920
  ds_read_b64_tr_b16 a[248:249], v16 offset:28736
  ds_read_b64_tr_b16 a[250:251], v16 offset:28992
  ds_read_b64_tr_b16 a[252:253], v16 offset:29760
  ds_read_b64_tr_b16 a[254:255], v16 offset:30016
  s_waitcnt lgkmcnt(0)
  s_mov_b32 m0, 0x1c000
  s_mov_b32 s27, 0x240000
  buffer_load_dwordx4 v8, s[16:19], s27 offen  lds
  s_mov_b32 m0, 0x1c400
  s_mov_b32 s27, 0x248000
  buffer_load_dwordx4 v8, s[16:19], s27 offen  lds
  s_mov_b32 m0, 0x1c800
  s_mov_b32 s27, 0x250000
  buffer_load_dwordx4 v9, s[16:19], s27 offen  lds
  s_mov_b32 m0, 0x1cc00
  s_mov_b32 s27, 0x258000
  buffer_load_dwordx4 v9, s[16:19], s27 offen  lds
  s_mov_b32 m0, 0x1d000
  s_mov_b32 s27, 0x2c0000
  buffer_load_dwordx4 v8, s[16:19], s27 offen  lds
  s_mov_b32 m0, 0x1d400
  s_mov_b32 s27, 0x2c8000
  buffer_load_dwordx4 v8, s[16:19], s27 offen  lds
  s_mov_b32 m0, 0x1d800
  s_mov_b32 s27, 0x2d0000
  buffer_load_dwordx4 v9, s[16:19], s27 offen  lds
  s_mov_b32 m0, 0x1dc00
  s_mov_b32 s27, 0x2d8000
  buffer_load_dwordx4 v9, s[16:19], s27 offen  lds
  s_mov_b32 m0, 0x1e000
  s_mov_b32 s27, 0x340000
  buffer_load_dwordx4 v8, s[16:19], s27 offen  lds
  s_mov_b32 m0, 0x1e400
  s_mov_b32 s27, 0x348000
  buffer_load_dwordx4 v8, s[16:19], s27 offen  lds
  s_mov_b32 m0, 0x1e800
  s_mov_b32 s27, 0x350000
  buffer_load_dwordx4 v9, s[16:19], s27 offen  lds
  s_mov_b32 m0, 0x1ec00
  s_mov_b32 s27, 0x358000
  buffer_load_dwordx4 v9, s[16:19], s27 offen  lds
  s_mov_b32 m0, 0x1f000
  s_mov_b32 s27, 0x3c0000
  buffer_load_dwordx4 v8, s[16:19], s27 offen  lds
  s_mov_b32 m0, 0x1f400
  s_mov_b32 s27, 0x3c8000
  buffer_load_dwordx4 v8, s[16:19], s27 offen  lds
  s_mov_b32 m0, 0x1f800
  s_mov_b32 s27, 0x3d0000
  buffer_load_dwordx4 v9, s[16:19], s27 offen  lds
  s_mov_b32 m0, 0x1fc00
  s_mov_b32 s27, 0x3d8000
  buffer_load_dwordx4 v9, s[16:19], s27 offen  lds
  s_waitcnt vmcnt(28)
  s_waitcnt lgkmcnt(0)
  s_barrier
  ds_read_b64_tr_b16 a[96:97], v14 offset:0
  ds_read_b64_tr_b16 a[98:99], v14 offset:512
  ds_read_b64_tr_b16 a[100:101], v15 offset:0
  ds_read_b64_tr_b16 a[102:103], v15 offset:512
  ds_read_b64_tr_b16 a[104:105], v14 offset:32
  ds_read_b64_tr_b16 a[106:107], v14 offset:544
  ds_read_b64_tr_b16 a[108:109], v15 offset:32
  ds_read_b64_tr_b16 a[110:111], v15 offset:544
  s_waitcnt vmcnt(24)
  s_waitcnt lgkmcnt(0)
  s_barrier
  s_mov_b32 m0, 0x18000
  s_mov_b32 s27, 0x440000
  buffer_load_dwordx4 v8, s[16:19], s27 offen  lds
  s_mov_b32 m0, 0x18400
  s_mov_b32 s27, 0x448000
  buffer_load_dwordx4 v8, s[16:19], s27 offen  lds
  s_mov_b32 m0, 0x18800
  s_mov_b32 s27, 0x450000
  buffer_load_dwordx4 v9, s[16:19], s27 offen  lds
  s_mov_b32 m0, 0x18c00
  s_mov_b32 s27, 0x458000
  buffer_load_dwordx4 v9, s[16:19], s27 offen  lds
  ds_read_b64_tr_b16 a[112:113], v14 offset:4096
  ds_read_b64_tr_b16 a[114:115], v14 offset:4608
  ds_read_b64_tr_b16 a[116:117], v15 offset:4096
  ds_read_b64_tr_b16 a[118:119], v15 offset:4608
  ds_read_b64_tr_b16 a[120:121], v14 offset:4128
  ds_read_b64_tr_b16 a[122:123], v14 offset:4640
  ds_read_b64_tr_b16 a[124:125], v15 offset:4128
  ds_read_b64_tr_b16 a[126:127], v15 offset:4640
  s_waitcnt vmcnt(24)
  s_waitcnt lgkmcnt(0)
  s_barrier
  s_mov_b32 m0, 0x19000
  s_mov_b32 s27, 0x40000
  buffer_load_dwordx4 v8, s[8:11], s27 offen  lds
  s_mov_b32 m0, 0x19400
  s_mov_b32 s27, 0x48000
  buffer_load_dwordx4 v8, s[8:11], s27 offen  lds
  s_mov_b32 m0, 0x19800
  s_mov_b32 s27, 0x50000
  buffer_load_dwordx4 v9, s[8:11], s27 offen  lds
  s_mov_b32 m0, 0x19c00
  s_mov_b32 s27, 0x58000
  buffer_load_dwordx4 v9, s[8:11], s27 offen  lds
  ds_read_b64_tr_b16 a[128:129], v14 offset:8192
  ds_read_b64_tr_b16 a[130:131], v14 offset:8704
  ds_read_b64_tr_b16 a[132:133], v15 offset:8192
  ds_read_b64_tr_b16 a[134:135], v15 offset:8704
  ds_read_b64_tr_b16 a[136:137], v14 offset:8224
  ds_read_b64_tr_b16 a[138:139], v14 offset:8736
  ds_read_b64_tr_b16 a[140:141], v15 offset:8224
  ds_read_b64_tr_b16 a[142:143], v15 offset:8736
  s_waitcnt vmcnt(24)
  s_waitcnt lgkmcnt(0)
  s_barrier
  s_mov_b32 m0, 0x1a000
  s_mov_b32 s27, 0xc0000
  buffer_load_dwordx4 v8, s[8:11], s27 offen  lds
  s_mov_b32 m0, 0x1a400
  s_mov_b32 s27, 0xc8000
  buffer_load_dwordx4 v8, s[8:11], s27 offen  lds
  s_mov_b32 m0, 0x1a800
  s_mov_b32 s27, 0xd0000
  buffer_load_dwordx4 v9, s[8:11], s27 offen  lds
  s_mov_b32 m0, 0x1ac00
  s_mov_b32 s27, 0xd8000
  buffer_load_dwordx4 v9, s[8:11], s27 offen  lds
  ds_read_b64_tr_b16 a[144:145], v14 offset:12288
  ds_read_b64_tr_b16 a[146:147], v14 offset:12800
  ds_read_b64_tr_b16 a[148:149], v15 offset:12288
  ds_read_b64_tr_b16 a[150:151], v15 offset:12800
  ds_read_b64_tr_b16 a[152:153], v14 offset:12320
  ds_read_b64_tr_b16 a[154:155], v14 offset:12832
  ds_read_b64_tr_b16 a[156:157], v15 offset:12320
  ds_read_b64_tr_b16 a[158:159], v15 offset:12832
  s_waitcnt vmcnt(24)
  s_waitcnt lgkmcnt(0)
  s_barrier
  s_mov_b32 m0, 0x1b000
  s_mov_b32 s27, 0x140000
  buffer_load_dwordx4 v8, s[8:11], s27 offen  lds
  s_mov_b32 m0, 0x1b400
  s_mov_b32 s27, 0x148000
  buffer_load_dwordx4 v8, s[8:11], s27 offen  lds
  s_mov_b32 m0, 0x1b800
  s_mov_b32 s27, 0x150000
  buffer_load_dwordx4 v9, s[8:11], s27 offen  lds
  s_mov_b32 m0, 0x1bc00
  s_mov_b32 s27, 0x158000
  buffer_load_dwordx4 v9, s[8:11], s27 offen  lds
  ds_read_b64_tr_b16 a[64:65], v14 offset:16384
  ds_read_b64_tr_b16 a[66:67], v14 offset:16896
  ds_read_b64_tr_b16 a[68:69], v15 offset:16384
  ds_read_b64_tr_b16 a[70:71], v15 offset:16896
  ds_read_b64_tr_b16 a[72:73], v14 offset:16416
  ds_read_b64_tr_b16 a[74:75], v14 offset:16928
  ds_read_b64_tr_b16 a[76:77], v15 offset:16416
  ds_read_b64_tr_b16 a[78:79], v15 offset:16928
  s_waitcnt vmcnt(24)
  s_waitcnt lgkmcnt(0)
  s_barrier
  s_mov_b32 m0, 0x1c000
  s_mov_b32 s27, 0x1c0000
  buffer_load_dwordx4 v8, s[8:11], s27 offen  lds
  s_mov_b32 m0, 0x1c400
  s_mov_b32 s27, 0x1c8000
  buffer_load_dwordx4 v8, s[8:11], s27 offen  lds
  s_mov_b32 m0, 0x1c800
  s_mov_b32 s27, 0x1d0000
  buffer_load_dwordx4 v9, s[8:11], s27 offen  lds
  s_mov_b32 m0, 0x1cc00
  s_mov_b32 s27, 0x1d8000
  buffer_load_dwordx4 v9, s[8:11], s27 offen  lds
  ds_read_b64_tr_b16 a[48:49], v14 offset:20480
  ds_read_b64_tr_b16 a[50:51], v14 offset:20992
  ds_read_b64_tr_b16 a[52:53], v15 offset:20480
  ds_read_b64_tr_b16 a[54:55], v15 offset:20992
  ds_read_b64_tr_b16 a[56:57], v14 offset:20512
  ds_read_b64_tr_b16 a[58:59], v14 offset:21024
  ds_read_b64_tr_b16 a[60:61], v15 offset:20512
  ds_read_b64_tr_b16 a[62:63], v15 offset:21024
  s_waitcnt vmcnt(24)
  s_waitcnt lgkmcnt(0)
  s_barrier
  s_mov_b32 m0, 0x1d000
  s_mov_b32 s27, 0x240000
  buffer_load_dwordx4 v8, s[8:11], s27 offen  lds
  s_mov_b32 m0, 0x1d400
  s_mov_b32 s27, 0x248000
  buffer_load_dwordx4 v8, s[8:11], s27 offen  lds
  s_mov_b32 m0, 0x1d800
  s_mov_b32 s27, 0x250000
  buffer_load_dwordx4 v9, s[8:11], s27 offen  lds
  s_mov_b32 m0, 0x1dc00
  s_mov_b32 s27, 0x258000
  buffer_load_dwordx4 v9, s[8:11], s27 offen  lds
  ds_read_b64_tr_b16 a[160:161], v14 offset:24576
  ds_read_b64_tr_b16 a[162:163], v14 offset:25088
  ds_read_b64_tr_b16 a[164:165], v15 offset:24576
  ds_read_b64_tr_b16 a[166:167], v15 offset:25088
  ds_read_b64_tr_b16 a[168:169], v14 offset:24608
  ds_read_b64_tr_b16 a[170:171], v14 offset:25120
  ds_read_b64_tr_b16 a[172:173], v15 offset:24608
  ds_read_b64_tr_b16 a[174:175], v15 offset:25120
  s_waitcnt vmcnt(24)
  s_waitcnt lgkmcnt(0)
  s_barrier
  s_mov_b32 m0, 0x1e000
  s_mov_b32 s27, 0x2c0000
  buffer_load_dwordx4 v8, s[8:11], s27 offen  lds
  s_mov_b32 m0, 0x1e400
  s_mov_b32 s27, 0x2c8000
  buffer_load_dwordx4 v8, s[8:11], s27 offen  lds
  s_mov_b32 m0, 0x1e800
  s_mov_b32 s27, 0x2d0000
  buffer_load_dwordx4 v9, s[8:11], s27 offen  lds
  s_mov_b32 m0, 0x1ec00
  s_mov_b32 s27, 0x2d8000
  buffer_load_dwordx4 v9, s[8:11], s27 offen  lds
  ds_read_b64_tr_b16 a[176:177], v14 offset:28672
  ds_read_b64_tr_b16 a[178:179], v14 offset:29184
  ds_read_b64_tr_b16 a[180:181], v15 offset:28672
  ds_read_b64_tr_b16 a[182:183], v15 offset:29184
  ds_read_b64_tr_b16 a[184:185], v14 offset:28704
  ds_read_b64_tr_b16 a[186:187], v14 offset:29216
  ds_read_b64_tr_b16 a[188:189], v15 offset:28704
  ds_read_b64_tr_b16 a[190:191], v15 offset:29216
  s_waitcnt vmcnt(24)
  s_waitcnt lgkmcnt(0)
  s_barrier
  s_mov_b32 m0, 0x1f000
  s_mov_b32 s27, 0x340000
  buffer_load_dwordx4 v8, s[8:11], s27 offen  lds
  s_mov_b32 m0, 0x1f400
  s_mov_b32 s27, 0x348000
  buffer_load_dwordx4 v8, s[8:11], s27 offen  lds
  s_mov_b32 m0, 0x1f800
  s_mov_b32 s27, 0x350000
  buffer_load_dwordx4 v9, s[8:11], s27 offen  lds
  s_mov_b32 m0, 0x1fc00
  s_mov_b32 s27, 0x358000
  buffer_load_dwordx4 v9, s[8:11], s27 offen  lds
  ds_read_b64_tr_b16 a[80:81], v14 offset:0
  ds_read_b64_tr_b16 a[82:83], v14 offset:512
  ds_read_b64_tr_b16 a[84:85], v15 offset:0
  ds_read_b64_tr_b16 a[86:87], v15 offset:512
  ds_read_b64_tr_b16 a[88:89], v14 offset:32
  ds_read_b64_tr_b16 a[90:91], v14 offset:544
  ds_read_b64_tr_b16 a[92:93], v15 offset:32
  ds_read_b64_tr_b16 a[94:95], v15 offset:544
  s_waitcnt vmcnt(24)
  s_waitcnt lgkmcnt(0)
  s_barrier
  s_mov_b32 m0, 0x18000
  s_mov_b32 s27, 0x3c0000
  buffer_load_dwordx4 v8, s[8:11], s27 offen  lds
  s_mov_b32 m0, 0x18400
  s_mov_b32 s27, 0x3c8000
  buffer_load_dwordx4 v8, s[8:11], s27 offen  lds
  s_mov_b32 m0, 0x18800
  s_mov_b32 s27, 0x3d0000
  buffer_load_dwordx4 v9, s[8:11], s27 offen  lds
  s_mov_b32 m0, 0x18c00
  s_mov_b32 s27, 0x3d8000
  buffer_load_dwordx4 v9, s[8:11], s27 offen  lds
  ds_read_b64_tr_b16 v[112:113], v12 offset:4096
  ds_read_b64_tr_b16 v[114:115], v12 offset:4608
  ds_read_b64_tr_b16 v[116:117], v13 offset:4096
  ds_read_b64_tr_b16 v[118:119], v13 offset:4608
  ds_read_b64_tr_b16 v[120:121], v12 offset:4104
  ds_read_b64_tr_b16 v[122:123], v12 offset:4616
  ds_read_b64_tr_b16 v[124:125], v13 offset:4104
  ds_read_b64_tr_b16 v[126:127], v13 offset:4616
  s_waitcnt vmcnt(24)
  s_waitcnt lgkmcnt(0)
  s_barrier
  s_mov_b32 m0, 0x19000
  s_mov_b32 s27, 0x40000
  buffer_load_dwordx4 v8, s[12:15], s27 offen  lds
  s_mov_b32 m0, 0x19400
  s_mov_b32 s27, 0x48000
  buffer_load_dwordx4 v8, s[12:15], s27 offen  lds
  s_mov_b32 m0, 0x19800
  s_mov_b32 s27, 0x50000
  buffer_load_dwordx4 v9, s[12:15], s27 offen  lds
  s_mov_b32 m0, 0x19c00
  s_mov_b32 s27, 0x58000
  buffer_load_dwordx4 v9, s[12:15], s27 offen  lds
  ds_read_b64_tr_b16 v[128:129], v12 offset:8192
  ds_read_b64_tr_b16 v[130:131], v12 offset:8704
  ds_read_b64_tr_b16 v[132:133], v13 offset:8192
  ds_read_b64_tr_b16 v[134:135], v13 offset:8704
  ds_read_b64_tr_b16 v[136:137], v12 offset:8200
  ds_read_b64_tr_b16 v[138:139], v12 offset:8712
  ds_read_b64_tr_b16 v[140:141], v13 offset:8200
  ds_read_b64_tr_b16 v[142:143], v13 offset:8712
  s_waitcnt vmcnt(24)
  s_waitcnt lgkmcnt(0)
  s_barrier
  s_mov_b32 m0, 0x1a000
  s_mov_b32 s27, 0xc0000
  buffer_load_dwordx4 v8, s[12:15], s27 offen  lds
  s_mov_b32 m0, 0x1a400
  s_mov_b32 s27, 0xc8000
  buffer_load_dwordx4 v8, s[12:15], s27 offen  lds
  s_mov_b32 m0, 0x1a800
  s_mov_b32 s27, 0xd0000
  buffer_load_dwordx4 v9, s[12:15], s27 offen  lds
  s_mov_b32 m0, 0x1ac00
  s_mov_b32 s27, 0xd8000
  buffer_load_dwordx4 v9, s[12:15], s27 offen  lds
  ds_read_b64_tr_b16 v[144:145], v12 offset:12288
  ds_read_b64_tr_b16 v[146:147], v12 offset:12800
  ds_read_b64_tr_b16 v[148:149], v13 offset:12288
  ds_read_b64_tr_b16 v[150:151], v13 offset:12800
  ds_read_b64_tr_b16 v[152:153], v12 offset:12296
  ds_read_b64_tr_b16 v[154:155], v12 offset:12808
  ds_read_b64_tr_b16 v[156:157], v13 offset:12296
  ds_read_b64_tr_b16 v[158:159], v13 offset:12808
  s_waitcnt vmcnt(24)
  s_waitcnt lgkmcnt(0)
  s_barrier
  s_mov_b32 m0, 0x1b000
  s_mov_b32 s27, 0x140000
  buffer_load_dwordx4 v8, s[12:15], s27 offen  lds
  s_mov_b32 m0, 0x1b400
  s_mov_b32 s27, 0x148000
  buffer_load_dwordx4 v8, s[12:15], s27 offen  lds
  s_mov_b32 m0, 0x1b800
  s_mov_b32 s27, 0x150000
  buffer_load_dwordx4 v9, s[12:15], s27 offen  lds
  s_mov_b32 m0, 0x1bc00
  s_mov_b32 s27, 0x158000
  buffer_load_dwordx4 v9, s[12:15], s27 offen  lds
  ds_read_b64_tr_b16 v[160:161], v12 offset:16384
  ds_read_b64_tr_b16 v[162:163], v12 offset:16896
  ds_read_b64_tr_b16 v[164:165], v13 offset:16384
  ds_read_b64_tr_b16 v[166:167], v13 offset:16896
  ds_read_b64_tr_b16 v[168:169], v12 offset:16392
  ds_read_b64_tr_b16 v[170:171], v12 offset:16904
  ds_read_b64_tr_b16 v[172:173], v13 offset:16392
  ds_read_b64_tr_b16 v[174:175], v13 offset:16904
  s_waitcnt vmcnt(24)
  s_waitcnt lgkmcnt(0)
  s_barrier
  s_mov_b32 m0, 0x1c000
  s_mov_b32 s27, 0x1c0000
  buffer_load_dwordx4 v8, s[12:15], s27 offen  lds
  s_mov_b32 m0, 0x1c400
  s_mov_b32 s27, 0x1c8000
  buffer_load_dwordx4 v8, s[12:15], s27 offen  lds
  s_mov_b32 m0, 0x1c800
  s_mov_b32 s27, 0x1d0000
  buffer_load_dwordx4 v9, s[12:15], s27 offen  lds
  s_mov_b32 m0, 0x1cc00
  s_mov_b32 s27, 0x1d8000
  buffer_load_dwordx4 v9, s[12:15], s27 offen  lds
  ds_read_b64_tr_b16 v[96:97], v12 offset:20480
  ds_read_b64_tr_b16 v[98:99], v12 offset:20992
  ds_read_b64_tr_b16 v[100:101], v13 offset:20480
  ds_read_b64_tr_b16 v[102:103], v13 offset:20992
  ds_read_b64_tr_b16 v[104:105], v12 offset:20488
  ds_read_b64_tr_b16 v[106:107], v12 offset:21000
  ds_read_b64_tr_b16 v[108:109], v13 offset:20488
  ds_read_b64_tr_b16 v[110:111], v13 offset:21000
  s_waitcnt vmcnt(24)
  s_waitcnt lgkmcnt(0)
  s_barrier
  s_mov_b32 m0, 0x1d000
  s_mov_b32 s27, 0x240000
  buffer_load_dwordx4 v8, s[12:15], s27 offen  lds
  s_mov_b32 m0, 0x1d400
  s_mov_b32 s27, 0x248000
  buffer_load_dwordx4 v8, s[12:15], s27 offen  lds
  s_mov_b32 m0, 0x1d800
  s_mov_b32 s27, 0x250000
  buffer_load_dwordx4 v9, s[12:15], s27 offen  lds
  s_mov_b32 m0, 0x1dc00
  s_mov_b32 s27, 0x258000
  buffer_load_dwordx4 v9, s[12:15], s27 offen  lds
  ds_read_b64_tr_b16 v[80:81], v12 offset:24576
  ds_read_b64_tr_b16 v[82:83], v12 offset:25088
  ds_read_b64_tr_b16 v[84:85], v13 offset:24576
  ds_read_b64_tr_b16 v[86:87], v13 offset:25088
  ds_read_b64_tr_b16 v[88:89], v12 offset:24584
  ds_read_b64_tr_b16 v[90:91], v12 offset:25096
  ds_read_b64_tr_b16 v[92:93], v13 offset:24584
  ds_read_b64_tr_b16 v[94:95], v13 offset:25096
  s_waitcnt vmcnt(24)
  s_waitcnt lgkmcnt(0)
  s_barrier
  s_mov_b32 m0, 0x1e000
  s_mov_b32 s27, 0x2c0000
  buffer_load_dwordx4 v8, s[12:15], s27 offen  lds
  s_mov_b32 m0, 0x1e400
  s_mov_b32 s27, 0x2c8000
  buffer_load_dwordx4 v8, s[12:15], s27 offen  lds
  s_mov_b32 m0, 0x1e800
  s_mov_b32 s27, 0x2d0000
  buffer_load_dwordx4 v9, s[12:15], s27 offen  lds
  s_mov_b32 m0, 0x1ec00
  s_mov_b32 s27, 0x2d8000
  buffer_load_dwordx4 v9, s[12:15], s27 offen  lds
  ds_read_b64_tr_b16 v[176:177], v12 offset:28672
  ds_read_b64_tr_b16 v[178:179], v12 offset:29184
  ds_read_b64_tr_b16 v[180:181], v13 offset:28672
  ds_read_b64_tr_b16 v[182:183], v13 offset:29184
  ds_read_b64_tr_b16 v[184:185], v12 offset:28680
  ds_read_b64_tr_b16 v[186:187], v12 offset:29192
  ds_read_b64_tr_b16 v[188:189], v13 offset:28680
  ds_read_b64_tr_b16 v[190:191], v13 offset:29192
  s_waitcnt vmcnt(24)
  s_waitcnt lgkmcnt(0)
  s_barrier
  s_mov_b32 m0, 0x1f000
  s_mov_b32 s27, 0x340000
  buffer_load_dwordx4 v8, s[12:15], s27 offen  lds
  s_mov_b32 m0, 0x1f400
  s_mov_b32 s27, 0x348000
  buffer_load_dwordx4 v8, s[12:15], s27 offen  lds
  s_mov_b32 m0, 0x1f800
  s_mov_b32 s27, 0x350000
  buffer_load_dwordx4 v9, s[12:15], s27 offen  lds
  s_mov_b32 m0, 0x1fc00
  s_mov_b32 s27, 0x358000
  buffer_load_dwordx4 v9, s[12:15], s27 offen  lds
  ds_read_b64_tr_b16 v[192:193], v12 offset:0
  ds_read_b64_tr_b16 v[194:195], v12 offset:512
  ds_read_b64_tr_b16 v[196:197], v13 offset:0
  ds_read_b64_tr_b16 v[198:199], v13 offset:512
  ds_read_b64_tr_b16 v[200:201], v12 offset:8
  ds_read_b64_tr_b16 v[202:203], v12 offset:520
  ds_read_b64_tr_b16 v[204:205], v13 offset:8
  ds_read_b64_tr_b16 v[206:207], v13 offset:520
  s_waitcnt vmcnt(24)
  s_waitcnt lgkmcnt(0)
  s_barrier
  s_mov_b32 m0, 0x18000
  s_mov_b32 s27, 0x3c0000
  buffer_load_dwordx4 v8, s[12:15], s27 offen  lds
  s_mov_b32 m0, 0x18400
  s_mov_b32 s27, 0x3c8000
  buffer_load_dwordx4 v8, s[12:15], s27 offen  lds
  s_mov_b32 m0, 0x18800
  s_mov_b32 s27, 0x3d0000
  buffer_load_dwordx4 v9, s[12:15], s27 offen  lds
  s_mov_b32 m0, 0x18c00
  s_mov_b32 s27, 0x3d8000
  buffer_load_dwordx4 v9, s[12:15], s27 offen  lds
  ds_read_b64_tr_b16 v[208:209], v12 offset:4096
  ds_read_b64_tr_b16 v[210:211], v12 offset:4608
  ds_read_b64_tr_b16 v[212:213], v13 offset:4096
  ds_read_b64_tr_b16 v[214:215], v13 offset:4608
  ds_read_b64_tr_b16 v[216:217], v12 offset:4104
  ds_read_b64_tr_b16 v[218:219], v12 offset:4616
  ds_read_b64_tr_b16 v[220:221], v13 offset:4104
  ds_read_b64_tr_b16 v[222:223], v13 offset:4616
  s_waitcnt vmcnt(24)
  s_waitcnt lgkmcnt(0)
  s_barrier
  s_mov_b32 m0, 0x19000
  s_mov_b32 s27, 0x440000
  buffer_load_dwordx4 v8, s[12:15], s27 offen  lds
  s_mov_b32 m0, 0x19400
  s_mov_b32 s27, 0x448000
  buffer_load_dwordx4 v8, s[12:15], s27 offen  lds
  s_mov_b32 m0, 0x19800
  s_mov_b32 s27, 0x450000
  buffer_load_dwordx4 v9, s[12:15], s27 offen  lds
  s_mov_b32 m0, 0x19c00
  s_mov_b32 s27, 0x458000
  buffer_load_dwordx4 v9, s[12:15], s27 offen  lds
  ds_read_b64_tr_b16 v[224:225], v12 offset:8192
  ds_read_b64_tr_b16 v[226:227], v12 offset:8704
  ds_read_b64_tr_b16 v[228:229], v13 offset:8192
  ds_read_b64_tr_b16 v[230:231], v13 offset:8704
  ds_read_b64_tr_b16 v[232:233], v12 offset:8200
  ds_read_b64_tr_b16 v[234:235], v12 offset:8712
  ds_read_b64_tr_b16 v[236:237], v13 offset:8200
  ds_read_b64_tr_b16 v[238:239], v13 offset:8712
  s_waitcnt vmcnt(24)
  s_waitcnt lgkmcnt(0)
  s_barrier
  s_mov_b32 m0, 0x1a000
  s_mov_b32 s27, 0x440000
  buffer_load_dwordx4 v8, s[8:11], s27 offen  lds
  s_mov_b32 m0, 0x1a400
  s_mov_b32 s27, 0x448000
  buffer_load_dwordx4 v8, s[8:11], s27 offen  lds
  s_mov_b32 m0, 0x1a800
  s_mov_b32 s27, 0x450000
  buffer_load_dwordx4 v9, s[8:11], s27 offen  lds
  s_mov_b32 m0, 0x1ac00
  s_mov_b32 s27, 0x458000
  buffer_load_dwordx4 v9, s[8:11], s27 offen  lds
  ds_read_b64_tr_b16 v[240:241], v12 offset:12288
  ds_read_b64_tr_b16 v[242:243], v12 offset:12800
  ds_read_b64_tr_b16 v[244:245], v13 offset:12288
  ds_read_b64_tr_b16 v[246:247], v13 offset:12800
  ds_read_b64_tr_b16 v[248:249], v12 offset:12296
  ds_read_b64_tr_b16 v[250:251], v12 offset:12808
  ds_read_b64_tr_b16 v[252:253], v13 offset:12296
  ds_read_b64_tr_b16 v[254:255], v13 offset:12808
  s_waitcnt vmcnt(24)
  s_waitcnt lgkmcnt(0)
  s_barrier
  ds_read_b64_tr_b16 a[0:1], v12 offset:16384
  ds_read_b64_tr_b16 a[2:3], v12 offset:16896
  ds_read_b64_tr_b16 a[4:5], v13 offset:16384
  ds_read_b64_tr_b16 a[6:7], v13 offset:16896
  ds_read_b64_tr_b16 a[8:9], v12 offset:16392
  ds_read_b64_tr_b16 a[10:11], v12 offset:16904
  ds_read_b64_tr_b16 a[12:13], v13 offset:16392
  ds_read_b64_tr_b16 a[14:15], v13 offset:16904
  s_waitcnt vmcnt(20)
  s_waitcnt lgkmcnt(0)
  s_barrier
  ds_read_b64_tr_b16 v[36:37], v12 offset:20480
  ds_read_b64_tr_b16 v[38:39], v12 offset:20992
  ds_read_b64_tr_b16 v[40:41], v13 offset:20480
  ds_read_b64_tr_b16 v[42:43], v13 offset:20992
  ds_read_b64_tr_b16 v[44:45], v12 offset:20488
  ds_read_b64_tr_b16 v[46:47], v12 offset:21000
  ds_read_b64_tr_b16 v[48:49], v13 offset:20488
  ds_read_b64_tr_b16 v[50:51], v13 offset:21000
  s_waitcnt vmcnt(16)
  s_waitcnt lgkmcnt(0)
  s_barrier
  s_mov_b32 m0, 0x1c000
  s_mov_b32 s27, 0x12280
  buffer_load_dwordx4 v10, s[52:55], s27 offen  lds
  s_mov_b32 m0, 0x1c400
  s_mov_b32 s27, 0x14680
  buffer_load_dwordx4 v10, s[52:55], s27 offen  lds
  s_mov_b32 m0, 0x1c800
  s_mov_b32 s27, 0x16a80
  buffer_load_dwordx4 v10, s[52:55], s27 offen  lds
  s_mov_b32 m0, 0x1cc00
  s_mov_b32 s27, 0x18e80
  buffer_load_dwordx4 v10, s[52:55], s27 offen  lds
  s_mov_b32 m0, 0x1d000
  s_mov_b32 s27, 0x1b280
  buffer_load_dwordx4 v10, s[52:55], s27 offen  lds
  s_mov_b32 m0, 0x1d400
  s_mov_b32 s27, 0x1d680
  buffer_load_dwordx4 v10, s[52:55], s27 offen  lds
  s_mov_b32 m0, 0x1d800
  s_mov_b32 s27, 0x1fa80
  buffer_load_dwordx4 v10, s[52:55], s27 offen  lds
  s_mov_b32 m0, 0x1dc00
  s_mov_b32 s27, 0x21e80
  buffer_load_dwordx4 v10, s[52:55], s27 offen  lds
  ds_read_b64_tr_b16 v[20:21], v12 offset:24576
  ds_read_b64_tr_b16 v[22:23], v12 offset:25088
  ds_read_b64_tr_b16 v[24:25], v13 offset:24576
  ds_read_b64_tr_b16 v[26:27], v13 offset:25088
  ds_read_b64_tr_b16 v[28:29], v12 offset:24584
  ds_read_b64_tr_b16 v[30:31], v12 offset:25096
  ds_read_b64_tr_b16 v[32:33], v13 offset:24584
  ds_read_b64_tr_b16 v[34:35], v13 offset:25096
  s_waitcnt vmcnt(20)
  s_waitcnt lgkmcnt(0)
  s_barrier
  ds_read_b64_tr_b16 a[16:17], v12 offset:28672
  ds_read_b64_tr_b16 a[18:19], v12 offset:29184
  ds_read_b64_tr_b16 a[20:21], v13 offset:28672
  ds_read_b64_tr_b16 a[22:23], v13 offset:29184
  ds_read_b64_tr_b16 a[24:25], v12 offset:28680
  ds_read_b64_tr_b16 a[26:27], v12 offset:29192
  ds_read_b64_tr_b16 a[28:29], v13 offset:28680
  ds_read_b64_tr_b16 a[30:31], v13 offset:29192
  s_waitcnt vmcnt(16)
  s_waitcnt lgkmcnt(0)
  s_barrier
  s_mov_b32 m0, 0x1e000
  s_mov_b32 s27, 0x12300
  buffer_load_dwordx4 v10, s[52:55], s27 offen  lds
  s_mov_b32 m0, 0x1e400
  s_mov_b32 s27, 0x14700
  buffer_load_dwordx4 v10, s[52:55], s27 offen  lds
  s_mov_b32 m0, 0x1e800
  s_mov_b32 s27, 0x16b00
  buffer_load_dwordx4 v10, s[52:55], s27 offen  lds
  s_mov_b32 m0, 0x1ec00
  s_mov_b32 s27, 0x18f00
  buffer_load_dwordx4 v10, s[52:55], s27 offen  lds
  s_mov_b32 m0, 0x1f000
  s_mov_b32 s27, 0x1b300
  buffer_load_dwordx4 v10, s[52:55], s27 offen  lds
  s_mov_b32 m0, 0x1f400
  s_mov_b32 s27, 0x1d700
  buffer_load_dwordx4 v10, s[52:55], s27 offen  lds
  s_mov_b32 m0, 0x1f800
  s_mov_b32 s27, 0x1fb00
  buffer_load_dwordx4 v10, s[52:55], s27 offen  lds
  s_mov_b32 m0, 0x1fc00
  s_mov_b32 s27, 0x21f00
  buffer_load_dwordx4 v10, s[52:55], s27 offen  lds
  ds_read_b64_tr_b16 a[32:33], v12 offset:0
  ds_read_b64_tr_b16 a[34:35], v12 offset:512
  ds_read_b64_tr_b16 a[36:37], v13 offset:0
  ds_read_b64_tr_b16 a[38:39], v13 offset:512
  ds_read_b64_tr_b16 a[40:41], v12 offset:8
  ds_read_b64_tr_b16 a[42:43], v12 offset:520
  ds_read_b64_tr_b16 a[44:45], v13 offset:8
  ds_read_b64_tr_b16 a[46:47], v13 offset:520
  s_waitcnt vmcnt(20)
  s_waitcnt lgkmcnt(0)
  s_barrier
  ds_write_b128 v2, v[20:23] offset:0
  ds_write_b128 v2, v[24:27] offset:1024
  ds_write_b128 v2, v[28:31] offset:2048
  ds_write_b128 v2, v[32:35] offset:3072
  ds_write_b128 v2, v[36:39] offset:12288
  ds_write_b128 v2, v[40:43] offset:13312
  ds_write_b128 v2, v[44:47] offset:14336
  ds_write_b128 v2, v[48:51] offset:15360
  ds_read_b64_tr_b16 v[20:21], v12 offset:4096
  ds_read_b64_tr_b16 v[22:23], v12 offset:4608
  ds_read_b64_tr_b16 v[24:25], v13 offset:4096
  ds_read_b64_tr_b16 v[26:27], v13 offset:4608
  ds_read_b64_tr_b16 v[28:29], v12 offset:4104
  ds_read_b64_tr_b16 v[30:31], v12 offset:4616
  ds_read_b64_tr_b16 v[32:33], v13 offset:4104
  ds_read_b64_tr_b16 v[34:35], v13 offset:4616
  s_waitcnt vmcnt(16)
  s_waitcnt lgkmcnt(0)
  s_barrier
  ds_write_b128 v2, v[20:23] offset:4096
  ds_write_b128 v2, v[24:27] offset:5120
  ds_write_b128 v2, v[28:31] offset:6144
  ds_write_b128 v2, v[32:35] offset:7168
  ds_read_b64_tr_b16 v[36:37], v12 offset:8192
  ds_read_b64_tr_b16 v[38:39], v12 offset:8704
  ds_read_b64_tr_b16 v[40:41], v13 offset:8192
  ds_read_b64_tr_b16 v[42:43], v13 offset:8704
  ds_read_b64_tr_b16 v[44:45], v12 offset:8200
  ds_read_b64_tr_b16 v[46:47], v12 offset:8712
  ds_read_b64_tr_b16 v[48:49], v13 offset:8200
  ds_read_b64_tr_b16 v[50:51], v13 offset:8712
  s_waitcnt lgkmcnt(0)
  s_barrier
  ds_write_b128 v2, v[36:39] offset:8192
  ds_write_b128 v2, v[40:43] offset:9216
  ds_write_b128 v2, v[44:47] offset:10240
  ds_write_b128 v2, v[48:51] offset:11264
  s_waitcnt vmcnt(8)
  ds_read_b64_tr_b16 v[20:21], v16 offset:16384
  ds_read_b64_tr_b16 v[22:23], v16 offset:16640
  ds_read_b64_tr_b16 v[24:25], v16 offset:17408
  ds_read_b64_tr_b16 v[26:27], v16 offset:17664
  ds_read_b64_tr_b16 v[28:29], v16 offset:20480
  ds_read_b64_tr_b16 v[30:31], v16 offset:20736
  ds_read_b64_tr_b16 v[32:33], v16 offset:21504
  ds_read_b64_tr_b16 v[34:35], v16 offset:21760
  ds_read_b64_tr_b16 v[36:37], v16 offset:16448
  ds_read_b64_tr_b16 v[38:39], v16 offset:16704
  ds_read_b64_tr_b16 v[40:41], v16 offset:17472
  ds_read_b64_tr_b16 v[42:43], v16 offset:17728
  ds_read_b64_tr_b16 v[44:45], v16 offset:20544
  ds_read_b64_tr_b16 v[46:47], v16 offset:20800
  ds_read_b64_tr_b16 v[48:49], v16 offset:21568
  ds_read_b64_tr_b16 v[50:51], v16 offset:21824
  s_waitcnt lgkmcnt(0)
  ds_write_b128 v2, v[20:23] offset:16384
  ds_write_b128 v2, v[24:27] offset:17408
  ds_write_b128 v2, v[28:31] offset:18432
  ds_write_b128 v2, v[32:35] offset:19456
  ds_write_b128 v2, v[36:39] offset:20480
  ds_write_b128 v2, v[40:43] offset:21504
  ds_write_b128 v2, v[44:47] offset:22528
  ds_write_b128 v2, v[48:51] offset:23552
  s_waitcnt vmcnt(0)
  ds_read_b64_tr_b16 v[20:21], v16 offset:24576
  ds_read_b64_tr_b16 v[22:23], v16 offset:24832
  ds_read_b64_tr_b16 v[24:25], v16 offset:25600
  ds_read_b64_tr_b16 v[26:27], v16 offset:25856
  ds_read_b64_tr_b16 v[28:29], v16 offset:28672
  ds_read_b64_tr_b16 v[30:31], v16 offset:28928
  ds_read_b64_tr_b16 v[32:33], v16 offset:29696
  ds_read_b64_tr_b16 v[34:35], v16 offset:29952
  ds_read_b64_tr_b16 v[36:37], v16 offset:24640
  ds_read_b64_tr_b16 v[38:39], v16 offset:24896
  ds_read_b64_tr_b16 v[40:41], v16 offset:25664
  ds_read_b64_tr_b16 v[42:43], v16 offset:25920
  ds_read_b64_tr_b16 v[44:45], v16 offset:28736
  ds_read_b64_tr_b16 v[46:47], v16 offset:28992
  ds_read_b64_tr_b16 v[48:49], v16 offset:29760
  ds_read_b64_tr_b16 v[50:51], v16 offset:30016
  s_waitcnt lgkmcnt(0)
  ds_write_b128 v2, v[20:23] offset:24576
  ds_write_b128 v2, v[24:27] offset:25600
  ds_write_b128 v2, v[28:31] offset:26624
  ds_write_b128 v2, v[32:35] offset:27648
  ds_write_b128 v2, v[36:39] offset:28672
  ds_write_b128 v2, v[40:43] offset:29696
  ds_write_b128 v2, v[44:47] offset:30720
  ds_write_b128 v2, v[48:51] offset:31744
  s_waitcnt lgkmcnt(0)
  s_mov_b32 s28, 0
L_reg_89:
  v_mov_b32 v8, 0
  buffer_load_dword v9, v8, s[20:23], 0 offen offset:64 sc1
  s_add_u32 s28, s28, 1
  s_cmp_gt_u32 s28, 1048576
  s_cbranch_scc1 L_fail
  s_waitcnt vmcnt(0)
  v_readfirstlane_b32 s67, v9
L_regc_90:
  s_and_b32 s26, s67, 0xffff
  s_cmp_lt_u32 s26, 256
  s_cbranch_scc1 L_reg_89
  s_lshr_b32 s67, s67, 16
  s_sub_u32 s26, s57, 16384
  s_mov_b32 s27, 0
L_poll_91:
  buffer_load_dword v3, v0, s[4:7], s26 offen sc1
  s_waitcnt vmcnt(0)
  v_cmp_eq_u32 vcc, 0, v3
  s_and_b64 vcc, vcc, s[92:93]
  s_cbranch_vccz L_polld_92
  s_add_u32 s27, s27, 1
  s_cmp_lt_u32 s27, 1048576
  s_cbranch_scc1 L_poll_91
  s_branch L_fail
L_polld_92:
  s_sub_u32 s26, s57, 8192
  s_mov_b32 s27, 0
L_poll_93:
  buffer_load_dword v3, v0, s[4:7], s26 offen sc1
  s_waitcnt vmcnt(0)
  v_cmp_eq_u32 vcc, 0, v3
  s_and_b64 vcc, vcc, s[92:93]
  s_cbranch_vccz L_polld_94
  s_add_u32 s27, s27, 1
  s_cmp_lt_u32 s27, 1048576
  s_cbranch_scc1 L_poll_93
  s_branch L_fail
L_polld_94:
  v_min_u32 v8, -2, v64
  v_min_u32 v9, -2, v65
  v_min_u32 v10, -2, v66
  v_min_u32 v11, -2, v67
  v_min_u32 v12, -2, v68
  v_min_u32 v13, -2, v69
  v_min_u32 v14, -2, v70
  v_min_u32 v15, -2, v71
  s_cmp_ge_u32 s67, 32
  s_cbranch_scc0 L_slowmode2
  s_mov_b32 m0, 0
  ds_read_b128 v[60:63], v2 offset:0
  ds_read_b128 v[64:67], v2 offset:1024
  ds_read_b128 v[20:23], v2 offset:2048
  ds_read_b128 v[24:27], v2 offset:3072
  ds_read_b128 v[28:31], v2 offset:12288
  ds_read_b128 v[32:35], v2 offset:13312
  ds_read_b128 v[36:39], v2 offset:14336
  ds_read_b128 v[40:43], v2 offset:15360
  v_mov_b64 v[44:45], 0
  v_mov_b64 v[46:47], 0
  v_mov_b64 v[48:49], 0
  v_mov_b64 v[50:51], 0
  v_mov_b64 v[52:53], 0
  v_mov_b64 v[54:55], 0
  v_mov_b64 v[56:57], 0
  v_mov_b64 v[58:59], 0
  v_mov_b64 v[68:69], 0
  v_mov_b64 v[70:71], 0
  v_mov_b64 v[72:73], 0
  v_mov_b64 v[74:75], 0
  v_mov_b32 v16, -1
  s_branch L_chk2f
.p2align 7
  s_nop 0
  s_nop 0
  s_nop 0
  s_nop 0
  s_nop 0
  s_nop 0
L_top2f:
  s_waitcnt vmcnt(0)
  s_barrier
  buffer_load_dwordx4 v[8:11], v0, s[4:7], s58 offen offset:1024 sc1
  s_mov_b32 s56, 0
  buffer_load_dwordx4 v[12:15], v0, s[4:7], s58 offen offset:0 sc1
  s_bfe_u32 s46, s37, 0x10001
L_chk2f:
  s_waitcnt vmcnt(1) lgkmcnt(0)
  v_smfmac_f32_16x16x64_bf16 v[48:51], v[8:11], v[60:67], v1
  ds_write_b128 v0, v[8:11] offset:5120
  s_waitcnt lgkmcnt(5)
  v_smfmac_f32_16x16x64_bf16 v[56:59], v[8:11], v[20:27], v1
  v_smfmac_f32_16x16x64_bf16 v[44:47], v[8:11], v[80:87], v1
  v_smfmac_f32_16x16x64_bf16 v[52:55], v[8:11], v[88:95], v1
  s_waitcnt vmcnt(0)
  ds_write_b128 v0, v[12:15] offset:4096
  s_waitcnt lgkmcnt(4)
  v_smfmac_f32_16x16x64_bf16 v[48:51], v[12:15], v[28:35], v1
  v_max3_u32 v3, v8, v9, v10
  v_max3_u32 v3, v3, v11, v12
  v_max3_u32 v3, v3, v13, v14
  v_max_u32 v3, v3, v15
  s_waitcnt lgkmcnt(2)
  v_smfmac_f32_16x16x64_bf16 v[56:59], v[12:15], v[36:43], v1
  ds_read_b128 v[60:63], v2 offset:4096
  v_cmp_eq_u32 vcc, -1, v3
  v_smfmac_f32_16x16x64_bf16 v[44:47], v[12:15], v[96:103], v1
  ds_read_b128 v[64:67], v2 offset:5120
  s_cbranch_vccnz L_retry2f
  v_smfmac_f32_16x16x64_bf16 v[52:55], v[12:15], v[104:111], v1
  s_waitcnt lgkmcnt(2)
  s_barrier
  ds_read_b128 v[20:23], v0 offset:0
  v_smfmac_f32_16x16x64_bf16 v[68:71], v[8:11], a[48:55], v1
  ds_read_b128 v[24:27], v0 offset:1024
  s_mov_b64 vcc, s[62:63]
  v_smfmac_f32_16x16x64_bf16 v[72:75], v[8:11], a[56:63], v1
  buffer_store_dword v16, v7, s[4:7], s61 offen
  ds_read_b128 v[28:31], v0 offset:2048
  v_smfmac_f32_16x16x64_bf16 v[68:71], v[12:15], a[64:71], v1
  ds_read_b128 v[16:19], v0 offset:8192
  v_smfmac_f32_16x16x64_bf16 v[72:75], v[12:15], a[72:79], v1
  ds_read_b128 v[8:11], v2 offset:6144
  s_waitcnt lgkmcnt(4)
  v_smfmac_f32_16x16x64_bf16 v[44:47], v[20:23], v[112:119], v1
  ds_read_b128 v[12:15], v2 offset:7168
  v_smfmac_f32_16x16x64_bf16 v[48:51], v[20:23], v[208:215], v1
  ds_read_b128 v[32:35], v0 offset:3072
  v_smfmac_f32_16x16x64_bf16 v[52:55], v[20:23], v[120:127], v1
  ds_read_b128 v[36:39], v0 offset:6144
  v_smfmac_f32_16x16x64_bf16 v[56:59], v[20:23], v[216:223], v1
  ds_read_b128 v[40:43], v0 offset:7168
  s_waitcnt lgkmcnt(5)
  v_smfmac_f32_16x16x64_bf16 v[48:51], v[16:19], v[60:67], v1
  ds_read_b128 v[60:63], v2 offset:8192
  ds_read_b128 v[64:67], v2 offset:9216
  v_smfmac_f32_16x16x64_bf16 v[44:47], v[24:27], v[128:135], v1
  s_waitcnt lgkmcnt(5)
  v_smfmac_f32_16x16x64_bf16 v[56:59], v[16:19], v[8:15], v1
  ds_read_b128 v[8:11], v2 offset:10240
  ds_read_b128 v[12:15], v2 offset:11264
  v_smfmac_f32_16x16x64_bf16 v[52:55], v[24:27], v[136:143], v1
  v_smfmac_f32_16x16x64_bf16 v[48:51], v[24:27], v[224:231], v1
  s_waitcnt lgkmcnt(2)
  v_smfmac_f32_16x16x64_bf16 v[44:47], v[16:19], v[60:67], v1
  buffer_load_dwordx4 v[60:63], v0, s[4:7], s42 offen sc1
  s_add_u32 s26, s42, 4096
  v_smfmac_f32_16x16x64_bf16 v[56:59], v[24:27], v[232:239], v1
  s_waitcnt lgkmcnt(0)
  v_smfmac_f32_16x16x64_bf16 v[52:55], v[16:19], v[8:15], v1
  buffer_load_dwordx4 v[64:67], v0, s[4:7], s26 offen sc1
  v_smfmac_f32_16x16x64_bf16 v[48:51], v[28:31], v[240:247], v1
  v_smfmac_f32_16x16x64_bf16 v[44:47], v[28:31], v[144:151], v1
  buffer_load_dwordx4 v[8:11], v0, s[4:7], s43 offen sc1
  v_smfmac_f32_16x16x64_bf16 v[48:51], v[32:35], a[0:7], v1
  v_smfmac_f32_16x16x64_bf16 v[44:47], v[32:35], v[160:167], v1
  buffer_load_dwordx4 v[12:15], v0, s[4:7], s43 offen offset:1024 sc1
  v_smfmac_f32_16x16x64_bf16 v[48:51], v[36:39], a[16:23], v1
  s_add_u32 s42, s42, 0x40000
  s_add_u32 s43, s43, 0x40000
  v_smfmac_f32_16x16x64_bf16 v[44:47], v[36:39], v[176:183], v1
  s_add_u32 s27, s44, 0x800000
  v_smfmac_f32_16x16x64_bf16 v[48:51], v[40:43], a[32:39], v1
  v_smfmac_f32_16x16x64_bf16 v[44:47], v[40:43], v[192:199], v1
  v_smfmac_f32_16x16x64_bf16 v[56:59], v[28:31], v[248:255], v1
  v_smfmac_f32_16x16x64_bf16 v[52:55], v[28:31], v[152:159], v1
  v_add_f32 v48, v48, v50
  v_smfmac_f32_16x16x64_bf16 v[56:59], v[32:35], a[8:15], v1
  v_add_f32 v49, v49, v51
  v_smfmac_f32_16x16x64_bf16 v[52:55], v[32:35], v[168:175], v1
  v_cvt_pk_bf16_f32 v50, v48, v49
  v_smfmac_f32_16x16x64_bf16 v[56:59], v[36:39], a[24:31], v1
  v_add_f32 v44, v44, v46
  v_smfmac_f32_16x16x64_bf16 v[52:55], v[36:39], v[184:191], v1
  v_add_f32 v45, v45, v47
  v_smfmac_f32_16x16x64_bf16 v[56:59], v[40:43], a[40:47], v1
  v_cvt_pk_bf16_f32 v51, v44, v45
  v_smfmac_f32_16x16x64_bf16 v[52:55], v[40:43], v[200:207], v1
  v_mfma_f32_16x16x16_bf16 v[44:47], v[50:51], v[4:5], 0
  v_add_f32 v56, v56, v58
  v_add_f32 v57, v57, v59
  v_cvt_pk_bf16_f32 v58, v56, v57
  s_nop 0
  v_add_f32 v52, v52, v54
  v_add_f32 v53, v53, v55
  v_cvt_pk_bf16_f32 v59, v52, v53
  s_nop 0
  v_cvt_pk_bf16_f32 v48, v44, v45
  v_cvt_pk_bf16_f32 v49, v46, v47
  v_mfma_f32_16x16x16_bf16 v[52:55], v[58:59], v[4:5], 0
  v_min_u32 v48, -2, v48
  v_smfmac_f32_16x16x64_bf16 v[68:71], v[16:19], a[80:87], v1
  v_smfmac_f32_16x16x64_bf16 v[72:75], v[16:19], a[88:95], v1
  v_cvt_pk_bf16_f32 v50, v52, v53
  v_cvt_pk_bf16_f32 v51, v54, v55
  s_waitcnt vmcnt(2)
  s_nop 0
  v_mfma_f32_16x16x32_bf16 v[52:55], v[64:67], v[48:51], 0
  v_lshrrev_b32 v3, 1, v0
  v_mfma_f32_16x16x32_bf16 v[44:47], v[60:63], v[48:51], 0
  v_bfi_b32 v17, 31, v0, v3
  v_mfma_f32_16x16x32_bf16 v[56:59], v[48:51], v[48:51], 0
  v_smfmac_f32_16x16x64_bf16 v[68:71], v[20:23], a[96:103], v1
  v_cndmask_b32_dpp v44, v52, v44, vcc quad_perm:[2,3,2,3] row_mask:0xf bank_mask:0xf
  v_cndmask_b32_dpp v45, v53, v45, vcc quad_perm:[2,3,2,3] row_mask:0xf bank_mask:0xf
  v_cndmask_b32_dpp v46, v54, v46, vcc quad_perm:[2,3,2,3] row_mask:0xf bank_mask:0xf
  v_cndmask_b32_dpp v47, v55, v47, vcc quad_perm:[2,3,2,3] row_mask:0xf bank_mask:0xf
  ds_write_b128 v0, v[44:47] offset:11776
  v_cndmask_b32_dpp v56, v57, v56, vcc quad_perm:[2,3,2,3] row_mask:0xf bank_mask:0xf
  ds_write_addtid_b32 v56 offset:12800
  v_smfmac_f32_16x16x64_bf16 v[72:75], v[20:23], a[104:111], v1
  v_smfmac_f32_16x16x64_bf16 v[68:71], v[24:27], a[112:119], v1
  v_smfmac_f32_16x16x64_bf16 v[72:75], v[24:27], a[120:127], v1
  s_waitcnt lgkmcnt(0)
  s_barrier
  v_smfmac_f32_16x16x64_bf16 v[68:71], v[28:31], a[128:135], v1
  ds_read_b128 v[60:63], v0 offset:9216
  ds_read_b128 v[64:67], v0 offset:10496
  ds_read_b128 v[52:55], v0 offset:13056
  v_smfmac_f32_16x16x64_bf16 v[72:75], v[28:31], a[136:143], v1
  ds_read_addtid_b32 v57 offset:10240
  ds_read_addtid_b32 v58 offset:11520
  ds_read_addtid_b32 v59 offset:14080
  v_smfmac_f32_16x16x64_bf16 v[68:71], v[32:35], a[144:151], v1
  ds_read_b128 v[20:23], v0 offset:14336
  v_mul_f32 v56, s90, v56
  v_smfmac_f32_16x16x64_bf16 v[72:75], v[32:35], a[152:159], v1
  s_not_b64 exec, s[62:63]
  buffer_store_dwordx4 v[48:51], v17, s[4:7], s44 offen sc1
  s_mov_b64 exec, -1
  ds_read_b128 v[24:27], v0 offset:15360
  v_mul_f32 v44, s90, v44
  v_smfmac_f32_16x16x64_bf16 v[68:71], v[36:39], a[160:167], v1
  ds_read_b128 v[28:31], v2 offset:20480
  v_mul_f32 v45, s90, v45
  v_smfmac_f32_16x16x64_bf16 v[72:75], v[36:39], a[168:175], v1
  ds_read_b128 v[32:35], v2 offset:21504
  v_mul_f32 v46, s90, v46
  v_smfmac_f32_16x16x64_bf16 v[68:71], v[40:43], a[176:183], v1
  ds_read_b128 v[36:39], v2 offset:24576
  v_mul_f32 v47, s90, v47
  v_smfmac_f32_16x16x64_bf16 v[72:75], v[40:43], a[184:191], v1
  ds_read_b128 v[40:43], v2 offset:25600
  s_waitcnt lgkmcnt(6)
  v_fmac_f32 v56, s90, v57
  v_fmac_f32 v56, s90, v58
  v_fmac_f32 v56, s90, v59
  v_pk_fma_f32 v[44:45], v[60:61], s[90:91], v[44:45]
  v_pk_fma_f32 v[46:47], v[62:63], s[90:91], v[46:47]
  v_pk_fma_f32 v[44:45], v[64:65], s[90:91], v[44:45]
  v_pk_fma_f32 v[46:47], v[66:67], s[90:91], v[46:47]
  v_pk_fma_f32 v[44:45], v[52:53], s[90:91], v[44:45]
  v_pk_fma_f32 v[46:47], v[54:55], s[90:91], v[46:47]
  v_pk_add_f32 v[68:69], v[68:69], v[70:71]
  v_pk_add_f32 v[72:73], v[72:73], v[74:75]
  v_exp_f32 v44, v44
  v_exp_f32 v45, v45
  v_exp_f32 v46, v46
  v_cvt_pk_bf16_f32 v44, v44, v45
  v_exp_f32 v47, v47
  v_cvt_pk_bf16_f32 v70, v68, v69
  v_mov_b32_dpp v16, v44 quad_perm:[2,3,2,3] row_mask:0xf bank_mask:0xf
  v_cvt_pk_bf16_f32 v45, v46, v47
  v_mov_b32_dpp v17, v44 quad_perm:[0,1,0,1] row_mask:0xf bank_mask:0xf
  v_cvt_pk_bf16_f32 v71, v72, v73
  v_mov_b32_dpp v18, v45 quad_perm:[2,3,2,3] row_mask:0xf bank_mask:0xf
  v_mov_b32_dpp v19, v45 quad_perm:[0,1,0,1] row_mask:0xf bank_mask:0xf
  v_exp_f32_dpp v57, v56 quad_perm:[2,3,2,3] row_mask:0xf bank_mask:0xf
  v_min_u32 v70, -2, v70
  s_waitcnt lgkmcnt(4)
  v_mfma_f32_16x16x32_bf16 v[48:51], v[24:27], v[16:19], 0
  ds_read_b128 v[44:47], v0 offset:14336
  v_exp_f32_dpp v58, v56 quad_perm:[0,1,0,1] row_mask:0xf bank_mask:0xf
  s_waitcnt vmcnt(2)
  v_mfma_f32_16x16x32_bf16 v[52:55], v[8:11], v[16:19], 0
  ds_read_b128 v[72:75], v0 offset:14336
  v_cvt_pk_bf16_f32 v20, v57, v58
  s_waitcnt vmcnt(1)
  v_mfma_f32_16x16x32_bf16 v[60:63], v[12:15], v[16:19], 0
  ds_read_b128 v[64:67], v2 offset:29696
  v_cvt_pk_bf16_f32 v23, v57, v58
  v_mfma_f32_16x16x16_bf16 v[48:51], v[24:25], v[20:21], v[48:51]
  buffer_store_dwordx2 v[70:71], v3, s[4:7], s27 offen sc1
  ds_read_b128 v[24:27], v2 offset:17408
  v_mov_b64 v[56:57], 0
  v_mov_b64 v[58:59], 0
  v_mfma_f32_16x16x16_bf16 v[52:55], v[70:71], v[20:21], v[52:55]
  s_cmp_eq_u32 s37, 63
  s_cbranch_scc1 L_last2f
  v_mfma_f32_16x16x16_bf16 v[60:63], v[70:71], v[22:23], v[60:63]
  ds_read_b128 v[20:23], v2 offset:16384
  ds_read_b128 v[68:71], v0 offset:14336
  v_rcp_f32 v3, v48
  s_add_u32 s94, s41, s47
  v_pk_mul_f32 v[52:53], v[52:53], v[2:3] op_sel:[0,1] op_sel_hi:[1,1]
  v_pk_mul_f32 v[54:55], v[54:55], v[2:3] op_sel:[0,1] op_sel_hi:[1,1]
  v_cvt_pk_bf16_f32 v52, v52, v53
  v_cvt_pk_bf16_f32 v53, v54, v55
  v_pk_mul_f32 v[60:61], v[60:61], v[2:3] op_sel:[0,1] op_sel_hi:[1,1]
  v_pk_mul_f32 v[62:63], v[62:63], v[2:3] op_sel:[0,1] op_sel_hi:[1,1]
  v_cvt_pk_bf16_f32 v54, v60, v61
  v_cvt_pk_bf16_f32 v55, v62, v63
  ds_write_b128 v0, v[52:55] offset:2048
  s_waitcnt lgkmcnt(9)
  v_smfmac_f32_16x16x64_bf16 v[56:59], v[52:55], v[28:35], v1
  ds_read_b128 v[60:63], v2 offset:28672
  v_subrev_u32 v16, 0x2b800000, v3
  v_cmp_lt_u32 vcc, 0x23000000, v16
  s_waitcnt lgkmcnt(2)
  v_smfmac_f32_16x16x64_bf16 v[68:71], v[52:55], v[36:43], v1
  ds_read_b128 v[28:31], v2 offset:18432
  v_smfmac_f32_16x16x64_bf16 v[44:47], v[52:55], v[20:27], v1
  ds_read_b128 v[32:35], v2 offset:19456
  s_cbranch_vccnz L_guard2f
L_safe2f:
  s_waitcnt lgkmcnt(3)
  s_barrier
  ds_read_b128 v[8:11], v0 offset:0
  ds_read_b128 v[12:15], v0 offset:1024
  ds_read_b128 v[16:19], v0 offset:3072
  s_waitcnt lgkmcnt(5)
  v_smfmac_f32_16x16x64_bf16 v[72:75], v[52:55], v[60:67], v1
  ds_read_b128 v[36:39], v2 offset:22528
  s_waitcnt lgkmcnt(3)
  v_smfmac_f32_16x16x64_bf16 v[44:47], v[8:11], a[192:199], v1
  ds_read_b128 v[40:43], v2 offset:23552
  s_waitcnt lgkmcnt(3)
  v_smfmac_f32_16x16x64_bf16 v[44:47], v[12:15], a[200:207], v1
  ds_read_b128 v[20:23], v2 offset:26624
  s_waitcnt lgkmcnt(3)
  v_smfmac_f32_16x16x64_bf16 v[44:47], v[16:19], v[28:35], v1
  ds_read_b128 v[24:27], v2 offset:27648
  v_smfmac_f32_16x16x64_bf16 v[56:59], v[8:11], a[208:215], v1
  ds_read_b128 v[60:63], v2 offset:30720
  v_smfmac_f32_16x16x64_bf16 v[56:59], v[12:15], a[216:223], v1
  ds_read_b128 v[64:67], v2 offset:31744
  v_cvt_pk_bf16_f32 v44, v44, v45
  s_waitcnt lgkmcnt(4)
  v_smfmac_f32_16x16x64_bf16 v[56:59], v[16:19], v[36:43], v1
  v_cvt_pk_bf16_f32 v45, v46, v47
  v_smfmac_f32_16x16x64_bf16 v[68:71], v[8:11], a[224:231], v1
  v_bfi_b32 v44, 1, s46, v44
  v_smfmac_f32_16x16x64_bf16 v[68:71], v[12:15], a[232:239], v1
  v_cvt_pk_bf16_f32 v46, v56, v57
  s_waitcnt lgkmcnt(2)
  v_smfmac_f32_16x16x64_bf16 v[68:71], v[16:19], v[20:27], v1
  v_cvt_pk_bf16_f32 v47, v58, v59
  v_smfmac_f32_16x16x64_bf16 v[72:75], v[8:11], a[240:247], v1
  v_bfi_b32 v46, 1, s46, v46
  v_smfmac_f32_16x16x64_bf16 v[72:75], v[12:15], a[248:255], v1
  s_add_u32 s26, s94, 0x28000
  v_cvt_pk_bf16_f32 v68, v68, v69
  s_waitcnt lgkmcnt(0)
  v_smfmac_f32_16x16x64_bf16 v[72:75], v[16:19], v[60:67], v1
  buffer_store_dwordx4 v[44:47], v0, s[4:7], s26 offen
  v_cvt_pk_bf16_f32 v69, v70, v71
  s_add_u32 s26, s94, 0x30000
  v_bfi_b32 v68, 1, s46, v68
  s_nop 3
  v_cvt_pk_bf16_f32 v70, v72, v73
  v_cvt_pk_bf16_f32 v71, v74, v75
  v_bfi_b32 v70, 1, s46, v70
  buffer_store_dwordx4 v[68:71], v0, s[4:7], s26 offen
  s_add_u32 s28, s41, s66
  s_add_u32 s48, s28, 0
  s_add_u32 s49, s28, 8192
  s_add_u32 s50, s28, 16384
  s_add_u32 s51, s28, 24576
  s_waitcnt vmcnt(0)
  s_barrier
  buffer_load_dwordx4 v[44:47], v6, s[4:7], s48 offen sc1
  buffer_load_dwordx4 v[48:51], v6, s[4:7], s49 offen sc1
  buffer_load_dwordx4 v[52:55], v6, s[4:7], s50 offen sc1
  buffer_load_dwordx4 v[56:59], v6, s[4:7], s51 offen sc1
  s_add_u32 s37, s37, 1
  s_xor_b32 s41, s41, 0x48000
  s_add_u32 s61, s40, s60
  s_mov_b32 s26, s38
  s_mov_b32 s38, s40
  s_mov_b32 s40, s39
  s_mov_b32 s39, s26
  s_add_u32 s58, s40, 4096
  s_add_u32 s44, s44, 0x20000
  s_add_u32 s26, s40, s60
  s_mov_b32 s56, 0
  ds_read_b128 v[60:63], v2 offset:0
  ds_read_b128 v[64:67], v2 offset:1024
  ds_read_b128 v[20:23], v2 offset:2048
  ds_read_b128 v[24:27], v2 offset:3072
  ds_read_b128 v[28:31], v2 offset:12288
  ds_read_b128 v[32:35], v2 offset:13312
  ds_read_b128 v[36:39], v2 offset:14336
  ds_read_b128 v[40:43], v2 offset:15360
  v_mov_b32 v68, 0
  v_mov_b32 v69, 0
  v_mov_b32 v70, 0
  v_mov_b32 v71, 0
  v_mov_b32 v72, 0
  v_mov_b32 v73, 0
  v_mov_b32 v74, 0
  v_mov_b32 v75, 0
  v_mov_b32 v16, -1
L_rchk2f:
  s_waitcnt vmcnt(3)
  v_mfma_f32_16x16x32_bf16 v[8:11], v[44:47], v[76:79], 0
  v_bitop3_b32 v12, v44, v46, s46 bitop3:0x7e
  s_waitcnt vmcnt(2)
  v_mfma_f32_16x16x32_bf16 v[8:11], v[48:51], v[76:79], v[8:11]
  v_bitop3_b32 v13, v48, v50, s46 bitop3:0x7e
  s_waitcnt vmcnt(1)
  v_mfma_f32_16x16x32_bf16 v[8:11], v[52:55], v[76:79], v[8:11]
  v_bitop3_b32 v14, v52, v54, s46 bitop3:0x7e
  v_or3_b32 v12, v12, v13, v14
  s_waitcnt vmcnt(0)
  v_mfma_f32_16x16x32_bf16 v[8:11], v[56:59], v[76:79], v[8:11]
  v_bitop3_b32 v3, v56, v58, s46 bitop3:0x7e
  v_bitop3_b32 v3, v3, v12, 1 bitop3:0xa8
  v_cmp_ne_u32 vcc, 0, v3
  v_mov_b64 v[44:45], 0
  v_mov_b64 v[46:47], 0
  v_mov_b64 v[48:49], 0
  s_nop 1
  v_permlane32_swap_b32 v8, v10
  v_permlane32_swap_b32 v9, v11
  v_pk_add_f32 v[8:9], v[8:9], v[10:11]
  v_cvt_pk_bf16_f32 v8, v8, v9
  v_min_u32 v8, -2, v8
  s_cbranch_vccnz L_r2f
  buffer_store_dword v8, v7, s[4:7], s26 offen
  v_mov_b64 v[50:51], 0
  v_mov_b64 v[52:53], 0
  v_mov_b64 v[54:55], 0
  v_mov_b64 v[56:57], 0
  v_mov_b64 v[58:59], 0
L_end2f:
  s_branch L_top2f
L_retry2f:
  buffer_load_dwordx4 v[8:11], v0, s[4:7], s58 offen offset:1024 sc1
  buffer_load_dwordx4 v[12:15], v0, s[4:7], s58 offen offset:0 sc1
  ds_read_b128 v[60:63], v2 offset:0
  ds_read_b128 v[64:67], v2 offset:1024
  s_nop 1
  v_mov_b64 v[44:45], 0
  v_mov_b64 v[46:47], 0
  v_mov_b64 v[48:49], 0
  v_mov_b64 v[50:51], 0
  v_mov_b64 v[52:53], 0
  v_mov_b64 v[54:55], 0
  v_mov_b64 v[56:57], 0
  v_mov_b64 v[58:59], 0
  v_mov_b64 v[68:69], 0
  v_mov_b64 v[70:71], 0
  v_mov_b64 v[72:73], 0
  v_mov_b64 v[74:75], 0
  s_add_u32 s56, s56, 1
  s_cmp_lt_u32 s56, 1048576
  s_cbranch_scc1 L_chk2f
  s_branch L_fail
L_guard2f:
  s_waitcnt vmcnt(0) lgkmcnt(0)
  v_lshrrev_b32 v3, 1, v0
  buffer_load_dwordx2 v[70:71], v3, s[4:7], s27 offen sc1
  s_nop 2
  ds_read_b128 v[44:47], v0 offset:11776
  ds_read_addtid_b32 v56 offset:12800
  ds_read_b128 v[60:63], v0 offset:9216
  ds_read_b128 v[64:67], v0 offset:10496
  ds_read_b128 v[52:55], v0 offset:13056
  ds_read_addtid_b32 v57 offset:10240
  ds_read_addtid_b32 v58 offset:11520
  ds_read_addtid_b32 v59 offset:14080
  ds_read_b128 v[20:23], v0 offset:14336
  ds_read_b128 v[24:27], v0 offset:15360
  s_waitcnt lgkmcnt(7)
  v_pk_add_f32 v[44:45], v[44:45], v[60:61]
  v_pk_add_f32 v[46:47], v[46:47], v[62:63]
  s_waitcnt lgkmcnt(4)
  v_add_f32 v56, v56, v57
  v_pk_add_f32 v[44:45], v[44:45], v[64:65]
  v_pk_add_f32 v[46:47], v[46:47], v[66:67]
  s_waitcnt lgkmcnt(3)
  v_add_f32 v56, v56, v58
  v_pk_add_f32 v[44:45], v[44:45], v[52:53]
  v_pk_add_f32 v[46:47], v[46:47], v[54:55]
  s_waitcnt lgkmcnt(2)
  v_add_f32 v56, v56, v59
  v_max3_f32 v50, v44, v45, v46
  v_max3_f32 v50, v50, v47, v56
  s_nop 1
  v_max_f32_dpp v48, v50, v50 quad_perm:[2,3,0,1] row_mask:0xf bank_mask:0xf
  v_max_f32_dpp v49, v50, v50 quad_perm:[2,3,0,1] row_mask:0xf bank_mask:0xf
  s_nop 1
  v_permlane32_swap_b32 v48, v49
  v_max_f32 v50, v48, v49
  v_max_f32 v51, v48, v49
  s_nop 1
  v_permlane16_swap_b32 v50, v51
  v_max_f32 v50, v50, v51
  v_sub_f32 v44, v44, v50
  v_mul_f32 v44, s90, v44
  v_sub_f32 v45, v45, v50
  v_mul_f32 v45, s90, v45
  v_sub_f32 v46, v46, v50
  v_mul_f32 v46, s90, v46
  v_sub_f32 v47, v47, v50
  v_mul_f32 v47, s90, v47
  v_sub_f32 v56, v56, v50
  v_mul_f32 v56, s90, v56
  v_exp_f32 v44, v44
  v_exp_f32 v45, v45
  v_exp_f32 v46, v46
  v_exp_f32 v47, v47
  v_exp_f32_dpp v57, v56 quad_perm:[2,3,2,3] row_mask:0xf bank_mask:0xf
  v_exp_f32_dpp v58, v56 quad_perm:[0,1,0,1] row_mask:0xf bank_mask:0xf
  v_cvt_pk_bf16_f32 v44, v44, v45
  v_cvt_pk_bf16_f32 v45, v46, v47
  s_waitcnt lgkmcnt(1)
  v_cvt_pk_bf16_f32 v20, v57, v58
  v_cvt_pk_bf16_f32 v23, v57, v58
  v_mov_b32_dpp v16, v44 quad_perm:[2,3,2,3] row_mask:0xf bank_mask:0xf
  v_mov_b32_dpp v17, v44 quad_perm:[0,1,0,1] row_mask:0xf bank_mask:0xf
  v_mov_b32_dpp v18, v45 quad_perm:[2,3,2,3] row_mask:0xf bank_mask:0xf
  v_mov_b32_dpp v19, v45 quad_perm:[0,1,0,1] row_mask:0xf bank_mask:0xf
  s_waitcnt lgkmcnt(0)
  s_nop 0
  v_mfma_f32_16x16x32_bf16 v[48:51], v[24:27], v[16:19], 0
  v_mfma_f32_16x16x32_bf16 v[52:55], v[8:11], v[16:19], 0
  v_mfma_f32_16x16x32_bf16 v[60:63], v[12:15], v[16:19], 0
  v_mfma_f32_16x16x16_bf16 v[48:51], v[24:25], v[20:21], v[48:51]
  s_waitcnt vmcnt(0)
  v_mfma_f32_16x16x16_bf16 v[52:55], v[70:71], v[20:21], v[52:55]
  v_mfma_f32_16x16x16_bf16 v[60:63], v[70:71], v[22:23], v[60:63]
  v_rcp_f32 v3, v48
  s_add_u32 s94, s41, s47
  s_nop 1
  v_pk_mul_f32 v[52:53], v[52:53], v[2:3] op_sel:[0,1] op_sel_hi:[1,1]
  v_pk_mul_f32 v[54:55], v[54:55], v[2:3] op_sel:[0,1] op_sel_hi:[1,1]
  v_cvt_pk_bf16_f32 v52, v52, v53
  v_cvt_pk_bf16_f32 v53, v54, v55
  v_pk_mul_f32 v[60:61], v[60:61], v[2:3] op_sel:[0,1] op_sel_hi:[1,1]
  v_pk_mul_f32 v[62:63], v[62:63], v[2:3] op_sel:[0,1] op_sel_hi:[1,1]
  v_cvt_pk_bf16_f32 v54, v60, v61
  v_cvt_pk_bf16_f32 v55, v62, v63
  ds_write_b128 v0, v[52:55] offset:2048
  ds_read_b128 v[44:47], v0 offset:14336
  ds_read_b128 v[56:59], v0 offset:14336
  ds_read_b128 v[68:71], v0 offset:14336
  ds_read_b128 v[72:75], v0 offset:14336
  ds_read_b128 v[20:23], v2 offset:16384
  ds_read_b128 v[24:27], v2 offset:17408
  ds_read_b128 v[28:31], v2 offset:20480
  ds_read_b128 v[32:35], v2 offset:21504
  ds_read_b128 v[36:39], v2 offset:24576
  ds_read_b128 v[40:43], v2 offset:25600
  ds_read_b128 v[60:63], v2 offset:28672
  ds_read_b128 v[64:67], v2 offset:29696
  s_waitcnt lgkmcnt(4)
  v_smfmac_f32_16x16x64_bf16 v[56:59], v[52:55], v[28:35], v1
  s_waitcnt lgkmcnt(2)
  v_smfmac_f32_16x16x64_bf16 v[68:71], v[52:55], v[36:43], v1
  v_smfmac_f32_16x16x64_bf16 v[44:47], v[52:55], v[20:27], v1
  ds_read_b128 v[28:31], v2 offset:18432
  ds_read_b128 v[32:35], v2 offset:19456
  s_waitcnt vmcnt(0) lgkmcnt(0)
  s_branch L_safe2f
L_r2f:
  buffer_load_dwordx4 v[44:47], v6, s[4:7], s48 offen sc1
  buffer_load_dwordx4 v[48:51], v6, s[4:7], s49 offen sc1
  buffer_load_dwordx4 v[52:55], v6, s[4:7], s50 offen sc1
  buffer_load_dwordx4 v[56:59], v6, s[4:7], s51 offen sc1
  s_add_u32 s56, s56, 1
  s_cmp_lt_u32 s56, 1048576
  s_cbranch_scc1 L_rchk2f
  s_branch L_fail
L_last2f:
  s_waitcnt vmcnt(0)
  s_barrier
  s_branch L_exit
L_slowmode2:
  s_mov_b32 m0, 0
  ds_read_b128 v[60:63], v2 offset:0
  ds_read_b128 v[64:67], v2 offset:1024
  ds_read_b128 v[20:23], v2 offset:2048
  ds_read_b128 v[24:27], v2 offset:3072
  ds_read_b128 v[28:31], v2 offset:12288
  ds_read_b128 v[32:35], v2 offset:13312
  ds_read_b128 v[36:39], v2 offset:14336
  ds_read_b128 v[40:43], v2 offset:15360
  v_mov_b64 v[44:45], 0
  v_mov_b64 v[46:47], 0
  v_mov_b64 v[48:49], 0
  v_mov_b64 v[50:51], 0
  v_mov_b64 v[52:53], 0
  v_mov_b64 v[54:55], 0
  v_mov_b64 v[56:57], 0
  v_mov_b64 v[58:59], 0
  v_mov_b64 v[68:69], 0
  v_mov_b64 v[70:71], 0
  v_mov_b64 v[72:73], 0
  v_mov_b64 v[74:75], 0
  v_mov_b32 v16, -1
  s_branch L_chk2s
L_top2s:
  s_waitcnt vmcnt(0)
  s_barrier
  buffer_load_dwordx4 v[8:11], v0, s[4:7], s58 offen offset:1024 sc1
  s_mov_b32 s56, 0
  buffer_load_dwordx4 v[12:15], v0, s[4:7], s58 offen offset:0 sc1
  s_bfe_u32 s46, s37, 0x10001
L_chk2s:
  s_waitcnt vmcnt(1) lgkmcnt(0)
  v_smfmac_f32_16x16x64_bf16 v[48:51], v[8:11], v[60:67], v1
  ds_write_b128 v0, v[8:11] offset:5120
  s_waitcnt lgkmcnt(5)
  v_smfmac_f32_16x16x64_bf16 v[56:59], v[8:11], v[20:27], v1
  v_smfmac_f32_16x16x64_bf16 v[44:47], v[8:11], v[80:87], v1
  v_smfmac_f32_16x16x64_bf16 v[52:55], v[8:11], v[88:95], v1
  s_waitcnt vmcnt(0)
  ds_write_b128 v0, v[12:15] offset:4096
  s_waitcnt lgkmcnt(4)
  v_smfmac_f32_16x16x64_bf16 v[48:51], v[12:15], v[28:35], v1
  v_max3_u32 v3, v8, v9, v10
  v_max3_u32 v3, v3, v11, v12
  v_max3_u32 v3, v3, v13, v14
  v_max_u32 v3, v3, v15
  s_waitcnt lgkmcnt(2)
  v_smfmac_f32_16x16x64_bf16 v[56:59], v[12:15], v[36:43], v1
  ds_read_b128 v[60:63], v2 offset:4096
  v_cmp_eq_u32 vcc, -1, v3
  v_smfmac_f32_16x16x64_bf16 v[44:47], v[12:15], v[96:103], v1
  ds_read_b128 v[64:67], v2 offset:5120
  s_cbranch_vccnz L_retry2s
  v_smfmac_f32_16x16x64_bf16 v[52:55], v[12:15], v[104:111], v1
  s_waitcnt lgkmcnt(2)
  s_barrier
  ds_read_b128 v[20:23], v0 offset:0
  v_smfmac_f32_16x16x64_bf16 v[68:71], v[8:11], a[48:55], v1
  ds_read_b128 v[24:27], v0 offset:1024
  s_mov_b64 vcc, s[62:63]
  v_smfmac_f32_16x16x64_bf16 v[72:75], v[8:11], a[56:63], v1
  buffer_store_dword v16, v7, s[4:7], s61 offen sc1
  ds_read_b128 v[28:31], v0 offset:2048
  v_smfmac_f32_16x16x64_bf16 v[68:71], v[12:15], a[64:71], v1
  ds_read_b128 v[16:19], v0 offset:8192
  v_smfmac_f32_16x16x64_bf16 v[72:75], v[12:15], a[72:79], v1
  ds_read_b128 v[8:11], v2 offset:6144
  s_waitcnt lgkmcnt(4)
  v_smfmac_f32_16x16x64_bf16 v[44:47], v[20:23], v[112:119], v1
  ds_read_b128 v[12:15], v2 offset:7168
  v_smfmac_f32_16x16x64_bf16 v[48:51], v[20:23], v[208:215], v1
  ds_read_b128 v[32:35], v0 offset:3072
  v_smfmac_f32_16x16x64_bf16 v[52:55], v[20:23], v[120:127], v1
  ds_read_b128 v[36:39], v0 offset:6144
  v_smfmac_f32_16x16x64_bf16 v[56:59], v[20:23], v[216:223], v1
  ds_read_b128 v[40:43], v0 offset:7168
  s_waitcnt lgkmcnt(5)
  v_smfmac_f32_16x16x64_bf16 v[48:51], v[16:19], v[60:67], v1
  ds_read_b128 v[60:63], v2 offset:8192
  ds_read_b128 v[64:67], v2 offset:9216
  v_smfmac_f32_16x16x64_bf16 v[44:47], v[24:27], v[128:135], v1
  s_waitcnt lgkmcnt(5)
  v_smfmac_f32_16x16x64_bf16 v[56:59], v[16:19], v[8:15], v1
  ds_read_b128 v[8:11], v2 offset:10240
  ds_read_b128 v[12:15], v2 offset:11264
  v_smfmac_f32_16x16x64_bf16 v[52:55], v[24:27], v[136:143], v1
  v_smfmac_f32_16x16x64_bf16 v[48:51], v[24:27], v[224:231], v1
  s_waitcnt lgkmcnt(2)
  v_smfmac_f32_16x16x64_bf16 v[44:47], v[16:19], v[60:67], v1
  buffer_load_dwordx4 v[60:63], v0, s[4:7], s42 offen sc1
  s_add_u32 s26, s42, 4096
  v_smfmac_f32_16x16x64_bf16 v[56:59], v[24:27], v[232:239], v1
  s_waitcnt lgkmcnt(0)
  v_smfmac_f32_16x16x64_bf16 v[52:55], v[16:19], v[8:15], v1
  buffer_load_dwordx4 v[64:67], v0, s[4:7], s26 offen sc1
  v_smfmac_f32_16x16x64_bf16 v[48:51], v[28:31], v[240:247], v1
  v_smfmac_f32_16x16x64_bf16 v[44:47], v[28:31], v[144:151], v1
  buffer_load_dwordx4 v[8:11], v0, s[4:7], s43 offen sc1
  v_smfmac_f32_16x16x64_bf16 v[48:51], v[32:35], a[0:7], v1
  v_smfmac_f32_16x16x64_bf16 v[44:47], v[32:35], v[160:167], v1
  buffer_load_dwordx4 v[12:15], v0, s[4:7], s43 offen offset:1024 sc1
  v_smfmac_f32_16x16x64_bf16 v[48:51], v[36:39], a[16:23], v1
  s_add_u32 s42, s42, 0x40000
  s_add_u32 s43, s43, 0x40000
  v_smfmac_f32_16x16x64_bf16 v[44:47], v[36:39], v[176:183], v1
  s_add_u32 s27, s44, 0x800000
  v_smfmac_f32_16x16x64_bf16 v[48:51], v[40:43], a[32:39], v1
  v_smfmac_f32_16x16x64_bf16 v[44:47], v[40:43], v[192:199], v1
  v_smfmac_f32_16x16x64_bf16 v[56:59], v[28:31], v[248:255], v1
  v_smfmac_f32_16x16x64_bf16 v[52:55], v[28:31], v[152:159], v1
  v_add_f32 v48, v48, v50
  v_smfmac_f32_16x16x64_bf16 v[56:59], v[32:35], a[8:15], v1
  v_add_f32 v49, v49, v51
  v_smfmac_f32_16x16x64_bf16 v[52:55], v[32:35], v[168:175], v1
  v_cvt_pk_bf16_f32 v50, v48, v49
  v_smfmac_f32_16x16x64_bf16 v[56:59], v[36:39], a[24:31], v1
  v_add_f32 v44, v44, v46
  v_smfmac_f32_16x16x64_bf16 v[52:55], v[36:39], v[184:191], v1
  v_add_f32 v45, v45, v47
  v_smfmac_f32_16x16x64_bf16 v[56:59], v[40:43], a[40:47], v1
  v_cvt_pk_bf16_f32 v51, v44, v45
  v_smfmac_f32_16x16x64_bf16 v[52:55], v[40:43], v[200:207], v1
  v_mfma_f32_16x16x16_bf16 v[44:47], v[50:51], v[4:5], 0
  v_add_f32 v56, v56, v58
  v_add_f32 v57, v57, v59
  v_cvt_pk_bf16_f32 v58, v56, v57
  s_nop 0
  v_add_f32 v52, v52, v54
  v_add_f32 v53, v53, v55
  v_cvt_pk_bf16_f32 v59, v52, v53
  s_nop 0
  v_cvt_pk_bf16_f32 v48, v44, v45
  v_cvt_pk_bf16_f32 v49, v46, v47
  v_mfma_f32_16x16x16_bf16 v[52:55], v[58:59], v[4:5], 0
  v_min_u32 v48, -2, v48
  v_smfmac_f32_16x16x64_bf16 v[68:71], v[16:19], a[80:87], v1
  v_smfmac_f32_16x16x64_bf16 v[72:75], v[16:19], a[88:95], v1
  v_cvt_pk_bf16_f32 v50, v52, v53
  v_cvt_pk_bf16_f32 v51, v54, v55
  s_waitcnt vmcnt(2)
  s_nop 0
  v_mfma_f32_16x16x32_bf16 v[52:55], v[64:67], v[48:51], 0
  v_lshrrev_b32 v3, 1, v0
  v_mfma_f32_16x16x32_bf16 v[44:47], v[60:63], v[48:51], 0
  v_bfi_b32 v17, 31, v0, v3
  v_mfma_f32_16x16x32_bf16 v[56:59], v[48:51], v[48:51], 0
  v_smfmac_f32_16x16x64_bf16 v[68:71], v[20:23], a[96:103], v1
  v_cndmask_b32_dpp v44, v52, v44, vcc quad_perm:[2,3,2,3] row_mask:0xf bank_mask:0xf
  v_cndmask_b32_dpp v45, v53, v45, vcc quad_perm:[2,3,2,3] row_mask:0xf bank_mask:0xf
  v_cndmask_b32_dpp v46, v54, v46, vcc quad_perm:[2,3,2,3] row_mask:0xf bank_mask:0xf
  v_cndmask_b32_dpp v47, v55, v47, vcc quad_perm:[2,3,2,3] row_mask:0xf bank_mask:0xf
  ds_write_b128 v0, v[44:47] offset:11776
  v_cndmask_b32_dpp v56, v57, v56, vcc quad_perm:[2,3,2,3] row_mask:0xf bank_mask:0xf
  ds_write_addtid_b32 v56 offset:12800
  v_smfmac_f32_16x16x64_bf16 v[72:75], v[20:23], a[104:111], v1
  v_smfmac_f32_16x16x64_bf16 v[68:71], v[24:27], a[112:119], v1
  v_smfmac_f32_16x16x64_bf16 v[72:75], v[24:27], a[120:127], v1
  s_waitcnt lgkmcnt(0)
  s_barrier
  v_smfmac_f32_16x16x64_bf16 v[68:71], v[28:31], a[128:135], v1
  ds_read_b128 v[60:63], v0 offset:9216
  ds_read_b128 v[64:67], v0 offset:10496
  ds_read_b128 v[52:55], v0 offset:13056
  v_smfmac_f32_16x16x64_bf16 v[72:75], v[28:31], a[136:143], v1
  ds_read_addtid_b32 v57 offset:10240
  ds_read_addtid_b32 v58 offset:11520
  ds_read_addtid_b32 v59 offset:14080
  v_smfmac_f32_16x16x64_bf16 v[68:71], v[32:35], a[144:151], v1
  ds_read_b128 v[20:23], v0 offset:14336
  v_mul_f32 v56, s90, v56
  v_smfmac_f32_16x16x64_bf16 v[72:75], v[32:35], a[152:159], v1
  s_not_b64 exec, s[62:63]
  buffer_store_dwordx4 v[48:51], v17, s[4:7], s44 offen sc1
  s_mov_b64 exec, -1
  ds_read_b128 v[24:27], v0 offset:15360
  v_mul_f32 v44, s90, v44
  v_smfmac_f32_16x16x64_bf16 v[68:71], v[36:39], a[160:167], v1
  ds_read_b128 v[28:31], v2 offset:20480
  v_mul_f32 v45, s90, v45
  v_smfmac_f32_16x16x64_bf16 v[72:75], v[36:39], a[168:175], v1
  ds_read_b128 v[32:35], v2 offset:21504
  v_mul_f32 v46, s90, v46
  v_smfmac_f32_16x16x64_bf16 v[68:71], v[40:43], a[176:183], v1
  ds_read_b128 v[36:39], v2 offset:24576
  v_mul_f32 v47, s90, v47
  v_smfmac_f32_16x16x64_bf16 v[72:75], v[40:43], a[184:191], v1
  ds_read_b128 v[40:43], v2 offset:25600
  s_waitcnt lgkmcnt(6)
  v_fmac_f32 v56, s90, v57
  v_fmac_f32 v56, s90, v58
  v_fmac_f32 v56, s90, v59
  v_pk_fma_f32 v[44:45], v[60:61], s[90:91], v[44:45]
  v_pk_fma_f32 v[46:47], v[62:63], s[90:91], v[46:47]
  v_pk_fma_f32 v[44:45], v[64:65], s[90:91], v[44:45]
  v_pk_fma_f32 v[46:47], v[66:67], s[90:91], v[46:47]
  v_pk_fma_f32 v[44:45], v[52:53], s[90:91], v[44:45]
  v_pk_fma_f32 v[46:47], v[54:55], s[90:91], v[46:47]
  v_pk_add_f32 v[68:69], v[68:69], v[70:71]
  v_pk_add_f32 v[72:73], v[72:73], v[74:75]
  v_exp_f32 v44, v44
  v_exp_f32 v45, v45
  v_exp_f32 v46, v46
  v_cvt_pk_bf16_f32 v44, v44, v45
  v_exp_f32 v47, v47
  v_cvt_pk_bf16_f32 v70, v68, v69
  v_mov_b32_dpp v16, v44 quad_perm:[2,3,2,3] row_mask:0xf bank_mask:0xf
  v_cvt_pk_bf16_f32 v45, v46, v47
  v_mov_b32_dpp v17, v44 quad_perm:[0,1,0,1] row_mask:0xf bank_mask:0xf
  v_cvt_pk_bf16_f32 v71, v72, v73
  v_mov_b32_dpp v18, v45 quad_perm:[2,3,2,3] row_mask:0xf bank_mask:0xf
  v_mov_b32_dpp v19, v45 quad_perm:[0,1,0,1] row_mask:0xf bank_mask:0xf
  v_exp_f32_dpp v57, v56 quad_perm:[2,3,2,3] row_mask:0xf bank_mask:0xf
  v_min_u32 v70, -2, v70
  s_waitcnt lgkmcnt(4)
  v_mfma_f32_16x16x32_bf16 v[48:51], v[24:27], v[16:19], 0
  ds_read_b128 v[44:47], v0 offset:14336
  v_exp_f32_dpp v58, v56 quad_perm:[0,1,0,1] row_mask:0xf bank_mask:0xf
  s_waitcnt vmcnt(2)
  v_mfma_f32_16x16x32_bf16 v[52:55], v[8:11], v[16:19], 0
  ds_read_b128 v[72:75], v0 offset:14336
  v_cvt_pk_bf16_f32 v20, v57, v58
  s_waitcnt vmcnt(1)
  v_mfma_f32_16x16x32_bf16 v[60:63], v[12:15], v[16:19], 0
  ds_read_b128 v[64:67], v2 offset:29696
  v_cvt_pk_bf16_f32 v23, v57, v58
  v_mfma_f32_16x16x16_bf16 v[48:51], v[24:25], v[20:21], v[48:51]
  buffer_store_dwordx2 v[70:71], v3, s[4:7], s27 offen sc1
  ds_read_b128 v[24:27], v2 offset:17408
  v_mov_b64 v[56:57], 0
  v_mov_b64 v[58:59], 0
  v_mfma_f32_16x16x16_bf16 v[52:55], v[70:71], v[20:21], v[52:55]
  s_cmp_eq_u32 s37, 63
  s_cbranch_scc1 L_last2s
  v_mfma_f32_16x16x16_bf16 v[60:63], v[70:71], v[22:23], v[60:63]
  ds_read_b128 v[20:23], v2 offset:16384
  ds_read_b128 v[68:71], v0 offset:14336
  v_rcp_f32 v3, v48
  s_add_u32 s94, s41, s47
  v_pk_mul_f32 v[52:53], v[52:53], v[2:3] op_sel:[0,1] op_sel_hi:[1,1]
  v_pk_mul_f32 v[54:55], v[54:55], v[2:3] op_sel:[0,1] op_sel_hi:[1,1]
  v_cvt_pk_bf16_f32 v52, v52, v53
  v_cvt_pk_bf16_f32 v53, v54, v55
  v_pk_mul_f32 v[60:61], v[60:61], v[2:3] op_sel:[0,1] op_sel_hi:[1,1]
  v_pk_mul_f32 v[62:63], v[62:63], v[2:3] op_sel:[0,1] op_sel_hi:[1,1]
  v_cvt_pk_bf16_f32 v54, v60, v61
  v_cvt_pk_bf16_f32 v55, v62, v63
  ds_write_b128 v0, v[52:55] offset:2048
  s_waitcnt lgkmcnt(9)
  v_smfmac_f32_16x16x64_bf16 v[56:59], v[52:55], v[28:35], v1
  ds_read_b128 v[60:63], v2 offset:28672
  v_subrev_u32 v16, 0x2b800000, v3
  v_cmp_lt_u32 vcc, 0x23000000, v16
  s_waitcnt lgkmcnt(2)
  v_smfmac_f32_16x16x64_bf16 v[68:71], v[52:55], v[36:43], v1
  ds_read_b128 v[28:31], v2 offset:18432
  v_smfmac_f32_16x16x64_bf16 v[44:47], v[52:55], v[20:27], v1
  ds_read_b128 v[32:35], v2 offset:19456
  s_cbranch_vccnz L_guard2s
L_safe2s:
  s_waitcnt lgkmcnt(3)
  s_barrier
  ds_read_b128 v[8:11], v0 offset:0
  ds_read_b128 v[12:15], v0 offset:1024
  ds_read_b128 v[16:19], v0 offset:3072
  s_waitcnt lgkmcnt(5)
  v_smfmac_f32_16x16x64_bf16 v[72:75], v[52:55], v[60:67], v1
  ds_read_b128 v[36:39], v2 offset:22528
  s_waitcnt lgkmcnt(3)
  v_smfmac_f32_16x16x64_bf16 v[44:47], v[8:11], a[192:199], v1
  ds_read_b128 v[40:43], v2 offset:23552
  s_waitcnt lgkmcnt(3)
  v_smfmac_f32_16x16x64_bf16 v[44:47], v[12:15], a[200:207], v1
  ds_read_b128 v[20:23], v2 offset:26624
  s_waitcnt lgkmcnt(3)
  v_smfmac_f32_16x16x64_bf16 v[44:47], v[16:19], v[28:35], v1
  ds_read_b128 v[24:27], v2 offset:27648
  v_smfmac_f32_16x16x64_bf16 v[56:59], v[8:11], a[208:215], v1
  ds_read_b128 v[60:63], v2 offset:30720
  v_smfmac_f32_16x16x64_bf16 v[56:59], v[12:15], a[216:223], v1
  ds_read_b128 v[64:67], v2 offset:31744
  v_cvt_pk_bf16_f32 v44, v44, v45
  s_waitcnt lgkmcnt(4)
  v_smfmac_f32_16x16x64_bf16 v[56:59], v[16:19], v[36:43], v1
  v_cvt_pk_bf16_f32 v45, v46, v47
  v_smfmac_f32_16x16x64_bf16 v[68:71], v[8:11], a[224:231], v1
  v_bfi_b32 v44, 1, s46, v44
  v_smfmac_f32_16x16x64_bf16 v[68:71], v[12:15], a[232:239], v1
  v_cvt_pk_bf16_f32 v46, v56, v57
  s_waitcnt lgkmcnt(2)
  v_smfmac_f32_16x16x64_bf16 v[68:71], v[16:19], v[20:27], v1
  v_cvt_pk_bf16_f32 v47, v58, v59
  v_smfmac_f32_16x16x64_bf16 v[72:75], v[8:11], a[240:247], v1
  v_bfi_b32 v46, 1, s46, v46
  v_smfmac_f32_16x16x64_bf16 v[72:75], v[12:15], a[248:255], v1
  s_add_u32 s26, s94, 0x28000
  v_cvt_pk_bf16_f32 v68, v68, v69
  s_waitcnt lgkmcnt(0)
  v_smfmac_f32_16x16x64_bf16 v[72:75], v[16:19], v[60:67], v1
  buffer_store_dwordx4 v[44:47], v0, s[4:7], s26 offen sc1
  v_cvt_pk_bf16_f32 v69, v70, v71
  s_add_u32 s26, s94, 0x30000
  v_bfi_b32 v68, 1, s46, v68
  s_nop 3
  v_cvt_pk_bf16_f32 v70, v72, v73
  v_cvt_pk_bf16_f32 v71, v74, v75
  v_bfi_b32 v70, 1, s46, v70
  buffer_store_dwordx4 v[68:71], v0, s[4:7], s26 offen sc1
  s_add_u32 s28, s41, s66
  s_add_u32 s48, s28, 0
  s_add_u32 s49, s28, 8192
  s_add_u32 s50, s28, 16384
  s_add_u32 s51, s28, 24576
  s_waitcnt vmcnt(0)
  s_barrier
  buffer_load_dwordx4 v[44:47], v6, s[4:7], s48 offen sc1
  buffer_load_dwordx4 v[48:51], v6, s[4:7], s49 offen sc1
  buffer_load_dwordx4 v[52:55], v6, s[4:7], s50 offen sc1
  buffer_load_dwordx4 v[56:59], v6, s[4:7], s51 offen sc1
  s_add_u32 s37, s37, 1
  s_xor_b32 s41, s41, 0x48000
  s_add_u32 s61, s40, s60
  s_mov_b32 s26, s38
  s_mov_b32 s38, s40
  s_mov_b32 s40, s39
  s_mov_b32 s39, s26
  s_add_u32 s58, s40, 4096
  s_add_u32 s44, s44, 0x20000
  s_add_u32 s26, s40, s60
  s_mov_b32 s56, 0
  ds_read_b128 v[60:63], v2 offset:0
  ds_read_b128 v[64:67], v2 offset:1024
  ds_read_b128 v[20:23], v2 offset:2048
  ds_read_b128 v[24:27], v2 offset:3072
  ds_read_b128 v[28:31], v2 offset:12288
  ds_read_b128 v[32:35], v2 offset:13312
  ds_read_b128 v[36:39], v2 offset:14336
  ds_read_b128 v[40:43], v2 offset:15360
  v_mov_b32 v68, 0
  v_mov_b32 v69, 0
  v_mov_b32 v70, 0
  v_mov_b32 v71, 0
  v_mov_b32 v72, 0
  v_mov_b32 v73, 0
  v_mov_b32 v74, 0
  v_mov_b32 v75, 0
  v_mov_b32 v16, -1
L_rchk2s:
  s_waitcnt vmcnt(3)
  v_mfma_f32_16x16x32_bf16 v[8:11], v[44:47], v[76:79], 0
  v_bitop3_b32 v12, v44, v46, s46 bitop3:0x7e
  s_waitcnt vmcnt(2)
  v_mfma_f32_16x16x32_bf16 v[8:11], v[48:51], v[76:79], v[8:11]
  v_bitop3_b32 v13, v48, v50, s46 bitop3:0x7e
  s_waitcnt vmcnt(1)
  v_mfma_f32_16x16x32_bf16 v[8:11], v[52:55], v[76:79], v[8:11]
  v_bitop3_b32 v14, v52, v54, s46 bitop3:0x7e
  v_or3_b32 v12, v12, v13, v14
  s_waitcnt vmcnt(0)
  v_mfma_f32_16x16x32_bf16 v[8:11], v[56:59], v[76:79], v[8:11]
  v_bitop3_b32 v3, v56, v58, s46 bitop3:0x7e
  v_bitop3_b32 v3, v3, v12, 1 bitop3:0xa8
  v_cmp_ne_u32 vcc, 0, v3
  v_mov_b64 v[44:45], 0
  v_mov_b64 v[46:47], 0
  v_mov_b64 v[48:49], 0
  s_nop 1
  v_permlane32_swap_b32 v8, v10
  v_permlane32_swap_b32 v9, v11
  v_pk_add_f32 v[8:9], v[8:9], v[10:11]
  v_cvt_pk_bf16_f32 v8, v8, v9
  v_min_u32 v8, -2, v8
  s_cbranch_vccnz L_r2s
  buffer_store_dword v8, v7, s[4:7], s26 offen sc1
  v_mov_b64 v[50:51], 0
  v_mov_b64 v[52:53], 0
  v_mov_b64 v[54:55], 0
  v_mov_b64 v[56:57], 0
  v_mov_b64 v[58:59], 0
L_end2s:
  s_branch L_top2s
L_retry2s:
  buffer_load_dwordx4 v[8:11], v0, s[4:7], s58 offen offset:1024 sc1
  buffer_load_dwordx4 v[12:15], v0, s[4:7], s58 offen offset:0 sc1
  ds_read_b128 v[60:63], v2 offset:0
  ds_read_b128 v[64:67], v2 offset:1024
  s_nop 1
  v_mov_b64 v[44:45], 0
  v_mov_b64 v[46:47], 0
  v_mov_b64 v[48:49], 0
  v_mov_b64 v[50:51], 0
  v_mov_b64 v[52:53], 0
  v_mov_b64 v[54:55], 0
  v_mov_b64 v[56:57], 0
  v_mov_b64 v[58:59], 0
  v_mov_b64 v[68:69], 0
  v_mov_b64 v[70:71], 0
  v_mov_b64 v[72:73], 0
  v_mov_b64 v[74:75], 0
  s_add_u32 s56, s56, 1
  s_cmp_lt_u32 s56, 1048576
  s_cbranch_scc1 L_chk2s
  s_branch L_fail
L_guard2s:
  s_waitcnt vmcnt(0) lgkmcnt(0)
  v_lshrrev_b32 v3, 1, v0
  buffer_load_dwordx2 v[70:71], v3, s[4:7], s27 offen sc1
  s_nop 2
  ds_read_b128 v[44:47], v0 offset:11776
  ds_read_addtid_b32 v56 offset:12800
  ds_read_b128 v[60:63], v0 offset:9216
  ds_read_b128 v[64:67], v0 offset:10496
  ds_read_b128 v[52:55], v0 offset:13056
  ds_read_addtid_b32 v57 offset:10240
  ds_read_addtid_b32 v58 offset:11520
  ds_read_addtid_b32 v59 offset:14080
  ds_read_b128 v[20:23], v0 offset:14336
  ds_read_b128 v[24:27], v0 offset:15360
  s_waitcnt lgkmcnt(7)
  v_pk_add_f32 v[44:45], v[44:45], v[60:61]
  v_pk_add_f32 v[46:47], v[46:47], v[62:63]
  s_waitcnt lgkmcnt(4)
  v_add_f32 v56, v56, v57
  v_pk_add_f32 v[44:45], v[44:45], v[64:65]
  v_pk_add_f32 v[46:47], v[46:47], v[66:67]
  s_waitcnt lgkmcnt(3)
  v_add_f32 v56, v56, v58
  v_pk_add_f32 v[44:45], v[44:45], v[52:53]
  v_pk_add_f32 v[46:47], v[46:47], v[54:55]
  s_waitcnt lgkmcnt(2)
  v_add_f32 v56, v56, v59
  v_max3_f32 v50, v44, v45, v46
  v_max3_f32 v50, v50, v47, v56
  s_nop 1
  v_max_f32_dpp v48, v50, v50 quad_perm:[2,3,0,1] row_mask:0xf bank_mask:0xf
  v_max_f32_dpp v49, v50, v50 quad_perm:[2,3,0,1] row_mask:0xf bank_mask:0xf
  s_nop 1
  v_permlane32_swap_b32 v48, v49
  v_max_f32 v50, v48, v49
  v_max_f32 v51, v48, v49
  s_nop 1
  v_permlane16_swap_b32 v50, v51
  v_max_f32 v50, v50, v51
  v_sub_f32 v44, v44, v50
  v_mul_f32 v44, s90, v44
  v_sub_f32 v45, v45, v50
  v_mul_f32 v45, s90, v45
  v_sub_f32 v46, v46, v50
  v_mul_f32 v46, s90, v46
  v_sub_f32 v47, v47, v50
  v_mul_f32 v47, s90, v47
  v_sub_f32 v56, v56, v50
  v_mul_f32 v56, s90, v56
  v_exp_f32 v44, v44
  v_exp_f32 v45, v45
  v_exp_f32 v46, v46
  v_exp_f32 v47, v47
  v_exp_f32_dpp v57, v56 quad_perm:[2,3,2,3] row_mask:0xf bank_mask:0xf
  v_exp_f32_dpp v58, v56 quad_perm:[0,1,0,1] row_mask:0xf bank_mask:0xf
  v_cvt_pk_bf16_f32 v44, v44, v45
  v_cvt_pk_bf16_f32 v45, v46, v47
  s_waitcnt lgkmcnt(1)
  v_cvt_pk_bf16_f32 v20, v57, v58
  v_cvt_pk_bf16_f32 v23, v57, v58
  v_mov_b32_dpp v16, v44 quad_perm:[2,3,2,3] row_mask:0xf bank_mask:0xf
  v_mov_b32_dpp v17, v44 quad_perm:[0,1,0,1] row_mask:0xf bank_mask:0xf
  v_mov_b32_dpp v18, v45 quad_perm:[2,3,2,3] row_mask:0xf bank_mask:0xf
  v_mov_b32_dpp v19, v45 quad_perm:[0,1,0,1] row_mask:0xf bank_mask:0xf
  s_waitcnt lgkmcnt(0)
  s_nop 0
  v_mfma_f32_16x16x32_bf16 v[48:51], v[24:27], v[16:19], 0
  v_mfma_f32_16x16x32_bf16 v[52:55], v[8:11], v[16:19], 0
  v_mfma_f32_16x16x32_bf16 v[60:63], v[12:15], v[16:19], 0
  v_mfma_f32_16x16x16_bf16 v[48:51], v[24:25], v[20:21], v[48:51]
  s_waitcnt vmcnt(0)
  v_mfma_f32_16x16x16_bf16 v[52:55], v[70:71], v[20:21], v[52:55]
  v_mfma_f32_16x16x16_bf16 v[60:63], v[70:71], v[22:23], v[60:63]
  v_rcp_f32 v3, v48
  s_add_u32 s94, s41, s47
  s_nop 1
  v_pk_mul_f32 v[52:53], v[52:53], v[2:3] op_sel:[0,1] op_sel_hi:[1,1]
  v_pk_mul_f32 v[54:55], v[54:55], v[2:3] op_sel:[0,1] op_sel_hi:[1,1]
  v_cvt_pk_bf16_f32 v52, v52, v53
  v_cvt_pk_bf16_f32 v53, v54, v55
  v_pk_mul_f32 v[60:61], v[60:61], v[2:3] op_sel:[0,1] op_sel_hi:[1,1]
  v_pk_mul_f32 v[62:63], v[62:63], v[2:3] op_sel:[0,1] op_sel_hi:[1,1]
  v_cvt_pk_bf16_f32 v54, v60, v61
  v_cvt_pk_bf16_f32 v55, v62, v63
  ds_write_b128 v0, v[52:55] offset:2048
  ds_read_b128 v[44:47], v0 offset:14336
  ds_read_b128 v[56:59], v0 offset:14336
  ds_read_b128 v[68:71], v0 offset:14336
  ds_read_b128 v[72:75], v0 offset:14336
  ds_read_b128 v[20:23], v2 offset:16384
  ds_read_b128 v[24:27], v2 offset:17408
  ds_read_b128 v[28:31], v2 offset:20480
  ds_read_b128 v[32:35], v2 offset:21504
  ds_read_b128 v[36:39], v2 offset:24576
  ds_read_b128 v[40:43], v2 offset:25600
  ds_read_b128 v[60:63], v2 offset:28672
  ds_read_b128 v[64:67], v2 offset:29696
  s_waitcnt lgkmcnt(4)
  v_smfmac_f32_16x16x64_bf16 v[56:59], v[52:55], v[28:35], v1
  s_waitcnt lgkmcnt(2)
  v_smfmac_f32_16x16x64_bf16 v[68:71], v[52:55], v[36:43], v1
  v_smfmac_f32_16x16x64_bf16 v[44:47], v[52:55], v[20:27], v1
  ds_read_b128 v[28:31], v2 offset:18432
  ds_read_b128 v[32:35], v2 offset:19456
  s_waitcnt vmcnt(0) lgkmcnt(0)
  s_branch L_safe2s
L_r2s:
  buffer_load_dwordx4 v[44:47], v6, s[4:7], s48 offen sc1
  buffer_load_dwordx4 v[48:51], v6, s[4:7], s49 offen sc1
  buffer_load_dwordx4 v[52:55], v6, s[4:7], s50 offen sc1
  buffer_load_dwordx4 v[56:59], v6, s[4:7], s51 offen sc1
  s_add_u32 s56, s56, 1
  s_cmp_lt_u32 s56, 1048576
  s_cbranch_scc1 L_rchk2s
  s_branch L_fail
L_last2s:
  s_waitcnt vmcnt(0)
  s_barrier
  s_branch L_exit
L_recw3:
  v_add_u32 v2, 131072, v0
  v_lshrrev_b32 v20, 4, v1
  v_lshlrev_b32 v21, 13, v20
  v_and_b32 v20, 1, v20
  v_lshlrev_b32 v20, 6, v20
  v_and_b32 v22, 0xf0, v0
  v_xor_b32 v20, v20, v22
  s_lshl_b32 s27, s36, 8
  v_add3_u32 v8, v20, v21, s27
  v_xor_b32 v9, 0x80, v8
  s_mul_i32 s27, s36, 147456
  v_lshrrev_b32 v20, 3, v1
  v_mul_u32_u24 v20, 1152, v20
  v_and_b32 v21, 0x70, v0
  v_add3_u32 v10, v20, v21, s27
  v_lshrrev_b32 v20, 2, v1
  v_mul_u32_u24 v20, 1152, v20
  v_and_b32 v21, 0x30, v0
  v_add3_u32 v11, v20, v21, s27
  v_bfe_u32 v20, v1, 2, 2
  v_and_b32 v21, 1, v1
  v_lshl_add_u32 v20, v20, 1, v21
  v_mul_u32_u24 v20, 1152, v20
  v_lshrrev_b32 v21, 4, v1
  v_lshl_add_u32 v20, v21, 5, v20
  v_bfe_u32 v21, v1, 1, 1
  v_lshl_add_u32 v20, v21, 4, v20
  buffer_load_dwordx4 v[64:67], v20, s[84:87], 0 offen offset:768
  buffer_load_dwordx4 v[68:71], v20, s[84:87], 0 offen offset:896
  s_mov_b32 m0, 0x24000
  s_mov_b32 s27, 0x380
  buffer_load_dwordx4 v10, s[52:55], s27 offen  lds
  s_mov_b32 m0, 0x24400
  s_mov_b32 s27, 0x2780
  buffer_load_dwordx4 v10, s[52:55], s27 offen  lds
  s_mov_b32 m0, 0x24800
  s_mov_b32 s27, 0x4b80
  buffer_load_dwordx4 v10, s[52:55], s27 offen  lds
  s_mov_b32 m0, 0x24c00
  s_mov_b32 s27, 0x6f80
  buffer_load_dwordx4 v10, s[52:55], s27 offen  lds
  s_mov_b32 m0, 0x25000
  s_mov_b32 s27, 0x9380
  buffer_load_dwordx4 v10, s[52:55], s27 offen  lds
  s_mov_b32 m0, 0x25400
  s_mov_b32 s27, 0xb780
  buffer_load_dwordx4 v10, s[52:55], s27 offen  lds
  s_mov_b32 m0, 0x25800
  s_mov_b32 s27, 0xdb80
  buffer_load_dwordx4 v10, s[52:55], s27 offen  lds
  s_mov_b32 m0, 0x25c00
  s_mov_b32 s27, 0xff80
  buffer_load_dwordx4 v10, s[52:55], s27 offen  lds
  s_mov_b32 m0, 0x26000
  s_mov_b32 s27, 0x400
  buffer_load_dwordx4 v10, s[52:55], s27 offen  lds
  s_mov_b32 m0, 0x26400
  s_mov_b32 s27, 0x2800
  buffer_load_dwordx4 v10, s[52:55], s27 offen  lds
  s_mov_b32 m0, 0x26800
  s_mov_b32 s27, 0x4c00
  buffer_load_dwordx4 v10, s[52:55], s27 offen  lds
  s_mov_b32 m0, 0x26c00
  s_mov_b32 s27, 0x7000
  buffer_load_dwordx4 v10, s[52:55], s27 offen  lds
  s_mov_b32 m0, 0x27000
  s_mov_b32 s27, 0x9400
  buffer_load_dwordx4 v10, s[52:55], s27 offen  lds
  s_mov_b32 m0, 0x27400
  s_mov_b32 s27, 0xb800
  buffer_load_dwordx4 v10, s[52:55], s27 offen  lds
  s_mov_b32 m0, 0x27800
  s_mov_b32 s27, 0xdc00
  buffer_load_dwordx4 v10, s[52:55], s27 offen  lds
  s_mov_b32 m0, 0x27c00
  s_mov_b32 s27, 0x10000
  buffer_load_dwordx4 v10, s[52:55], s27 offen  lds
  s_mov_b32 m0, 0x20000
  s_mov_b32 s27, 0x60000
  buffer_load_dwordx4 v8, s[16:19], s27 offen  lds
  s_mov_b32 m0, 0x20400
  s_mov_b32 s27, 0x68000
  buffer_load_dwordx4 v8, s[16:19], s27 offen  lds
  s_mov_b32 m0, 0x20800
  s_mov_b32 s27, 0x70000
  buffer_load_dwordx4 v9, s[16:19], s27 offen  lds
  s_mov_b32 m0, 0x20c00
  s_mov_b32 s27, 0x78000
  buffer_load_dwordx4 v9, s[16:19], s27 offen  lds
  s_mov_b32 m0, 0x21000
  s_mov_b32 s27, 0xe0000
  buffer_load_dwordx4 v8, s[16:19], s27 offen  lds
  s_mov_b32 m0, 0x21400
  s_mov_b32 s27, 0xe8000
  buffer_load_dwordx4 v8, s[16:19], s27 offen  lds
  s_mov_b32 m0, 0x21800
  s_mov_b32 s27, 0xf0000
  buffer_load_dwordx4 v9, s[16:19], s27 offen  lds
  s_mov_b32 m0, 0x21c00
  s_mov_b32 s27, 0xf8000
  buffer_load_dwordx4 v9, s[16:19], s27 offen  lds
  s_mov_b32 m0, 0x22000
  s_mov_b32 s27, 0x160000
  buffer_load_dwordx4 v8, s[16:19], s27 offen  lds
  s_mov_b32 m0, 0x22400
  s_mov_b32 s27, 0x168000
  buffer_load_dwordx4 v8, s[16:19], s27 offen  lds
  s_mov_b32 m0, 0x22800
  s_mov_b32 s27, 0x170000
  buffer_load_dwordx4 v9, s[16:19], s27 offen  lds
  s_mov_b32 m0, 0x22c00
  s_mov_b32 s27, 0x178000
  buffer_load_dwordx4 v9, s[16:19], s27 offen  lds
  s_mov_b32 m0, 0x23000
  s_mov_b32 s27, 0x1e0000
  buffer_load_dwordx4 v8, s[16:19], s27 offen  lds
  s_mov_b32 m0, 0x23400
  s_mov_b32 s27, 0x1e8000
  buffer_load_dwordx4 v8, s[16:19], s27 offen  lds
  s_mov_b32 m0, 0x23800
  s_mov_b32 s27, 0x1f0000
  buffer_load_dwordx4 v9, s[16:19], s27 offen  lds
  s_mov_b32 m0, 0x23c00
  s_mov_b32 s27, 0x1f8000
  buffer_load_dwordx4 v9, s[16:19], s27 offen  lds
  v_bfe_u32 v20, v1, 4, 1
  v_lshlrev_b32 v20, 10, v20
  v_bfe_u32 v21, v1, 3, 1
  v_lshl_add_u32 v20, v21, 11, v20
  v_bfe_u32 v22, v1, 2, 1
  v_lshl_add_u32 v20, v22, 8, v20
  v_bfe_u32 v23, v1, 2, 2
  v_xor_b32 v23, 3, v23
  v_lshl_add_u32 v20, v23, 6, v20
  v_bfe_u32 v23, v1, 5, 1
  v_and_b32 v24, 3, v1
  v_mul_u32_u24 v25, 40960, v23
  v_add_u32 v25, 16384, v25
  v_add_u32 v25, v25, v20
  v_lshl_add_u32 v12, v24, 4, v25
  v_lshl_add_u32 v14, v24, 3, v25
  v_mul_u32_u24 v25, 32768, v23
  v_add_u32 v25, 98304, v25
  v_add_u32 v25, v25, v20
  v_lshl_add_u32 v13, v24, 4, v25
  v_lshl_add_u32 v15, v24, 3, v25
  v_and_b32 v20, 16, v1
  v_lshl_add_u32 v20, v23, 2, v20
  v_add_u32 v20, v20, v22
  v_lshlrev_b32 v25, 5, v21
  v_lshl_add_u32 v25, v24, 3, v25
  v_add_u32 v25, 131072, v25
  v_lshl_add_u32 v16, v20, 7, v25
  v_lshl_add_u32 v17, v20, 6, v25
  v_and_b32 v24, 15, v1
  v_lshrrev_b32 v25, 4, v1
  v_lshlrev_b32 v26, 2, v25
  v_sub_u32 v27, v24, v26
  v_mov_b32 v28, 0x3f80
  v_cmp_eq_u32 vcc, 0, v27
  s_nop 1
  v_cndmask_b32 v4, 0, v28, vcc
  v_mov_b32 v28, 0x3f800000
  v_cmp_eq_u32 vcc, 1, v27
  s_nop 1
  v_cndmask_b32 v4, v4, v28, vcc
  v_mov_b32 v28, 0x3f80
  v_cmp_eq_u32 vcc, 2, v27
  s_nop 1
  v_cndmask_b32 v5, 0, v28, vcc
  v_mov_b32 v28, 0x3f800000
  v_cmp_eq_u32 vcc, 3, v27
  s_nop 1
  v_cndmask_b32 v5, v5, v28, vcc
  v_and_b32 v6, 0x380, v0
  v_and_b32 v26, 0x70, v0
  v_lshl_add_u32 v6, v6, 3, v26
  v_bfe_u32 v7, v1, 4, 1
  v_bfe_u32 v26, v1, 5, 1
  v_lshl_add_u32 v7, v7, 1, v26
  v_and_b32 v26, 0x10, v0
  v_lshl_add_u32 v7, v7, 2, v26
  v_and_b32 v26, 0x60, v0
  v_lshl_add_u32 v7, v26, 3, v7
  v_and_b32 v26, 0x80, v0
  v_lshl_add_u32 v7, v26, 23, v7
  v_and_b32 v26, 0x10, v0
  v_mov_b32 v28, 0x3f80
  v_lshlrev_b32 v28, v26, v28
  v_lshrrev_b32 v26, 1, v24
  v_cmp_eq_u32 vcc, 0, v26
  s_nop 1
  v_cndmask_b32 v76, 0, v28, vcc
  v_cmp_eq_u32 vcc, 1, v26
  s_nop 1
  v_cndmask_b32 v77, 0, v28, vcc
  v_cmp_eq_u32 vcc, 2, v26
  s_nop 1
  v_cndmask_b32 v78, 0, v28, vcc
  v_cmp_eq_u32 vcc, 3, v26
  s_nop 1
  v_cndmask_b32 v79, 0, v28, vcc
  s_mov_b32 s62, 0xcccccccc
  s_mov_b32 s63, 0xcccccccc
  s_mov_b32 s64, 0x3f803f80
  s_mov_b32 s65, 0x3f803f80
  s_mov_b32 s90, 0x3e0293ee
  s_mov_b32 s91, 0x3e0293ee
  v_mov_b32 v27, 0x44444444
  v_mov_b32 v28, 0xeeeeeeee
  v_cndmask_b32 v1, v27, v28, s[62:63]
  s_mov_b32 s37, 0
  s_mov_b32 s41, 0x110000
  s_mov_b32 s46, 0
  s_mov_b32 s40, 0x100000
  s_mov_b32 s39, 0x104000
  s_mov_b32 s38, 0x108000
  s_lshl_b32 s26, s36, 13
  s_add_u32 s42, s26, 0x2000c00
  s_add_u32 s43, s26, 0x3001800
  s_lshl_b32 s26, s36, 12
  s_add_u32 s44, s26, 0x4000c00
  s_lshl_b32 s47, s36, 10
  s_add_u32 s26, s36, 32
  s_lshr_b32 s27, s26, 3
  s_and_b32 s28, s26, 7
  s_lshl_b32 s66, s27, 15
  s_lshl_b32 s29, s28, 7
  s_add_u32 s66, s66, s29
  s_lshl_b32 s60, s27, 10
  s_lshl_b32 s29, s28, 5
  s_add_u32 s60, s60, s29
  s_mov_b32 s61, 0x40000000
  s_lshr_b32 s26, s36, 1
  s_lshl_b32 s26, s26, 9
  s_and_b32 s27, s36, 1
  s_lshl_b32 s28, s27, 1
  s_lshl_b32 s92, 0x330, s28
  s_mov_b32 s93, 0
  s_add_u32 s57, s26, 0x84000
  s_lshl_b32 s27, s27, 4
  s_add_u32 s45, s26, s27
  s_add_u32 s45, s45, 0x7e0c0
  s_waitcnt vmcnt(24)
  ds_read_b64_tr_b16 a[192:193], v16 offset:16384
  ds_read_b64_tr_b16 a[194:195], v16 offset:16640
  ds_read_b64_tr_b16 a[196:197], v16 offset:17408
  ds_read_b64_tr_b16 a[198:199], v16 offset:17664
  ds_read_b64_tr_b16 a[200:201], v16 offset:20480
  ds_read_b64_tr_b16 a[202:203], v16 offset:20736
  ds_read_b64_tr_b16 a[204:205], v16 offset:21504
  ds_read_b64_tr_b16 a[206:207], v16 offset:21760
  ds_read_b64_tr_b16 a[208:209], v16 offset:16448
  ds_read_b64_tr_b16 a[210:211], v16 offset:16704
  ds_read_b64_tr_b16 a[212:213], v16 offset:17472
  ds_read_b64_tr_b16 a[214:215], v16 offset:17728
  ds_read_b64_tr_b16 a[216:217], v16 offset:20544
  ds_read_b64_tr_b16 a[218:219], v16 offset:20800
  ds_read_b64_tr_b16 a[220:221], v16 offset:21568
  ds_read_b64_tr_b16 a[222:223], v16 offset:21824
  s_waitcnt vmcnt(16)
  ds_read_b64_tr_b16 a[224:225], v16 offset:24576
  ds_read_b64_tr_b16 a[226:227], v16 offset:24832
  ds_read_b64_tr_b16 a[228:229], v16 offset:25600
  ds_read_b64_tr_b16 a[230:231], v16 offset:25856
  ds_read_b64_tr_b16 a[232:233], v16 offset:28672
  ds_read_b64_tr_b16 a[234:235], v16 offset:28928
  ds_read_b64_tr_b16 a[236:237], v16 offset:29696
  ds_read_b64_tr_b16 a[238:239], v16 offset:29952
  ds_read_b64_tr_b16 a[240:241], v16 offset:24640
  ds_read_b64_tr_b16 a[242:243], v16 offset:24896
  ds_read_b64_tr_b16 a[244:245], v16 offset:25664
  ds_read_b64_tr_b16 a[246:247], v16 offset:25920
  ds_read_b64_tr_b16 a[248:249], v16 offset:28736
  ds_read_b64_tr_b16 a[250:251], v16 offset:28992
  ds_read_b64_tr_b16 a[252:253], v16 offset:29760
  ds_read_b64_tr_b16 a[254:255], v16 offset:30016
  s_waitcnt lgkmcnt(0)
  s_mov_b32 m0, 0x24000
  s_mov_b32 s27, 0x260000
  buffer_load_dwordx4 v8, s[16:19], s27 offen  lds
  s_mov_b32 m0, 0x24400
  s_mov_b32 s27, 0x268000
  buffer_load_dwordx4 v8, s[16:19], s27 offen  lds
  s_mov_b32 m0, 0x24800
  s_mov_b32 s27, 0x270000
  buffer_load_dwordx4 v9, s[16:19], s27 offen  lds
  s_mov_b32 m0, 0x24c00
  s_mov_b32 s27, 0x278000
  buffer_load_dwordx4 v9, s[16:19], s27 offen  lds
  s_mov_b32 m0, 0x25000
  s_mov_b32 s27, 0x2e0000
  buffer_load_dwordx4 v8, s[16:19], s27 offen  lds
  s_mov_b32 m0, 0x25400
  s_mov_b32 s27, 0x2e8000
  buffer_load_dwordx4 v8, s[16:19], s27 offen  lds
  s_mov_b32 m0, 0x25800
  s_mov_b32 s27, 0x2f0000
  buffer_load_dwordx4 v9, s[16:19], s27 offen  lds
  s_mov_b32 m0, 0x25c00
  s_mov_b32 s27, 0x2f8000
  buffer_load_dwordx4 v9, s[16:19], s27 offen  lds
  s_mov_b32 m0, 0x26000
  s_mov_b32 s27, 0x360000
  buffer_load_dwordx4 v8, s[16:19], s27 offen  lds
  s_mov_b32 m0, 0x26400
  s_mov_b32 s27, 0x368000
  buffer_load_dwordx4 v8, s[16:19], s27 offen  lds
  s_mov_b32 m0, 0x26800
  s_mov_b32 s27, 0x370000
  buffer_load_dwordx4 v9, s[16:19], s27 offen  lds
  s_mov_b32 m0, 0x26c00
  s_mov_b32 s27, 0x378000
  buffer_load_dwordx4 v9, s[16:19], s27 offen  lds
  s_mov_b32 m0, 0x27000
  s_mov_b32 s27, 0x3e0000
  buffer_load_dwordx4 v8, s[16:19], s27 offen  lds
  s_mov_b32 m0, 0x27400
  s_mov_b32 s27, 0x3e8000
  buffer_load_dwordx4 v8, s[16:19], s27 offen  lds
  s_mov_b32 m0, 0x27800
  s_mov_b32 s27, 0x3f0000
  buffer_load_dwordx4 v9, s[16:19], s27 offen  lds
  s_mov_b32 m0, 0x27c00
  s_mov_b32 s27, 0x3f8000
  buffer_load_dwordx4 v9, s[16:19], s27 offen  lds
  s_waitcnt vmcnt(28)
  s_waitcnt lgkmcnt(0)
  s_barrier
  ds_read_b64_tr_b16 a[96:97], v14 offset:0
  ds_read_b64_tr_b16 a[98:99], v14 offset:512
  ds_read_b64_tr_b16 a[100:101], v15 offset:0
  ds_read_b64_tr_b16 a[102:103], v15 offset:512
  ds_read_b64_tr_b16 a[104:105], v14 offset:32
  ds_read_b64_tr_b16 a[106:107], v14 offset:544
  ds_read_b64_tr_b16 a[108:109], v15 offset:32
  ds_read_b64_tr_b16 a[110:111], v15 offset:544
  s_waitcnt vmcnt(24)
  s_waitcnt lgkmcnt(0)
  s_barrier
  s_mov_b32 m0, 0x20000
  s_mov_b32 s27, 0x460000
  buffer_load_dwordx4 v8, s[16:19], s27 offen  lds
  s_mov_b32 m0, 0x20400
  s_mov_b32 s27, 0x468000
  buffer_load_dwordx4 v8, s[16:19], s27 offen  lds
  s_mov_b32 m0, 0x20800
  s_mov_b32 s27, 0x470000
  buffer_load_dwordx4 v9, s[16:19], s27 offen  lds
  s_mov_b32 m0, 0x20c00
  s_mov_b32 s27, 0x478000
  buffer_load_dwordx4 v9, s[16:19], s27 offen  lds
  ds_read_b64_tr_b16 a[112:113], v14 offset:4096
  ds_read_b64_tr_b16 a[114:115], v14 offset:4608
  ds_read_b64_tr_b16 a[116:117], v15 offset:4096
  ds_read_b64_tr_b16 a[118:119], v15 offset:4608
  ds_read_b64_tr_b16 a[120:121], v14 offset:4128
  ds_read_b64_tr_b16 a[122:123], v14 offset:4640
  ds_read_b64_tr_b16 a[124:125], v15 offset:4128
  ds_read_b64_tr_b16 a[126:127], v15 offset:4640
  s_waitcnt vmcnt(24)
  s_waitcnt lgkmcnt(0)
  s_barrier
  s_mov_b32 m0, 0x21000
  s_mov_b32 s27, 0x60000
  buffer_load_dwordx4 v8, s[8:11], s27 offen  lds
  s_mov_b32 m0, 0x21400
  s_mov_b32 s27, 0x68000
  buffer_load_dwordx4 v8, s[8:11], s27 offen  lds
  s_mov_b32 m0, 0x21800
  s_mov_b32 s27, 0x70000
  buffer_load_dwordx4 v9, s[8:11], s27 offen  lds
  s_mov_b32 m0, 0x21c00
  s_mov_b32 s27, 0x78000
  buffer_load_dwordx4 v9, s[8:11], s27 offen  lds
  ds_read_b64_tr_b16 a[128:129], v14 offset:8192
  ds_read_b64_tr_b16 a[130:131], v14 offset:8704
  ds_read_b64_tr_b16 a[132:133], v15 offset:8192
  ds_read_b64_tr_b16 a[134:135], v15 offset:8704
  ds_read_b64_tr_b16 a[136:137], v14 offset:8224
  ds_read_b64_tr_b16 a[138:139], v14 offset:8736
  ds_read_b64_tr_b16 a[140:141], v15 offset:8224
  ds_read_b64_tr_b16 a[142:143], v15 offset:8736
  s_waitcnt vmcnt(24)
  s_waitcnt lgkmcnt(0)
  s_barrier
  s_mov_b32 m0, 0x22000
  s_mov_b32 s27, 0xe0000
  buffer_load_dwordx4 v8, s[8:11], s27 offen  lds
  s_mov_b32 m0, 0x22400
  s_mov_b32 s27, 0xe8000
  buffer_load_dwordx4 v8, s[8:11], s27 offen  lds
  s_mov_b32 m0, 0x22800
  s_mov_b32 s27, 0xf0000
  buffer_load_dwordx4 v9, s[8:11], s27 offen  lds
  s_mov_b32 m0, 0x22c00
  s_mov_b32 s27, 0xf8000
  buffer_load_dwordx4 v9, s[8:11], s27 offen  lds
  ds_read_b64_tr_b16 a[144:145], v14 offset:12288
  ds_read_b64_tr_b16 a[146:147], v14 offset:12800
  ds_read_b64_tr_b16 a[148:149], v15 offset:12288
  ds_read_b64_tr_b16 a[150:151], v15 offset:12800
  ds_read_b64_tr_b16 a[152:153], v14 offset:12320
  ds_read_b64_tr_b16 a[154:155], v14 offset:12832
  ds_read_b64_tr_b16 a[156:157], v15 offset:12320
  ds_read_b64_tr_b16 a[158:159], v15 offset:12832
  s_waitcnt vmcnt(24)
  s_waitcnt lgkmcnt(0)
  s_barrier
  s_mov_b32 m0, 0x23000
  s_mov_b32 s27, 0x160000
  buffer_load_dwordx4 v8, s[8:11], s27 offen  lds
  s_mov_b32 m0, 0x23400
  s_mov_b32 s27, 0x168000
  buffer_load_dwordx4 v8, s[8:11], s27 offen  lds
  s_mov_b32 m0, 0x23800
  s_mov_b32 s27, 0x170000
  buffer_load_dwordx4 v9, s[8:11], s27 offen  lds
  s_mov_b32 m0, 0x23c00
  s_mov_b32 s27, 0x178000
  buffer_load_dwordx4 v9, s[8:11], s27 offen  lds
  ds_read_b64_tr_b16 a[160:161], v14 offset:16384
  ds_read_b64_tr_b16 a[162:163], v14 offset:16896
  ds_read_b64_tr_b16 a[164:165], v15 offset:16384
  ds_read_b64_tr_b16 a[166:167], v15 offset:16896
  ds_read_b64_tr_b16 a[168:169], v14 offset:16416
  ds_read_b64_tr_b16 a[170:171], v14 offset:16928
  ds_read_b64_tr_b16 a[172:173], v15 offset:16416
  ds_read_b64_tr_b16 a[174:175], v15 offset:16928
  s_waitcnt vmcnt(24)
  s_waitcnt lgkmcnt(0)
  s_barrier
  s_mov_b32 m0, 0x24000
  s_mov_b32 s27, 0x1e0000
  buffer_load_dwordx4 v8, s[8:11], s27 offen  lds
  s_mov_b32 m0, 0x24400
  s_mov_b32 s27, 0x1e8000
  buffer_load_dwordx4 v8, s[8:11], s27 offen  lds
  s_mov_b32 m0, 0x24800
  s_mov_b32 s27, 0x1f0000
  buffer_load_dwordx4 v9, s[8:11], s27 offen  lds
  s_mov_b32 m0, 0x24c00
  s_mov_b32 s27, 0x1f8000
  buffer_load_dwordx4 v9, s[8:11], s27 offen  lds
  ds_read_b64_tr_b16 a[176:177], v14 offset:20480
  ds_read_b64_tr_b16 a[178:179], v14 offset:20992
  ds_read_b64_tr_b16 a[180:181], v15 offset:20480
  ds_read_b64_tr_b16 a[182:183], v15 offset:20992
  ds_read_b64_tr_b16 a[184:185], v14 offset:20512
  ds_read_b64_tr_b16 a[186:187], v14 offset:21024
  ds_read_b64_tr_b16 a[188:189], v15 offset:20512
  ds_read_b64_tr_b16 a[190:191], v15 offset:21024
  s_waitcnt vmcnt(24)
  s_waitcnt lgkmcnt(0)
  s_barrier
  s_mov_b32 m0, 0x25000
  s_mov_b32 s27, 0x260000
  buffer_load_dwordx4 v8, s[8:11], s27 offen  lds
  s_mov_b32 m0, 0x25400
  s_mov_b32 s27, 0x268000
  buffer_load_dwordx4 v8, s[8:11], s27 offen  lds
  s_mov_b32 m0, 0x25800
  s_mov_b32 s27, 0x270000
  buffer_load_dwordx4 v9, s[8:11], s27 offen  lds
  s_mov_b32 m0, 0x25c00
  s_mov_b32 s27, 0x278000
  buffer_load_dwordx4 v9, s[8:11], s27 offen  lds
  ds_read_b64_tr_b16 a[48:49], v14 offset:24576
  ds_read_b64_tr_b16 a[50:51], v14 offset:25088
  ds_read_b64_tr_b16 a[52:53], v15 offset:24576
  ds_read_b64_tr_b16 a[54:55], v15 offset:25088
  ds_read_b64_tr_b16 a[56:57], v14 offset:24608
  ds_read_b64_tr_b16 a[58:59], v14 offset:25120
  ds_read_b64_tr_b16 a[60:61], v15 offset:24608
  ds_read_b64_tr_b16 a[62:63], v15 offset:25120
  s_waitcnt vmcnt(24)
  s_waitcnt lgkmcnt(0)
  s_barrier
  s_mov_b32 m0, 0x26000
  s_mov_b32 s27, 0x2e0000
  buffer_load_dwordx4 v8, s[8:11], s27 offen  lds
  s_mov_b32 m0, 0x26400
  s_mov_b32 s27, 0x2e8000
  buffer_load_dwordx4 v8, s[8:11], s27 offen  lds
  s_mov_b32 m0, 0x26800
  s_mov_b32 s27, 0x2f0000
  buffer_load_dwordx4 v9, s[8:11], s27 offen  lds
  s_mov_b32 m0, 0x26c00
  s_mov_b32 s27, 0x2f8000
  buffer_load_dwordx4 v9, s[8:11], s27 offen  lds
  ds_read_b64_tr_b16 a[64:65], v14 offset:28672
  ds_read_b64_tr_b16 a[66:67], v14 offset:29184
  ds_read_b64_tr_b16 a[68:69], v15 offset:28672
  ds_read_b64_tr_b16 a[70:71], v15 offset:29184
  ds_read_b64_tr_b16 a[72:73], v14 offset:28704
  ds_read_b64_tr_b16 a[74:75], v14 offset:29216
  ds_read_b64_tr_b16 a[76:77], v15 offset:28704
  ds_read_b64_tr_b16 a[78:79], v15 offset:29216
  s_waitcnt vmcnt(24)
  s_waitcnt lgkmcnt(0)
  s_barrier
  s_mov_b32 m0, 0x27000
  s_mov_b32 s27, 0x360000
  buffer_load_dwordx4 v8, s[8:11], s27 offen  lds
  s_mov_b32 m0, 0x27400
  s_mov_b32 s27, 0x368000
  buffer_load_dwordx4 v8, s[8:11], s27 offen  lds
  s_mov_b32 m0, 0x27800
  s_mov_b32 s27, 0x370000
  buffer_load_dwordx4 v9, s[8:11], s27 offen  lds
  s_mov_b32 m0, 0x27c00
  s_mov_b32 s27, 0x378000
  buffer_load_dwordx4 v9, s[8:11], s27 offen  lds
  ds_read_b64_tr_b16 a[80:81], v14 offset:0
  ds_read_b64_tr_b16 a[82:83], v14 offset:512
  ds_read_b64_tr_b16 a[84:85], v15 offset:0
  ds_read_b64_tr_b16 a[86:87], v15 offset:512
  ds_read_b64_tr_b16 a[88:89], v14 offset:32
  ds_read_b64_tr_b16 a[90:91], v14 offset:544
  ds_read_b64_tr_b16 a[92:93], v15 offset:32
  ds_read_b64_tr_b16 a[94:95], v15 offset:544
  s_waitcnt vmcnt(24)
  s_waitcnt lgkmcnt(0)
  s_barrier
  s_mov_b32 m0, 0x20000
  s_mov_b32 s27, 0x3e0000
  buffer_load_dwordx4 v8, s[8:11], s27 offen  lds
  s_mov_b32 m0, 0x20400
  s_mov_b32 s27, 0x3e8000
  buffer_load_dwordx4 v8, s[8:11], s27 offen  lds
  s_mov_b32 m0, 0x20800
  s_mov_b32 s27, 0x3f0000
  buffer_load_dwordx4 v9, s[8:11], s27 offen  lds
  s_mov_b32 m0, 0x20c00
  s_mov_b32 s27, 0x3f8000
  buffer_load_dwordx4 v9, s[8:11], s27 offen  lds
  ds_read_b64_tr_b16 v[112:113], v12 offset:4096
  ds_read_b64_tr_b16 v[114:115], v12 offset:4608
  ds_read_b64_tr_b16 v[116:117], v13 offset:4096
  ds_read_b64_tr_b16 v[118:119], v13 offset:4608
  ds_read_b64_tr_b16 v[120:121], v12 offset:4104
  ds_read_b64_tr_b16 v[122:123], v12 offset:4616
  ds_read_b64_tr_b16 v[124:125], v13 offset:4104
  ds_read_b64_tr_b16 v[126:127], v13 offset:4616
  s_waitcnt vmcnt(24)
  s_waitcnt lgkmcnt(0)
  s_barrier
  s_mov_b32 m0, 0x21000
  s_mov_b32 s27, 0x60000
  buffer_load_dwordx4 v8, s[12:15], s27 offen  lds
  s_mov_b32 m0, 0x21400
  s_mov_b32 s27, 0x68000
  buffer_load_dwordx4 v8, s[12:15], s27 offen  lds
  s_mov_b32 m0, 0x21800
  s_mov_b32 s27, 0x70000
  buffer_load_dwordx4 v9, s[12:15], s27 offen  lds
  s_mov_b32 m0, 0x21c00
  s_mov_b32 s27, 0x78000
  buffer_load_dwordx4 v9, s[12:15], s27 offen  lds
  ds_read_b64_tr_b16 v[128:129], v12 offset:8192
  ds_read_b64_tr_b16 v[130:131], v12 offset:8704
  ds_read_b64_tr_b16 v[132:133], v13 offset:8192
  ds_read_b64_tr_b16 v[134:135], v13 offset:8704
  ds_read_b64_tr_b16 v[136:137], v12 offset:8200
  ds_read_b64_tr_b16 v[138:139], v12 offset:8712
  ds_read_b64_tr_b16 v[140:141], v13 offset:8200
  ds_read_b64_tr_b16 v[142:143], v13 offset:8712
  s_waitcnt vmcnt(24)
  s_waitcnt lgkmcnt(0)
  s_barrier
  s_mov_b32 m0, 0x22000
  s_mov_b32 s27, 0xe0000
  buffer_load_dwordx4 v8, s[12:15], s27 offen  lds
  s_mov_b32 m0, 0x22400
  s_mov_b32 s27, 0xe8000
  buffer_load_dwordx4 v8, s[12:15], s27 offen  lds
  s_mov_b32 m0, 0x22800
  s_mov_b32 s27, 0xf0000
  buffer_load_dwordx4 v9, s[12:15], s27 offen  lds
  s_mov_b32 m0, 0x22c00
  s_mov_b32 s27, 0xf8000
  buffer_load_dwordx4 v9, s[12:15], s27 offen  lds
  ds_read_b64_tr_b16 v[144:145], v12 offset:12288
  ds_read_b64_tr_b16 v[146:147], v12 offset:12800
  ds_read_b64_tr_b16 v[148:149], v13 offset:12288
  ds_read_b64_tr_b16 v[150:151], v13 offset:12800
  ds_read_b64_tr_b16 v[152:153], v12 offset:12296
  ds_read_b64_tr_b16 v[154:155], v12 offset:12808
  ds_read_b64_tr_b16 v[156:157], v13 offset:12296
  ds_read_b64_tr_b16 v[158:159], v13 offset:12808
  s_waitcnt vmcnt(24)
  s_waitcnt lgkmcnt(0)
  s_barrier
  s_mov_b32 m0, 0x23000
  s_mov_b32 s27, 0x160000
  buffer_load_dwordx4 v8, s[12:15], s27 offen  lds
  s_mov_b32 m0, 0x23400
  s_mov_b32 s27, 0x168000
  buffer_load_dwordx4 v8, s[12:15], s27 offen  lds
  s_mov_b32 m0, 0x23800
  s_mov_b32 s27, 0x170000
  buffer_load_dwordx4 v9, s[12:15], s27 offen  lds
  s_mov_b32 m0, 0x23c00
  s_mov_b32 s27, 0x178000
  buffer_load_dwordx4 v9, s[12:15], s27 offen  lds
  ds_read_b64_tr_b16 v[160:161], v12 offset:16384
  ds_read_b64_tr_b16 v[162:163], v12 offset:16896
  ds_read_b64_tr_b16 v[164:165], v13 offset:16384
  ds_read_b64_tr_b16 v[166:167], v13 offset:16896
  ds_read_b64_tr_b16 v[168:169], v12 offset:16392
  ds_read_b64_tr_b16 v[170:171], v12 offset:16904
  ds_read_b64_tr_b16 v[172:173], v13 offset:16392
  ds_read_b64_tr_b16 v[174:175], v13 offset:16904
  s_waitcnt vmcnt(24)
  s_waitcnt lgkmcnt(0)
  s_barrier
  s_mov_b32 m0, 0x24000
  s_mov_b32 s27, 0x1e0000
  buffer_load_dwordx4 v8, s[12:15], s27 offen  lds
  s_mov_b32 m0, 0x24400
  s_mov_b32 s27, 0x1e8000
  buffer_load_dwordx4 v8, s[12:15], s27 offen  lds
  s_mov_b32 m0, 0x24800
  s_mov_b32 s27, 0x1f0000
  buffer_load_dwordx4 v9, s[12:15], s27 offen  lds
  s_mov_b32 m0, 0x24c00
  s_mov_b32 s27, 0x1f8000
  buffer_load_dwordx4 v9, s[12:15], s27 offen  lds
  ds_read_b64_tr_b16 v[176:177], v12 offset:20480
  ds_read_b64_tr_b16 v[178:179], v12 offset:20992
  ds_read_b64_tr_b16 v[180:181], v13 offset:20480
  ds_read_b64_tr_b16 v[182:183], v13 offset:20992
  ds_read_b64_tr_b16 v[184:185], v12 offset:20488
  ds_read_b64_tr_b16 v[186:187], v12 offset:21000
  ds_read_b64_tr_b16 v[188:189], v13 offset:20488
  ds_read_b64_tr_b16 v[190:191], v13 offset:21000
  s_waitcnt vmcnt(24)
  s_waitcnt lgkmcnt(0)
  s_barrier
  s_mov_b32 m0, 0x25000
  s_mov_b32 s27, 0x260000
  buffer_load_dwordx4 v8, s[12:15], s27 offen  lds
  s_mov_b32 m0, 0x25400
  s_mov_b32 s27, 0x268000
  buffer_load_dwordx4 v8, s[12:15], s27 offen  lds
  s_mov_b32 m0, 0x25800
  s_mov_b32 s27, 0x270000
  buffer_load_dwordx4 v9, s[12:15], s27 offen  lds
  s_mov_b32 m0, 0x25c00
  s_mov_b32 s27, 0x278000
  buffer_load_dwordx4 v9, s[12:15], s27 offen  lds
  ds_read_b64_tr_b16 v[192:193], v12 offset:24576
  ds_read_b64_tr_b16 v[194:195], v12 offset:25088
  ds_read_b64_tr_b16 v[196:197], v13 offset:24576
  ds_read_b64_tr_b16 v[198:199], v13 offset:25088
  ds_read_b64_tr_b16 v[200:201], v12 offset:24584
  ds_read_b64_tr_b16 v[202:203], v12 offset:25096
  ds_read_b64_tr_b16 v[204:205], v13 offset:24584
  ds_read_b64_tr_b16 v[206:207], v13 offset:25096
  s_waitcnt vmcnt(24)
  s_waitcnt lgkmcnt(0)
  s_barrier
  s_mov_b32 m0, 0x26000
  s_mov_b32 s27, 0x2e0000
  buffer_load_dwordx4 v8, s[12:15], s27 offen  lds
  s_mov_b32 m0, 0x26400
  s_mov_b32 s27, 0x2e8000
  buffer_load_dwordx4 v8, s[12:15], s27 offen  lds
  s_mov_b32 m0, 0x26800
  s_mov_b32 s27, 0x2f0000
  buffer_load_dwordx4 v9, s[12:15], s27 offen  lds
  s_mov_b32 m0, 0x26c00
  s_mov_b32 s27, 0x2f8000
  buffer_load_dwordx4 v9, s[12:15], s27 offen  lds
  ds_read_b64_tr_b16 v[80:81], v12 offset:28672
  ds_read_b64_tr_b16 v[82:83], v12 offset:29184
  ds_read_b64_tr_b16 v[84:85], v13 offset:28672
  ds_read_b64_tr_b16 v[86:87], v13 offset:29184
  ds_read_b64_tr_b16 v[88:89], v12 offset:28680
  ds_read_b64_tr_b16 v[90:91], v12 offset:29192
  ds_read_b64_tr_b16 v[92:93], v13 offset:28680
  ds_read_b64_tr_b16 v[94:95], v13 offset:29192
  s_waitcnt vmcnt(24)
  s_waitcnt lgkmcnt(0)
  s_barrier
  s_mov_b32 m0, 0x27000
  s_mov_b32 s27, 0x360000
  buffer_load_dwordx4 v8, s[12:15], s27 offen  lds
  s_mov_b32 m0, 0x27400
  s_mov_b32 s27, 0x368000
  buffer_load_dwordx4 v8, s[12:15], s27 offen  lds
  s_mov_b32 m0, 0x27800
  s_mov_b32 s27, 0x370000
  buffer_load_dwordx4 v9, s[12:15], s27 offen  lds
  s_mov_b32 m0, 0x27c00
  s_mov_b32 s27, 0x378000
  buffer_load_dwordx4 v9, s[12:15], s27 offen  lds
  ds_read_b64_tr_b16 v[96:97], v12 offset:0
  ds_read_b64_tr_b16 v[98:99], v12 offset:512
  ds_read_b64_tr_b16 v[100:101], v13 offset:0
  ds_read_b64_tr_b16 v[102:103], v13 offset:512
  ds_read_b64_tr_b16 v[104:105], v12 offset:8
  ds_read_b64_tr_b16 v[106:107], v12 offset:520
  ds_read_b64_tr_b16 v[108:109], v13 offset:8
  ds_read_b64_tr_b16 v[110:111], v13 offset:520
  s_waitcnt vmcnt(24)
  s_waitcnt lgkmcnt(0)
  s_barrier
  s_mov_b32 m0, 0x20000
  s_mov_b32 s27, 0x3e0000
  buffer_load_dwordx4 v8, s[12:15], s27 offen  lds
  s_mov_b32 m0, 0x20400
  s_mov_b32 s27, 0x3e8000
  buffer_load_dwordx4 v8, s[12:15], s27 offen  lds
  s_mov_b32 m0, 0x20800
  s_mov_b32 s27, 0x3f0000
  buffer_load_dwordx4 v9, s[12:15], s27 offen  lds
  s_mov_b32 m0, 0x20c00
  s_mov_b32 s27, 0x3f8000
  buffer_load_dwordx4 v9, s[12:15], s27 offen  lds
  ds_read_b64_tr_b16 v[208:209], v12 offset:4096
  ds_read_b64_tr_b16 v[210:211], v12 offset:4608
  ds_read_b64_tr_b16 v[212:213], v13 offset:4096
  ds_read_b64_tr_b16 v[214:215], v13 offset:4608
  ds_read_b64_tr_b16 v[216:217], v12 offset:4104
  ds_read_b64_tr_b16 v[218:219], v12 offset:4616
  ds_read_b64_tr_b16 v[220:221], v13 offset:4104
  ds_read_b64_tr_b16 v[222:223], v13 offset:4616
  s_waitcnt vmcnt(24)
  s_waitcnt lgkmcnt(0)
  s_barrier
  s_mov_b32 m0, 0x21000
  s_mov_b32 s27, 0x460000
  buffer_load_dwordx4 v8, s[12:15], s27 offen  lds
  s_mov_b32 m0, 0x21400
  s_mov_b32 s27, 0x468000
  buffer_load_dwordx4 v8, s[12:15], s27 offen  lds
  s_mov_b32 m0, 0x21800
  s_mov_b32 s27, 0x470000
  buffer_load_dwordx4 v9, s[12:15], s27 offen  lds
  s_mov_b32 m0, 0x21c00
  s_mov_b32 s27, 0x478000
  buffer_load_dwordx4 v9, s[12:15], s27 offen  lds
  ds_read_b64_tr_b16 v[224:225], v12 offset:8192
  ds_read_b64_tr_b16 v[226:227], v12 offset:8704
  ds_read_b64_tr_b16 v[228:229], v13 offset:8192
  ds_read_b64_tr_b16 v[230:231], v13 offset:8704
  ds_read_b64_tr_b16 v[232:233], v12 offset:8200
  ds_read_b64_tr_b16 v[234:235], v12 offset:8712
  ds_read_b64_tr_b16 v[236:237], v13 offset:8200
  ds_read_b64_tr_b16 v[238:239], v13 offset:8712
  s_waitcnt vmcnt(24)
  s_waitcnt lgkmcnt(0)
  s_barrier
  s_mov_b32 m0, 0x22000
  s_mov_b32 s27, 0x460000
  buffer_load_dwordx4 v8, s[8:11], s27 offen  lds
  s_mov_b32 m0, 0x22400
  s_mov_b32 s27, 0x468000
  buffer_load_dwordx4 v8, s[8:11], s27 offen  lds
  s_mov_b32 m0, 0x22800
  s_mov_b32 s27, 0x470000
  buffer_load_dwordx4 v9, s[8:11], s27 offen  lds
  s_mov_b32 m0, 0x22c00
  s_mov_b32 s27, 0x478000
  buffer_load_dwordx4 v9, s[8:11], s27 offen  lds
  ds_read_b64_tr_b16 v[240:241], v12 offset:12288
  ds_read_b64_tr_b16 v[242:243], v12 offset:12800
  ds_read_b64_tr_b16 v[244:245], v13 offset:12288
  ds_read_b64_tr_b16 v[246:247], v13 offset:12800
  ds_read_b64_tr_b16 v[248:249], v12 offset:12296
  ds_read_b64_tr_b16 v[250:251], v12 offset:12808
  ds_read_b64_tr_b16 v[252:253], v13 offset:12296
  ds_read_b64_tr_b16 v[254:255], v13 offset:12808
  s_waitcnt vmcnt(24)
  s_waitcnt lgkmcnt(0)
  s_barrier
  ds_read_b64_tr_b16 a[0:1], v12 offset:16384
  ds_read_b64_tr_b16 a[2:3], v12 offset:16896
  ds_read_b64_tr_b16 a[4:5], v13 offset:16384
  ds_read_b64_tr_b16 a[6:7], v13 offset:16896
  ds_read_b64_tr_b16 a[8:9], v12 offset:16392
  ds_read_b64_tr_b16 a[10:11], v12 offset:16904
  ds_read_b64_tr_b16 a[12:13], v13 offset:16392
  ds_read_b64_tr_b16 a[14:15], v13 offset:16904
  s_waitcnt vmcnt(20)
  s_waitcnt lgkmcnt(0)
  s_barrier
  ds_read_b64_tr_b16 a[16:17], v12 offset:20480
  ds_read_b64_tr_b16 a[18:19], v12 offset:20992
  ds_read_b64_tr_b16 a[20:21], v13 offset:20480
  ds_read_b64_tr_b16 a[22:23], v13 offset:20992
  ds_read_b64_tr_b16 a[24:25], v12 offset:20488
  ds_read_b64_tr_b16 a[26:27], v12 offset:21000
  ds_read_b64_tr_b16 a[28:29], v13 offset:20488
  ds_read_b64_tr_b16 a[30:31], v13 offset:21000
  s_waitcnt vmcnt(16)
  s_waitcnt lgkmcnt(0)
  s_barrier
  s_mov_b32 m0, 0x24000
  s_mov_b32 s27, 0x12380
  buffer_load_dwordx4 v10, s[52:55], s27 offen  lds
  s_mov_b32 m0, 0x24400
  s_mov_b32 s27, 0x14780
  buffer_load_dwordx4 v10, s[52:55], s27 offen  lds
  s_mov_b32 m0, 0x24800
  s_mov_b32 s27, 0x16b80
  buffer_load_dwordx4 v10, s[52:55], s27 offen  lds
  s_mov_b32 m0, 0x24c00
  s_mov_b32 s27, 0x18f80
  buffer_load_dwordx4 v10, s[52:55], s27 offen  lds
  s_mov_b32 m0, 0x25000
  s_mov_b32 s27, 0x1b380
  buffer_load_dwordx4 v10, s[52:55], s27 offen  lds
  s_mov_b32 m0, 0x25400
  s_mov_b32 s27, 0x1d780
  buffer_load_dwordx4 v10, s[52:55], s27 offen  lds
  s_mov_b32 m0, 0x25800
  s_mov_b32 s27, 0x1fb80
  buffer_load_dwordx4 v10, s[52:55], s27 offen  lds
  s_mov_b32 m0, 0x25c00
  s_mov_b32 s27, 0x21f80
  buffer_load_dwordx4 v10, s[52:55], s27 offen  lds
  ds_read_b64_tr_b16 a[32:33], v12 offset:24576
  ds_read_b64_tr_b16 a[34:35], v12 offset:25088
  ds_read_b64_tr_b16 a[36:37], v13 offset:24576
  ds_read_b64_tr_b16 a[38:39], v13 offset:25088
  ds_read_b64_tr_b16 a[40:41], v12 offset:24584
  ds_read_b64_tr_b16 a[42:43], v12 offset:25096
  ds_read_b64_tr_b16 a[44:45], v13 offset:24584
  ds_read_b64_tr_b16 a[46:47], v13 offset:25096
  s_waitcnt vmcnt(20)
  s_waitcnt lgkmcnt(0)
  s_barrier
  ds_read_b64_tr_b16 v[20:21], v12 offset:28672
  ds_read_b64_tr_b16 v[22:23], v12 offset:29184
  ds_read_b64_tr_b16 v[24:25], v13 offset:28672
  ds_read_b64_tr_b16 v[26:27], v13 offset:29184
  ds_read_b64_tr_b16 v[28:29], v12 offset:28680
  ds_read_b64_tr_b16 v[30:31], v12 offset:29192
  ds_read_b64_tr_b16 v[32:33], v13 offset:28680
  ds_read_b64_tr_b16 v[34:35], v13 offset:29192
  s_waitcnt vmcnt(16)
  s_waitcnt lgkmcnt(0)
  s_barrier
  s_mov_b32 m0, 0x26000
  s_mov_b32 s27, 0x12400
  buffer_load_dwordx4 v10, s[52:55], s27 offen  lds
  s_mov_b32 m0, 0x26400
  s_mov_b32 s27, 0x14800
  buffer_load_dwordx4 v10, s[52:55], s27 offen  lds
  s_mov_b32 m0, 0x26800
  s_mov_b32 s27, 0x16c00
  buffer_load_dwordx4 v10, s[52:55], s27 offen  lds
  s_mov_b32 m0, 0x26c00
  s_mov_b32 s27, 0x19000
  buffer_load_dwordx4 v10, s[52:55], s27 offen  lds
  s_mov_b32 m0, 0x27000
  s_mov_b32 s27, 0x1b400
  buffer_load_dwordx4 v10, s[52:55], s27 offen  lds
  s_mov_b32 m0, 0x27400
  s_mov_b32 s27, 0x1d800
  buffer_load_dwordx4 v10, s[52:55], s27 offen  lds
  s_mov_b32 m0, 0x27800
  s_mov_b32 s27, 0x1fc00
  buffer_load_dwordx4 v10, s[52:55], s27 offen  lds
  s_mov_b32 m0, 0x27c00
  s_mov_b32 s27, 0x22000
  buffer_load_dwordx4 v10, s[52:55], s27 offen  lds
  ds_read_b64_tr_b16 v[36:37], v12 offset:0
  ds_read_b64_tr_b16 v[38:39], v12 offset:512
  ds_read_b64_tr_b16 v[40:41], v13 offset:0
  ds_read_b64_tr_b16 v[42:43], v13 offset:512
  ds_read_b64_tr_b16 v[44:45], v12 offset:8
  ds_read_b64_tr_b16 v[46:47], v12 offset:520
  ds_read_b64_tr_b16 v[48:49], v13 offset:8
  ds_read_b64_tr_b16 v[50:51], v13 offset:520
  s_waitcnt vmcnt(20)
  s_waitcnt lgkmcnt(0)
  s_barrier
  ds_write_b128 v2, v[20:23] offset:0
  ds_write_b128 v2, v[24:27] offset:1024
  ds_write_b128 v2, v[28:31] offset:2048
  ds_write_b128 v2, v[32:35] offset:3072
  ds_write_b128 v2, v[36:39] offset:12288
  ds_write_b128 v2, v[40:43] offset:13312
  ds_write_b128 v2, v[44:47] offset:14336
  ds_write_b128 v2, v[48:51] offset:15360
  ds_read_b64_tr_b16 v[20:21], v12 offset:4096
  ds_read_b64_tr_b16 v[22:23], v12 offset:4608
  ds_read_b64_tr_b16 v[24:25], v13 offset:4096
  ds_read_b64_tr_b16 v[26:27], v13 offset:4608
  ds_read_b64_tr_b16 v[28:29], v12 offset:4104
  ds_read_b64_tr_b16 v[30:31], v12 offset:4616
  ds_read_b64_tr_b16 v[32:33], v13 offset:4104
  ds_read_b64_tr_b16 v[34:35], v13 offset:4616
  s_waitcnt vmcnt(16)
  s_waitcnt lgkmcnt(0)
  s_barrier
  ds_write_b128 v2, v[20:23] offset:4096
  ds_write_b128 v2, v[24:27] offset:5120
  ds_write_b128 v2, v[28:31] offset:6144
  ds_write_b128 v2, v[32:35] offset:7168
  ds_read_b64_tr_b16 v[36:37], v12 offset:8192
  ds_read_b64_tr_b16 v[38:39], v12 offset:8704
  ds_read_b64_tr_b16 v[40:41], v13 offset:8192
  ds_read_b64_tr_b16 v[42:43], v13 offset:8704
  ds_read_b64_tr_b16 v[44:45], v12 offset:8200
  ds_read_b64_tr_b16 v[46:47], v12 offset:8712
  ds_read_b64_tr_b16 v[48:49], v13 offset:8200
  ds_read_b64_tr_b16 v[50:51], v13 offset:8712
  s_waitcnt lgkmcnt(0)
  s_barrier
  ds_write_b128 v2, v[36:39] offset:8192
  ds_write_b128 v2, v[40:43] offset:9216
  ds_write_b128 v2, v[44:47] offset:10240
  ds_write_b128 v2, v[48:51] offset:11264
  s_waitcnt vmcnt(8)
  ds_read_b64_tr_b16 v[20:21], v16 offset:16384
  ds_read_b64_tr_b16 v[22:23], v16 offset:16640
  ds_read_b64_tr_b16 v[24:25], v16 offset:17408
  ds_read_b64_tr_b16 v[26:27], v16 offset:17664
  ds_read_b64_tr_b16 v[28:29], v16 offset:20480
  ds_read_b64_tr_b16 v[30:31], v16 offset:20736
  ds_read_b64_tr_b16 v[32:33], v16 offset:21504
  ds_read_b64_tr_b16 v[34:35], v16 offset:21760
  ds_read_b64_tr_b16 v[36:37], v16 offset:16448
  ds_read_b64_tr_b16 v[38:39], v16 offset:16704
  ds_read_b64_tr_b16 v[40:41], v16 offset:17472
  ds_read_b64_tr_b16 v[42:43], v16 offset:17728
  ds_read_b64_tr_b16 v[44:45], v16 offset:20544
  ds_read_b64_tr_b16 v[46:47], v16 offset:20800
  ds_read_b64_tr_b16 v[48:49], v16 offset:21568
  ds_read_b64_tr_b16 v[50:51], v16 offset:21824
  s_waitcnt lgkmcnt(0)
  ds_write_b128 v2, v[20:23] offset:16384
  ds_write_b128 v2, v[24:27] offset:17408
  ds_write_b128 v2, v[28:31] offset:18432
  ds_write_b128 v2, v[32:35] offset:19456
  ds_write_b128 v2, v[36:39] offset:20480
  ds_write_b128 v2, v[40:43] offset:21504
  ds_write_b128 v2, v[44:47] offset:22528
  ds_write_b128 v2, v[48:51] offset:23552
  s_waitcnt vmcnt(0)
  ds_read_b64_tr_b16 v[20:21], v16 offset:24576
  ds_read_b64_tr_b16 v[22:23], v16 offset:24832
  ds_read_b64_tr_b16 v[24:25], v16 offset:25600
  ds_read_b64_tr_b16 v[26:27], v16 offset:25856
  ds_read_b64_tr_b16 v[28:29], v16 offset:28672
  ds_read_b64_tr_b16 v[30:31], v16 offset:28928
  ds_read_b64_tr_b16 v[32:33], v16 offset:29696
  ds_read_b64_tr_b16 v[34:35], v16 offset:29952
  ds_read_b64_tr_b16 v[36:37], v16 offset:24640
  ds_read_b64_tr_b16 v[38:39], v16 offset:24896
  ds_read_b64_tr_b16 v[40:41], v16 offset:25664
  ds_read_b64_tr_b16 v[42:43], v16 offset:25920
  ds_read_b64_tr_b16 v[44:45], v16 offset:28736
  ds_read_b64_tr_b16 v[46:47], v16 offset:28992
  ds_read_b64_tr_b16 v[48:49], v16 offset:29760
  ds_read_b64_tr_b16 v[50:51], v16 offset:30016
  s_waitcnt lgkmcnt(0)
  ds_write_b128 v2, v[20:23] offset:24576
  ds_write_b128 v2, v[24:27] offset:25600
  ds_write_b128 v2, v[28:31] offset:26624
  ds_write_b128 v2, v[32:35] offset:27648
  ds_write_b128 v2, v[36:39] offset:28672
  ds_write_b128 v2, v[40:43] offset:29696
  ds_write_b128 v2, v[44:47] offset:30720
  ds_write_b128 v2, v[48:51] offset:31744
  s_waitcnt lgkmcnt(0)
  s_mov_b32 s28, 0
L_reg_95:
  v_mov_b32 v8, 0
  buffer_load_dword v9, v8, s[20:23], 0 offen offset:64 sc1
  s_add_u32 s28, s28, 1
  s_cmp_gt_u32 s28, 1048576
  s_cbranch_scc1 L_fail
  s_waitcnt vmcnt(0)
  v_readfirstlane_b32 s67, v9
L_regc_96:
  s_and_b32 s26, s67, 0xffff
  s_cmp_lt_u32 s26, 256
  s_cbranch_scc1 L_reg_95
  s_lshr_b32 s67, s67, 16
  s_sub_u32 s26, s57, 16384
  s_mov_b32 s27, 0
L_poll_97:
  buffer_load_dword v3, v0, s[4:7], s26 offen sc1
  s_waitcnt vmcnt(0)
  v_cmp_eq_u32 vcc, 0, v3
  s_and_b64 vcc, vcc, s[92:93]
  s_cbranch_vccz L_polld_98
  s_add_u32 s27, s27, 1
  s_cmp_lt_u32 s27, 1048576
  s_cbranch_scc1 L_poll_97
  s_branch L_fail
L_polld_98:
  s_sub_u32 s26, s57, 8192
  s_mov_b32 s27, 0
L_poll_99:
  buffer_load_dword v3, v0, s[4:7], s26 offen sc1
  s_waitcnt vmcnt(0)
  v_cmp_eq_u32 vcc, 0, v3
  s_and_b64 vcc, vcc, s[92:93]
  s_cbranch_vccz L_polld_100
  s_add_u32 s27, s27, 1
  s_cmp_lt_u32 s27, 1048576
  s_cbranch_scc1 L_poll_99
  s_branch L_fail
L_polld_100:
  v_min_u32 v8, -2, v64
  v_min_u32 v9, -2, v65
  v_min_u32 v10, -2, v66
  v_min_u32 v11, -2, v67
  v_min_u32 v12, -2, v68
  v_min_u32 v13, -2, v69
  v_min_u32 v14, -2, v70
  v_min_u32 v15, -2, v71
  s_cmp_ge_u32 s67, 32
  s_cbranch_scc0 L_slowmode3
  s_mov_b32 m0, 0
  ds_read_b128 v[60:63], v2 offset:0
  ds_read_b128 v[64:67], v2 offset:1024
  ds_read_b128 v[20:23], v2 offset:2048
  ds_read_b128 v[24:27], v2 offset:3072
  ds_read_b128 v[28:31], v2 offset:12288
  ds_read_b128 v[32:35], v2 offset:13312
  ds_read_b128 v[36:39], v2 offset:14336
  ds_read_b128 v[40:43], v2 offset:15360
  v_mov_b64 v[44:45], 0
  v_mov_b64 v[46:47], 0
  v_mov_b64 v[48:49], 0
  v_mov_b64 v[50:51], 0
  v_mov_b64 v[52:53], 0
  v_mov_b64 v[54:55], 0
  v_mov_b64 v[56:57], 0
  v_mov_b64 v[58:59], 0
  v_mov_b64 v[68:69], 0
  v_mov_b64 v[70:71], 0
  v_mov_b64 v[72:73], 0
  v_mov_b64 v[74:75], 0
  v_mov_b32 v16, -1
  s_branch L_chk3f
.p2align 7
  s_nop 0
  s_nop 0
  s_nop 0
  s_nop 0
  s_nop 0
  s_nop 0
L_top3f:
  s_waitcnt vmcnt(0)
  s_barrier
  buffer_load_dwordx4 v[8:11], v0, s[4:7], s58 offen offset:0 sc1
  s_mov_b32 s56, 0
  buffer_load_dwordx4 v[12:15], v0, s[4:7], s58 offen offset:1024 sc1
  s_bfe_u32 s46, s37, 0x10001
L_chk3f:
  s_waitcnt vmcnt(1) lgkmcnt(0)
  v_smfmac_f32_16x16x64_bf16 v[48:51], v[8:11], v[60:67], v1
  ds_write_b128 v0, v[8:11] offset:6144
  s_waitcnt lgkmcnt(5)
  v_smfmac_f32_16x16x64_bf16 v[56:59], v[8:11], v[20:27], v1
  v_smfmac_f32_16x16x64_bf16 v[44:47], v[8:11], v[80:87], v1
  v_smfmac_f32_16x16x64_bf16 v[52:55], v[8:11], v[88:95], v1
  s_waitcnt vmcnt(0)
  ds_write_b128 v0, v[12:15] offset:7168
  s_waitcnt lgkmcnt(4)
  v_smfmac_f32_16x16x64_bf16 v[48:51], v[12:15], v[28:35], v1
  v_max3_u32 v3, v8, v9, v10
  v_max3_u32 v3, v3, v11, v12
  v_max3_u32 v3, v3, v13, v14
  v_max_u32 v3, v3, v15
  s_waitcnt lgkmcnt(2)
  v_smfmac_f32_16x16x64_bf16 v[56:59], v[12:15], v[36:43], v1
  ds_read_b128 v[60:63], v2 offset:4096
  v_cmp_eq_u32 vcc, -1, v3
  v_smfmac_f32_16x16x64_bf16 v[44:47], v[12:15], v[96:103], v1
  ds_read_b128 v[64:67], v2 offset:5120
  s_cbranch_vccnz L_retry3f
  v_smfmac_f32_16x16x64_bf16 v[52:55], v[12:15], v[104:111], v1
  s_waitcnt lgkmcnt(2)
  s_barrier
  ds_read_b128 v[20:23], v0 offset:0
  v_smfmac_f32_16x16x64_bf16 v[68:71], v[8:11], a[48:55], v1
  ds_read_b128 v[24:27], v0 offset:1024
  s_mov_b64 vcc, s[62:63]
  v_smfmac_f32_16x16x64_bf16 v[72:75], v[8:11], a[56:63], v1
  ds_read_b128 v[28:31], v0 offset:2048
  v_smfmac_f32_16x16x64_bf16 v[68:71], v[12:15], a[64:71], v1
  buffer_store_dword v16, v7, s[4:7], s61 offen
  ds_read_b128 v[16:19], v0 offset:8192
  v_smfmac_f32_16x16x64_bf16 v[72:75], v[12:15], a[72:79], v1
  ds_read_b128 v[8:11], v2 offset:6144
  s_waitcnt lgkmcnt(4)
  v_smfmac_f32_16x16x64_bf16 v[44:47], v[20:23], v[112:119], v1
  ds_read_b128 v[12:15], v2 offset:7168
  v_smfmac_f32_16x16x64_bf16 v[48:51], v[20:23], v[208:215], v1
  ds_read_b128 v[32:35], v0 offset:3072
  v_smfmac_f32_16x16x64_bf16 v[52:55], v[20:23], v[120:127], v1
  ds_read_b128 v[36:39], v0 offset:4096
  v_smfmac_f32_16x16x64_bf16 v[56:59], v[20:23], v[216:223], v1
  ds_read_b128 v[40:43], v0 offset:5120
  s_waitcnt lgkmcnt(5)
  v_smfmac_f32_16x16x64_bf16 v[48:51], v[16:19], v[60:67], v1
  ds_read_b128 v[60:63], v2 offset:8192
  ds_read_b128 v[64:67], v2 offset:9216
  v_smfmac_f32_16x16x64_bf16 v[44:47], v[24:27], v[128:135], v1
  s_waitcnt lgkmcnt(5)
  v_smfmac_f32_16x16x64_bf16 v[56:59], v[16:19], v[8:15], v1
  ds_read_b128 v[8:11], v2 offset:10240
  ds_read_b128 v[12:15], v2 offset:11264
  v_smfmac_f32_16x16x64_bf16 v[52:55], v[24:27], v[136:143], v1
  v_smfmac_f32_16x16x64_bf16 v[48:51], v[24:27], v[224:231], v1
  s_waitcnt lgkmcnt(2)
  v_smfmac_f32_16x16x64_bf16 v[44:47], v[16:19], v[60:67], v1
  buffer_load_dwordx4 v[60:63], v0, s[4:7], s42 offen sc1
  s_add_u32 s26, s42, 4096
  v_smfmac_f32_16x16x64_bf16 v[56:59], v[24:27], v[232:239], v1
  s_waitcnt lgkmcnt(0)
  v_smfmac_f32_16x16x64_bf16 v[52:55], v[16:19], v[8:15], v1
  buffer_load_dwordx4 v[64:67], v0, s[4:7], s26 offen sc1
  v_smfmac_f32_16x16x64_bf16 v[48:51], v[28:31], v[240:247], v1
  v_smfmac_f32_16x16x64_bf16 v[44:47], v[28:31], v[144:151], v1
  buffer_load_dwordx4 v[8:11], v0, s[4:7], s43 offen sc1
  v_smfmac_f32_16x16x64_bf16 v[48:51], v[32:35], a[0:7], v1
  v_smfmac_f32_16x16x64_bf16 v[44:47], v[32:35], v[160:167], v1
  buffer_load_dwordx4 v[12:15], v0, s[4:7], s43 offen offset:1024 sc1
  v_smfmac_f32_16x16x64_bf16 v[48:51], v[36:39], a[16:23], v1
  s_add_u32 s42, s42, 0x40000
  s_add_u32 s43, s43, 0x40000
  v_smfmac_f32_16x16x64_bf16 v[44:47], v[36:39], v[176:183], v1
  s_add_u32 s27, s44, 0x800000
  v_smfmac_f32_16x16x64_bf16 v[48:51], v[40:43], a[32:39], v1
  v_smfmac_f32_16x16x64_bf16 v[44:47], v[40:43], v[192:199], v1
  v_smfmac_f32_16x16x64_bf16 v[56:59], v[28:31], v[248:255], v1
  v_smfmac_f32_16x16x64_bf16 v[52:55], v[28:31], v[152:159], v1
  v_add_f32 v48, v48, v50
  v_smfmac_f32_16x16x64_bf16 v[56:59], v[32:35], a[8:15], v1
  v_add_f32 v49, v49, v51
  v_smfmac_f32_16x16x64_bf16 v[52:55], v[32:35], v[168:175], v1
  v_cvt_pk_bf16_f32 v50, v48, v49
  v_smfmac_f32_16x16x64_bf16 v[56:59], v[36:39], a[24:31], v1
  v_add_f32 v44, v44, v46
  v_smfmac_f32_16x16x64_bf16 v[52:55], v[36:39], v[184:191], v1
  v_add_f32 v45, v45, v47
  v_smfmac_f32_16x16x64_bf16 v[56:59], v[40:43], a[40:47], v1
  v_cvt_pk_bf16_f32 v51, v44, v45
  v_smfmac_f32_16x16x64_bf16 v[52:55], v[40:43], v[200:207], v1
  v_mfma_f32_16x16x16_bf16 v[44:47], v[50:51], v[4:5], 0
  v_add_f32 v56, v56, v58
  v_add_f32 v57, v57, v59
  v_cvt_pk_bf16_f32 v58, v56, v57
  s_nop 0
  v_add_f32 v52, v52, v54
  v_add_f32 v53, v53, v55
  v_cvt_pk_bf16_f32 v59, v52, v53
  s_nop 0
  v_cvt_pk_bf16_f32 v48, v44, v45
  v_cvt_pk_bf16_f32 v49, v46, v47
  v_mfma_f32_16x16x16_bf16 v[52:55], v[58:59], v[4:5], 0
  v_min_u32 v48, -2, v48
  v_smfmac_f32_16x16x64_bf16 v[68:71], v[16:19], a[80:87], v1
  v_smfmac_f32_16x16x64_bf16 v[72:75], v[16:19], a[88:95], v1
  v_cvt_pk_bf16_f32 v50, v52, v53
  v_cvt_pk_bf16_f32 v51, v54, v55
  s_waitcnt vmcnt(2)
  s_nop 0
  v_mfma_f32_16x16x32_bf16 v[52:55], v[64:67], v[48:51], 0
  v_lshrrev_b32 v3, 1, v0
  v_mfma_f32_16x16x32_bf16 v[44:47], v[60:63], v[48:51], 0
  v_bfi_b32 v17, 31, v0, v3
  v_mfma_f32_16x16x32_bf16 v[56:59], v[48:51], v[48:51], 0
  v_smfmac_f32_16x16x64_bf16 v[68:71], v[20:23], a[96:103], v1
  v_cndmask_b32_dpp v44, v52, v44, vcc quad_perm:[2,3,2,3] row_mask:0xf bank_mask:0xf
  v_cndmask_b32_dpp v45, v53, v45, vcc quad_perm:[2,3,2,3] row_mask:0xf bank_mask:0xf
  v_cndmask_b32_dpp v46, v54, v46, vcc quad_perm:[2,3,2,3] row_mask:0xf bank_mask:0xf
  v_cndmask_b32_dpp v47, v55, v47, vcc quad_perm:[2,3,2,3] row_mask:0xf bank_mask:0xf
  ds_write_b128 v0, v[44:47] offset:13056
  v_cndmask_b32_dpp v56, v57, v56, vcc quad_perm:[2,3,2,3] row_mask:0xf bank_mask:0xf
  ds_write_addtid_b32 v56 offset:14080
  v_smfmac_f32_16x16x64_bf16 v[72:75], v[20:23], a[104:111], v1
  v_smfmac_f32_16x16x64_bf16 v[68:71], v[24:27], a[112:119], v1
  v_smfmac_f32_16x16x64_bf16 v[72:75], v[24:27], a[120:127], v1
  s_waitcnt lgkmcnt(0)
  s_barrier
  v_smfmac_f32_16x16x64_bf16 v[68:71], v[28:31], a[128:135], v1
  ds_read_b128 v[60:63], v0 offset:9216
  ds_read_b128 v[64:67], v0 offset:10496
  ds_read_b128 v[52:55], v0 offset:11776
  v_smfmac_f32_16x16x64_bf16 v[72:75], v[28:31], a[136:143], v1
  ds_read_addtid_b32 v57 offset:10240
  ds_read_addtid_b32 v58 offset:11520
  ds_read_addtid_b32 v59 offset:12800
  v_smfmac_f32_16x16x64_bf16 v[68:71], v[32:35], a[144:151], v1
  ds_read_b128 v[20:23], v0 offset:14336
  v_mul_f32 v56, s90, v56
  v_smfmac_f32_16x16x64_bf16 v[72:75], v[32:35], a[152:159], v1
  ds_read_b128 v[24:27], v0 offset:15360
  v_mul_f32 v44, s90, v44
  v_smfmac_f32_16x16x64_bf16 v[68:71], v[36:39], a[160:167], v1
  s_not_b64 exec, s[62:63]
  buffer_store_dwordx4 v[48:51], v17, s[4:7], s44 offen sc1
  s_mov_b64 exec, -1
  ds_read_b128 v[28:31], v2 offset:22528
  v_mul_f32 v45, s90, v45
  v_smfmac_f32_16x16x64_bf16 v[72:75], v[36:39], a[168:175], v1
  ds_read_b128 v[32:35], v2 offset:23552
  v_mul_f32 v46, s90, v46
  v_smfmac_f32_16x16x64_bf16 v[68:71], v[40:43], a[176:183], v1
  ds_read_b128 v[36:39], v2 offset:26624
  v_mul_f32 v47, s90, v47
  v_smfmac_f32_16x16x64_bf16 v[72:75], v[40:43], a[184:191], v1
  ds_read_b128 v[40:43], v2 offset:27648
  s_waitcnt lgkmcnt(6)
  v_fmac_f32 v56, s90, v57
  v_fmac_f32 v56, s90, v58
  v_fmac_f32 v56, s90, v59
  v_pk_fma_f32 v[44:45], v[60:61], s[90:91], v[44:45]
  v_pk_fma_f32 v[46:47], v[62:63], s[90:91], v[46:47]
  v_pk_fma_f32 v[44:45], v[64:65], s[90:91], v[44:45]
  v_pk_fma_f32 v[46:47], v[66:67], s[90:91], v[46:47]
  v_pk_fma_f32 v[44:45], v[52:53], s[90:91], v[44:45]
  v_pk_fma_f32 v[46:47], v[54:55], s[90:91], v[46:47]
  v_pk_add_f32 v[68:69], v[68:69], v[70:71]
  v_pk_add_f32 v[72:73], v[72:73], v[74:75]
  v_exp_f32 v44, v44
  v_exp_f32 v45, v45
  v_exp_f32 v46, v46
  v_cvt_pk_bf16_f32 v44, v44, v45
  v_exp_f32 v47, v47
  v_cvt_pk_bf16_f32 v70, v68, v69
  v_mov_b32_dpp v16, v44 quad_perm:[2,3,2,3] row_mask:0xf bank_mask:0xf
  v_cvt_pk_bf16_f32 v45, v46, v47
  v_mov_b32_dpp v17, v44 quad_perm:[0,1,0,1] row_mask:0xf bank_mask:0xf
  v_cvt_pk_bf16_f32 v71, v72, v73
  v_mov_b32_dpp v18, v45 quad_perm:[2,3,2,3] row_mask:0xf bank_mask:0xf
  v_mov_b32_dpp v19, v45 quad_perm:[0,1,0,1] row_mask:0xf bank_mask:0xf
  v_exp_f32_dpp v57, v56 quad_perm:[2,3,2,3] row_mask:0xf bank_mask:0xf
  v_min_u32 v70, -2, v70
  s_waitcnt lgkmcnt(4)
  v_mfma_f32_16x16x32_bf16 v[48:51], v[24:27], v[16:19], 0
  ds_read_b128 v[44:47], v0 offset:14336
  v_exp_f32_dpp v58, v56 quad_perm:[0,1,0,1] row_mask:0xf bank_mask:0xf
  s_waitcnt vmcnt(2)
  v_mfma_f32_16x16x32_bf16 v[52:55], v[8:11], v[16:19], 0
  ds_read_b128 v[72:75], v0 offset:14336
  v_cvt_pk_bf16_f32 v20, v57, v58
  s_waitcnt vmcnt(1)
  v_mfma_f32_16x16x32_bf16 v[60:63], v[12:15], v[16:19], 0
  ds_read_b128 v[64:67], v2 offset:31744
  v_cvt_pk_bf16_f32 v23, v57, v58
  v_mfma_f32_16x16x16_bf16 v[48:51], v[24:25], v[20:21], v[48:51]
  ds_read_b128 v[24:27], v2 offset:19456
  v_mov_b64 v[56:57], 0
  v_mov_b64 v[58:59], 0
  v_mfma_f32_16x16x16_bf16 v[52:55], v[70:71], v[20:21], v[52:55]
  buffer_store_dwordx2 v[70:71], v3, s[4:7], s27 offen sc1
  s_cmp_eq_u32 s37, 63
  s_cbranch_scc1 L_last3f
  v_mfma_f32_16x16x16_bf16 v[60:63], v[70:71], v[22:23], v[60:63]
  ds_read_b128 v[20:23], v2 offset:18432
  ds_read_b128 v[68:71], v0 offset:14336
  v_rcp_f32 v3, v48
  s_add_u32 s94, s41, s47
  v_pk_mul_f32 v[52:53], v[52:53], v[2:3] op_sel:[0,1] op_sel_hi:[1,1]
  v_pk_mul_f32 v[54:55], v[54:55], v[2:3] op_sel:[0,1] op_sel_hi:[1,1]
  v_cvt_pk_bf16_f32 v52, v52, v53
  v_cvt_pk_bf16_f32 v53, v54, v55
  v_pk_mul_f32 v[60:61], v[60:61], v[2:3] op_sel:[0,1] op_sel_hi:[1,1]
  v_pk_mul_f32 v[62:63], v[62:63], v[2:3] op_sel:[0,1] op_sel_hi:[1,1]
  v_cvt_pk_bf16_f32 v54, v60, v61
  v_cvt_pk_bf16_f32 v55, v62, v63
  ds_write_b128 v0, v[52:55] offset:3072
  s_waitcnt lgkmcnt(9)
  v_smfmac_f32_16x16x64_bf16 v[56:59], v[52:55], v[28:35], v1
  ds_read_b128 v[60:63], v2 offset:30720
  v_subrev_u32 v16, 0x2b800000, v3
  v_cmp_lt_u32 vcc, 0x23000000, v16
  s_waitcnt lgkmcnt(2)
  v_smfmac_f32_16x16x64_bf16 v[68:71], v[52:55], v[36:43], v1
  ds_read_b128 v[28:31], v2 offset:16384
  v_smfmac_f32_16x16x64_bf16 v[44:47], v[52:55], v[20:27], v1
  ds_read_b128 v[32:35], v2 offset:17408
  s_cbranch_vccnz L_guard3f
L_safe3f:
  s_waitcnt lgkmcnt(3)
  s_barrier
  ds_read_b128 v[8:11], v0 offset:0
  ds_read_b128 v[12:15], v0 offset:1024
  ds_read_b128 v[16:19], v0 offset:2048
  s_waitcnt lgkmcnt(5)
  v_smfmac_f32_16x16x64_bf16 v[72:75], v[52:55], v[60:67], v1
  ds_read_b128 v[36:39], v2 offset:20480
  s_waitcnt lgkmcnt(3)
  v_smfmac_f32_16x16x64_bf16 v[44:47], v[8:11], a[192:199], v1
  ds_read_b128 v[40:43], v2 offset:21504
  s_waitcnt lgkmcnt(3)
  v_smfmac_f32_16x16x64_bf16 v[44:47], v[12:15], a[200:207], v1
  ds_read_b128 v[20:23], v2 offset:24576
  s_waitcnt lgkmcnt(3)
  v_smfmac_f32_16x16x64_bf16 v[44:47], v[16:19], v[28:35], v1
  ds_read_b128 v[24:27], v2 offset:25600
  v_smfmac_f32_16x16x64_bf16 v[56:59], v[8:11], a[208:215], v1
  ds_read_b128 v[60:63], v2 offset:28672
  v_smfmac_f32_16x16x64_bf16 v[56:59], v[12:15], a[216:223], v1
  ds_read_b128 v[64:67], v2 offset:29696
  v_cvt_pk_bf16_f32 v44, v44, v45
  s_waitcnt lgkmcnt(4)
  v_smfmac_f32_16x16x64_bf16 v[56:59], v[16:19], v[36:43], v1
  v_cvt_pk_bf16_f32 v45, v46, v47
  v_smfmac_f32_16x16x64_bf16 v[68:71], v[8:11], a[224:231], v1
  v_bfi_b32 v44, 1, s46, v44
  v_smfmac_f32_16x16x64_bf16 v[68:71], v[12:15], a[232:239], v1
  v_cvt_pk_bf16_f32 v46, v56, v57
  s_waitcnt lgkmcnt(2)
  v_smfmac_f32_16x16x64_bf16 v[68:71], v[16:19], v[20:27], v1
  v_cvt_pk_bf16_f32 v47, v58, v59
  v_smfmac_f32_16x16x64_bf16 v[72:75], v[8:11], a[240:247], v1
  v_bfi_b32 v46, 1, s46, v46
  v_smfmac_f32_16x16x64_bf16 v[72:75], v[12:15], a[248:255], v1
  v_cvt_pk_bf16_f32 v68, v68, v69
  s_waitcnt lgkmcnt(0)
  v_smfmac_f32_16x16x64_bf16 v[72:75], v[16:19], v[60:67], v1
  v_cvt_pk_bf16_f32 v69, v70, v71
  s_add_u32 s26, s94, 0x38000
  buffer_store_dwordx4 v[44:47], v0, s[4:7], s26 offen
  v_bfi_b32 v68, 1, s46, v68
  s_nop 3
  v_cvt_pk_bf16_f32 v70, v72, v73
  v_cvt_pk_bf16_f32 v71, v74, v75
  v_bfi_b32 v70, 1, s46, v70
  s_add_u32 s26, s94, 0x40000
  buffer_store_dwordx4 v[68:71], v0, s[4:7], s26 offen
  s_add_u32 s28, s41, s66
  s_add_u32 s48, s28, 0
  s_add_u32 s49, s28, 8192
  s_add_u32 s50, s28, 16384
  s_add_u32 s51, s28, 24576
  s_waitcnt vmcnt(0)
  s_barrier
  buffer_load_dwordx4 v[44:47], v6, s[4:7], s48 offen sc1
  buffer_load_dwordx4 v[48:51], v6, s[4:7], s49 offen sc1
  buffer_load_dwordx4 v[52:55], v6, s[4:7], s50 offen sc1
  buffer_load_dwordx4 v[56:59], v6, s[4:7], s51 offen sc1
  s_add_u32 s37, s37, 1
  s_xor_b32 s41, s41, 0x48000
  s_add_u32 s61, s40, s60
  s_mov_b32 s26, s38
  s_mov_b32 s38, s40
  s_mov_b32 s40, s39
  s_mov_b32 s39, s26
  s_add_u32 s58, s40, 6144
  s_add_u32 s44, s44, 0x20000
  s_add_u32 s26, s40, s60
  s_mov_b32 s56, 0
  ds_read_b128 v[60:63], v2 offset:0
  ds_read_b128 v[64:67], v2 offset:1024
  ds_read_b128 v[20:23], v2 offset:2048
  ds_read_b128 v[24:27], v2 offset:3072
  ds_read_b128 v[28:31], v2 offset:12288
  ds_read_b128 v[32:35], v2 offset:13312
  ds_read_b128 v[36:39], v2 offset:14336
  ds_read_b128 v[40:43], v2 offset:15360
  v_mov_b32 v68, 0
  v_mov_b32 v69, 0
  v_mov_b32 v70, 0
  v_mov_b32 v71, 0
  v_mov_b32 v72, 0
  v_mov_b32 v73, 0
  v_mov_b32 v74, 0
  v_mov_b32 v75, 0
  v_mov_b32 v16, -1
L_rchk3f:
  s_waitcnt vmcnt(3)
  v_mfma_f32_16x16x32_bf16 v[8:11], v[44:47], v[76:79], 0
  v_bitop3_b32 v12, v44, v46, s46 bitop3:0x7e
  s_waitcnt vmcnt(2)
  v_mfma_f32_16x16x32_bf16 v[8:11], v[48:51], v[76:79], v[8:11]
  v_bitop3_b32 v13, v48, v50, s46 bitop3:0x7e
  s_waitcnt vmcnt(1)
  v_mfma_f32_16x16x32_bf16 v[8:11], v[52:55], v[76:79], v[8:11]
  v_bitop3_b32 v14, v52, v54, s46 bitop3:0x7e
  v_or3_b32 v12, v12, v13, v14
  s_waitcnt vmcnt(0)
  v_mfma_f32_16x16x32_bf16 v[8:11], v[56:59], v[76:79], v[8:11]
  v_bitop3_b32 v3, v56, v58, s46 bitop3:0x7e
  v_bitop3_b32 v3, v3, v12, 1 bitop3:0xa8
  v_cmp_ne_u32 vcc, 0, v3
  v_mov_b64 v[44:45], 0
  v_mov_b64 v[46:47], 0
  v_mov_b64 v[48:49], 0
  s_nop 1
  v_permlane32_swap_b32 v8, v10
  v_permlane32_swap_b32 v9, v11
  v_pk_add_f32 v[8:9], v[8:9], v[10:11]
  v_cvt_pk_bf16_f32 v8, v8, v9
  v_min_u32 v8, -2, v8
  s_cbranch_vccnz L_r3f
  buffer_store_dword v8, v7, s[4:7], s26 offen
  v_mov_b64 v[50:51], 0
  v_mov_b64 v[52:53], 0
  v_mov_b64 v[54:55], 0
  v_mov_b64 v[56:57], 0
  v_mov_b64 v[58:59], 0
L_end3f:
  s_branch L_top3f
L_retry3f:
  buffer_load_dwordx4 v[8:11], v0, s[4:7], s58 offen offset:0 sc1
  buffer_load_dwordx4 v[12:15], v0, s[4:7], s58 offen offset:1024 sc1
  ds_read_b128 v[60:63], v2 offset:0
  ds_read_b128 v[64:67], v2 offset:1024
  s_nop 1
  v_mov_b64 v[44:45], 0
  v_mov_b64 v[46:47], 0
  v_mov_b64 v[48:49], 0
  v_mov_b64 v[50:51], 0
  v_mov_b64 v[52:53], 0
  v_mov_b64 v[54:55], 0
  v_mov_b64 v[56:57], 0
  v_mov_b64 v[58:59], 0
  v_mov_b64 v[68:69], 0
  v_mov_b64 v[70:71], 0
  v_mov_b64 v[72:73], 0
  v_mov_b64 v[74:75], 0
  s_add_u32 s56, s56, 1
  s_cmp_lt_u32 s56, 1048576
  s_cbranch_scc1 L_chk3f
  s_branch L_fail
L_guard3f:
  s_waitcnt vmcnt(0) lgkmcnt(0)
  v_lshrrev_b32 v3, 1, v0
  buffer_load_dwordx2 v[70:71], v3, s[4:7], s27 offen sc1
  s_nop 2
  ds_read_b128 v[44:47], v0 offset:13056
  ds_read_addtid_b32 v56 offset:14080
  ds_read_b128 v[60:63], v0 offset:9216
  ds_read_b128 v[64:67], v0 offset:10496
  ds_read_b128 v[52:55], v0 offset:11776
  ds_read_addtid_b32 v57 offset:10240
  ds_read_addtid_b32 v58 offset:11520
  ds_read_addtid_b32 v59 offset:12800
  ds_read_b128 v[20:23], v0 offset:14336
  ds_read_b128 v[24:27], v0 offset:15360
  s_waitcnt lgkmcnt(7)
  v_pk_add_f32 v[44:45], v[44:45], v[60:61]
  v_pk_add_f32 v[46:47], v[46:47], v[62:63]
  s_waitcnt lgkmcnt(4)
  v_add_f32 v56, v56, v57
  v_pk_add_f32 v[44:45], v[44:45], v[64:65]
  v_pk_add_f32 v[46:47], v[46:47], v[66:67]
  s_waitcnt lgkmcnt(3)
  v_add_f32 v56, v56, v58
  v_pk_add_f32 v[44:45], v[44:45], v[52:53]
  v_pk_add_f32 v[46:47], v[46:47], v[54:55]
  s_waitcnt lgkmcnt(2)
  v_add_f32 v56, v56, v59
  v_max3_f32 v50, v44, v45, v46
  v_max3_f32 v50, v50, v47, v56
  s_nop 1
  v_max_f32_dpp v48, v50, v50 quad_perm:[2,3,0,1] row_mask:0xf bank_mask:0xf
  v_max_f32_dpp v49, v50, v50 quad_perm:[2,3,0,1] row_mask:0xf bank_mask:0xf
  s_nop 1
  v_permlane32_swap_b32 v48, v49
  v_max_f32 v50, v48, v49
  v_max_f32 v51, v48, v49
  s_nop 1
  v_permlane16_swap_b32 v50, v51
  v_max_f32 v50, v50, v51
  v_sub_f32 v44, v44, v50
  v_mul_f32 v44, s90, v44
  v_sub_f32 v45, v45, v50
  v_mul_f32 v45, s90, v45
  v_sub_f32 v46, v46, v50
  v_mul_f32 v46, s90, v46
  v_sub_f32 v47, v47, v50
  v_mul_f32 v47, s90, v47
  v_sub_f32 v56, v56, v50
  v_mul_f32 v56, s90, v56
  v_exp_f32 v44, v44
  v_exp_f32 v45, v45
  v_exp_f32 v46, v46
  v_exp_f32 v47, v47
  v_exp_f32_dpp v57, v56 quad_perm:[2,3,2,3] row_mask:0xf bank_mask:0xf
  v_exp_f32_dpp v58, v56 quad_perm:[0,1,0,1] row_mask:0xf bank_mask:0xf
  v_cvt_pk_bf16_f32 v44, v44, v45
  v_cvt_pk_bf16_f32 v45, v46, v47
  s_waitcnt lgkmcnt(1)
  v_cvt_pk_bf16_f32 v20, v57, v58
  v_cvt_pk_bf16_f32 v23, v57, v58
  v_mov_b32_dpp v16, v44 quad_perm:[2,3,2,3] row_mask:0xf bank_mask:0xf
  v_mov_b32_dpp v17, v44 quad_perm:[0,1,0,1] row_mask:0xf bank_mask:0xf
  v_mov_b32_dpp v18, v45 quad_perm:[2,3,2,3] row_mask:0xf bank_mask:0xf
  v_mov_b32_dpp v19, v45 quad_perm:[0,1,0,1] row_mask:0xf bank_mask:0xf
  s_waitcnt lgkmcnt(0)
  s_nop 0
  v_mfma_f32_16x16x32_bf16 v[48:51], v[24:27], v[16:19], 0
  v_mfma_f32_16x16x32_bf16 v[52:55], v[8:11], v[16:19], 0
  v_mfma_f32_16x16x32_bf16 v[60:63], v[12:15], v[16:19], 0
  v_mfma_f32_16x16x16_bf16 v[48:51], v[24:25], v[20:21], v[48:51]
  s_waitcnt vmcnt(0)
  v_mfma_f32_16x16x16_bf16 v[52:55], v[70:71], v[20:21], v[52:55]
  v_mfma_f32_16x16x16_bf16 v[60:63], v[70:71], v[22:23], v[60:63]
  v_rcp_f32 v3, v48
  s_add_u32 s94, s41, s47
  s_nop 1
  v_pk_mul_f32 v[52:53], v[52:53], v[2:3] op_sel:[0,1] op_sel_hi:[1,1]
  v_pk_mul_f32 v[54:55], v[54:55], v[2:3] op_sel:[0,1] op_sel_hi:[1,1]
  v_cvt_pk_bf16_f32 v52, v52, v53
  v_cvt_pk_bf16_f32 v53, v54, v55
  v_pk_mul_f32 v[60:61], v[60:61], v[2:3] op_sel:[0,1] op_sel_hi:[1,1]
  v_pk_mul_f32 v[62:63], v[62:63], v[2:3] op_sel:[0,1] op_sel_hi:[1,1]
  v_cvt_pk_bf16_f32 v54, v60, v61
  v_cvt_pk_bf16_f32 v55, v62, v63
  ds_write_b128 v0, v[52:55] offset:3072
  ds_read_b128 v[44:47], v0 offset:14336
  ds_read_b128 v[56:59], v0 offset:14336
  ds_read_b128 v[68:71], v0 offset:14336
  ds_read_b128 v[72:75], v0 offset:14336
  ds_read_b128 v[20:23], v2 offset:18432
  ds_read_b128 v[24:27], v2 offset:19456
  ds_read_b128 v[28:31], v2 offset:22528
  ds_read_b128 v[32:35], v2 offset:23552
  ds_read_b128 v[36:39], v2 offset:26624
  ds_read_b128 v[40:43], v2 offset:27648
  ds_read_b128 v[60:63], v2 offset:30720
  ds_read_b128 v[64:67], v2 offset:31744
  s_waitcnt lgkmcnt(4)
  v_smfmac_f32_16x16x64_bf16 v[56:59], v[52:55], v[28:35], v1
  s_waitcnt lgkmcnt(2)
  v_smfmac_f32_16x16x64_bf16 v[68:71], v[52:55], v[36:43], v1
  v_smfmac_f32_16x16x64_bf16 v[44:47], v[52:55], v[20:27], v1
  ds_read_b128 v[28:31], v2 offset:16384
  ds_read_b128 v[32:35], v2 offset:17408
  s_waitcnt vmcnt(0) lgkmcnt(0)
  s_branch L_safe3f
L_r3f:
  buffer_load_dwordx4 v[44:47], v6, s[4:7], s48 offen sc1
  buffer_load_dwordx4 v[48:51], v6, s[4:7], s49 offen sc1
  buffer_load_dwordx4 v[52:55], v6, s[4:7], s50 offen sc1
  buffer_load_dwordx4 v[56:59], v6, s[4:7], s51 offen sc1
  s_add_u32 s56, s56, 1
  s_cmp_lt_u32 s56, 1048576
  s_cbranch_scc1 L_rchk3f
  s_branch L_fail
L_last3f:
  s_waitcnt vmcnt(0)
  s_barrier
  s_branch L_exit
L_slowmode3:
  s_mov_b32 m0, 0
  ds_read_b128 v[60:63], v2 offset:0
  ds_read_b128 v[64:67], v2 offset:1024
  ds_read_b128 v[20:23], v2 offset:2048
  ds_read_b128 v[24:27], v2 offset:3072
  ds_read_b128 v[28:31], v2 offset:12288
  ds_read_b128 v[32:35], v2 offset:13312
  ds_read_b128 v[36:39], v2 offset:14336
  ds_read_b128 v[40:43], v2 offset:15360
  v_mov_b64 v[44:45], 0
  v_mov_b64 v[46:47], 0
  v_mov_b64 v[48:49], 0
  v_mov_b64 v[50:51], 0
  v_mov_b64 v[52:53], 0
  v_mov_b64 v[54:55], 0
  v_mov_b64 v[56:57], 0
  v_mov_b64 v[58:59], 0
  v_mov_b64 v[68:69], 0
  v_mov_b64 v[70:71], 0
  v_mov_b64 v[72:73], 0
  v_mov_b64 v[74:75], 0
  v_mov_b32 v16, -1
  s_branch L_chk3s
L_top3s:
  s_waitcnt vmcnt(0)
  s_barrier
  buffer_load_dwordx4 v[8:11], v0, s[4:7], s58 offen offset:0 sc1
  s_mov_b32 s56, 0
  buffer_load_dwordx4 v[12:15], v0, s[4:7], s58 offen offset:1024 sc1
  s_bfe_u32 s46, s37, 0x10001
L_chk3s:
  s_waitcnt vmcnt(1) lgkmcnt(0)
  v_smfmac_f32_16x16x64_bf16 v[48:51], v[8:11], v[60:67], v1
  ds_write_b128 v0, v[8:11] offset:6144
  s_waitcnt lgkmcnt(5)
  v_smfmac_f32_16x16x64_bf16 v[56:59], v[8:11], v[20:27], v1
  v_smfmac_f32_16x16x64_bf16 v[44:47], v[8:11], v[80:87], v1
  v_smfmac_f32_16x16x64_bf16 v[52:55], v[8:11], v[88:95], v1
  s_waitcnt vmcnt(0)
  ds_write_b128 v0, v[12:15] offset:7168
  s_waitcnt lgkmcnt(4)
  v_smfmac_f32_16x16x64_bf16 v[48:51], v[12:15], v[28:35], v1
  v_max3_u32 v3, v8, v9, v10
  v_max3_u32 v3, v3, v11, v12
  v_max3_u32 v3, v3, v13, v14
  v_max_u32 v3, v3, v15
  s_waitcnt lgkmcnt(2)
  v_smfmac_f32_16x16x64_bf16 v[56:59], v[12:15], v[36:43], v1
  ds_read_b128 v[60:63], v2 offset:4096
  v_cmp_eq_u32 vcc, -1, v3
  v_smfmac_f32_16x16x64_bf16 v[44:47], v[12:15], v[96:103], v1
  ds_read_b128 v[64:67], v2 offset:5120
  s_cbranch_vccnz L_retry3s
  v_smfmac_f32_16x16x64_bf16 v[52:55], v[12:15], v[104:111], v1
  s_waitcnt lgkmcnt(2)
  s_barrier
  ds_read_b128 v[20:23], v0 offset:0
  v_smfmac_f32_16x16x64_bf16 v[68:71], v[8:11], a[48:55], v1
  ds_read_b128 v[24:27], v0 offset:1024
  s_mov_b64 vcc, s[62:63]
  v_smfmac_f32_16x16x64_bf16 v[72:75], v[8:11], a[56:63], v1
  ds_read_b128 v[28:31], v0 offset:2048
  v_smfmac_f32_16x16x64_bf16 v[68:71], v[12:15], a[64:71], v1
  buffer_store_dword v16, v7, s[4:7], s61 offen sc1
  ds_read_b128 v[16:19], v0 offset:8192
  v_smfmac_f32_16x16x64_bf16 v[72:75], v[12:15], a[72:79], v1
  ds_read_b128 v[8:11], v2 offset:6144
  s_waitcnt lgkmcnt(4)
  v_smfmac_f32_16x16x64_bf16 v[44:47], v[20:23], v[112:119], v1
  ds_read_b128 v[12:15], v2 offset:7168
  v_smfmac_f32_16x16x64_bf16 v[48:51], v[20:23], v[208:215], v1
  ds_read_b128 v[32:35], v0 offset:3072
  v_smfmac_f32_16x16x64_bf16 v[52:55], v[20:23], v[120:127], v1
  ds_read_b128 v[36:39], v0 offset:4096
  v_smfmac_f32_16x16x64_bf16 v[56:59], v[20:23], v[216:223], v1
  ds_read_b128 v[40:43], v0 offset:5120
  s_waitcnt lgkmcnt(5)
  v_smfmac_f32_16x16x64_bf16 v[48:51], v[16:19], v[60:67], v1
  ds_read_b128 v[60:63], v2 offset:8192
  ds_read_b128 v[64:67], v2 offset:9216
  v_smfmac_f32_16x16x64_bf16 v[44:47], v[24:27], v[128:135], v1
  s_waitcnt lgkmcnt(5)
  v_smfmac_f32_16x16x64_bf16 v[56:59], v[16:19], v[8:15], v1
  ds_read_b128 v[8:11], v2 offset:10240
  ds_read_b128 v[12:15], v2 offset:11264
  v_smfmac_f32_16x16x64_bf16 v[52:55], v[24:27], v[136:143], v1
  v_smfmac_f32_16x16x64_bf16 v[48:51], v[24:27], v[224:231], v1
  s_waitcnt lgkmcnt(2)
  v_smfmac_f32_16x16x64_bf16 v[44:47], v[16:19], v[60:67], v1
  buffer_load_dwordx4 v[60:63], v0, s[4:7], s42 offen sc1
  s_add_u32 s26, s42, 4096
  v_smfmac_f32_16x16x64_bf16 v[56:59], v[24:27], v[232:239], v1
  s_waitcnt lgkmcnt(0)
  v_smfmac_f32_16x16x64_bf16 v[52:55], v[16:19], v[8:15], v1
  buffer_load_dwordx4 v[64:67], v0, s[4:7], s26 offen sc1
  v_smfmac_f32_16x16x64_bf16 v[48:51], v[28:31], v[240:247], v1
  v_smfmac_f32_16x16x64_bf16 v[44:47], v[28:31], v[144:151], v1
  buffer_load_dwordx4 v[8:11], v0, s[4:7], s43 offen sc1
  v_smfmac_f32_16x16x64_bf16 v[48:51], v[32:35], a[0:7], v1
  v_smfmac_f32_16x16x64_bf16 v[44:47], v[32:35], v[160:167], v1
  buffer_load_dwordx4 v[12:15], v0, s[4:7], s43 offen offset:1024 sc1
  v_smfmac_f32_16x16x64_bf16 v[48:51], v[36:39], a[16:23], v1
  s_add_u32 s42, s42, 0x40000
  s_add_u32 s43, s43, 0x40000
  v_smfmac_f32_16x16x64_bf16 v[44:47], v[36:39], v[176:183], v1
  s_add_u32 s27, s44, 0x800000
  v_smfmac_f32_16x16x64_bf16 v[48:51], v[40:43], a[32:39], v1
  v_smfmac_f32_16x16x64_bf16 v[44:47], v[40:43], v[192:199], v1
  v_smfmac_f32_16x16x64_bf16 v[56:59], v[28:31], v[248:255], v1
  v_smfmac_f32_16x16x64_bf16 v[52:55], v[28:31], v[152:159], v1
  v_add_f32 v48, v48, v50
  v_smfmac_f32_16x16x64_bf16 v[56:59], v[32:35], a[8:15], v1
  v_add_f32 v49, v49, v51
  v_smfmac_f32_16x16x64_bf16 v[52:55], v[32:35], v[168:175], v1
  v_cvt_pk_bf16_f32 v50, v48, v49
  v_smfmac_f32_16x16x64_bf16 v[56:59], v[36:39], a[24:31], v1
  v_add_f32 v44, v44, v46
  v_smfmac_f32_16x16x64_bf16 v[52:55], v[36:39], v[184:191], v1
  v_add_f32 v45, v45, v47
  v_smfmac_f32_16x16x64_bf16 v[56:59], v[40:43], a[40:47], v1
  v_cvt_pk_bf16_f32 v51, v44, v45
  v_smfmac_f32_16x16x64_bf16 v[52:55], v[40:43], v[200:207], v1
  v_mfma_f32_16x16x16_bf16 v[44:47], v[50:51], v[4:5], 0
  v_add_f32 v56, v56, v58
  v_add_f32 v57, v57, v59
  v_cvt_pk_bf16_f32 v58, v56, v57
  s_nop 0
  v_add_f32 v52, v52, v54
  v_add_f32 v53, v53, v55
  v_cvt_pk_bf16_f32 v59, v52, v53
  s_nop 0
  v_cvt_pk_bf16_f32 v48, v44, v45
  v_cvt_pk_bf16_f32 v49, v46, v47
  v_mfma_f32_16x16x16_bf16 v[52:55], v[58:59], v[4:5], 0
  v_min_u32 v48, -2, v48
  v_smfmac_f32_16x16x64_bf16 v[68:71], v[16:19], a[80:87], v1
  v_smfmac_f32_16x16x64_bf16 v[72:75], v[16:19], a[88:95], v1
  v_cvt_pk_bf16_f32 v50, v52, v53
  v_cvt_pk_bf16_f32 v51, v54, v55
  s_waitcnt vmcnt(2)
  s_nop 0
  v_mfma_f32_16x16x32_bf16 v[52:55], v[64:67], v[48:51], 0
  v_lshrrev_b32 v3, 1, v0
  v_mfma_f32_16x16x32_bf16 v[44:47], v[60:63], v[48:51], 0
  v_bfi_b32 v17, 31, v0, v3
  v_mfma_f32_16x16x32_bf16 v[56:59], v[48:51], v[48:51], 0
  v_smfmac_f32_16x16x64_bf16 v[68:71], v[20:23], a[96:103], v1
  v_cndmask_b32_dpp v44, v52, v44, vcc quad_perm:[2,3,2,3] row_mask:0xf bank_mask:0xf
  v_cndmask_b32_dpp v45, v53, v45, vcc quad_perm:[2,3,2,3] row_mask:0xf bank_mask:0xf
  v_cndmask_b32_dpp v46, v54, v46, vcc quad_perm:[2,3,2,3] row_mask:0xf bank_mask:0xf
  v_cndmask_b32_dpp v47, v55, v47, vcc quad_perm:[2,3,2,3] row_mask:0xf bank_mask:0xf
  ds_write_b128 v0, v[44:47] offset:13056
  v_cndmask_b32_dpp v56, v57, v56, vcc quad_perm:[2,3,2,3] row_mask:0xf bank_mask:0xf
  ds_write_addtid_b32 v56 offset:14080
  v_smfmac_f32_16x16x64_bf16 v[72:75], v[20:23], a[104:111], v1
  v_smfmac_f32_16x16x64_bf16 v[68:71], v[24:27], a[112:119], v1
  v_smfmac_f32_16x16x64_bf16 v[72:75], v[24:27], a[120:127], v1
  s_waitcnt lgkmcnt(0)
  s_barrier
  v_smfmac_f32_16x16x64_bf16 v[68:71], v[28:31], a[128:135], v1
  ds_read_b128 v[60:63], v0 offset:9216
  ds_read_b128 v[64:67], v0 offset:10496
  ds_read_b128 v[52:55], v0 offset:11776
  v_smfmac_f32_16x16x64_bf16 v[72:75], v[28:31], a[136:143], v1
  ds_read_addtid_b32 v57 offset:10240
  ds_read_addtid_b32 v58 offset:11520
  ds_read_addtid_b32 v59 offset:12800
  v_smfmac_f32_16x16x64_bf16 v[68:71], v[32:35], a[144:151], v1
  ds_read_b128 v[20:23], v0 offset:14336
  v_mul_f32 v56, s90, v56
  v_smfmac_f32_16x16x64_bf16 v[72:75], v[32:35], a[152:159], v1
  ds_read_b128 v[24:27], v0 offset:15360
  v_mul_f32 v44, s90, v44
  v_smfmac_f32_16x16x64_bf16 v[68:71], v[36:39], a[160:167], v1
  s_not_b64 exec, s[62:63]
  buffer_store_dwordx4 v[48:51], v17, s[4:7], s44 offen sc1
  s_mov_b64 exec, -1
  ds_read_b128 v[28:31], v2 offset:22528
  v_mul_f32 v45, s90, v45
  v_smfmac_f32_16x16x64_bf16 v[72:75], v[36:39], a[168:175], v1
  ds_read_b128 v[32:35], v2 offset:23552
  v_mul_f32 v46, s90, v46
  v_smfmac_f32_16x16x64_bf16 v[68:71], v[40:43], a[176:183], v1
  ds_read_b128 v[36:39], v2 offset:26624
  v_mul_f32 v47, s90, v47
  v_smfmac_f32_16x16x64_bf16 v[72:75], v[40:43], a[184:191], v1
  ds_read_b128 v[40:43], v2 offset:27648
  s_waitcnt lgkmcnt(6)
  v_fmac_f32 v56, s90, v57
  v_fmac_f32 v56, s90, v58
  v_fmac_f32 v56, s90, v59
  v_pk_fma_f32 v[44:45], v[60:61], s[90:91], v[44:45]
  v_pk_fma_f32 v[46:47], v[62:63], s[90:91], v[46:47]
  v_pk_fma_f32 v[44:45], v[64:65], s[90:91], v[44:45]
  v_pk_fma_f32 v[46:47], v[66:67], s[90:91], v[46:47]
  v_pk_fma_f32 v[44:45], v[52:53], s[90:91], v[44:45]
  v_pk_fma_f32 v[46:47], v[54:55], s[90:91], v[46:47]
  v_pk_add_f32 v[68:69], v[68:69], v[70:71]
  v_pk_add_f32 v[72:73], v[72:73], v[74:75]
  v_exp_f32 v44, v44
  v_exp_f32 v45, v45
  v_exp_f32 v46, v46
  v_cvt_pk_bf16_f32 v44, v44, v45
  v_exp_f32 v47, v47
  v_cvt_pk_bf16_f32 v70, v68, v69
  v_mov_b32_dpp v16, v44 quad_perm:[2,3,2,3] row_mask:0xf bank_mask:0xf
  v_cvt_pk_bf16_f32 v45, v46, v47
  v_mov_b32_dpp v17, v44 quad_perm:[0,1,0,1] row_mask:0xf bank_mask:0xf
  v_cvt_pk_bf16_f32 v71, v72, v73
  v_mov_b32_dpp v18, v45 quad_perm:[2,3,2,3] row_mask:0xf bank_mask:0xf
  v_mov_b32_dpp v19, v45 quad_perm:[0,1,0,1] row_mask:0xf bank_mask:0xf
  v_exp_f32_dpp v57, v56 quad_perm:[2,3,2,3] row_mask:0xf bank_mask:0xf
  v_min_u32 v70, -2, v70
  s_waitcnt lgkmcnt(4)
  v_mfma_f32_16x16x32_bf16 v[48:51], v[24:27], v[16:19], 0
  ds_read_b128 v[44:47], v0 offset:14336
  v_exp_f32_dpp v58, v56 quad_perm:[0,1,0,1] row_mask:0xf bank_mask:0xf
  s_waitcnt vmcnt(2)
  v_mfma_f32_16x16x32_bf16 v[52:55], v[8:11], v[16:19], 0
  ds_read_b128 v[72:75], v0 offset:14336
  v_cvt_pk_bf16_f32 v20, v57, v58
  s_waitcnt vmcnt(1)
  v_mfma_f32_16x16x32_bf16 v[60:63], v[12:15], v[16:19], 0
  ds_read_b128 v[64:67], v2 offset:31744
  v_cvt_pk_bf16_f32 v23, v57, v58
  v_mfma_f32_16x16x16_bf16 v[48:51], v[24:25], v[20:21], v[48:51]
  ds_read_b128 v[24:27], v2 offset:19456
  v_mov_b64 v[56:57], 0
  v_mov_b64 v[58:59], 0
  v_mfma_f32_16x16x16_bf16 v[52:55], v[70:71], v[20:21], v[52:55]
  buffer_store_dwordx2 v[70:71], v3, s[4:7], s27 offen sc1
  s_cmp_eq_u32 s37, 63
  s_cbranch_scc1 L_last3s
  v_mfma_f32_16x16x16_bf16 v[60:63], v[70:71], v[22:23], v[60:63]
  ds_read_b128 v[20:23], v2 offset:18432
  ds_read_b128 v[68:71], v0 offset:14336
  v_rcp_f32 v3, v48
  s_add_u32 s94, s41, s47
  v_pk_mul_f32 v[52:53], v[52:53], v[2:3] op_sel:[0,1] op_sel_hi:[1,1]
  v_pk_mul_f32 v[54:55], v[54:55], v[2:3] op_sel:[0,1] op_sel_hi:[1,1]
  v_cvt_pk_bf16_f32 v52, v52, v53
  v_cvt_pk_bf16_f32 v53, v54, v55
  v_pk_mul_f32 v[60:61], v[60:61], v[2:3] op_sel:[0,1] op_sel_hi:[1,1]
  v_pk_mul_f32 v[62:63], v[62:63], v[2:3] op_sel:[0,1] op_sel_hi:[1,1]
  v_cvt_pk_bf16_f32 v54, v60, v61
  v_cvt_pk_bf16_f32 v55, v62, v63
  ds_write_b128 v0, v[52:55] offset:3072
  s_waitcnt lgkmcnt(9)
  v_smfmac_f32_16x16x64_bf16 v[56:59], v[52:55], v[28:35], v1
  ds_read_b128 v[60:63], v2 offset:30720
  v_subrev_u32 v16, 0x2b800000, v3
  v_cmp_lt_u32 vcc, 0x23000000, v16
  s_waitcnt lgkmcnt(2)
  v_smfmac_f32_16x16x64_bf16 v[68:71], v[52:55], v[36:43], v1
  ds_read_b128 v[28:31], v2 offset:16384
  v_smfmac_f32_16x16x64_bf16 v[44:47], v[52:55], v[20:27], v1
  ds_read_b128 v[32:35], v2 offset:17408
  s_cbranch_vccnz L_guard3s
L_safe3s:
  s_waitcnt lgkmcnt(3)
  s_barrier
  ds_read_b128 v[8:11], v0 offset:0
  ds_read_b128 v[12:15], v0 offset:1024
  ds_read_b128 v[16:19], v0 offset:2048
  s_waitcnt lgkmcnt(5)
  v_smfmac_f32_16x16x64_bf16 v[72:75], v[52:55], v[60:67], v1
  ds_read_b128 v[36:39], v2 offset:20480
  s_waitcnt lgkmcnt(3)
  v_smfmac_f32_16x16x64_bf16 v[44:47], v[8:11], a[192:199], v1
  ds_read_b128 v[40:43], v2 offset:21504
  s_waitcnt lgkmcnt(3)
  v_smfmac_f32_16x16x64_bf16 v[44:47], v[12:15], a[200:207], v1
  ds_read_b128 v[20:23], v2 offset:24576
  s_waitcnt lgkmcnt(3)
  v_smfmac_f32_16x16x64_bf16 v[44:47], v[16:19], v[28:35], v1
  ds_read_b128 v[24:27], v2 offset:25600
  v_smfmac_f32_16x16x64_bf16 v[56:59], v[8:11], a[208:215], v1
  ds_read_b128 v[60:63], v2 offset:28672
  v_smfmac_f32_16x16x64_bf16 v[56:59], v[12:15], a[216:223], v1
  ds_read_b128 v[64:67], v2 offset:29696
  v_cvt_pk_bf16_f32 v44, v44, v45
  s_waitcnt lgkmcnt(4)
  v_smfmac_f32_16x16x64_bf16 v[56:59], v[16:19], v[36:43], v1
  v_cvt_pk_bf16_f32 v45, v46, v47
  v_smfmac_f32_16x16x64_bf16 v[68:71], v[8:11], a[224:231], v1
  v_bfi_b32 v44, 1, s46, v44
  v_smfmac_f32_16x16x64_bf16 v[68:71], v[12:15], a[232:239], v1
  v_cvt_pk_bf16_f32 v46, v56, v57
  s_waitcnt lgkmcnt(2)
  v_smfmac_f32_16x16x64_bf16 v[68:71], v[16:19], v[20:27], v1
  v_cvt_pk_bf16_f32 v47, v58, v59
  v_smfmac_f32_16x16x64_bf16 v[72:75], v[8:11], a[240:247], v1
  v_bfi_b32 v46, 1, s46, v46
  v_smfmac_f32_16x16x64_bf16 v[72:75], v[12:15], a[248:255], v1
  v_cvt_pk_bf16_f32 v68, v68, v69
  s_waitcnt lgkmcnt(0)
  v_smfmac_f32_16x16x64_bf16 v[72:75], v[16:19], v[60:67], v1
  v_cvt_pk_bf16_f32 v69, v70, v71
  s_add_u32 s26, s94, 0x38000
  buffer_store_dwordx4 v[44:47], v0, s[4:7], s26 offen sc1
  v_bfi_b32 v68, 1, s46, v68
  s_nop 3
  v_cvt_pk_bf16_f32 v70, v72, v73
  v_cvt_pk_bf16_f32 v71, v74, v75
  v_bfi_b32 v70, 1, s46, v70
  s_add_u32 s26, s94, 0x40000
  buffer_store_dwordx4 v[68:71], v0, s[4:7], s26 offen sc1
  s_add_u32 s28, s41, s66
  s_add_u32 s48, s28, 0
  s_add_u32 s49, s28, 8192
  s_add_u32 s50, s28, 16384
  s_add_u32 s51, s28, 24576
  s_waitcnt vmcnt(0)
  s_barrier
  buffer_load_dwordx4 v[44:47], v6, s[4:7], s48 offen sc1
  buffer_load_dwordx4 v[48:51], v6, s[4:7], s49 offen sc1
  buffer_load_dwordx4 v[52:55], v6, s[4:7], s50 offen sc1
  buffer_load_dwordx4 v[56:59], v6, s[4:7], s51 offen sc1
  s_add_u32 s37, s37, 1
  s_xor_b32 s41, s41, 0x48000
  s_add_u32 s61, s40, s60
  s_mov_b32 s26, s38
  s_mov_b32 s38, s40
  s_mov_b32 s40, s39
  s_mov_b32 s39, s26
  s_add_u32 s58, s40, 6144
  s_add_u32 s44, s44, 0x20000
  s_add_u32 s26, s40, s60
  s_mov_b32 s56, 0
  ds_read_b128 v[60:63], v2 offset:0
  ds_read_b128 v[64:67], v2 offset:1024
  ds_read_b128 v[20:23], v2 offset:2048
  ds_read_b128 v[24:27], v2 offset:3072
  ds_read_b128 v[28:31], v2 offset:12288
  ds_read_b128 v[32:35], v2 offset:13312
  ds_read_b128 v[36:39], v2 offset:14336
  ds_read_b128 v[40:43], v2 offset:15360
  v_mov_b32 v68, 0
  v_mov_b32 v69, 0
  v_mov_b32 v70, 0
  v_mov_b32 v71, 0
  v_mov_b32 v72, 0
  v_mov_b32 v73, 0
  v_mov_b32 v74, 0
  v_mov_b32 v75, 0
  v_mov_b32 v16, -1
L_rchk3s:
  s_waitcnt vmcnt(3)
  v_mfma_f32_16x16x32_bf16 v[8:11], v[44:47], v[76:79], 0
  v_bitop3_b32 v12, v44, v46, s46 bitop3:0x7e
  s_waitcnt vmcnt(2)
  v_mfma_f32_16x16x32_bf16 v[8:11], v[48:51], v[76:79], v[8:11]
  v_bitop3_b32 v13, v48, v50, s46 bitop3:0x7e
  s_waitcnt vmcnt(1)
  v_mfma_f32_16x16x32_bf16 v[8:11], v[52:55], v[76:79], v[8:11]
  v_bitop3_b32 v14, v52, v54, s46 bitop3:0x7e
  v_or3_b32 v12, v12, v13, v14
  s_waitcnt vmcnt(0)
  v_mfma_f32_16x16x32_bf16 v[8:11], v[56:59], v[76:79], v[8:11]
  v_bitop3_b32 v3, v56, v58, s46 bitop3:0x7e
  v_bitop3_b32 v3, v3, v12, 1 bitop3:0xa8
  v_cmp_ne_u32 vcc, 0, v3
  v_mov_b64 v[44:45], 0
  v_mov_b64 v[46:47], 0
  v_mov_b64 v[48:49], 0
  s_nop 1
  v_permlane32_swap_b32 v8, v10
  v_permlane32_swap_b32 v9, v11
  v_pk_add_f32 v[8:9], v[8:9], v[10:11]
  v_cvt_pk_bf16_f32 v8, v8, v9
  v_min_u32 v8, -2, v8
  s_cbranch_vccnz L_r3s
  buffer_store_dword v8, v7, s[4:7], s26 offen sc1
  v_mov_b64 v[50:51], 0
  v_mov_b64 v[52:53], 0
  v_mov_b64 v[54:55], 0
  v_mov_b64 v[56:57], 0
  v_mov_b64 v[58:59], 0
L_end3s:
  s_branch L_top3s
L_retry3s:
  buffer_load_dwordx4 v[8:11], v0, s[4:7], s58 offen offset:0 sc1
  buffer_load_dwordx4 v[12:15], v0, s[4:7], s58 offen offset:1024 sc1
  ds_read_b128 v[60:63], v2 offset:0
  ds_read_b128 v[64:67], v2 offset:1024
  s_nop 1
  v_mov_b64 v[44:45], 0
  v_mov_b64 v[46:47], 0
  v_mov_b64 v[48:49], 0
  v_mov_b64 v[50:51], 0
  v_mov_b64 v[52:53], 0
  v_mov_b64 v[54:55], 0
  v_mov_b64 v[56:57], 0
  v_mov_b64 v[58:59], 0
  v_mov_b64 v[68:69], 0
  v_mov_b64 v[70:71], 0
  v_mov_b64 v[72:73], 0
  v_mov_b64 v[74:75], 0
  s_add_u32 s56, s56, 1
  s_cmp_lt_u32 s56, 1048576
  s_cbranch_scc1 L_chk3s
  s_branch L_fail
L_guard3s:
  s_waitcnt vmcnt(0) lgkmcnt(0)
  v_lshrrev_b32 v3, 1, v0
  buffer_load_dwordx2 v[70:71], v3, s[4:7], s27 offen sc1
  s_nop 2
  ds_read_b128 v[44:47], v0 offset:13056
  ds_read_addtid_b32 v56 offset:14080
  ds_read_b128 v[60:63], v0 offset:9216
  ds_read_b128 v[64:67], v0 offset:10496
  ds_read_b128 v[52:55], v0 offset:11776
  ds_read_addtid_b32 v57 offset:10240
  ds_read_addtid_b32 v58 offset:11520
  ds_read_addtid_b32 v59 offset:12800
  ds_read_b128 v[20:23], v0 offset:14336
  ds_read_b128 v[24:27], v0 offset:15360
  s_waitcnt lgkmcnt(7)
  v_pk_add_f32 v[44:45], v[44:45], v[60:61]
  v_pk_add_f32 v[46:47], v[46:47], v[62:63]
  s_waitcnt lgkmcnt(4)
  v_add_f32 v56, v56, v57
  v_pk_add_f32 v[44:45], v[44:45], v[64:65]
  v_pk_add_f32 v[46:47], v[46:47], v[66:67]
  s_waitcnt lgkmcnt(3)
  v_add_f32 v56, v56, v58
  v_pk_add_f32 v[44:45], v[44:45], v[52:53]
  v_pk_add_f32 v[46:47], v[46:47], v[54:55]
  s_waitcnt lgkmcnt(2)
  v_add_f32 v56, v56, v59
  v_max3_f32 v50, v44, v45, v46
  v_max3_f32 v50, v50, v47, v56
  s_nop 1
  v_max_f32_dpp v48, v50, v50 quad_perm:[2,3,0,1] row_mask:0xf bank_mask:0xf
  v_max_f32_dpp v49, v50, v50 quad_perm:[2,3,0,1] row_mask:0xf bank_mask:0xf
  s_nop 1
  v_permlane32_swap_b32 v48, v49
  v_max_f32 v50, v48, v49
  v_max_f32 v51, v48, v49
  s_nop 1
  v_permlane16_swap_b32 v50, v51
  v_max_f32 v50, v50, v51
  v_sub_f32 v44, v44, v50
  v_mul_f32 v44, s90, v44
  v_sub_f32 v45, v45, v50
  v_mul_f32 v45, s90, v45
  v_sub_f32 v46, v46, v50
  v_mul_f32 v46, s90, v46
  v_sub_f32 v47, v47, v50
  v_mul_f32 v47, s90, v47
  v_sub_f32 v56, v56, v50
  v_mul_f32 v56, s90, v56
  v_exp_f32 v44, v44
  v_exp_f32 v45, v45
  v_exp_f32 v46, v46
  v_exp_f32 v47, v47
  v_exp_f32_dpp v57, v56 quad_perm:[2,3,2,3] row_mask:0xf bank_mask:0xf
  v_exp_f32_dpp v58, v56 quad_perm:[0,1,0,1] row_mask:0xf bank_mask:0xf
  v_cvt_pk_bf16_f32 v44, v44, v45
  v_cvt_pk_bf16_f32 v45, v46, v47
  s_waitcnt lgkmcnt(1)
  v_cvt_pk_bf16_f32 v20, v57, v58
  v_cvt_pk_bf16_f32 v23, v57, v58
  v_mov_b32_dpp v16, v44 quad_perm:[2,3,2,3] row_mask:0xf bank_mask:0xf
  v_mov_b32_dpp v17, v44 quad_perm:[0,1,0,1] row_mask:0xf bank_mask:0xf
  v_mov_b32_dpp v18, v45 quad_perm:[2,3,2,3] row_mask:0xf bank_mask:0xf
  v_mov_b32_dpp v19, v45 quad_perm:[0,1,0,1] row_mask:0xf bank_mask:0xf
  s_waitcnt lgkmcnt(0)
  s_nop 0
  v_mfma_f32_16x16x32_bf16 v[48:51], v[24:27], v[16:19], 0
  v_mfma_f32_16x16x32_bf16 v[52:55], v[8:11], v[16:19], 0
  v_mfma_f32_16x16x32_bf16 v[60:63], v[12:15], v[16:19], 0
  v_mfma_f32_16x16x16_bf16 v[48:51], v[24:25], v[20:21], v[48:51]
  s_waitcnt vmcnt(0)
  v_mfma_f32_16x16x16_bf16 v[52:55], v[70:71], v[20:21], v[52:55]
  v_mfma_f32_16x16x16_bf16 v[60:63], v[70:71], v[22:23], v[60:63]
  v_rcp_f32 v3, v48
  s_add_u32 s94, s41, s47
  s_nop 1
  v_pk_mul_f32 v[52:53], v[52:53], v[2:3] op_sel:[0,1] op_sel_hi:[1,1]
  v_pk_mul_f32 v[54:55], v[54:55], v[2:3] op_sel:[0,1] op_sel_hi:[1,1]
  v_cvt_pk_bf16_f32 v52, v52, v53
  v_cvt_pk_bf16_f32 v53, v54, v55
  v_pk_mul_f32 v[60:61], v[60:61], v[2:3] op_sel:[0,1] op_sel_hi:[1,1]
  v_pk_mul_f32 v[62:63], v[62:63], v[2:3] op_sel:[0,1] op_sel_hi:[1,1]
  v_cvt_pk_bf16_f32 v54, v60, v61
  v_cvt_pk_bf16_f32 v55, v62, v63
  ds_write_b128 v0, v[52:55] offset:3072
  ds_read_b128 v[44:47], v0 offset:14336
  ds_read_b128 v[56:59], v0 offset:14336
  ds_read_b128 v[68:71], v0 offset:14336
  ds_read_b128 v[72:75], v0 offset:14336
  ds_read_b128 v[20:23], v2 offset:18432
  ds_read_b128 v[24:27], v2 offset:19456
  ds_read_b128 v[28:31], v2 offset:22528
  ds_read_b128 v[32:35], v2 offset:23552
  ds_read_b128 v[36:39], v2 offset:26624
  ds_read_b128 v[40:43], v2 offset:27648
  ds_read_b128 v[60:63], v2 offset:30720
  ds_read_b128 v[64:67], v2 offset:31744
  s_waitcnt lgkmcnt(4)
  v_smfmac_f32_16x16x64_bf16 v[56:59], v[52:55], v[28:35], v1
  s_waitcnt lgkmcnt(2)
  v_smfmac_f32_16x16x64_bf16 v[68:71], v[52:55], v[36:43], v1
  v_smfmac_f32_16x16x64_bf16 v[44:47], v[52:55], v[20:27], v1
  ds_read_b128 v[28:31], v2 offset:16384
  ds_read_b128 v[32:35], v2 offset:17408
  s_waitcnt vmcnt(0) lgkmcnt(0)
  s_branch L_safe3s
L_r3s:
  buffer_load_dwordx4 v[44:47], v6, s[4:7], s48 offen sc1
  buffer_load_dwordx4 v[48:51], v6, s[4:7], s49 offen sc1
  buffer_load_dwordx4 v[52:55], v6, s[4:7], s50 offen sc1
  buffer_load_dwordx4 v[56:59], v6, s[4:7], s51 offen sc1
  s_add_u32 s56, s56, 1
  s_cmp_lt_u32 s56, 1048576
  s_cbranch_scc1 L_rchk3s
  s_branch L_fail
L_last3s:
  s_waitcnt vmcnt(0)
  s_barrier
  s_branch L_exit
.section .rodata,"a"
.p2align 6
.amdhsa_kernel sequential_preLN__memory_aug_recurrent_mem_tr__glu_gated_reglu__prompt_kernel
  .amdhsa_next_free_vgpr 512
  .amdhsa_next_free_sgpr 102
  .amdhsa_accum_offset 256
  .amdhsa_group_segment_fixed_size 0
  .amdhsa_kernarg_size 112
  .amdhsa_user_sgpr_count 2
  .amdhsa_user_sgpr_kernarg_segment_ptr 1
  .amdhsa_system_sgpr_workgroup_id_x 1
.end_amdhsa_kernel
```
